```python
import torch

def _softmax(x, axis=-1):
    return torch.softmax(x, dim=axis)
def _gelu(x):
    return torch.nn.functional.gelu(x, approximate="tanh")
def _silu(x):
    return torch.nn.functional.silu(x)
def _sigmoid(x):
    return torch.sigmoid(x)
def _layernorm(x, axis=-1, eps=1e-5):
    m = x.mean(dim=axis, keepdim=True)
    v = x.var(dim=axis, keepdim=True, unbiased=False)
    return (x - m) / torch.sqrt(v + eps)
def _scatter_add(tgt, idx, src, axis=0):
    return tgt.clone().index_add_(axis, idx, src)
def _segment_sum(src, seg, n):
    out = torch.zeros((n,) + src.shape[1:], dtype=src.dtype)
    return out.index_add_(0, seg, src)
def _pad(x, pw):
    flat = tuple(v for pair in reversed(pw) for v in pair)
    return torch.nn.functional.pad(x, flat)

kernel_name = 'recurrent_scan__sliding_block__geglu_ffn__prompt'

def setup_inputs():

    _w = (lambda a: (lambda t: t.to(torch.bfloat16) if t.is_floating_point() else t)(torch.as_tensor(a)))
    def _A_setup():
        B, S, D = 1, 2048, 640
        return {
            "x": _w((lambda *s: torch.randn(*s, dtype=torch.bfloat16) * 0.05)(B, S, D)),
            "wqkv": _w((lambda *s: torch.randn(*s, dtype=torch.bfloat16) * 0.05)(D, 3 * D)),
            "wo": _w((lambda *s: torch.randn(*s, dtype=torch.bfloat16) * 0.05)(D, D)),
        }
    _A_in = _A_setup()

    def _B_setup():
        B, S, D, F = 1, 2048, 640, 1728
        return {
            "x": _w((lambda *s: torch.randn(*s, dtype=torch.bfloat16) * 0.05)(B, S, D)),
            "w_gate": _w((lambda *s: torch.randn(*s, dtype=torch.bfloat16) * 0.05)(D, F)),
            "w_up": _w((lambda *s: torch.randn(*s, dtype=torch.bfloat16) * 0.05)(D, F)),
            "w_down": _w((lambda *s: torch.randn(*s, dtype=torch.bfloat16) * 0.05)(F, D)),
        }
    _B_in = _B_setup()

    return {
        "A_x": _A_in["x"],
        "A_wqkv": _A_in["wqkv"],
        "A_wo": _A_in["wo"],
        "B_x": _B_in["x"],
        "B_w_gate": _B_in["w_gate"],
        "B_w_up": _B_in["w_up"],
        "B_w_down": _B_in["w_down"],
    }

def reference(A_x, A_wqkv, A_wo, B_x, B_w_gate, B_w_up, B_w_down):
    def _A_ref(x, wqkv, wo):
        B, S, D = x.shape
        H = 32; Dh = D // H; W = 256
        qkv = (lambda x, *d: x.permute(*d))((x @ wqkv).reshape(B, S, 3, H, Dh), 2, 0, 3, 1, 4)
        q, k, v = qkv[0], qkv[1], qkv[2]
        scores = torch.einsum("bhqd,bhkd->bhqk", q, k) * (Dh ** -0.5)
        idx = torch.arange(S)
        mask = (idx[:, None] - idx[None, :] >= 0) & (idx[:, None] - idx[None, :] < W)
        scores = torch.where(mask[None, None], scores, -1e9)
        p = _softmax(scores, axis=-1)
        o = torch.einsum("bhqk,bhkd->bhqd", p, v)
        return (lambda x, *d: x.permute(*d))(o, 0, 2, 1, 3).reshape(B, S, D) @ wo

    def _B_ref(x, w_gate, w_up, w_down):
        return (_gelu(x @ w_gate) * (x @ w_up)) @ w_down

    x = A_x
    xn = _layernorm(x, axis=-1)
    s = _A_ref(xn, A_wqkv, A_wo)
    g = _silu(_B_ref(xn, B_w_gate, B_w_up, B_w_down))
    return x + s * g
```

```asm
; @launch grid=(256,1,1) block=(256,1,1) lds=163840
.amdgcn_target "amdgcn-amd-amdhsa--gfx950"
.text
.globl recurrent_scan__sliding_block__geglu_ffn__prompt_kernel
.p2align 8
.type recurrent_scan__sliding_block__geglu_ffn__prompt_kernel,@function
recurrent_scan__sliding_block__geglu_ffn__prompt_kernel:
s_cmp_ge_u32 s2, 256
s_cbranch_scc1 L_end
s_load_dwordx4 s[80:83], s[0:1], 0
s_load_dwordx2 s[84:85], s[0:1], 16
s_load_dwordx4 s[88:91], s[0:1], 32
s_load_dwordx4 s[92:95], s[0:1], 48
s_load_dwordx4 s[4:7], s[0:1], 64
v_and_b32 v1, 63, v0
v_lshrrev_b32 v38, 6, v0
s_and_b32 s45, s2, 7
s_lshr_b32 s46, s2, 3
v_readfirstlane_b32 s42, v38
s_and_b32 s47, s45, 1
s_lshl_b32 s47, s47, 3
s_and_b32 s48, s46, 7
s_add_u32 s40, s47, s48
s_lshr_b32 s47, s45, 1
s_lshl_b32 s47, s47, 2
s_lshr_b32 s48, s46, 3
s_add_u32 s41, s47, s48
v_lshrrev_b32 v38, 4, v1
v_and_b32 v39, 15, v1
v_xor_b32 v40, v39, v38
v_mul_u32_u24 v41, 1280, v38
v_lshl_add_u32 v128, v40, 4, v41
v_xor_b32 v42, 4, v40
v_lshl_add_u32 v42, v42, 4, v41
v_add_u32 v129, 4096, v42
v_xor_b32 v42, 8, v40
v_lshl_add_u32 v42, v42, 4, v41
v_add_u32 v130, 8192, v42
v_xor_b32 v42, 12, v40
v_lshl_add_u32 v42, v42, 4, v41
v_add_u32 v131, 12288, v42
s_lshl_b32 s45, s40, 7
s_lshl_b32 s46, s42, 5
s_add_u32 s45, s45, s46
s_mul_i32 s73, s45, 1280
s_lshl_b32 s74, s42, 13
v_lshrrev_b32 v38, 3, v1
v_and_b32 v39, 7, v1
s_lshr_b32 s43, s42, 1
s_and_b32 s44, s42, 1
s_waitcnt lgkmcnt(0)
s_mov_b32 s8, s80
s_mov_b32 s9, s81
s_mov_b32 s10, 2621440
s_mov_b32 s11, 0x00020000
s_add_u32 m0, s74, 49152
s_add_u32 s75, s73, 0
buffer_load_dwordx4 v128, s[8:11], s75 offen offset:0  lds
buffer_load_dwordx4 v129, s[8:11], s75 offen offset:1024  lds
buffer_load_dwordx4 v130, s[8:11], s75 offen offset:2048  lds
buffer_load_dwordx4 v131, s[8:11], s75 offen offset:3072  lds
s_add_u32 m0, s74, 53248
s_add_u32 s75, s73, 20480
buffer_load_dwordx4 v128, s[8:11], s75 offen offset:0  lds
buffer_load_dwordx4 v129, s[8:11], s75 offen offset:1024  lds
buffer_load_dwordx4 v130, s[8:11], s75 offen offset:2048  lds
buffer_load_dwordx4 v131, s[8:11], s75 offen offset:3072  lds
s_mov_b32 s12, s82
s_mov_b32 s13, s83
s_mov_b32 s14, 2457600
s_mov_b32 s15, 0x00020000
s_lshr_b32 s49, s41, 2
s_mul_i32 s50, s49, 7
s_and_b32 s51, s41, 3
s_cmp_eq_u32 s51, 2
s_cselect_b32 s52, 3, s51
s_cmp_eq_u32 s51, 3
s_cselect_b32 s52, 6, s52
s_add_u32 s64, s50, s52
s_lshl_b32 s59, s42, 12
s_lshl_b32 s52, s42, 5
v_lshrrev_b32 v40, 4, v1
v_and_b32 v40, 1, v40
v_lshlrev_b32 v40, 2, v40
v_xor_b32 v40, v39, v40
v_lshlrev_b32 v40, 4, v40
v_add_u32 v41, s52, v38
v_mul_u32_u24 v42, 3840, v41
v_add_u32 v3, v42, v40
v_add_u32 v4, 29696, v3
v_add_u32 v5, 29696, v4
v_add_u32 v6, 29696, v5
s_cmp_lg_u32 s2, 0
s_cbranch_scc1 L_np_1
s_cmp_lg_u32 s42, 0
s_cbranch_scc1 L_np_1
s_memrealtime s[46:47]
s_waitcnt lgkmcnt(0)
s_or_b32 s46, s46, 1
s_mov_b64 exec, 1
v_mov_b32 v32, 0
v_mov_b32 v33, s46
global_store_dword v32, v33, s[4:5] sc0 sc1
s_mov_b64 exec, -1
L_np_1:
s_mov_b32 s77, s40
s_mov_b32 s96, s41
s_lshl_b32 s60, s64, 7
s_add_u32 s60, s60, 0
s_add_u32 m0, s59, 0
s_nop 0
buffer_load_dwordx4 v3, s[12:15], s60 offen offset:0  lds
buffer_load_dwordx4 v4, s[12:15], s60 offen offset:1024  lds
buffer_load_dwordx4 v5, s[12:15], s60 offen offset:2048  lds
buffer_load_dwordx4 v6, s[12:15], s60 offen offset:3072  lds
v_and_b32 v43, 31, v1
v_lshrrev_b32 v35, 5, v1
v_and_b32 v42, 15, v1
v_xor_b32 v42, v42, v35
s_lshl_b32 s52, s43, 1
s_add_u32 m0, s74, 81920
s_add_u32 s75, s73, 256
buffer_load_dwordx4 v128, s[8:11], s75 offen offset:0  lds
v_xor_b32 v42, s52, v42
v_lshlrev_b32 v42, 4, v42
s_lshl_b32 s52, s42, 5
v_add_u32 v36, s52, v43
v_lshl_add_u32 v42, v36, 8, v42
buffer_load_dwordx4 v129, s[8:11], s75 offen offset:1024  lds
v_add_u32 v14, 49152, v42
v_xor_b32 v15, 8192, v14
v_lshrrev_b32 v42, 4, v1
v_and_b32 v36, 1, v42
v_lshrrev_b32 v42, 1, v42
buffer_load_dwordx4 v130, s[8:11], s75 offen offset:2048  lds
v_bfe_u32 v37, v1, 2, 2
v_lshl_add_u32 v42, v42, 3, v37
v_lshlrev_b32 v42, 7, v42
v_lshrrev_b32 v37, 1, v37
v_lshlrev_b32 v37, 2, v37
buffer_load_dwordx4 v131, s[8:11], s75 offen offset:3072  lds
v_lshlrev_b32 v36, 1, v36
v_and_b32 v39, 1, v1
v_add_u32 v36, v36, v39
s_lshl_b32 s52, s44, 2
v_add_u32 v36, s52, v36
s_add_u32 m0, s74, 86016
s_add_u32 s75, s73, 20736
buffer_load_dwordx4 v128, s[8:11], s75 offen offset:0  lds
v_xor_b32 v36, v36, v37
v_lshl_add_u32 v42, v36, 4, v42
v_bfe_u32 v36, v1, 1, 1
v_lshl_add_u32 v42, v36, 3, v42
s_lshl_b32 s52, s43, 11
buffer_load_dwordx4 v129, s[8:11], s75 offen offset:1024  lds
v_add_u32 v11, s52, v42
s_sub_u32 s52, 2048, s52
v_add_u32 v12, s52, v42
v_and_b32 v42, 31, v1
v_cmp_eq_u32 s[52:53], 0, v42
buffer_load_dwordx4 v130, s[8:11], s75 offen offset:2048  lds
v_cmp_eq_u32 s[54:55], 17, v42
s_nop 0
s_or_b64 s[52:53], s[52:53], s[54:55]
v_mov_b32 v42, 0x3f803f80
v_cndmask_b32_e64 v20, 0, v42, s[52:53]
v_cndmask_b32_e64 v21, 0, v42, s[52:53]
buffer_load_dwordx4 v131, s[8:11], s75 offen offset:3072  lds
v_cndmask_b32_e64 v22, 0, v42, s[52:53]
v_cndmask_b32_e64 v23, 0, v42, s[52:53]
v_xor_b32 v168, 0, v14
v_xor_b32 v176, 0, v15
v_xor_b32 v169, 32, v14
s_lshl_b32 s60, s64, 7
s_add_u32 s60, s60, 491520
s_add_u32 m0, s59, 16384
s_nop 0
buffer_load_dwordx4 v3, s[12:15], s60 offen offset:0  lds
v_xor_b32 v177, 32, v15
v_xor_b32 v170, 64, v14
v_xor_b32 v178, 64, v15
v_xor_b32 v171, 96, v14
v_xor_b32 v179, 96, v15
buffer_load_dwordx4 v4, s[12:15], s60 offen offset:1024  lds
v_xor_b32 v172, 128, v14
v_xor_b32 v180, 128, v15
v_xor_b32 v173, 160, v14
v_xor_b32 v181, 160, v15
v_xor_b32 v174, 192, v14
buffer_load_dwordx4 v5, s[12:15], s60 offen offset:2048  lds
v_xor_b32 v182, 192, v15
v_xor_b32 v175, 224, v14
v_xor_b32 v183, 224, v15
buffer_load_dwordx4 v6, s[12:15], s60 offen offset:3072  lds
s_getpc_b64 s[46:47]
L_pfc:
s_add_u32 s46, s46, L_p1_A-L_pfc
s_addc_u32 s47, s47, 0
s_cmp_lt_u32 s51, 2
s_cselect_b32 s48, 15, 7
s_cbranch_scc1 L_pfc_a
s_mov_b32 s54, L_p1_B-L_p1_A
s_mov_b32 s55, L_common-L_p1_B-4
s_cmp_eq_u32 s51, 2
s_cbranch_scc1 L_pfc_go
s_cmp_ge_u32 s41, 12
s_cbranch_scc1 L_pfc_go
s_mov_b32 s54, L_p1_D-L_p1_A
s_mov_b32 s55, L_p1_B-L_p1_D-4
s_branch L_pfc_go
L_pfc_a:
s_mov_b32 s54, 0
s_mov_b32 s55, L_p1_D-L_p1_A-4
L_pfc_go:
s_lshr_b32 s52, s2, 3
s_and_b32 s53, s52, s48
s_lshl_b32 s53, s53, 2
s_add_u32 s53, s53, s42
s_mul_i32 s53, s53, 6
v_min_u32 v46, 5, v1
v_add_u32 v46, s53, v46
v_lshlrev_b32 v46, 7, v46
v_min_u32 v46, s55, v46
v_add_u32 v46, s54, v46
s_lshl_b32 s52, s52, 2
s_add_u32 s52, s52, s42
s_lshl_b32 s52, s52, 1
v_subrev_u32 v47, 6, v1
v_min_u32 v47, 1, v47
v_add_u32 v47, s52, v47
v_lshlrev_b32 v47, 7, v47
s_mov_b32 s53, L_end-L_common-4
v_min_u32 v47, s53, v47
v_add_u32 v47, L_common-L_p1_A, v47
v_cmp_gt_u32 s[52:53], 6, v1
s_nop 1
v_cndmask_b32_e64 v46, v47, v46, s[52:53]
global_load_dword v222, v46, s[46:47]
s_mov_b32 s32, s84
s_mov_b32 s33, s85
s_mov_b32 s34, 819200
s_mov_b32 s35, 0x00020000
s_mov_b32 s28, s92
s_mov_b32 s29, s93
s_mov_b32 s30, 2211840
s_mov_b32 s31, 0x00020000
s_sub_u32 s52, s2, 128
s_lshl_b32 s52, s52, 2
s_add_u32 s52, s52, s42
s_mul_i32 s52, s52, 47
v_add_u32 v186, s52, v1
v_lshlrev_b32 v186, 7, v186
s_cmp_lt_u32 s51, 2
s_cselect_b32 s54, 0, 47
v_cmp_gt_u32 s[52:53], s54, v1
v_mov_b32 v187, 0x40000000
s_nop 0
v_cndmask_b32_e64 v186, v187, v186, s[52:53]
v_subrev_u32 v187, 2211840, v186
buffer_load_dword v188, v186, s[28:31], 0 offen
buffer_load_dword v189, v187, s[32:35], 0 offen
v_mov_b32 v24, 0
v_mov_b32 v25, 0
v_mov_b32 v26, 0
v_mov_b32 v27, 0
v_mov_b32 v28, 0
v_mov_b32 v29, 0
v_mov_b32 v30, 0
v_mov_b32 v31, 0
s_cmp_lt_u32 s51, 2
s_cbranch_scc1 L_p1_A
s_cmp_eq_u32 s51, 2
s_cbranch_scc1 L_p1_B
s_cmp_ge_u32 s41, 12
s_cbranch_scc1 L_p1_B
s_branch L_p1_D
L_p1_A:
s_waitcnt vmcnt(15)
s_barrier
ds_read_b128 a[0:3], v168 offset:0
ds_read_b128 a[4:7], v176 offset:0
ds_read_b64_tr_b16 v[48:49], v11 offset:0
ds_read_b64_tr_b16 v[50:51], v11 offset:512
ds_read_b128 a[8:11], v169 offset:0
ds_read_b128 a[12:15], v177 offset:0
ds_read_b64_tr_b16 v[52:53], v12 offset:0
ds_read_b64_tr_b16 v[54:55], v12 offset:512
s_waitcnt lgkmcnt(4)
v_mfma_f32_32x32x16_bf16 v[224:239], v[48:51], a[0:3], 0
s_add_u32 s65, s50, 2
s_lshl_b32 s52, s51, 1
s_add_u32 s66, s50, s52
s_mov_b32 s67, s66
ds_read_b64_tr_b16 v[56:57], v11 offset:4096
ds_read_b128 a[16:19], v170 offset:0
v_mfma_f32_32x32x16_bf16 v[240:255], v[48:51], a[4:7], 0
s_add_u32 s68, s66, 1
s_mov_b32 s69, s68
s_mov_b32 s16, s88
s_mov_b32 s17, s89
s_mov_b32 s18, 2211840
ds_read_b64_tr_b16 v[58:59], v11 offset:4608
ds_read_b128 a[20:23], v178 offset:0
ds_read_b128 v[136:139], v168 offset:0
ds_read_b128 v[140:143], v169 offset:0
ds_read_b128 v[144:147], v170 offset:0
v_mfma_f32_16x16x32_bf16 v[44:47], v[20:23], v[48:51], 0
s_mov_b32 s19, 0x00020000
s_mov_b32 s20, s90
s_mov_b32 s21, s91
s_mov_b32 s22, 2211840
s_mov_b32 s23, 0x00020000
s_waitcnt lgkmcnt(7)
v_mfma_f32_32x32x16_bf16 v[224:239], v[52:55], a[8:11], v[224:239]
s_mov_b32 s24, s6
s_mov_b32 s25, s7
s_mov_b32 s26, 33554432
s_mov_b32 s27, 0x00020000
ds_read_b64_tr_b16 v[60:61], v12 offset:4096
ds_read_b128 a[24:27], v171 offset:0
v_mfma_f32_32x32x16_bf16 v[240:255], v[52:55], a[12:15], v[240:255]
s_mov_b32 s32, s84
s_mov_b32 s33, s85
s_mov_b32 s34, 819200
s_mov_b32 s35, 0x00020000
s_mov_b32 s28, s92
ds_read_b64_tr_b16 v[62:63], v12 offset:4608
ds_read_b128 a[28:31], v179 offset:0
ds_read_b128 v[148:151], v171 offset:0
s_waitcnt lgkmcnt(8)
v_mfma_f32_32x32x16_bf16 v[224:239], v[56:59], a[16:19], v[224:239]
s_mov_b32 s29, s93
s_mov_b32 s30, 2211840
s_mov_b32 s31, 0x00020000
s_mov_b32 s36, s94
s_mov_b32 s37, s95
ds_read_b64_tr_b16 v[48:49], v11 offset:8192
ds_read_b128 a[32:35], v172 offset:0
v_mfma_f32_32x32x16_bf16 v[240:255], v[56:59], a[20:23], v[240:255]
s_mov_b32 s38, 2621440
s_mov_b32 s39, 0x00020000
v_mul_u32_u24 v42, 3456, v41
v_add_u32 v7, v42, v40
v_add_u32 v8, 26624, v7
ds_read_b64_tr_b16 v[50:51], v11 offset:8704
ds_read_b128 a[36:39], v180 offset:0
ds_read_b128 v[152:155], v172 offset:0
v_mfma_f32_16x16x32_bf16 v[44:47], v[20:23], v[56:59], v[44:47]
v_add_u32 v9, 26624, v8
v_add_u32 v10, 26624, v9
v_lshlrev_b32 v42, 4, v43
v_lshl_add_u32 v16, v35, 9, v42
s_waitcnt lgkmcnt(6)
v_mfma_f32_32x32x16_bf16 v[224:239], v[60:63], a[24:27], v[224:239]
v_lshrrev_b32 v42, 4, v43
v_mul_u32_u24 v42, 55296, v42
v_and_b32 v41, 15, v43
v_lshl_add_u32 v42, v41, 4, v42
v_lshl_add_u32 v17, v35, 8, v42
ds_read_b64_tr_b16 v[52:53], v12 offset:8192
ds_read_b128 a[40:43], v173 offset:0
v_mfma_f32_32x32x16_bf16 v[240:255], v[60:63], a[28:31], v[240:255]
s_lshl_b32 s52, s44, 8
s_add_u32 s52, s52, 149504
v_lshl_add_u32 v19, v43, 2, s52
s_lshl_b32 s53, s43, 7
s_add_u32 s52, s52, s53
ds_read_b64_tr_b16 v[54:55], v12 offset:8704
ds_read_b128 a[44:47], v181 offset:0
ds_read_b128 v[156:159], v173 offset:0
s_waitcnt lgkmcnt(6)
v_mfma_f32_32x32x16_bf16 v[224:239], v[48:51], a[32:35], v[224:239]
v_lshl_add_u32 v18, v1, 2, s52
v_cmp_gt_u32 s[52:53], 16, v1
v_mov_b32 v42, 151040
s_nop 0
v_cndmask_b32_e64 v18, v42, v18, s[52:53]
ds_read_b64_tr_b16 v[56:57], v11 offset:12288
ds_read_b128 a[48:51], v174 offset:0
v_mfma_f32_32x32x16_bf16 v[240:255], v[48:51], a[36:39], v[240:255]
s_lshl_b32 s52, s40, 2
s_add_u32 s55, s52, s42
s_xor_b32 s54, s42, 1
s_add_u32 s56, s52, s54
s_and_b32 s52, s40, 7
ds_read_b64_tr_b16 v[58:59], v11 offset:12800
ds_read_b128 a[52:55], v182 offset:0
ds_read_b128 v[160:163], v174 offset:0
v_mfma_f32_16x16x32_bf16 v[44:47], v[20:23], v[48:51], v[44:47]
s_mul_i32 s52, s52, 80
s_mul_i32 s53, s42, 20
s_add_u32 s52, s52, s53
v_add_u32 v15, s52, v1
v_cmp_gt_u32 s[52:53], 20, v1
s_waitcnt lgkmcnt(6)
v_mfma_f32_32x32x16_bf16 v[224:239], v[52:55], a[40:43], v[224:239]
v_mov_b32 v14, 0x100000
v_cndmask_b32_e64 v15, v14, v15, s[52:53]
s_add_u32 m0, s74, 114688
s_add_u32 s75, s73, 512
buffer_load_dwordx4 v128, s[8:11], s75 offen offset:0  lds
ds_read_b64_tr_b16 v[60:61], v12 offset:12288
ds_read_b128 a[56:59], v175 offset:0
v_mfma_f32_32x32x16_bf16 v[240:255], v[52:55], a[44:47], v[240:255]
buffer_load_dwordx4 v129, s[8:11], s75 offen offset:1024  lds
buffer_load_dwordx4 v130, s[8:11], s75 offen offset:2048  lds
buffer_load_dwordx4 v131, s[8:11], s75 offen offset:3072  lds
s_add_u32 m0, s74, 118784
ds_read_b64_tr_b16 v[62:63], v12 offset:12800
ds_read_b128 a[60:63], v183 offset:0
ds_read_b128 v[164:167], v175 offset:0
s_waitcnt lgkmcnt(6)
v_mfma_f32_32x32x16_bf16 v[224:239], v[56:59], a[48:51], v[224:239]
s_add_u32 s75, s73, 20992
buffer_load_dwordx4 v128, s[8:11], s75 offen offset:0  lds
buffer_load_dwordx4 v129, s[8:11], s75 offen offset:1024  lds
buffer_load_dwordx4 v130, s[8:11], s75 offen offset:2048  lds
buffer_load_dwordx4 v131, s[8:11], s75 offen offset:3072  lds
v_mfma_f32_32x32x16_bf16 v[240:255], v[56:59], a[52:55], v[240:255]
s_lshl_b32 s60, s64, 7
s_add_u32 s60, s60, 983040
s_add_u32 m0, s59, 32768
s_nop 0
buffer_load_dwordx4 v3, s[12:15], s60 offen offset:0  lds
buffer_load_dwordx4 v4, s[12:15], s60 offen offset:1024  lds
v_mfma_f32_16x16x32_bf16 v[44:47], v[20:23], v[56:59], v[44:47]
buffer_load_dwordx4 v5, s[12:15], s60 offen offset:2048  lds
buffer_load_dwordx4 v6, s[12:15], s60 offen offset:3072  lds
v_mul_u32_u24 v190, 3840, v15
s_lshl_b32 s97, s65, 7
buffer_load_dword v190, v190, s[12:15], s97 offen
s_waitcnt lgkmcnt(1)
v_mfma_f32_32x32x16_bf16 v[224:239], v[60:63], a[56:59], v[224:239]
v_mfma_f32_32x32x16_bf16 v[240:255], v[60:63], a[60:63], v[240:255]
s_waitcnt vmcnt(16) lgkmcnt(0)
s_barrier
v_add_u32 v11, 0x4000, v11
v_add_u32 v12, 0x4000, v12
ds_read_b128 a[64:67], v168 offset:32768
ds_read_b128 a[68:71], v176 offset:32768
ds_read_b64_tr_b16 v[48:49], v11 offset:0
ds_read_b64_tr_b16 v[50:51], v11 offset:512
ds_read_b128 a[72:75], v169 offset:32768
ds_read_b128 a[76:79], v177 offset:32768
ds_read_b64_tr_b16 v[52:53], v12 offset:0
ds_read_b64_tr_b16 v[54:55], v12 offset:512
v_dot2c_f32_bf16 v24, 0x3f803f80, v136
v_dot2c_f32_bf16 v28, v136, v136
v_dot2c_f32_bf16 v25, 0x3f803f80, v137
v_dot2c_f32_bf16 v29, v137, v137
v_dot2c_f32_bf16 v26, 0x3f803f80, v138
v_dot2c_f32_bf16 v30, v138, v138
v_dot2c_f32_bf16 v27, 0x3f803f80, v139
v_dot2c_f32_bf16 v31, v139, v139
v_dot2c_f32_bf16 v24, 0x3f803f80, v140
v_dot2c_f32_bf16 v28, v140, v140
v_dot2c_f32_bf16 v25, 0x3f803f80, v141
v_dot2c_f32_bf16 v29, v141, v141
v_dot2c_f32_bf16 v26, 0x3f803f80, v142
v_dot2c_f32_bf16 v30, v142, v142
v_dot2c_f32_bf16 v27, 0x3f803f80, v143
v_dot2c_f32_bf16 v31, v143, v143
v_dot2c_f32_bf16 v24, 0x3f803f80, v144
v_dot2c_f32_bf16 v28, v144, v144
v_dot2c_f32_bf16 v25, 0x3f803f80, v145
v_dot2c_f32_bf16 v29, v145, v145
v_dot2c_f32_bf16 v26, 0x3f803f80, v146
v_dot2c_f32_bf16 v30, v146, v146
v_dot2c_f32_bf16 v27, 0x3f803f80, v147
v_dot2c_f32_bf16 v31, v147, v147
v_dot2c_f32_bf16 v24, 0x3f803f80, v148
v_dot2c_f32_bf16 v28, v148, v148
v_dot2c_f32_bf16 v25, 0x3f803f80, v149
v_dot2c_f32_bf16 v29, v149, v149
v_dot2c_f32_bf16 v26, 0x3f803f80, v150
v_dot2c_f32_bf16 v30, v150, v150
v_dot2c_f32_bf16 v27, 0x3f803f80, v151
v_dot2c_f32_bf16 v31, v151, v151
v_dot2c_f32_bf16 v24, 0x3f803f80, v152
v_dot2c_f32_bf16 v28, v152, v152
v_dot2c_f32_bf16 v25, 0x3f803f80, v153
v_dot2c_f32_bf16 v29, v153, v153
v_dot2c_f32_bf16 v26, 0x3f803f80, v154
v_dot2c_f32_bf16 v30, v154, v154
v_dot2c_f32_bf16 v27, 0x3f803f80, v155
v_dot2c_f32_bf16 v31, v155, v155
v_dot2c_f32_bf16 v24, 0x3f803f80, v156
v_dot2c_f32_bf16 v28, v156, v156
v_dot2c_f32_bf16 v25, 0x3f803f80, v157
v_dot2c_f32_bf16 v29, v157, v157
v_dot2c_f32_bf16 v26, 0x3f803f80, v158
v_dot2c_f32_bf16 v30, v158, v158
v_dot2c_f32_bf16 v27, 0x3f803f80, v159
v_dot2c_f32_bf16 v31, v159, v159
v_dot2c_f32_bf16 v24, 0x3f803f80, v160
v_dot2c_f32_bf16 v28, v160, v160
v_dot2c_f32_bf16 v25, 0x3f803f80, v161
v_dot2c_f32_bf16 v29, v161, v161
v_dot2c_f32_bf16 v26, 0x3f803f80, v162
v_dot2c_f32_bf16 v30, v162, v162
v_dot2c_f32_bf16 v27, 0x3f803f80, v163
v_dot2c_f32_bf16 v31, v163, v163
v_dot2c_f32_bf16 v24, 0x3f803f80, v164
v_dot2c_f32_bf16 v28, v164, v164
v_dot2c_f32_bf16 v25, 0x3f803f80, v165
v_dot2c_f32_bf16 v29, v165, v165
v_dot2c_f32_bf16 v26, 0x3f803f80, v166
v_dot2c_f32_bf16 v30, v166, v166
v_dot2c_f32_bf16 v27, 0x3f803f80, v167
v_dot2c_f32_bf16 v31, v167, v167
s_cmp_lg_u32 s42, 0
s_cbranch_scc1 L_w0_3
v_mov_b32 v0, 0
global_load_dword v13, v0, s[4:5] sc0 sc1
L_w0_3:
s_waitcnt lgkmcnt(4)
v_mfma_f32_32x32x16_bf16 v[224:239], v[48:51], a[64:67], v[224:239]
s_add_u32 m0, s74, 49152
ds_read_b64_tr_b16 v[56:57], v11 offset:4096
ds_read_b128 a[80:83], v170 offset:32768
v_mfma_f32_32x32x16_bf16 v[240:255], v[48:51], a[68:71], v[240:255]
s_add_u32 s75, s73, 768
ds_read_b64_tr_b16 v[58:59], v11 offset:4608
ds_read_b128 a[84:87], v178 offset:32768
ds_read_b128 v[136:139], v168 offset:32768
v_add_u32 v168, 0x10000, v168
v_add_u32 v176, 0x10000, v176
ds_read_b128 v[140:143], v169 offset:32768
v_add_u32 v169, 0x10000, v169
v_add_u32 v177, 0x10000, v177
ds_read_b128 v[144:147], v170 offset:32768
v_add_u32 v170, 0x10000, v170
v_add_u32 v178, 0x10000, v178
v_mfma_f32_16x16x32_bf16 v[44:47], v[20:23], v[48:51], v[44:47]
buffer_load_dwordx4 v128, s[8:11], s75 offen offset:0  lds
s_waitcnt lgkmcnt(7)
v_mfma_f32_32x32x16_bf16 v[224:239], v[52:55], a[72:75], v[224:239]
buffer_load_dwordx4 v129, s[8:11], s75 offen offset:1024  lds
ds_read_b64_tr_b16 v[60:61], v12 offset:4096
ds_read_b128 a[88:91], v171 offset:32768
v_mfma_f32_32x32x16_bf16 v[240:255], v[52:55], a[76:79], v[240:255]
buffer_load_dwordx4 v130, s[8:11], s75 offen offset:2048  lds
ds_read_b64_tr_b16 v[62:63], v12 offset:4608
ds_read_b128 a[92:95], v179 offset:32768
ds_read_b128 v[148:151], v171 offset:32768
v_add_u32 v171, 0x10000, v171
v_add_u32 v179, 0x10000, v179
s_waitcnt lgkmcnt(8)
v_mfma_f32_32x32x16_bf16 v[224:239], v[56:59], a[80:83], v[224:239]
buffer_load_dwordx4 v131, s[8:11], s75 offen offset:3072  lds
ds_read_b64_tr_b16 v[48:49], v11 offset:8192
ds_read_b128 a[96:99], v172 offset:32768
v_mfma_f32_32x32x16_bf16 v[240:255], v[56:59], a[84:87], v[240:255]
s_add_u32 m0, s74, 53248
ds_read_b64_tr_b16 v[50:51], v11 offset:8704
ds_read_b128 a[100:103], v180 offset:32768
ds_read_b128 v[152:155], v172 offset:32768
v_add_u32 v172, 0x10000, v172
v_add_u32 v180, 0x10000, v180
v_mfma_f32_16x16x32_bf16 v[44:47], v[20:23], v[56:59], v[44:47]
s_add_u32 s75, s73, 21248
s_waitcnt lgkmcnt(6)
v_mfma_f32_32x32x16_bf16 v[224:239], v[60:63], a[88:91], v[224:239]
buffer_load_dwordx4 v128, s[8:11], s75 offen offset:0  lds
ds_read_b64_tr_b16 v[52:53], v12 offset:8192
ds_read_b128 a[104:107], v173 offset:32768
v_mfma_f32_32x32x16_bf16 v[240:255], v[60:63], a[92:95], v[240:255]
buffer_load_dwordx4 v129, s[8:11], s75 offen offset:1024  lds
ds_read_b64_tr_b16 v[54:55], v12 offset:8704
ds_read_b128 a[108:111], v181 offset:32768
ds_read_b128 v[156:159], v173 offset:32768
v_add_u32 v173, 0x10000, v173
v_add_u32 v181, 0x10000, v181
s_waitcnt lgkmcnt(6)
v_mfma_f32_32x32x16_bf16 v[224:239], v[48:51], a[96:99], v[224:239]
buffer_load_dwordx4 v130, s[8:11], s75 offen offset:2048  lds
ds_read_b64_tr_b16 v[56:57], v11 offset:12288
ds_read_b128 a[112:115], v174 offset:32768
v_mfma_f32_32x32x16_bf16 v[240:255], v[48:51], a[100:103], v[240:255]
buffer_load_dwordx4 v131, s[8:11], s75 offen offset:3072  lds
ds_read_b64_tr_b16 v[58:59], v11 offset:12800
ds_read_b128 a[116:119], v182 offset:32768
ds_read_b128 v[160:163], v174 offset:32768
v_add_u32 v174, 0x10000, v174
v_add_u32 v182, 0x10000, v182
v_mfma_f32_16x16x32_bf16 v[44:47], v[20:23], v[48:51], v[44:47]
s_lshl_b32 s60, s64, 7
s_waitcnt lgkmcnt(6)
v_mfma_f32_32x32x16_bf16 v[224:239], v[52:55], a[104:107], v[224:239]
s_add_u32 s60, s60, 1474560
ds_read_b64_tr_b16 v[60:61], v12 offset:12288
ds_read_b128 a[120:123], v175 offset:32768
v_mfma_f32_32x32x16_bf16 v[240:255], v[52:55], a[108:111], v[240:255]
s_add_u32 m0, s59, 0
ds_read_b64_tr_b16 v[62:63], v12 offset:12800
ds_read_b128 a[124:127], v183 offset:32768
ds_read_b128 v[164:167], v175 offset:32768
v_add_u32 v175, 0x10000, v175
v_add_u32 v183, 0x10000, v183
s_waitcnt lgkmcnt(6)
v_mfma_f32_32x32x16_bf16 v[224:239], v[56:59], a[112:115], v[224:239]
buffer_load_dwordx4 v3, s[12:15], s60 offen offset:0  lds
v_mfma_f32_32x32x16_bf16 v[240:255], v[56:59], a[116:119], v[240:255]
buffer_load_dwordx4 v4, s[12:15], s60 offen offset:1024  lds
v_mfma_f32_16x16x32_bf16 v[44:47], v[20:23], v[56:59], v[44:47]
buffer_load_dwordx4 v5, s[12:15], s60 offen offset:2048  lds
buffer_load_dwordx4 v6, s[12:15], s60 offen offset:3072  lds
s_waitcnt lgkmcnt(1)
v_mfma_f32_32x32x16_bf16 v[224:239], v[60:63], a[120:123], v[224:239]
v_mfma_f32_32x32x16_bf16 v[240:255], v[60:63], a[124:127], v[240:255]
s_waitcnt vmcnt(13) lgkmcnt(0)
s_barrier
v_add_u32 v11, 0x4000, v11
v_add_u32 v12, 0x4000, v12
ds_read_b128 a[128:131], v168 offset:0
ds_read_b128 a[132:135], v176 offset:0
ds_read_b64_tr_b16 v[48:49], v11 offset:0
ds_read_b64_tr_b16 v[50:51], v11 offset:512
ds_read_b128 a[136:139], v169 offset:0
ds_read_b128 a[140:143], v177 offset:0
ds_read_b64_tr_b16 v[52:53], v12 offset:0
ds_read_b64_tr_b16 v[54:55], v12 offset:512
v_dot2c_f32_bf16 v24, 0x3f803f80, v136
v_dot2c_f32_bf16 v28, v136, v136
v_dot2c_f32_bf16 v25, 0x3f803f80, v137
v_dot2c_f32_bf16 v29, v137, v137
v_dot2c_f32_bf16 v26, 0x3f803f80, v138
v_dot2c_f32_bf16 v30, v138, v138
v_dot2c_f32_bf16 v27, 0x3f803f80, v139
v_dot2c_f32_bf16 v31, v139, v139
v_dot2c_f32_bf16 v24, 0x3f803f80, v140
v_dot2c_f32_bf16 v28, v140, v140
v_dot2c_f32_bf16 v25, 0x3f803f80, v141
v_dot2c_f32_bf16 v29, v141, v141
v_dot2c_f32_bf16 v26, 0x3f803f80, v142
v_dot2c_f32_bf16 v30, v142, v142
v_dot2c_f32_bf16 v27, 0x3f803f80, v143
v_dot2c_f32_bf16 v31, v143, v143
v_dot2c_f32_bf16 v24, 0x3f803f80, v144
v_dot2c_f32_bf16 v28, v144, v144
v_dot2c_f32_bf16 v25, 0x3f803f80, v145
v_dot2c_f32_bf16 v29, v145, v145
v_dot2c_f32_bf16 v26, 0x3f803f80, v146
v_dot2c_f32_bf16 v30, v146, v146
v_dot2c_f32_bf16 v27, 0x3f803f80, v147
v_dot2c_f32_bf16 v31, v147, v147
v_dot2c_f32_bf16 v24, 0x3f803f80, v148
v_dot2c_f32_bf16 v28, v148, v148
v_dot2c_f32_bf16 v25, 0x3f803f80, v149
v_dot2c_f32_bf16 v29, v149, v149
v_dot2c_f32_bf16 v26, 0x3f803f80, v150
v_dot2c_f32_bf16 v30, v150, v150
v_dot2c_f32_bf16 v27, 0x3f803f80, v151
v_dot2c_f32_bf16 v31, v151, v151
v_dot2c_f32_bf16 v24, 0x3f803f80, v152
v_dot2c_f32_bf16 v28, v152, v152
v_dot2c_f32_bf16 v25, 0x3f803f80, v153
v_dot2c_f32_bf16 v29, v153, v153
v_dot2c_f32_bf16 v26, 0x3f803f80, v154
v_dot2c_f32_bf16 v30, v154, v154
v_dot2c_f32_bf16 v27, 0x3f803f80, v155
v_dot2c_f32_bf16 v31, v155, v155
v_dot2c_f32_bf16 v24, 0x3f803f80, v156
v_dot2c_f32_bf16 v28, v156, v156
v_dot2c_f32_bf16 v25, 0x3f803f80, v157
v_dot2c_f32_bf16 v29, v157, v157
v_dot2c_f32_bf16 v26, 0x3f803f80, v158
v_dot2c_f32_bf16 v30, v158, v158
v_dot2c_f32_bf16 v27, 0x3f803f80, v159
v_dot2c_f32_bf16 v31, v159, v159
v_dot2c_f32_bf16 v24, 0x3f803f80, v160
v_dot2c_f32_bf16 v28, v160, v160
v_dot2c_f32_bf16 v25, 0x3f803f80, v161
v_dot2c_f32_bf16 v29, v161, v161
v_dot2c_f32_bf16 v26, 0x3f803f80, v162
v_dot2c_f32_bf16 v30, v162, v162
v_dot2c_f32_bf16 v27, 0x3f803f80, v163
v_dot2c_f32_bf16 v31, v163, v163
v_dot2c_f32_bf16 v24, 0x3f803f80, v164
v_dot2c_f32_bf16 v28, v164, v164
v_dot2c_f32_bf16 v25, 0x3f803f80, v165
v_dot2c_f32_bf16 v29, v165, v165
v_dot2c_f32_bf16 v26, 0x3f803f80, v166
v_dot2c_f32_bf16 v30, v166, v166
v_dot2c_f32_bf16 v27, 0x3f803f80, v167
v_dot2c_f32_bf16 v31, v167, v167
s_waitcnt lgkmcnt(4)
v_mfma_f32_32x32x16_bf16 v[224:239], v[48:51], a[128:131], v[224:239]
s_add_u32 m0, s74, 81920
ds_read_b64_tr_b16 v[56:57], v11 offset:4096
ds_read_b128 a[144:147], v170 offset:0
v_mfma_f32_32x32x16_bf16 v[240:255], v[48:51], a[132:135], v[240:255]
s_add_u32 s75, s73, 1024
ds_read_b64_tr_b16 v[58:59], v11 offset:4608
ds_read_b128 a[148:151], v178 offset:0
ds_read_b128 v[136:139], v168 offset:0
v_add_u32 v168, 0xffff0000, v168
v_add_u32 v176, 0xffff0000, v176
ds_read_b128 v[140:143], v169 offset:0
v_add_u32 v169, 0xffff0000, v169
v_add_u32 v177, 0xffff0000, v177
ds_read_b128 v[144:147], v170 offset:0
v_add_u32 v170, 0xffff0000, v170
v_add_u32 v178, 0xffff0000, v178
v_mfma_f32_16x16x32_bf16 v[44:47], v[20:23], v[48:51], v[44:47]
buffer_load_dwordx4 v128, s[8:11], s75 offen offset:0  lds
s_waitcnt lgkmcnt(7)
v_mfma_f32_32x32x16_bf16 v[224:239], v[52:55], a[136:139], v[224:239]
buffer_load_dwordx4 v129, s[8:11], s75 offen offset:1024  lds
ds_read_b64_tr_b16 v[60:61], v12 offset:4096
ds_read_b128 a[152:155], v171 offset:0
v_mfma_f32_32x32x16_bf16 v[240:255], v[52:55], a[140:143], v[240:255]
buffer_load_dwordx4 v130, s[8:11], s75 offen offset:2048  lds
ds_read_b64_tr_b16 v[62:63], v12 offset:4608
ds_read_b128 a[156:159], v179 offset:0
ds_read_b128 v[148:151], v171 offset:0
v_add_u32 v171, 0xffff0000, v171
v_add_u32 v179, 0xffff0000, v179
s_waitcnt lgkmcnt(8)
v_mfma_f32_32x32x16_bf16 v[224:239], v[56:59], a[144:147], v[224:239]
buffer_load_dwordx4 v131, s[8:11], s75 offen offset:3072  lds
ds_read_b64_tr_b16 v[48:49], v11 offset:8192
ds_read_b128 a[160:163], v172 offset:0
v_mfma_f32_32x32x16_bf16 v[240:255], v[56:59], a[148:151], v[240:255]
s_add_u32 m0, s74, 86016
ds_read_b64_tr_b16 v[50:51], v11 offset:8704
ds_read_b128 a[164:167], v180 offset:0
ds_read_b128 v[152:155], v172 offset:0
v_add_u32 v172, 0xffff0000, v172
v_add_u32 v180, 0xffff0000, v180
v_mfma_f32_16x16x32_bf16 v[44:47], v[20:23], v[56:59], v[44:47]
s_add_u32 s75, s73, 21504
s_waitcnt lgkmcnt(6)
v_mfma_f32_32x32x16_bf16 v[224:239], v[60:63], a[152:155], v[224:239]
buffer_load_dwordx4 v128, s[8:11], s75 offen offset:0  lds
ds_read_b64_tr_b16 v[52:53], v12 offset:8192
ds_read_b128 a[168:171], v173 offset:0
v_mfma_f32_32x32x16_bf16 v[240:255], v[60:63], a[156:159], v[240:255]
buffer_load_dwordx4 v129, s[8:11], s75 offen offset:1024  lds
ds_read_b64_tr_b16 v[54:55], v12 offset:8704
ds_read_b128 a[172:175], v181 offset:0
ds_read_b128 v[156:159], v173 offset:0
v_add_u32 v173, 0xffff0000, v173
v_add_u32 v181, 0xffff0000, v181
s_waitcnt lgkmcnt(6)
v_mfma_f32_32x32x16_bf16 v[224:239], v[48:51], a[160:163], v[224:239]
buffer_load_dwordx4 v130, s[8:11], s75 offen offset:2048  lds
ds_read_b64_tr_b16 v[56:57], v11 offset:12288
ds_read_b128 a[176:179], v174 offset:0
v_mfma_f32_32x32x16_bf16 v[240:255], v[48:51], a[164:167], v[240:255]
buffer_load_dwordx4 v131, s[8:11], s75 offen offset:3072  lds
ds_read_b64_tr_b16 v[58:59], v11 offset:12800
ds_read_b128 a[180:183], v182 offset:0
ds_read_b128 v[160:163], v174 offset:0
v_add_u32 v174, 0xffff0000, v174
v_add_u32 v182, 0xffff0000, v182
v_mfma_f32_16x16x32_bf16 v[44:47], v[20:23], v[48:51], v[44:47]
s_lshl_b32 s60, s64, 7
s_waitcnt lgkmcnt(6)
v_mfma_f32_32x32x16_bf16 v[224:239], v[52:55], a[168:171], v[224:239]
s_add_u32 s60, s60, 1966080
ds_read_b64_tr_b16 v[60:61], v12 offset:12288
ds_read_b128 a[184:187], v175 offset:0
v_mfma_f32_32x32x16_bf16 v[240:255], v[52:55], a[172:175], v[240:255]
s_add_u32 m0, s59, 16384
ds_read_b64_tr_b16 v[62:63], v12 offset:12800
ds_read_b128 a[188:191], v183 offset:0
ds_read_b128 v[164:167], v175 offset:0
v_add_u32 v175, 0xffff0000, v175
v_add_u32 v183, 0xffff0000, v183
s_waitcnt lgkmcnt(6)
v_mfma_f32_32x32x16_bf16 v[224:239], v[56:59], a[176:179], v[224:239]
buffer_load_dwordx4 v3, s[12:15], s60 offen offset:0  lds
v_mfma_f32_32x32x16_bf16 v[240:255], v[56:59], a[180:183], v[240:255]
buffer_load_dwordx4 v4, s[12:15], s60 offen offset:1024  lds
v_mfma_f32_16x16x32_bf16 v[44:47], v[20:23], v[56:59], v[44:47]
buffer_load_dwordx4 v5, s[12:15], s60 offen offset:2048  lds
buffer_load_dwordx4 v6, s[12:15], s60 offen offset:3072  lds
s_waitcnt lgkmcnt(1)
v_mfma_f32_32x32x16_bf16 v[224:239], v[60:63], a[184:187], v[224:239]
v_mfma_f32_32x32x16_bf16 v[240:255], v[60:63], a[188:191], v[240:255]
s_waitcnt vmcnt(12) lgkmcnt(0)
s_barrier
v_add_u32 v11, 0xffff8000, v11
v_add_u32 v12, 0xffff8000, v12
ds_read_b128 a[192:195], v168 offset:0
ds_read_b128 a[196:199], v176 offset:0
ds_read_b64_tr_b16 v[48:49], v11 offset:0
ds_read_b64_tr_b16 v[50:51], v11 offset:512
ds_read_b128 a[200:203], v169 offset:0
ds_read_b128 a[204:207], v177 offset:0
ds_read_b64_tr_b16 v[52:53], v12 offset:0
ds_read_b64_tr_b16 v[54:55], v12 offset:512
v_dot2c_f32_bf16 v24, 0x3f803f80, v136
v_dot2c_f32_bf16 v28, v136, v136
v_dot2c_f32_bf16 v25, 0x3f803f80, v137
v_dot2c_f32_bf16 v29, v137, v137
v_dot2c_f32_bf16 v26, 0x3f803f80, v138
v_dot2c_f32_bf16 v30, v138, v138
v_dot2c_f32_bf16 v27, 0x3f803f80, v139
v_dot2c_f32_bf16 v31, v139, v139
v_dot2c_f32_bf16 v24, 0x3f803f80, v140
v_dot2c_f32_bf16 v28, v140, v140
v_dot2c_f32_bf16 v25, 0x3f803f80, v141
v_dot2c_f32_bf16 v29, v141, v141
v_dot2c_f32_bf16 v26, 0x3f803f80, v142
v_dot2c_f32_bf16 v30, v142, v142
v_dot2c_f32_bf16 v27, 0x3f803f80, v143
v_dot2c_f32_bf16 v31, v143, v143
v_dot2c_f32_bf16 v24, 0x3f803f80, v144
v_dot2c_f32_bf16 v28, v144, v144
v_dot2c_f32_bf16 v25, 0x3f803f80, v145
v_dot2c_f32_bf16 v29, v145, v145
v_dot2c_f32_bf16 v26, 0x3f803f80, v146
v_dot2c_f32_bf16 v30, v146, v146
v_dot2c_f32_bf16 v27, 0x3f803f80, v147
v_dot2c_f32_bf16 v31, v147, v147
v_dot2c_f32_bf16 v24, 0x3f803f80, v148
v_dot2c_f32_bf16 v28, v148, v148
v_dot2c_f32_bf16 v25, 0x3f803f80, v149
v_dot2c_f32_bf16 v29, v149, v149
v_dot2c_f32_bf16 v26, 0x3f803f80, v150
v_dot2c_f32_bf16 v30, v150, v150
v_dot2c_f32_bf16 v27, 0x3f803f80, v151
v_dot2c_f32_bf16 v31, v151, v151
v_dot2c_f32_bf16 v24, 0x3f803f80, v152
v_dot2c_f32_bf16 v28, v152, v152
v_dot2c_f32_bf16 v25, 0x3f803f80, v153
v_dot2c_f32_bf16 v29, v153, v153
v_dot2c_f32_bf16 v26, 0x3f803f80, v154
v_dot2c_f32_bf16 v30, v154, v154
v_dot2c_f32_bf16 v27, 0x3f803f80, v155
v_dot2c_f32_bf16 v31, v155, v155
v_dot2c_f32_bf16 v24, 0x3f803f80, v156
v_dot2c_f32_bf16 v28, v156, v156
v_dot2c_f32_bf16 v25, 0x3f803f80, v157
v_dot2c_f32_bf16 v29, v157, v157
v_dot2c_f32_bf16 v26, 0x3f803f80, v158
v_dot2c_f32_bf16 v30, v158, v158
v_dot2c_f32_bf16 v27, 0x3f803f80, v159
v_dot2c_f32_bf16 v31, v159, v159
v_dot2c_f32_bf16 v24, 0x3f803f80, v160
v_dot2c_f32_bf16 v28, v160, v160
v_dot2c_f32_bf16 v25, 0x3f803f80, v161
v_dot2c_f32_bf16 v29, v161, v161
v_dot2c_f32_bf16 v26, 0x3f803f80, v162
v_dot2c_f32_bf16 v30, v162, v162
v_dot2c_f32_bf16 v27, 0x3f803f80, v163
v_dot2c_f32_bf16 v31, v163, v163
v_dot2c_f32_bf16 v24, 0x3f803f80, v164
v_dot2c_f32_bf16 v28, v164, v164
v_dot2c_f32_bf16 v25, 0x3f803f80, v165
v_dot2c_f32_bf16 v29, v165, v165
v_dot2c_f32_bf16 v26, 0x3f803f80, v166
v_dot2c_f32_bf16 v30, v166, v166
v_dot2c_f32_bf16 v27, 0x3f803f80, v167
v_dot2c_f32_bf16 v31, v167, v167
s_waitcnt lgkmcnt(4)
v_mfma_f32_32x32x16_bf16 v[224:239], v[48:51], a[192:195], v[224:239]
ds_read_b64_tr_b16 v[56:57], v11 offset:4096
ds_read_b128 a[208:211], v170 offset:0
v_mfma_f32_32x32x16_bf16 v[240:255], v[48:51], a[196:199], v[240:255]
s_lshl_b32 s60, s65, 7
ds_read_b64_tr_b16 v[58:59], v11 offset:4608
ds_read_b128 a[212:215], v178 offset:0
ds_read_b128 v[136:139], v168 offset:0
ds_read_b128 v[140:143], v169 offset:0
ds_read_b128 v[144:147], v170 offset:0
v_mfma_f32_16x16x32_bf16 v[44:47], v[20:23], v[48:51], v[44:47]
s_add_u32 s60, s60, 0
s_waitcnt lgkmcnt(7)
v_mfma_f32_32x32x16_bf16 v[224:239], v[52:55], a[200:203], v[224:239]
s_add_u32 m0, s59, 32768
ds_read_b64_tr_b16 v[60:61], v12 offset:4096
ds_read_b128 a[216:219], v171 offset:0
v_mfma_f32_32x32x16_bf16 v[240:255], v[52:55], a[204:207], v[240:255]
buffer_load_dwordx4 v3, s[12:15], s60 offen offset:0  lds
ds_read_b64_tr_b16 v[62:63], v12 offset:4608
ds_read_b128 a[220:223], v179 offset:0
ds_read_b128 v[148:151], v171 offset:0
s_waitcnt lgkmcnt(8)
v_mfma_f32_32x32x16_bf16 v[224:239], v[56:59], a[208:211], v[224:239]
buffer_load_dwordx4 v4, s[12:15], s60 offen offset:1024  lds
ds_read_b64_tr_b16 v[48:49], v11 offset:8192
ds_read_b128 a[224:227], v172 offset:0
v_mfma_f32_32x32x16_bf16 v[240:255], v[56:59], a[212:215], v[240:255]
buffer_load_dwordx4 v5, s[12:15], s60 offen offset:2048  lds
ds_read_b64_tr_b16 v[50:51], v11 offset:8704
ds_read_b128 a[228:231], v180 offset:0
ds_read_b128 v[152:155], v172 offset:0
v_mfma_f32_16x16x32_bf16 v[44:47], v[20:23], v[56:59], v[44:47]
buffer_load_dwordx4 v6, s[12:15], s60 offen offset:3072  lds
s_waitcnt lgkmcnt(6)
v_mfma_f32_32x32x16_bf16 v[224:239], v[60:63], a[216:219], v[224:239]
s_lshl_b32 s60, s65, 7
ds_read_b64_tr_b16 v[52:53], v12 offset:8192
ds_read_b128 a[232:235], v173 offset:0
v_mfma_f32_32x32x16_bf16 v[240:255], v[60:63], a[220:223], v[240:255]
s_add_u32 s60, s60, 491520
ds_read_b64_tr_b16 v[54:55], v12 offset:8704
ds_read_b128 a[236:239], v181 offset:0
ds_read_b128 v[156:159], v173 offset:0
s_waitcnt lgkmcnt(6)
v_mfma_f32_32x32x16_bf16 v[224:239], v[48:51], a[224:227], v[224:239]
s_add_u32 m0, s59, 114688
ds_read_b64_tr_b16 v[56:57], v11 offset:12288
ds_read_b128 a[240:243], v174 offset:0
v_mfma_f32_32x32x16_bf16 v[240:255], v[48:51], a[228:231], v[240:255]
buffer_load_dwordx4 v3, s[12:15], s60 offen offset:0  lds
ds_read_b64_tr_b16 v[58:59], v11 offset:12800
ds_read_b128 a[244:247], v182 offset:0
ds_read_b128 v[160:163], v174 offset:0
v_mfma_f32_16x16x32_bf16 v[44:47], v[20:23], v[48:51], v[44:47]
buffer_load_dwordx4 v4, s[12:15], s60 offen offset:1024  lds
s_waitcnt lgkmcnt(6)
v_mfma_f32_32x32x16_bf16 v[224:239], v[52:55], a[232:235], v[224:239]
buffer_load_dwordx4 v5, s[12:15], s60 offen offset:2048  lds
ds_read_b64_tr_b16 v[60:61], v12 offset:12288
ds_read_b128 a[248:251], v175 offset:0
v_mfma_f32_32x32x16_bf16 v[240:255], v[52:55], a[236:239], v[240:255]
buffer_load_dwordx4 v6, s[12:15], s60 offen offset:3072  lds
ds_read_b64_tr_b16 v[62:63], v12 offset:12800
ds_read_b128 a[252:255], v183 offset:0
ds_read_b128 v[164:167], v175 offset:0
s_waitcnt lgkmcnt(6)
v_mfma_f32_32x32x16_bf16 v[224:239], v[56:59], a[240:243], v[224:239]
v_mul_u32_u24 v191, 3456, v15
v_mfma_f32_32x32x16_bf16 v[240:255], v[56:59], a[244:247], v[240:255]
s_lshl_b32 s97, s66, 7
v_mfma_f32_16x16x32_bf16 v[44:47], v[20:23], v[56:59], v[44:47]
buffer_load_dword v191, v191, s[16:19], s97 offen
s_waitcnt lgkmcnt(1)
v_mfma_f32_32x32x16_bf16 v[224:239], v[60:63], a[248:251], v[224:239]
v_mfma_f32_32x32x16_bf16 v[240:255], v[60:63], a[252:255], v[240:255]
s_waitcnt vmcnt(9) lgkmcnt(0)
s_barrier
v_add_u32 v11, 0x4000, v11
v_add_u32 v12, 0x4000, v12
ds_read_b128 v[64:67], v168 offset:32768
ds_read_b128 v[68:71], v176 offset:32768
ds_read_b64_tr_b16 v[48:49], v11 offset:0
ds_read_b64_tr_b16 v[50:51], v11 offset:512
ds_read_b128 v[72:75], v169 offset:32768
ds_read_b128 v[76:79], v177 offset:32768
ds_read_b64_tr_b16 v[52:53], v12 offset:0
ds_read_b64_tr_b16 v[54:55], v12 offset:512
v_dot2c_f32_bf16 v24, 0x3f803f80, v136
v_dot2c_f32_bf16 v28, v136, v136
v_dot2c_f32_bf16 v25, 0x3f803f80, v137
v_dot2c_f32_bf16 v29, v137, v137
v_dot2c_f32_bf16 v26, 0x3f803f80, v138
v_dot2c_f32_bf16 v30, v138, v138
v_dot2c_f32_bf16 v27, 0x3f803f80, v139
v_dot2c_f32_bf16 v31, v139, v139
v_dot2c_f32_bf16 v24, 0x3f803f80, v140
v_dot2c_f32_bf16 v28, v140, v140
v_dot2c_f32_bf16 v25, 0x3f803f80, v141
v_dot2c_f32_bf16 v29, v141, v141
v_dot2c_f32_bf16 v26, 0x3f803f80, v142
v_dot2c_f32_bf16 v30, v142, v142
v_dot2c_f32_bf16 v27, 0x3f803f80, v143
v_dot2c_f32_bf16 v31, v143, v143
v_dot2c_f32_bf16 v24, 0x3f803f80, v144
v_dot2c_f32_bf16 v28, v144, v144
v_dot2c_f32_bf16 v25, 0x3f803f80, v145
v_dot2c_f32_bf16 v29, v145, v145
v_dot2c_f32_bf16 v26, 0x3f803f80, v146
v_dot2c_f32_bf16 v30, v146, v146
v_dot2c_f32_bf16 v27, 0x3f803f80, v147
v_dot2c_f32_bf16 v31, v147, v147
v_dot2c_f32_bf16 v24, 0x3f803f80, v148
v_dot2c_f32_bf16 v28, v148, v148
v_dot2c_f32_bf16 v25, 0x3f803f80, v149
v_dot2c_f32_bf16 v29, v149, v149
v_dot2c_f32_bf16 v26, 0x3f803f80, v150
v_dot2c_f32_bf16 v30, v150, v150
v_dot2c_f32_bf16 v27, 0x3f803f80, v151
v_dot2c_f32_bf16 v31, v151, v151
v_dot2c_f32_bf16 v24, 0x3f803f80, v152
v_dot2c_f32_bf16 v28, v152, v152
v_dot2c_f32_bf16 v25, 0x3f803f80, v153
v_dot2c_f32_bf16 v29, v153, v153
v_dot2c_f32_bf16 v26, 0x3f803f80, v154
v_dot2c_f32_bf16 v30, v154, v154
v_dot2c_f32_bf16 v27, 0x3f803f80, v155
v_dot2c_f32_bf16 v31, v155, v155
v_dot2c_f32_bf16 v24, 0x3f803f80, v156
v_dot2c_f32_bf16 v28, v156, v156
v_dot2c_f32_bf16 v25, 0x3f803f80, v157
v_dot2c_f32_bf16 v29, v157, v157
v_dot2c_f32_bf16 v26, 0x3f803f80, v158
v_dot2c_f32_bf16 v30, v158, v158
v_dot2c_f32_bf16 v27, 0x3f803f80, v159
v_dot2c_f32_bf16 v31, v159, v159
v_dot2c_f32_bf16 v24, 0x3f803f80, v160
v_dot2c_f32_bf16 v28, v160, v160
v_dot2c_f32_bf16 v25, 0x3f803f80, v161
v_dot2c_f32_bf16 v29, v161, v161
v_dot2c_f32_bf16 v26, 0x3f803f80, v162
v_dot2c_f32_bf16 v30, v162, v162
v_dot2c_f32_bf16 v27, 0x3f803f80, v163
v_dot2c_f32_bf16 v31, v163, v163
v_dot2c_f32_bf16 v24, 0x3f803f80, v164
v_dot2c_f32_bf16 v28, v164, v164
v_dot2c_f32_bf16 v25, 0x3f803f80, v165
v_dot2c_f32_bf16 v29, v165, v165
v_dot2c_f32_bf16 v26, 0x3f803f80, v166
v_dot2c_f32_bf16 v30, v166, v166
v_dot2c_f32_bf16 v27, 0x3f803f80, v167
v_dot2c_f32_bf16 v31, v167, v167
s_waitcnt lgkmcnt(4)
v_mfma_f32_32x32x16_bf16 v[224:239], v[48:51], v[64:67], v[224:239]
ds_read_b64_tr_b16 v[56:57], v11 offset:4096
ds_read_b128 v[80:83], v170 offset:32768
v_mfma_f32_32x32x16_bf16 v[240:255], v[48:51], v[68:71], v[240:255]
s_lshl_b32 s60, s65, 7
ds_read_b64_tr_b16 v[58:59], v11 offset:4608
ds_read_b128 v[84:87], v178 offset:32768
ds_read_b128 v[136:139], v168 offset:32768
ds_read_b128 v[140:143], v169 offset:32768
ds_read_b128 v[144:147], v170 offset:32768
v_mfma_f32_16x16x32_bf16 v[44:47], v[20:23], v[48:51], v[44:47]
s_add_u32 s60, s60, 983040
s_waitcnt lgkmcnt(7)
v_mfma_f32_32x32x16_bf16 v[224:239], v[52:55], v[72:75], v[224:239]
s_add_u32 m0, s59, 131072
ds_read_b64_tr_b16 v[60:61], v12 offset:4096
ds_read_b128 v[88:91], v171 offset:32768
v_mfma_f32_32x32x16_bf16 v[240:255], v[52:55], v[76:79], v[240:255]
ds_read_b64_tr_b16 v[62:63], v12 offset:4608
ds_read_b128 v[92:95], v179 offset:32768
ds_read_b128 v[148:151], v171 offset:32768
s_waitcnt lgkmcnt(8)
v_mfma_f32_32x32x16_bf16 v[224:239], v[56:59], v[80:83], v[224:239]
buffer_load_dwordx4 v3, s[12:15], s60 offen offset:0  lds
ds_read_b64_tr_b16 v[48:49], v11 offset:8192
ds_read_b128 v[96:99], v172 offset:32768
v_mfma_f32_32x32x16_bf16 v[240:255], v[56:59], v[84:87], v[240:255]
buffer_load_dwordx4 v4, s[12:15], s60 offen offset:1024  lds
ds_read_b64_tr_b16 v[50:51], v11 offset:8704
ds_read_b128 v[100:103], v180 offset:32768
ds_read_b128 v[152:155], v172 offset:32768
v_mfma_f32_16x16x32_bf16 v[44:47], v[20:23], v[56:59], v[44:47]
buffer_load_dwordx4 v5, s[12:15], s60 offen offset:2048  lds
s_waitcnt lgkmcnt(6)
v_mfma_f32_32x32x16_bf16 v[224:239], v[60:63], v[88:91], v[224:239]
buffer_load_dwordx4 v6, s[12:15], s60 offen offset:3072  lds
ds_read_b64_tr_b16 v[52:53], v12 offset:8192
ds_read_b128 v[104:107], v173 offset:32768
v_mfma_f32_32x32x16_bf16 v[240:255], v[60:63], v[92:95], v[240:255]
ds_read_b64_tr_b16 v[54:55], v12 offset:8704
ds_read_b128 v[108:111], v181 offset:32768
ds_read_b128 v[156:159], v173 offset:32768
s_waitcnt lgkmcnt(6)
v_mfma_f32_32x32x16_bf16 v[224:239], v[48:51], v[96:99], v[224:239]
s_lshl_b32 s60, s65, 7
ds_read_b64_tr_b16 v[56:57], v11 offset:12288
ds_read_b128 v[112:115], v174 offset:32768
v_mfma_f32_32x32x16_bf16 v[240:255], v[48:51], v[100:103], v[240:255]
s_add_u32 s60, s60, 1474560
ds_read_b64_tr_b16 v[58:59], v11 offset:12800
ds_read_b128 v[116:119], v182 offset:32768
ds_read_b128 v[160:163], v174 offset:32768
v_mfma_f32_16x16x32_bf16 v[44:47], v[20:23], v[48:51], v[44:47]
s_add_u32 m0, s59, 0
s_waitcnt lgkmcnt(6)
v_mfma_f32_32x32x16_bf16 v[224:239], v[52:55], v[104:107], v[224:239]
ds_read_b64_tr_b16 v[60:61], v12 offset:12288
ds_read_b128 v[120:123], v175 offset:32768
v_mfma_f32_32x32x16_bf16 v[240:255], v[52:55], v[108:111], v[240:255]
buffer_load_dwordx4 v3, s[12:15], s60 offen offset:0  lds
ds_read_b64_tr_b16 v[62:63], v12 offset:12800
ds_read_b128 v[124:127], v183 offset:32768
ds_read_b128 v[164:167], v175 offset:32768
s_waitcnt lgkmcnt(6)
v_mfma_f32_32x32x16_bf16 v[224:239], v[56:59], v[112:115], v[224:239]
buffer_load_dwordx4 v4, s[12:15], s60 offen offset:1024  lds
v_mfma_f32_32x32x16_bf16 v[240:255], v[56:59], v[116:119], v[240:255]
buffer_load_dwordx4 v5, s[12:15], s60 offen offset:2048  lds
v_mfma_f32_16x16x32_bf16 v[44:47], v[20:23], v[56:59], v[44:47]
buffer_load_dwordx4 v6, s[12:15], s60 offen offset:3072  lds
s_waitcnt lgkmcnt(1)
v_mfma_f32_32x32x16_bf16 v[224:239], v[60:63], v[120:123], v[224:239]
s_nop 4
ds_write_b32 v18, v44 offset:0
ds_write_b32 v18, v45 offset:64
v_mfma_f32_32x32x16_bf16 v[240:255], v[60:63], v[124:127], v[240:255]
s_waitcnt vmcnt(9) lgkmcnt(0)
s_cmp_lg_u32 s42, 0
s_cbranch_scc1 L_nc_4
v_readfirstlane_b32 s79, v13
s_nop 1
s_cmp_lg_u32 s79, 0
s_cbranch_scc1 L_nc_4
s_cmp_lg_u32 s42, 0
s_cbranch_scc1 L_ng_5_ok
s_mov_b32 s46, 0x40000
v_mov_b32 v0, 0
L_ng_5:
global_load_dword v13, v0, s[4:5] sc0 sc1
s_waitcnt vmcnt(0)
v_readfirstlane_b32 s79, v13
s_nop 1
s_cmp_lg_u32 s79, 0
s_cbranch_scc1 L_ng_5_ok
s_sleep 1
s_sub_u32 s46, s46, 1
s_cmp_lg_u32 s46, 0
s_cbranch_scc1 L_ng_5
L_ng_5_ok:
L_nc_4:
s_barrier
v_add_u32 v11, 0x4000, v11
v_add_u32 v12, 0x4000, v12
s_and_b32 s58, s41, 1
s_xor_b32 s58, s58, s44
s_lshl_b32 s57, s58, 6
v_xor_b32 v11, s57, v11
v_xor_b32 v12, s57, v12
ds_read_b64_tr_b16 v[48:49], v11 offset:0
ds_read_b64_tr_b16 v[50:51], v11 offset:512
ds_read_b64_tr_b16 v[52:53], v12 offset:0
ds_read_b64_tr_b16 v[54:55], v12 offset:512
v_dot2c_f32_bf16 v24, 0x3f803f80, v136
v_dot2c_f32_bf16 v28, v136, v136
v_dot2c_f32_bf16 v25, 0x3f803f80, v137
v_dot2c_f32_bf16 v29, v137, v137
v_dot2c_f32_bf16 v26, 0x3f803f80, v138
v_dot2c_f32_bf16 v30, v138, v138
v_dot2c_f32_bf16 v27, 0x3f803f80, v139
v_dot2c_f32_bf16 v31, v139, v139
v_dot2c_f32_bf16 v24, 0x3f803f80, v140
v_dot2c_f32_bf16 v28, v140, v140
v_dot2c_f32_bf16 v25, 0x3f803f80, v141
v_dot2c_f32_bf16 v29, v141, v141
v_dot2c_f32_bf16 v26, 0x3f803f80, v142
v_dot2c_f32_bf16 v30, v142, v142
v_dot2c_f32_bf16 v27, 0x3f803f80, v143
v_dot2c_f32_bf16 v31, v143, v143
v_dot2c_f32_bf16 v24, 0x3f803f80, v144
v_dot2c_f32_bf16 v28, v144, v144
v_dot2c_f32_bf16 v25, 0x3f803f80, v145
v_dot2c_f32_bf16 v29, v145, v145
v_dot2c_f32_bf16 v26, 0x3f803f80, v146
v_dot2c_f32_bf16 v30, v146, v146
v_dot2c_f32_bf16 v27, 0x3f803f80, v147
v_dot2c_f32_bf16 v31, v147, v147
v_dot2c_f32_bf16 v24, 0x3f803f80, v148
v_dot2c_f32_bf16 v28, v148, v148
v_dot2c_f32_bf16 v25, 0x3f803f80, v149
v_dot2c_f32_bf16 v29, v149, v149
v_dot2c_f32_bf16 v26, 0x3f803f80, v150
v_dot2c_f32_bf16 v30, v150, v150
v_dot2c_f32_bf16 v27, 0x3f803f80, v151
v_dot2c_f32_bf16 v31, v151, v151
v_dot2c_f32_bf16 v24, 0x3f803f80, v152
v_dot2c_f32_bf16 v28, v152, v152
v_dot2c_f32_bf16 v25, 0x3f803f80, v153
v_dot2c_f32_bf16 v29, v153, v153
v_dot2c_f32_bf16 v26, 0x3f803f80, v154
v_dot2c_f32_bf16 v30, v154, v154
v_dot2c_f32_bf16 v27, 0x3f803f80, v155
v_dot2c_f32_bf16 v31, v155, v155
v_dot2c_f32_bf16 v24, 0x3f803f80, v156
v_dot2c_f32_bf16 v28, v156, v156
v_dot2c_f32_bf16 v25, 0x3f803f80, v157
v_dot2c_f32_bf16 v29, v157, v157
v_dot2c_f32_bf16 v26, 0x3f803f80, v158
v_dot2c_f32_bf16 v30, v158, v158
v_dot2c_f32_bf16 v27, 0x3f803f80, v159
v_dot2c_f32_bf16 v31, v159, v159
v_dot2c_f32_bf16 v24, 0x3f803f80, v160
v_dot2c_f32_bf16 v28, v160, v160
v_dot2c_f32_bf16 v25, 0x3f803f80, v161
v_dot2c_f32_bf16 v29, v161, v161
v_dot2c_f32_bf16 v26, 0x3f803f80, v162
v_dot2c_f32_bf16 v30, v162, v162
v_dot2c_f32_bf16 v27, 0x3f803f80, v163
v_dot2c_f32_bf16 v31, v163, v163
v_dot2c_f32_bf16 v24, 0x3f803f80, v164
v_dot2c_f32_bf16 v28, v164, v164
v_dot2c_f32_bf16 v25, 0x3f803f80, v165
v_dot2c_f32_bf16 v29, v165, v165
v_dot2c_f32_bf16 v26, 0x3f803f80, v166
v_dot2c_f32_bf16 v30, v166, v166
v_dot2c_f32_bf16 v27, 0x3f803f80, v167
v_dot2c_f32_bf16 v31, v167, v167
v_add_f32 v24, v24, v25
s_nop 0
v_add_f32 v26, v26, v27
v_add_f32 v28, v28, v29
v_add_f32 v30, v30, v31
v_add_f32 v24, v24, v26
v_add_f32 v28, v28, v30
v_mov_b32 v25, v24
v_mov_b32 v29, v28
s_nop 0
v_permlane32_swap_b32 v24, v25
v_permlane32_swap_b32 v28, v29
v_add_f32 v24, v24, v25
v_add_f32 v28, v28, v29
v_mul_f32 v24, 0x3acccccd, v24
v_mul_f32 v28, 0x3acccccd, v28
v_fma_f32 v28, -v24, v24, v28
v_max_f32 v28, 0, v28
v_cvt_pk_bf16_f32 v184, -v24, -v24
v_cvt_pk_bf16_f32 v185, v28, v28
v_lshlrev_b32 v185, 16, v185
v_add_f32 v185, 0x3727c5ac, v185
v_cvt_pk_bf16_f32 v185, v185, v185
v_lshlrev_b32 v185, 16, v185
v_sqrt_f32 v185, v185
s_nop 0
v_cvt_pk_bf16_f32 v185, v185, v185
v_lshlrev_b32 v186, 16, v185
v_rcp_f32 v185, v186
v_mul_f32 v186, v186, v186
v_mov_b32 v187, 0
v_and_b32 v24, 31, v1
s_lshl_b32 s52, s42, 5
v_add_u32 v24, s52, v24
v_lshlrev_b32 v24, 4, v24
v_add_u32 v24, 147456, v24
ds_write_b128 v24, v[184:187]
s_waitcnt lgkmcnt(3)
v_mfma_f32_32x32x16_bf16 v[128:143], v[48:51], a[0:3], 0
v_mul_u32_u24 v14, 3456, v15
s_lshl_b32 s97, s67, 7
buffer_load_dword v14, v14, s[20:23], s97 offen
ds_read_b64_tr_b16 v[56:57], v11 offset:4096
ds_read_b64_tr_b16 v[58:59], v11 offset:4608
v_mfma_f32_16x16x32_bf16 v[44:47], v[20:23], v[48:51], 0
s_lshl_b32 s60, s65, 7
s_waitcnt lgkmcnt(3)
v_mfma_f32_32x32x16_bf16 v[128:143], v[52:55], a[8:11], v[128:143]
s_add_u32 s60, s60, 1966080
s_add_u32 m0, s59, 49152
ds_read_b64_tr_b16 v[60:61], v12 offset:4096
ds_read_b64_tr_b16 v[62:63], v12 offset:4608
s_waitcnt lgkmcnt(2)
v_mfma_f32_32x32x16_bf16 v[128:143], v[56:59], a[16:19], v[128:143]
buffer_load_dwordx4 v3, s[12:15], s60 offen offset:0  lds
buffer_load_dwordx4 v4, s[12:15], s60 offen offset:1024  lds
ds_read_b64_tr_b16 v[48:49], v11 offset:8192
ds_read_b64_tr_b16 v[50:51], v11 offset:8704
v_mfma_f32_16x16x32_bf16 v[44:47], v[20:23], v[56:59], v[44:47]
buffer_load_dwordx4 v5, s[12:15], s60 offen offset:2048  lds
s_waitcnt lgkmcnt(2)
v_mfma_f32_32x32x16_bf16 v[128:143], v[60:63], a[24:27], v[128:143]
buffer_load_dwordx4 v6, s[12:15], s60 offen offset:3072  lds
s_lshl_b32 s60, s66, 7
ds_read_b64_tr_b16 v[52:53], v12 offset:8192
ds_read_b64_tr_b16 v[54:55], v12 offset:8704
s_waitcnt lgkmcnt(2)
v_mfma_f32_32x32x16_bf16 v[128:143], v[48:51], a[32:35], v[128:143]
s_add_u32 s60, s60, 0
s_add_u32 m0, s59, 65536
s_nop 0
buffer_load_dwordx4 v7, s[16:19], s60 offen offset:0  lds
ds_read_b64_tr_b16 v[56:57], v11 offset:12288
ds_read_b64_tr_b16 v[58:59], v11 offset:12800
v_mfma_f32_16x16x32_bf16 v[44:47], v[20:23], v[48:51], v[44:47]
s_waitcnt lgkmcnt(2)
v_mfma_f32_32x32x16_bf16 v[128:143], v[52:55], a[40:43], v[128:143]
buffer_load_dwordx4 v8, s[16:19], s60 offen offset:1024  lds
buffer_load_dwordx4 v9, s[16:19], s60 offen offset:2048  lds
ds_read_b64_tr_b16 v[60:61], v12 offset:12288
ds_read_b64_tr_b16 v[62:63], v12 offset:12800
s_waitcnt lgkmcnt(2)
v_mfma_f32_32x32x16_bf16 v[128:143], v[56:59], a[48:51], v[128:143]
buffer_load_dwordx4 v10, s[16:19], s60 offen offset:3072  lds
v_add_u32 v11, 0x14000, v11
v_add_u32 v12, 0x14000, v12
ds_read_b64_tr_b16 v[48:49], v11 offset:0
ds_read_b64_tr_b16 v[50:51], v11 offset:512
v_mfma_f32_16x16x32_bf16 v[44:47], v[20:23], v[56:59], v[44:47]
s_waitcnt lgkmcnt(2)
v_mfma_f32_32x32x16_bf16 v[128:143], v[60:63], a[56:59], v[128:143]
ds_read_b64_tr_b16 v[52:53], v12 offset:0
ds_read_b64_tr_b16 v[54:55], v12 offset:512
s_waitcnt vmcnt(13)
s_barrier
s_waitcnt lgkmcnt(2)
v_mfma_f32_32x32x16_bf16 v[128:143], v[48:51], a[64:67], v[128:143]
s_lshl_b32 s60, s66, 7
s_add_u32 s60, s60, 442368
s_add_u32 m0, s59, 16384
ds_read_b64_tr_b16 v[56:57], v11 offset:4096
ds_read_b64_tr_b16 v[58:59], v11 offset:4608
v_mfma_f32_16x16x32_bf16 v[44:47], v[20:23], v[48:51], v[44:47]
buffer_load_dwordx4 v7, s[16:19], s60 offen offset:0  lds
s_waitcnt lgkmcnt(2)
v_mfma_f32_32x32x16_bf16 v[128:143], v[52:55], a[72:75], v[128:143]
buffer_load_dwordx4 v8, s[16:19], s60 offen offset:1024  lds
v_and_b32 v38, 31, v1
ds_read_b64_tr_b16 v[60:61], v12 offset:4096
ds_read_b64_tr_b16 v[62:63], v12 offset:4608
s_waitcnt lgkmcnt(2)
v_mfma_f32_32x32x16_bf16 v[128:143], v[56:59], a[80:83], v[128:143]
buffer_load_dwordx4 v9, s[16:19], s60 offen offset:2048  lds
buffer_load_dwordx4 v10, s[16:19], s60 offen offset:3072  lds
ds_read_b64_tr_b16 v[48:49], v11 offset:8192
ds_read_b64_tr_b16 v[50:51], v11 offset:8704
v_mfma_f32_16x16x32_bf16 v[44:47], v[20:23], v[56:59], v[44:47]
s_waitcnt lgkmcnt(2)
v_mfma_f32_32x32x16_bf16 v[128:143], v[60:63], a[88:91], v[128:143]
s_lshl_b32 s60, s66, 7
s_add_u32 s60, s60, 884736
s_add_u32 m0, s59, 81920
s_lshl_b32 s52, s42, 5
ds_read_b64_tr_b16 v[52:53], v12 offset:8192
ds_read_b64_tr_b16 v[54:55], v12 offset:8704
s_waitcnt lgkmcnt(2)
v_mfma_f32_32x32x16_bf16 v[128:143], v[48:51], a[96:99], v[128:143]
buffer_load_dwordx4 v7, s[16:19], s60 offen offset:0  lds
v_add_u32 v38, s52, v38
ds_read_b64_tr_b16 v[56:57], v11 offset:12288
ds_read_b64_tr_b16 v[58:59], v11 offset:12800
v_mfma_f32_16x16x32_bf16 v[44:47], v[20:23], v[48:51], v[44:47]
buffer_load_dwordx4 v8, s[16:19], s60 offen offset:1024  lds
s_waitcnt lgkmcnt(2)
v_mfma_f32_32x32x16_bf16 v[128:143], v[52:55], a[104:107], v[128:143]
buffer_load_dwordx4 v9, s[16:19], s60 offen offset:2048  lds
v_lshlrev_b32 v38, 4, v38
ds_read_b64_tr_b16 v[60:61], v12 offset:12288
ds_read_b64_tr_b16 v[62:63], v12 offset:12800
s_waitcnt lgkmcnt(2)
v_mfma_f32_32x32x16_bf16 v[128:143], v[56:59], a[112:115], v[128:143]
buffer_load_dwordx4 v10, s[16:19], s60 offen offset:3072  lds
v_add_u32 v11, 0x4000, v11
v_add_u32 v12, 0x4000, v12
ds_read_b64_tr_b16 v[48:49], v11 offset:0
ds_read_b64_tr_b16 v[50:51], v11 offset:512
v_mfma_f32_16x16x32_bf16 v[44:47], v[20:23], v[56:59], v[44:47]
s_waitcnt lgkmcnt(2)
v_mfma_f32_32x32x16_bf16 v[128:143], v[60:63], a[120:123], v[128:143]
v_add_u32 v38, 147456, v38
ds_read_b64_tr_b16 v[52:53], v12 offset:0
ds_read_b64_tr_b16 v[54:55], v12 offset:512
s_waitcnt vmcnt(17)
s_barrier
s_waitcnt lgkmcnt(2)
v_mfma_f32_32x32x16_bf16 v[128:143], v[48:51], a[128:131], v[128:143]
s_lshl_b32 s60, s66, 7
s_add_u32 s60, s60, 1327104
s_add_u32 m0, s59, 98304
v_xor_b32 v39, 512, v38
ds_read_b64_tr_b16 v[56:57], v11 offset:4096
ds_read_b64_tr_b16 v[58:59], v11 offset:4608
v_mfma_f32_16x16x32_bf16 v[44:47], v[20:23], v[48:51], v[44:47]
buffer_load_dwordx4 v7, s[16:19], s60 offen offset:0  lds
s_waitcnt lgkmcnt(2)
v_mfma_f32_32x32x16_bf16 v[128:143], v[52:55], a[136:139], v[128:143]
buffer_load_dwordx4 v8, s[16:19], s60 offen offset:1024  lds
ds_read_b128 v[160:163], v38
ds_read_b64_tr_b16 v[60:61], v12 offset:4096
ds_read_b64_tr_b16 v[62:63], v12 offset:4608
s_waitcnt lgkmcnt(3)
v_mfma_f32_32x32x16_bf16 v[128:143], v[56:59], a[144:147], v[128:143]
buffer_load_dwordx4 v9, s[16:19], s60 offen offset:2048  lds
buffer_load_dwordx4 v10, s[16:19], s60 offen offset:3072  lds
ds_read_b64_tr_b16 v[48:49], v11 offset:8192
ds_read_b64_tr_b16 v[50:51], v11 offset:8704
v_mfma_f32_16x16x32_bf16 v[44:47], v[20:23], v[56:59], v[44:47]
s_waitcnt lgkmcnt(2)
v_mfma_f32_32x32x16_bf16 v[128:143], v[60:63], a[152:155], v[128:143]
s_lshl_b32 s60, s66, 7
s_add_u32 s60, s60, 1769472
s_add_u32 m0, s59, 32768
ds_read_b64_tr_b16 v[52:53], v12 offset:8192
ds_read_b64_tr_b16 v[54:55], v12 offset:8704
s_waitcnt lgkmcnt(2)
v_mfma_f32_32x32x16_bf16 v[128:143], v[48:51], a[160:163], v[128:143]
buffer_load_dwordx4 v7, s[16:19], s60 offen offset:0  lds
ds_read_b128 v[164:167], v39
v_cmp_gt_u32 s[52:53], 32, v1
ds_read_b64_tr_b16 v[56:57], v11 offset:12288
ds_read_b64_tr_b16 v[58:59], v11 offset:12800
v_mfma_f32_16x16x32_bf16 v[44:47], v[20:23], v[48:51], v[44:47]
buffer_load_dwordx4 v8, s[16:19], s60 offen offset:1024  lds
s_waitcnt lgkmcnt(3)
v_mfma_f32_32x32x16_bf16 v[128:143], v[52:55], a[168:171], v[128:143]
buffer_load_dwordx4 v9, s[16:19], s60 offen offset:2048  lds
ds_read_b64_tr_b16 v[60:61], v12 offset:12288
ds_read_b64_tr_b16 v[62:63], v12 offset:12800
s_waitcnt lgkmcnt(2)
v_mfma_f32_32x32x16_bf16 v[128:143], v[56:59], a[176:179], v[128:143]
buffer_load_dwordx4 v10, s[16:19], s60 offen offset:3072  lds
v_mov_b32 v25, 0
v_add_u32 v11, 0xfffe0000, v11
v_add_u32 v12, 0xfffe0000, v12
ds_read_b64_tr_b16 v[48:49], v11 offset:0
ds_read_b64_tr_b16 v[50:51], v11 offset:512
v_mfma_f32_16x16x32_bf16 v[44:47], v[20:23], v[56:59], v[44:47]
s_waitcnt lgkmcnt(2)
v_mfma_f32_32x32x16_bf16 v[128:143], v[60:63], a[184:187], v[128:143]
v_mov_b32 v27, 0
ds_read_b64_tr_b16 v[52:53], v12 offset:0
ds_read_b64_tr_b16 v[54:55], v12 offset:512
s_waitcnt vmcnt(20)
s_barrier
s_waitcnt lgkmcnt(2)
v_mfma_f32_32x32x16_bf16 v[128:143], v[48:51], a[192:195], v[128:143]
v_mov_b32 v29, 0
v_cndmask_b32_e64 v26, 0, v160, s[52:53]
ds_read_b64_tr_b16 v[56:57], v11 offset:4096
ds_read_b64_tr_b16 v[58:59], v11 offset:4608
v_mfma_f32_16x16x32_bf16 v[44:47], v[20:23], v[48:51], v[44:47]
s_waitcnt lgkmcnt(2)
v_mfma_f32_32x32x16_bf16 v[128:143], v[52:55], a[200:203], v[128:143]
v_mov_b32 v30, v161
v_mul_f32 v32, 0xc0135761, v161
ds_read_b64_tr_b16 v[60:61], v12 offset:4096
ds_read_b64_tr_b16 v[62:63], v12 offset:4608
s_waitcnt lgkmcnt(2)
v_mfma_f32_32x32x16_bf16 v[128:143], v[56:59], a[208:211], v[128:143]
v_mul_f32 v33, v161, v161
v_mul_f32 v33, v33, v161
v_mul_f32 v33, 0xbdd2d3e8, v33
ds_read_b64_tr_b16 v[48:49], v11 offset:8192
ds_read_b64_tr_b16 v[50:51], v11 offset:8704
v_mfma_f32_16x16x32_bf16 v[44:47], v[20:23], v[56:59], v[44:47]
v_mov_b32 v34, v162
s_waitcnt lgkmcnt(2)
v_mfma_f32_32x32x16_bf16 v[128:143], v[60:63], a[216:219], v[128:143]
v_cndmask_b32_e64 v28, 0, v164, s[52:53]
v_mov_b32 v31, v165
ds_read_b64_tr_b16 v[52:53], v12 offset:8192
ds_read_b64_tr_b16 v[54:55], v12 offset:8704
s_waitcnt lgkmcnt(2)
v_mfma_f32_32x32x16_bf16 v[128:143], v[48:51], a[224:227], v[128:143]
v_mul_f32 v35, 0xc0135761, v165
v_mul_f32 v36, v165, v165
ds_read_b64_tr_b16 v[56:57], v11 offset:12288
ds_read_b64_tr_b16 v[58:59], v11 offset:12800
v_mfma_f32_16x16x32_bf16 v[44:47], v[20:23], v[48:51], v[44:47]
v_mul_f32 v36, v36, v165
s_waitcnt lgkmcnt(2)
v_mfma_f32_32x32x16_bf16 v[128:143], v[52:55], a[232:235], v[128:143]
v_mul_f32 v36, 0xbdd2d3e8, v36
v_mov_b32 v37, v166
ds_read_b64_tr_b16 v[60:61], v12 offset:12288
ds_read_b64_tr_b16 v[62:63], v12 offset:12800
s_waitcnt lgkmcnt(2)
v_mfma_f32_32x32x16_bf16 v[128:143], v[56:59], a[240:243], v[128:143]
ds_read_b32 v38, v19 offset:0
ds_read_b32 v39, v19 offset:128
v_add_u32 v11, 0xc000, v11
v_add_u32 v12, 0xc000, v12
ds_read_b64_tr_b16 v[48:49], v11 offset:0
ds_read_b64_tr_b16 v[50:51], v11 offset:512
v_mfma_f32_16x16x32_bf16 v[44:47], v[20:23], v[56:59], v[44:47]
s_waitcnt lgkmcnt(4)
v_mfma_f32_32x32x16_bf16 v[128:143], v[60:63], a[248:251], v[128:143]
s_waitcnt lgkmcnt(2)
ds_read_b64_tr_b16 v[52:53], v12 offset:0
ds_read_b64_tr_b16 v[54:55], v12 offset:512
s_waitcnt vmcnt(16)
s_barrier
s_waitcnt lgkmcnt(2)
v_mfma_f32_32x32x16_bf16 v[128:143], v[48:51], v[64:67], v[128:143]
s_lshl_b32 s60, s67, 7
s_add_u32 s60, s60, 0
v_add_f32 v38, v38, v39
ds_read_b64_tr_b16 v[56:57], v11 offset:4096
ds_read_b64_tr_b16 v[58:59], v11 offset:4608
v_mfma_f32_16x16x32_bf16 v[44:47], v[20:23], v[48:51], v[44:47]
v_cvt_pk_bf16_f32 v39, v38, v38
s_waitcnt lgkmcnt(2)
v_mfma_f32_32x32x16_bf16 v[128:143], v[52:55], v[72:75], v[128:143]
s_add_u32 m0, s59, 0
v_lshlrev_b32 v39, 16, v39
ds_read_b64_tr_b16 v[60:61], v12 offset:4096
ds_read_b64_tr_b16 v[62:63], v12 offset:4608
s_waitcnt lgkmcnt(2)
v_mfma_f32_32x32x16_bf16 v[128:143], v[56:59], v[80:83], v[128:143]
buffer_load_dwordx4 v7, s[20:23], s60 offen offset:0  lds
v_sub_f32 v39, v38, v39
v_cvt_pk_bf16_f32 v24, v38, v39
ds_read_b64_tr_b16 v[48:49], v11 offset:8192
ds_read_b64_tr_b16 v[50:51], v11 offset:8704
v_mfma_f32_16x16x32_bf16 v[44:47], v[20:23], v[56:59], v[44:47]
s_waitcnt lgkmcnt(2)
v_mfma_f32_32x32x16_bf16 v[128:143], v[60:63], v[88:91], v[128:143]
buffer_load_dwordx4 v8, s[20:23], s60 offen offset:1024  lds
v_mfma_f32_32x32x8bf16_1k v[224:239], v[24:25], v[26:27], v[224:239]
ds_read_b64_tr_b16 v[52:53], v12 offset:8192
ds_read_b64_tr_b16 v[54:55], v12 offset:8704
s_waitcnt lgkmcnt(2)
v_mfma_f32_32x32x16_bf16 v[128:143], v[48:51], v[96:99], v[128:143]
buffer_load_dwordx4 v9, s[20:23], s60 offen offset:2048  lds
ds_read_b64_tr_b16 v[56:57], v11 offset:12288
ds_read_b64_tr_b16 v[58:59], v11 offset:12800
v_mfma_f32_16x16x32_bf16 v[44:47], v[20:23], v[48:51], v[44:47]
v_mfma_f32_32x32x8bf16_1k v[240:255], v[24:25], v[28:29], v[240:255]
s_waitcnt lgkmcnt(2)
v_mfma_f32_32x32x16_bf16 v[128:143], v[52:55], v[104:107], v[128:143]
buffer_load_dwordx4 v10, s[20:23], s60 offen offset:3072  lds
ds_read_b64_tr_b16 v[60:61], v12 offset:12288
ds_read_b64_tr_b16 v[62:63], v12 offset:12800
s_waitcnt lgkmcnt(2)
v_mfma_f32_32x32x16_bf16 v[128:143], v[56:59], v[112:115], v[128:143]
v_add_u32 v11, 0x4000, v11
v_add_u32 v12, 0x4000, v12
v_xor_b32 v11, s57, v11
v_xor_b32 v12, s57, v12
ds_read_b64_tr_b16 v[48:49], v11 offset:0
ds_read_b64_tr_b16 v[50:51], v11 offset:512
v_mfma_f32_16x16x32_bf16 v[44:47], v[20:23], v[56:59], v[44:47]
s_waitcnt lgkmcnt(2)
v_mfma_f32_32x32x16_bf16 v[128:143], v[60:63], v[120:123], v[128:143]
ds_read_b64_tr_b16 v[52:53], v12 offset:0
ds_read_b64_tr_b16 v[54:55], v12 offset:512
s_nop 3
ds_write_b32 v18, v44 offset:512
ds_write_b32 v18, v45 offset:576
s_waitcnt vmcnt(16) lgkmcnt(0)
s_barrier
v_mfma_f32_32x32x16_bf16 v[160:175], v[48:51], a[0:3], 0
v_mul_u32_u24 v14, 3456, v15
ds_read_b64_tr_b16 v[56:57], v11 offset:4096
v_mfma_f32_16x16x32_bf16 v[44:47], v[20:23], v[48:51], 0
s_lshl_b32 s97, s68, 7
v_mfma_f32_32x32x16_bf16 v[176:191], v[48:51], a[4:7], 0
s_cmp_lt_u32 s64, 10
s_cselect_b32 s63, 0x3ea52b5c, 1.0
ds_read_b64_tr_b16 v[58:59], v11 offset:4608
v_mfma_f32_32x32x16_bf16 v[160:175], v[52:55], a[8:11], v[160:175]
buffer_load_dword v14, v14, s[16:19], s97 offen
s_lshl_b32 s52, s64, 12
ds_read_b64_tr_b16 v[60:61], v12 offset:4096
v_mfma_f32_32x32x16_bf16 v[176:191], v[52:55], a[12:15], v[176:191]
s_lshl_b32 s53, s44, 11
ds_read_b64_tr_b16 v[62:63], v12 offset:4608
s_waitcnt lgkmcnt(2)
v_mfma_f32_32x32x16_bf16 v[160:175], v[56:59], a[16:19], v[160:175]
s_lshl_b32 s60, s67, 7
s_add_u32 s52, s52, s53
s_mul_i32 s53, s55, 122880
ds_read_b64_tr_b16 v[48:49], v11 offset:8192
v_mfma_f32_16x16x32_bf16 v[44:47], v[20:23], v[56:59], v[44:47]
s_add_u32 s60, s60, 442368
v_mfma_f32_32x32x16_bf16 v[176:191], v[56:59], a[20:23], v[176:191]
s_add_u32 m0, s59, 49152
s_add_u32 s61, s52, s53
ds_read_b64_tr_b16 v[50:51], v11 offset:8704
s_waitcnt lgkmcnt(2)
v_mfma_f32_32x32x16_bf16 v[160:175], v[60:63], a[24:27], v[160:175]
s_mul_i32 s53, s56, 122880
s_add_u32 s62, s52, s53
ds_read_b64_tr_b16 v[52:53], v12 offset:8192
v_mfma_f32_32x32x16_bf16 v[176:191], v[60:63], a[28:31], v[176:191]
buffer_load_dwordx4 v7, s[20:23], s60 offen offset:0  lds
v_mul_f32 v40, s63, v30
ds_read_b64_tr_b16 v[54:55], v12 offset:8704
s_waitcnt lgkmcnt(2)
v_mfma_f32_32x32x16_bf16 v[160:175], v[48:51], a[32:35], v[160:175]
v_mul_f32 v41, s63, v31
v_mul_f32 v224, v224, v40
ds_read_b64_tr_b16 v[56:57], v11 offset:12288
v_mfma_f32_16x16x32_bf16 v[44:47], v[20:23], v[48:51], v[44:47]
buffer_load_dwordx4 v8, s[20:23], s60 offen offset:1024  lds
v_mfma_f32_32x32x16_bf16 v[176:191], v[48:51], a[36:39], v[176:191]
v_mul_f32 v225, v225, v40
ds_read_b64_tr_b16 v[58:59], v11 offset:12800
s_waitcnt lgkmcnt(2)
v_mfma_f32_32x32x16_bf16 v[160:175], v[52:55], a[40:43], v[160:175]
buffer_load_dwordx4 v9, s[20:23], s60 offen offset:2048  lds
v_cvt_pk_bf16_f32 v224, v224, v225
v_mul_f32 v226, v226, v40
ds_read_b64_tr_b16 v[60:61], v12 offset:12288
v_mfma_f32_32x32x16_bf16 v[176:191], v[52:55], a[44:47], v[176:191]
v_mul_f32 v227, v227, v40
ds_read_b64_tr_b16 v[62:63], v12 offset:12800
s_waitcnt lgkmcnt(2)
v_mfma_f32_32x32x16_bf16 v[160:175], v[56:59], a[48:51], v[160:175]
v_cvt_pk_bf16_f32 v225, v226, v227
v_add_u32 v11, 0xffff4000, v11
v_add_u32 v12, 0xffff4000, v12
ds_read_b64_tr_b16 v[48:49], v11 offset:0
v_mfma_f32_16x16x32_bf16 v[44:47], v[20:23], v[56:59], v[44:47]
buffer_load_dwordx4 v10, s[20:23], s60 offen offset:3072  lds
v_mfma_f32_32x32x16_bf16 v[176:191], v[56:59], a[52:55], v[176:191]
v_mul_f32 v228, v228, v40
v_mul_f32 v229, v229, v40
ds_read_b64_tr_b16 v[50:51], v11 offset:512
s_waitcnt lgkmcnt(2)
v_mfma_f32_32x32x16_bf16 v[160:175], v[60:63], a[56:59], v[160:175]
v_cvt_pk_bf16_f32 v226, v228, v229
v_mul_f32 v230, v230, v40
ds_read_b64_tr_b16 v[52:53], v12 offset:0
v_mfma_f32_32x32x16_bf16 v[176:191], v[60:63], a[60:63], v[176:191]
ds_read_b64_tr_b16 v[54:55], v12 offset:512
s_waitcnt vmcnt(17)
s_barrier
s_waitcnt lgkmcnt(2)
v_mfma_f32_32x32x16_bf16 v[160:175], v[48:51], a[64:67], v[160:175]
s_lshl_b32 s60, s67, 7
v_mul_f32 v231, v231, v40
v_cvt_pk_bf16_f32 v227, v230, v231
ds_read_b64_tr_b16 v[56:57], v11 offset:4096
v_mfma_f32_16x16x32_bf16 v[44:47], v[20:23], v[48:51], v[44:47]
v_mul_f32 v232, v232, v40
v_mfma_f32_32x32x16_bf16 v[176:191], v[48:51], a[68:71], v[176:191]
s_add_u32 s60, s60, 884736
v_mul_f32 v233, v233, v40
ds_read_b64_tr_b16 v[58:59], v11 offset:4608
s_waitcnt lgkmcnt(2)
v_mfma_f32_32x32x16_bf16 v[160:175], v[52:55], a[72:75], v[160:175]
s_add_u32 m0, s59, 65536
v_cvt_pk_bf16_f32 v228, v232, v233
ds_read_b64_tr_b16 v[60:61], v12 offset:4096
v_mfma_f32_32x32x16_bf16 v[176:191], v[52:55], a[76:79], v[176:191]
v_mul_f32 v234, v234, v40
v_mul_f32 v235, v235, v40
ds_read_b64_tr_b16 v[62:63], v12 offset:4608
s_waitcnt lgkmcnt(2)
v_mfma_f32_32x32x16_bf16 v[160:175], v[56:59], a[80:83], v[160:175]
v_cvt_pk_bf16_f32 v229, v234, v235
v_mul_f32 v236, v236, v40
ds_read_b64_tr_b16 v[48:49], v11 offset:8192
v_mfma_f32_16x16x32_bf16 v[44:47], v[20:23], v[56:59], v[44:47]
buffer_load_dwordx4 v7, s[20:23], s60 offen offset:0  lds
v_mfma_f32_32x32x16_bf16 v[176:191], v[56:59], a[84:87], v[176:191]
v_mul_f32 v237, v237, v40
ds_read_b64_tr_b16 v[50:51], v11 offset:8704
s_waitcnt lgkmcnt(2)
v_mfma_f32_32x32x16_bf16 v[160:175], v[60:63], a[88:91], v[160:175]
v_cvt_pk_bf16_f32 v230, v236, v237
v_mul_f32 v238, v238, v40
ds_read_b64_tr_b16 v[52:53], v12 offset:8192
v_mfma_f32_32x32x16_bf16 v[176:191], v[60:63], a[92:95], v[176:191]
buffer_load_dwordx4 v8, s[20:23], s60 offen offset:1024  lds
v_mul_f32 v239, v239, v40
ds_read_b64_tr_b16 v[54:55], v12 offset:8704
s_waitcnt lgkmcnt(2)
v_mfma_f32_32x32x16_bf16 v[160:175], v[48:51], a[96:99], v[160:175]
v_cvt_pk_bf16_f32 v231, v238, v239
buffer_store_dwordx4 v[224:227], v16, s[24:27], s61 offen sc1
ds_read_b64_tr_b16 v[56:57], v11 offset:12288
v_mfma_f32_16x16x32_bf16 v[44:47], v[20:23], v[48:51], v[44:47]
v_mfma_f32_32x32x16_bf16 v[176:191], v[48:51], a[100:103], v[176:191]
buffer_load_dwordx4 v9, s[20:23], s60 offen offset:2048  lds
ds_read_b64_tr_b16 v[58:59], v11 offset:12800
s_waitcnt lgkmcnt(2)
v_mfma_f32_32x32x16_bf16 v[160:175], v[52:55], a[104:107], v[160:175]
buffer_store_dwordx4 v[228:231], v16, s[24:27], s61 offen offset:1024 sc1
v_mul_f32 v240, v240, v41
ds_read_b64_tr_b16 v[60:61], v12 offset:12288
v_mfma_f32_32x32x16_bf16 v[176:191], v[52:55], a[108:111], v[176:191]
v_mul_f32 v241, v241, v41
ds_read_b64_tr_b16 v[62:63], v12 offset:12800
s_waitcnt lgkmcnt(2)
v_mfma_f32_32x32x16_bf16 v[160:175], v[56:59], a[112:115], v[160:175]
buffer_load_dwordx4 v10, s[20:23], s60 offen offset:3072  lds
v_add_u32 v11, 0x10000, v11
v_add_u32 v12, 0x10000, v12
ds_read_b64_tr_b16 v[48:49], v11 offset:0
v_mfma_f32_16x16x32_bf16 v[44:47], v[20:23], v[56:59], v[44:47]
v_cvt_pk_bf16_f32 v240, v240, v241
v_mfma_f32_32x32x16_bf16 v[176:191], v[56:59], a[116:119], v[176:191]
v_mul_f32 v242, v242, v41
v_mul_f32 v243, v243, v41
ds_read_b64_tr_b16 v[50:51], v11 offset:512
s_waitcnt lgkmcnt(2)
v_mfma_f32_32x32x16_bf16 v[160:175], v[60:63], a[120:123], v[160:175]
v_cvt_pk_bf16_f32 v241, v242, v243
v_mul_f32 v244, v244, v41
ds_read_b64_tr_b16 v[52:53], v12 offset:0
v_mfma_f32_32x32x16_bf16 v[176:191], v[60:63], a[124:127], v[176:191]
ds_read_b64_tr_b16 v[54:55], v12 offset:512
s_waitcnt vmcnt(19)
s_barrier
s_waitcnt lgkmcnt(2)
v_mfma_f32_32x32x16_bf16 v[160:175], v[48:51], a[128:131], v[160:175]
s_lshl_b32 s60, s67, 7
v_mul_f32 v245, v245, v41
v_cvt_pk_bf16_f32 v242, v244, v245
ds_read_b64_tr_b16 v[56:57], v11 offset:4096
v_mfma_f32_16x16x32_bf16 v[44:47], v[20:23], v[48:51], v[44:47]
v_mul_f32 v246, v246, v41
v_mfma_f32_32x32x16_bf16 v[176:191], v[48:51], a[132:135], v[176:191]
s_add_u32 s60, s60, 1327104
v_mul_f32 v247, v247, v41
ds_read_b64_tr_b16 v[58:59], v11 offset:4608
s_waitcnt lgkmcnt(2)
v_mfma_f32_32x32x16_bf16 v[160:175], v[52:55], a[136:139], v[160:175]
s_add_u32 m0, s59, 16384
v_cvt_pk_bf16_f32 v243, v246, v247
ds_read_b64_tr_b16 v[60:61], v12 offset:4096
v_mfma_f32_32x32x16_bf16 v[176:191], v[52:55], a[140:143], v[176:191]
v_mul_f32 v248, v248, v41
v_mul_f32 v249, v249, v41
ds_read_b64_tr_b16 v[62:63], v12 offset:4608
s_waitcnt lgkmcnt(2)
v_mfma_f32_32x32x16_bf16 v[160:175], v[56:59], a[144:147], v[160:175]
v_cvt_pk_bf16_f32 v244, v248, v249
v_mul_f32 v250, v250, v41
ds_read_b64_tr_b16 v[48:49], v11 offset:8192
v_mfma_f32_16x16x32_bf16 v[44:47], v[20:23], v[56:59], v[44:47]
buffer_load_dwordx4 v7, s[20:23], s60 offen offset:0  lds
v_mfma_f32_32x32x16_bf16 v[176:191], v[56:59], a[148:151], v[176:191]
v_mul_f32 v251, v251, v41
ds_read_b64_tr_b16 v[50:51], v11 offset:8704
s_waitcnt lgkmcnt(2)
v_mfma_f32_32x32x16_bf16 v[160:175], v[60:63], a[152:155], v[160:175]
v_cvt_pk_bf16_f32 v245, v250, v251
v_mul_f32 v252, v252, v41
ds_read_b64_tr_b16 v[52:53], v12 offset:8192
v_mfma_f32_32x32x16_bf16 v[176:191], v[60:63], a[156:159], v[176:191]
buffer_load_dwordx4 v8, s[20:23], s60 offen offset:1024  lds
v_mul_f32 v253, v253, v41
ds_read_b64_tr_b16 v[54:55], v12 offset:8704
s_waitcnt lgkmcnt(2)
v_mfma_f32_32x32x16_bf16 v[160:175], v[48:51], a[160:163], v[160:175]
v_cvt_pk_bf16_f32 v246, v252, v253
v_mul_f32 v254, v254, v41
ds_read_b64_tr_b16 v[56:57], v11 offset:12288
v_mfma_f32_16x16x32_bf16 v[44:47], v[20:23], v[48:51], v[44:47]
v_mul_f32 v255, v255, v41
v_mfma_f32_32x32x16_bf16 v[176:191], v[48:51], a[164:167], v[176:191]
buffer_load_dwordx4 v9, s[20:23], s60 offen offset:2048  lds
v_cvt_pk_bf16_f32 v247, v254, v255
ds_read_b64_tr_b16 v[58:59], v11 offset:12800
s_waitcnt lgkmcnt(2)
v_mfma_f32_32x32x16_bf16 v[160:175], v[52:55], a[168:171], v[160:175]
buffer_store_dwordx4 v[240:243], v16, s[24:27], s62 offen sc1
ds_read_b64_tr_b16 v[60:61], v12 offset:12288
v_mfma_f32_32x32x16_bf16 v[176:191], v[52:55], a[172:175], v[176:191]
ds_read_b64_tr_b16 v[62:63], v12 offset:12800
s_waitcnt lgkmcnt(2)
v_mfma_f32_32x32x16_bf16 v[160:175], v[56:59], a[176:179], v[160:175]
buffer_load_dwordx4 v10, s[20:23], s60 offen offset:3072  lds
buffer_store_dwordx4 v[244:247], v16, s[24:27], s62 offen offset:1024 sc1
v_add_u32 v11, 0x4000, v11
v_add_u32 v12, 0x4000, v12
ds_read_b64_tr_b16 v[48:49], v11 offset:0
v_mfma_f32_16x16x32_bf16 v[44:47], v[20:23], v[56:59], v[44:47]
v_mfma_f32_32x32x16_bf16 v[176:191], v[56:59], a[180:183], v[176:191]
ds_read_b32 v38, v19 offset:512
ds_read_b32 v39, v19 offset:640
ds_read_b64_tr_b16 v[50:51], v11 offset:512
s_waitcnt lgkmcnt(4)
v_mfma_f32_32x32x16_bf16 v[160:175], v[60:63], a[184:187], v[160:175]
s_waitcnt lgkmcnt(1)
v_add_f32 v38, v38, v39
ds_read_b64_tr_b16 v[52:53], v12 offset:0
v_mfma_f32_32x32x16_bf16 v[176:191], v[60:63], a[188:191], v[176:191]
ds_read_b64_tr_b16 v[54:55], v12 offset:512
s_waitcnt vmcnt(21)
s_barrier
s_waitcnt lgkmcnt(2)
v_mfma_f32_32x32x16_bf16 v[160:175], v[48:51], a[192:195], v[160:175]
s_lshl_b32 s60, s67, 7
v_cvt_pk_bf16_f32 v39, v38, v38
v_lshlrev_b32 v39, 16, v39
ds_read_b64_tr_b16 v[56:57], v11 offset:4096
v_mfma_f32_16x16x32_bf16 v[44:47], v[20:23], v[48:51], v[44:47]
v_sub_f32 v39, v38, v39
v_mfma_f32_32x32x16_bf16 v[176:191], v[48:51], a[196:199], v[176:191]
s_add_u32 s60, s60, 1769472
v_cvt_pk_bf16_f32 v24, v38, v39
ds_read_b64_tr_b16 v[58:59], v11 offset:4608
s_waitcnt lgkmcnt(2)
v_mfma_f32_32x32x16_bf16 v[160:175], v[52:55], a[200:203], v[160:175]
s_add_u32 m0, s59, 81920
v_mfma_f32_32x32x8bf16_1k v[128:143], v[24:25], v[26:27], v[128:143]
ds_read_b64_tr_b16 v[60:61], v12 offset:4096
v_mfma_f32_32x32x16_bf16 v[176:191], v[52:55], a[204:207], v[176:191]
s_cmp_lt_u32 s65, 10
s_cselect_b32 s63, 0x3ea52b5c, 1.0
ds_read_b64_tr_b16 v[62:63], v12 offset:4608
s_waitcnt lgkmcnt(2)
v_mfma_f32_32x32x16_bf16 v[160:175], v[56:59], a[208:211], v[160:175]
s_lshl_b32 s52, s65, 12
ds_read_b64_tr_b16 v[48:49], v11 offset:8192
v_mfma_f32_16x16x32_bf16 v[44:47], v[20:23], v[56:59], v[44:47]
buffer_load_dwordx4 v7, s[20:23], s60 offen offset:0  lds
v_mfma_f32_32x32x16_bf16 v[176:191], v[56:59], a[212:215], v[176:191]
s_and_b32 s53, s41, 1
ds_read_b64_tr_b16 v[50:51], v11 offset:8704
s_waitcnt lgkmcnt(2)
v_mfma_f32_32x32x16_bf16 v[160:175], v[60:63], a[216:219], v[160:175]
s_lshl_b32 s53, s53, 11
s_add_u32 s52, s52, s53
ds_read_b64_tr_b16 v[52:53], v12 offset:8192
v_mfma_f32_32x32x16_bf16 v[176:191], v[60:63], a[220:223], v[176:191]
buffer_load_dwordx4 v8, s[20:23], s60 offen offset:1024  lds
s_mul_i32 s53, s55, 122880
ds_read_b64_tr_b16 v[54:55], v12 offset:8704
s_waitcnt lgkmcnt(2)
v_mfma_f32_32x32x16_bf16 v[160:175], v[48:51], a[224:227], v[160:175]
s_add_u32 s61, s52, s53
s_mul_i32 s53, s56, 122880
ds_read_b64_tr_b16 v[56:57], v11 offset:12288
v_mfma_f32_16x16x32_bf16 v[44:47], v[20:23], v[48:51], v[44:47]
s_add_u32 s62, s52, s53
v_mfma_f32_32x32x16_bf16 v[176:191], v[48:51], a[228:231], v[176:191]
buffer_load_dwordx4 v9, s[20:23], s60 offen offset:2048  lds
ds_read_b64_tr_b16 v[58:59], v11 offset:12800
s_waitcnt lgkmcnt(2)
v_mfma_f32_32x32x16_bf16 v[160:175], v[52:55], a[232:235], v[160:175]
v_mul_f32 v40, s63, v30
v_mul_f32 v41, s63, v31
ds_read_b64_tr_b16 v[60:61], v12 offset:12288
v_mfma_f32_32x32x16_bf16 v[176:191], v[52:55], a[236:239], v[176:191]
v_mul_f32 v128, v128, v40
v_mul_f32 v129, v129, v40
ds_read_b64_tr_b16 v[62:63], v12 offset:12800
s_waitcnt lgkmcnt(2)
v_mfma_f32_32x32x16_bf16 v[160:175], v[56:59], a[240:243], v[160:175]
buffer_load_dwordx4 v10, s[20:23], s60 offen offset:3072  lds
v_add_u32 v11, 0xffff0000, v11
v_add_u32 v12, 0xffff0000, v12
ds_read_b64_tr_b16 v[48:49], v11 offset:0
v_mfma_f32_16x16x32_bf16 v[44:47], v[20:23], v[56:59], v[44:47]
v_cvt_pk_bf16_f32 v128, v128, v129
v_mfma_f32_32x32x16_bf16 v[176:191], v[56:59], a[244:247], v[176:191]
v_mul_f32 v130, v130, v40
v_mul_f32 v131, v131, v40
ds_read_b64_tr_b16 v[50:51], v11 offset:512
s_waitcnt lgkmcnt(2)
v_mfma_f32_32x32x16_bf16 v[160:175], v[60:63], a[248:251], v[160:175]
v_cvt_pk_bf16_f32 v129, v130, v131
v_mul_f32 v132, v132, v40
ds_read_b64_tr_b16 v[52:53], v12 offset:0
v_mfma_f32_32x32x16_bf16 v[176:191], v[60:63], a[252:255], v[176:191]
ds_read_b64_tr_b16 v[54:55], v12 offset:512
s_waitcnt vmcnt(21)
s_barrier
s_waitcnt lgkmcnt(2)
v_mfma_f32_32x32x16_bf16 v[160:175], v[48:51], v[64:67], v[160:175]
s_lshl_b32 s60, s68, 7
v_mul_f32 v133, v133, v40
v_cvt_pk_bf16_f32 v130, v132, v133
ds_read_b64_tr_b16 v[56:57], v11 offset:4096
v_mfma_f32_16x16x32_bf16 v[44:47], v[20:23], v[48:51], v[44:47]
v_mul_f32 v134, v134, v40
v_mfma_f32_32x32x16_bf16 v[176:191], v[48:51], v[68:71], v[176:191]
s_add_u32 s60, s60, 0
v_mul_f32 v135, v135, v40
ds_read_b64_tr_b16 v[58:59], v11 offset:4608
s_waitcnt lgkmcnt(2)
v_mfma_f32_32x32x16_bf16 v[160:175], v[52:55], v[72:75], v[160:175]
s_add_u32 m0, s59, 98304
v_cvt_pk_bf16_f32 v131, v134, v135
ds_read_b64_tr_b16 v[60:61], v12 offset:4096
v_mfma_f32_32x32x16_bf16 v[176:191], v[52:55], v[76:79], v[176:191]
v_mul_f32 v136, v136, v40
v_mul_f32 v137, v137, v40
ds_read_b64_tr_b16 v[62:63], v12 offset:4608
s_waitcnt lgkmcnt(2)
v_mfma_f32_32x32x16_bf16 v[160:175], v[56:59], v[80:83], v[160:175]
v_cvt_pk_bf16_f32 v132, v136, v137
v_mul_f32 v138, v138, v40
ds_read_b64_tr_b16 v[48:49], v11 offset:8192
v_mfma_f32_16x16x32_bf16 v[44:47], v[20:23], v[56:59], v[44:47]
buffer_load_dwordx4 v7, s[16:19], s60 offen offset:0  lds
v_mfma_f32_32x32x16_bf16 v[176:191], v[56:59], v[84:87], v[176:191]
v_mul_f32 v139, v139, v40
ds_read_b64_tr_b16 v[50:51], v11 offset:8704
s_waitcnt lgkmcnt(2)
v_mfma_f32_32x32x16_bf16 v[160:175], v[60:63], v[88:91], v[160:175]
v_cvt_pk_bf16_f32 v133, v138, v139
v_mul_f32 v140, v140, v40
ds_read_b64_tr_b16 v[52:53], v12 offset:8192
v_mfma_f32_32x32x16_bf16 v[176:191], v[60:63], v[92:95], v[176:191]
buffer_load_dwordx4 v8, s[16:19], s60 offen offset:1024  lds
v_mul_f32 v141, v141, v40
ds_read_b64_tr_b16 v[54:55], v12 offset:8704
s_waitcnt lgkmcnt(2)
v_mfma_f32_32x32x16_bf16 v[160:175], v[48:51], v[96:99], v[160:175]
v_cvt_pk_bf16_f32 v134, v140, v141
v_mul_f32 v142, v142, v40
ds_read_b64_tr_b16 v[56:57], v11 offset:12288
v_mfma_f32_16x16x32_bf16 v[44:47], v[20:23], v[48:51], v[44:47]
v_mul_f32 v143, v143, v40
v_mfma_f32_32x32x16_bf16 v[176:191], v[48:51], v[100:103], v[176:191]
buffer_load_dwordx4 v9, s[16:19], s60 offen offset:2048  lds
ds_read_b64_tr_b16 v[58:59], v11 offset:12800
s_waitcnt lgkmcnt(2)
v_mfma_f32_32x32x16_bf16 v[160:175], v[52:55], v[104:107], v[160:175]
v_cvt_pk_bf16_f32 v135, v142, v143
buffer_store_dwordx4 v[128:131], v16, s[24:27], s61 offen sc1
ds_read_b64_tr_b16 v[60:61], v12 offset:12288
v_mfma_f32_32x32x16_bf16 v[176:191], v[52:55], v[108:111], v[176:191]
ds_read_b64_tr_b16 v[62:63], v12 offset:12800
s_waitcnt lgkmcnt(2)
v_mfma_f32_32x32x16_bf16 v[160:175], v[56:59], v[112:115], v[160:175]
buffer_load_dwordx4 v10, s[16:19], s60 offen offset:3072  lds
buffer_store_dwordx4 v[132:135], v16, s[24:27], s61 offen offset:1024 sc1
v_add_u32 v11, 0xffff8000, v11
v_add_u32 v12, 0xffff8000, v12
ds_read_b64_tr_b16 v[48:49], v11 offset:0
v_mfma_f32_16x16x32_bf16 v[44:47], v[20:23], v[56:59], v[44:47]
v_mfma_f32_32x32x16_bf16 v[176:191], v[56:59], v[116:119], v[176:191]
ds_read_b64_tr_b16 v[50:51], v11 offset:512
s_waitcnt lgkmcnt(2)
v_mfma_f32_32x32x16_bf16 v[160:175], v[60:63], v[120:123], v[160:175]
ds_read_b64_tr_b16 v[52:53], v12 offset:0
s_nop 2
ds_write_b32 v18, v44 offset:0
ds_write_b32 v18, v45 offset:64
v_mfma_f32_32x32x16_bf16 v[176:191], v[60:63], v[124:127], v[176:191]
ds_read_b64_tr_b16 v[54:55], v12 offset:512
s_waitcnt vmcnt(22) lgkmcnt(1)
s_barrier
v_mfma_f32_32x32x16_bf16 v[128:143], v[48:51], a[0:3], 0
v_mul_u32_u24 v14, 3456, v15
ds_read_b64_tr_b16 v[56:57], v11 offset:4096
v_mfma_f32_16x16x32_bf16 v[44:47], v[20:23], v[48:51], 0
s_lshl_b32 s97, s69, 7
v_mfma_f32_32x32x16_bf16 v[144:159], v[48:51], a[4:7], 0
ds_read_b64_tr_b16 v[58:59], v11 offset:4608
s_waitcnt lgkmcnt(2)
v_mfma_f32_32x32x16_bf16 v[128:143], v[52:55], a[8:11], v[128:143]
buffer_load_dword v14, v14, s[20:23], s97 offen
ds_read_b64_tr_b16 v[60:61], v12 offset:4096
v_mfma_f32_32x32x16_bf16 v[144:159], v[52:55], a[12:15], v[144:159]
ds_read_b64_tr_b16 v[62:63], v12 offset:4608
s_waitcnt lgkmcnt(2)
v_mfma_f32_32x32x16_bf16 v[128:143], v[56:59], a[16:19], v[128:143]
s_lshl_b32 s60, s68, 7
ds_read_b32 v38, v19 offset:0
ds_read_b64_tr_b16 v[48:49], v11 offset:8192
v_mfma_f32_16x16x32_bf16 v[44:47], v[20:23], v[56:59], v[44:47]
s_add_u32 s60, s60, 442368
v_mfma_f32_32x32x16_bf16 v[144:159], v[56:59], a[20:23], v[144:159]
s_add_u32 m0, s59, 32768
ds_read_b64_tr_b16 v[50:51], v11 offset:8704
s_waitcnt lgkmcnt(3)
v_mfma_f32_32x32x16_bf16 v[128:143], v[60:63], a[24:27], v[128:143]
ds_read_b64_tr_b16 v[52:53], v12 offset:8192
v_mfma_f32_32x32x16_bf16 v[144:159], v[60:63], a[28:31], v[144:159]
buffer_load_dwordx4 v7, s[16:19], s60 offen offset:0  lds
ds_read_b64_tr_b16 v[54:55], v12 offset:8704
s_waitcnt lgkmcnt(2)
v_mfma_f32_32x32x16_bf16 v[128:143], v[48:51], a[32:35], v[128:143]
ds_read_b64_tr_b16 v[56:57], v11 offset:12288
v_mfma_f32_16x16x32_bf16 v[44:47], v[20:23], v[48:51], v[44:47]
buffer_load_dwordx4 v8, s[16:19], s60 offen offset:1024  lds
v_mfma_f32_32x32x16_bf16 v[144:159], v[48:51], a[36:39], v[144:159]
ds_read_b64_tr_b16 v[58:59], v11 offset:12800
s_waitcnt lgkmcnt(2)
v_mfma_f32_32x32x16_bf16 v[128:143], v[52:55], a[40:43], v[128:143]
buffer_load_dwordx4 v9, s[16:19], s60 offen offset:2048  lds
ds_read_b32 v39, v19 offset:128
ds_read_b64_tr_b16 v[60:61], v12 offset:12288
v_mfma_f32_32x32x16_bf16 v[144:159], v[52:55], a[44:47], v[144:159]
ds_read_b64_tr_b16 v[62:63], v12 offset:12800
s_waitcnt lgkmcnt(3)
v_mfma_f32_32x32x16_bf16 v[128:143], v[56:59], a[48:51], v[128:143]
v_add_u32 v11, 0xc000, v11
v_add_u32 v12, 0xc000, v12
ds_read_b64_tr_b16 v[48:49], v11 offset:0
v_mfma_f32_16x16x32_bf16 v[44:47], v[20:23], v[56:59], v[44:47]
buffer_load_dwordx4 v10, s[16:19], s60 offen offset:3072  lds
v_mfma_f32_32x32x16_bf16 v[144:159], v[56:59], a[52:55], v[144:159]
ds_read_b64_tr_b16 v[50:51], v11 offset:512
s_waitcnt lgkmcnt(2)
v_mfma_f32_32x32x16_bf16 v[128:143], v[60:63], a[56:59], v[128:143]
ds_read_b64_tr_b16 v[52:53], v12 offset:0
v_mfma_f32_32x32x16_bf16 v[144:159], v[60:63], a[60:63], v[144:159]
ds_read_b64_tr_b16 v[54:55], v12 offset:512
s_waitcnt vmcnt(21)
s_barrier
s_waitcnt lgkmcnt(2)
v_mfma_f32_32x32x16_bf16 v[128:143], v[48:51], a[64:67], v[128:143]
s_lshl_b32 s60, s68, 7
ds_read_b64_tr_b16 v[56:57], v11 offset:4096
v_mfma_f32_16x16x32_bf16 v[44:47], v[20:23], v[48:51], v[44:47]
v_mfma_f32_32x32x16_bf16 v[144:159], v[48:51], a[68:71], v[144:159]
s_add_u32 s60, s60, 884736
ds_read_b64_tr_b16 v[58:59], v11 offset:4608
s_waitcnt lgkmcnt(2)
v_mfma_f32_32x32x16_bf16 v[128:143], v[52:55], a[72:75], v[128:143]
s_add_u32 m0, s59, 0
ds_read_b64_tr_b16 v[60:61], v12 offset:4096
v_mfma_f32_32x32x16_bf16 v[144:159], v[52:55], a[76:79], v[144:159]
ds_read_b64_tr_b16 v[62:63], v12 offset:4608
s_waitcnt lgkmcnt(2)
v_mfma_f32_32x32x16_bf16 v[128:143], v[56:59], a[80:83], v[128:143]
ds_read_b64_tr_b16 v[48:49], v11 offset:8192
v_mfma_f32_16x16x32_bf16 v[44:47], v[20:23], v[56:59], v[44:47]
buffer_load_dwordx4 v7, s[16:19], s60 offen offset:0  lds
v_mfma_f32_32x32x16_bf16 v[144:159], v[56:59], a[84:87], v[144:159]
ds_read_b64_tr_b16 v[50:51], v11 offset:8704
s_waitcnt lgkmcnt(2)
v_mfma_f32_32x32x16_bf16 v[128:143], v[60:63], a[88:91], v[128:143]
ds_read_b64_tr_b16 v[52:53], v12 offset:8192
v_mfma_f32_32x32x16_bf16 v[144:159], v[60:63], a[92:95], v[144:159]
buffer_load_dwordx4 v8, s[16:19], s60 offen offset:1024  lds
v_add_f32 v38, v38, v39
ds_read_b64_tr_b16 v[54:55], v12 offset:8704
s_waitcnt lgkmcnt(2)
v_mfma_f32_32x32x16_bf16 v[128:143], v[48:51], a[96:99], v[128:143]
ds_read_b64_tr_b16 v[56:57], v11 offset:12288
v_mfma_f32_16x16x32_bf16 v[44:47], v[20:23], v[48:51], v[44:47]
v_mfma_f32_32x32x16_bf16 v[144:159], v[48:51], a[100:103], v[144:159]
buffer_load_dwordx4 v9, s[16:19], s60 offen offset:2048  lds
ds_read_b64_tr_b16 v[58:59], v11 offset:12800
s_waitcnt lgkmcnt(2)
v_mfma_f32_32x32x16_bf16 v[128:143], v[52:55], a[104:107], v[128:143]
ds_read_b64_tr_b16 v[60:61], v12 offset:12288
v_mfma_f32_32x32x16_bf16 v[144:159], v[52:55], a[108:111], v[144:159]
ds_read_b64_tr_b16 v[62:63], v12 offset:12800
s_waitcnt lgkmcnt(2)
v_mfma_f32_32x32x16_bf16 v[128:143], v[56:59], a[112:115], v[128:143]
buffer_load_dwordx4 v10, s[16:19], s60 offen offset:3072  lds
v_add_u32 v11, 0x4000, v11
v_add_u32 v12, 0x4000, v12
ds_read_b64_tr_b16 v[48:49], v11 offset:0
v_mfma_f32_16x16x32_bf16 v[44:47], v[20:23], v[56:59], v[44:47]
v_mfma_f32_32x32x16_bf16 v[144:159], v[56:59], a[116:119], v[144:159]
v_cvt_pk_bf16_f32 v39, v38, v38
ds_read_b64_tr_b16 v[50:51], v11 offset:512
s_waitcnt lgkmcnt(2)
v_mfma_f32_32x32x16_bf16 v[128:143], v[60:63], a[120:123], v[128:143]
ds_read_b64_tr_b16 v[52:53], v12 offset:0
v_mfma_f32_32x32x16_bf16 v[144:159], v[60:63], a[124:127], v[144:159]
ds_read_b64_tr_b16 v[54:55], v12 offset:512
s_waitcnt vmcnt(9)
s_barrier
s_cmp_lg_u32 s42, 0
s_cbranch_scc1 L_sig_6
s_add_u32 s46, s40, 0
s_lshl_b32 s46, s46, 5
s_add_u32 s46, s46, s41
s_lshl_b32 s46, s46, 2
s_add_u32 s46, s46, 25165824
s_mov_b64 exec, 1
v_mov_b32 v0, s46
v_mov_b32 v13, s79
buffer_store_dword v13, v0, s[24:27], 0 offen sc1
s_mov_b64 exec, -1
L_sig_6:
s_waitcnt lgkmcnt(2)
v_mfma_f32_32x32x16_bf16 v[128:143], v[48:51], a[128:131], v[128:143]
s_lshl_b32 s60, s68, 7
ds_read_b64_tr_b16 v[56:57], v11 offset:4096
v_mfma_f32_16x16x32_bf16 v[44:47], v[20:23], v[48:51], v[44:47]
v_mfma_f32_32x32x16_bf16 v[144:159], v[48:51], a[132:135], v[144:159]
s_add_u32 s60, s60, 1327104
ds_read_b64_tr_b16 v[58:59], v11 offset:4608
s_waitcnt lgkmcnt(2)
v_mfma_f32_32x32x16_bf16 v[128:143], v[52:55], a[136:139], v[128:143]
s_add_u32 m0, s59, 49152
ds_read_b64_tr_b16 v[60:61], v12 offset:4096
v_mfma_f32_32x32x16_bf16 v[144:159], v[52:55], a[140:143], v[144:159]
ds_read_b64_tr_b16 v[62:63], v12 offset:4608
s_waitcnt lgkmcnt(2)
v_mfma_f32_32x32x16_bf16 v[128:143], v[56:59], a[144:147], v[128:143]
v_lshlrev_b32 v39, 16, v39
ds_read_b64_tr_b16 v[48:49], v11 offset:8192
v_mfma_f32_16x16x32_bf16 v[44:47], v[20:23], v[56:59], v[44:47]
buffer_load_dwordx4 v7, s[16:19], s60 offen offset:0  lds
v_mfma_f32_32x32x16_bf16 v[144:159], v[56:59], a[148:151], v[144:159]
ds_read_b64_tr_b16 v[50:51], v11 offset:8704
s_waitcnt lgkmcnt(2)
v_mfma_f32_32x32x16_bf16 v[128:143], v[60:63], a[152:155], v[128:143]
ds_read_b64_tr_b16 v[52:53], v12 offset:8192
v_mfma_f32_32x32x16_bf16 v[144:159], v[60:63], a[156:159], v[144:159]
buffer_load_dwordx4 v8, s[16:19], s60 offen offset:1024  lds
ds_read_b64_tr_b16 v[54:55], v12 offset:8704
s_waitcnt lgkmcnt(2)
v_mfma_f32_32x32x16_bf16 v[128:143], v[48:51], a[160:163], v[128:143]
ds_read_b64_tr_b16 v[56:57], v11 offset:12288
v_mfma_f32_16x16x32_bf16 v[44:47], v[20:23], v[48:51], v[44:47]
v_mfma_f32_32x32x16_bf16 v[144:159], v[48:51], a[164:167], v[144:159]
buffer_load_dwordx4 v9, s[16:19], s60 offen offset:2048  lds
ds_read_b64_tr_b16 v[58:59], v11 offset:12800
s_waitcnt lgkmcnt(2)
v_mfma_f32_32x32x16_bf16 v[128:143], v[52:55], a[168:171], v[128:143]
v_sub_f32 v39, v38, v39
ds_read_b64_tr_b16 v[60:61], v12 offset:12288
v_mfma_f32_32x32x16_bf16 v[144:159], v[52:55], a[172:175], v[144:159]
ds_read_b64_tr_b16 v[62:63], v12 offset:12800
s_waitcnt lgkmcnt(2)
v_mfma_f32_32x32x16_bf16 v[128:143], v[56:59], a[176:179], v[128:143]
buffer_load_dwordx4 v10, s[16:19], s60 offen offset:3072  lds
v_add_u32 v11, 0xffff4000, v11
v_add_u32 v12, 0xffff4000, v12
ds_read_b64_tr_b16 v[48:49], v11 offset:0
v_mfma_f32_16x16x32_bf16 v[44:47], v[20:23], v[56:59], v[44:47]
v_mfma_f32_32x32x16_bf16 v[144:159], v[56:59], a[180:183], v[144:159]
ds_read_b64_tr_b16 v[50:51], v11 offset:512
s_waitcnt lgkmcnt(2)
v_mfma_f32_32x32x16_bf16 v[128:143], v[60:63], a[184:187], v[128:143]
ds_read_b64_tr_b16 v[52:53], v12 offset:0
v_mfma_f32_32x32x16_bf16 v[144:159], v[60:63], a[188:191], v[144:159]
ds_read_b64_tr_b16 v[54:55], v12 offset:512
s_barrier
s_waitcnt lgkmcnt(2)
v_mfma_f32_32x32x16_bf16 v[128:143], v[48:51], a[192:195], v[128:143]
s_lshl_b32 s60, s68, 7
ds_read_b64_tr_b16 v[56:57], v11 offset:4096
v_mfma_f32_16x16x32_bf16 v[44:47], v[20:23], v[48:51], v[44:47]
v_cvt_pk_bf16_f32 v24, v38, v39
v_mfma_f32_32x32x16_bf16 v[144:159], v[48:51], a[196:199], v[144:159]
s_add_u32 s60, s60, 1769472
ds_read_b64_tr_b16 v[58:59], v11 offset:4608
s_waitcnt lgkmcnt(2)
v_mfma_f32_32x32x16_bf16 v[128:143], v[52:55], a[200:203], v[128:143]
s_add_u32 m0, s59, 65536
ds_read_b64_tr_b16 v[60:61], v12 offset:4096
v_mfma_f32_32x32x16_bf16 v[144:159], v[52:55], a[204:207], v[144:159]
ds_read_b64_tr_b16 v[62:63], v12 offset:4608
s_waitcnt lgkmcnt(2)
v_mfma_f32_32x32x16_bf16 v[128:143], v[56:59], a[208:211], v[128:143]
ds_read_b64_tr_b16 v[48:49], v11 offset:8192
v_mfma_f32_16x16x32_bf16 v[44:47], v[20:23], v[56:59], v[44:47]
buffer_load_dwordx4 v7, s[16:19], s60 offen offset:0  lds
v_mfma_f32_32x32x16_bf16 v[144:159], v[56:59], a[212:215], v[144:159]
ds_read_b64_tr_b16 v[50:51], v11 offset:8704
s_waitcnt lgkmcnt(2)
v_mfma_f32_32x32x16_bf16 v[128:143], v[60:63], a[216:219], v[128:143]
ds_read_b64_tr_b16 v[52:53], v12 offset:8192
v_mfma_f32_32x32x16_bf16 v[144:159], v[60:63], a[220:223], v[144:159]
buffer_load_dwordx4 v8, s[16:19], s60 offen offset:1024  lds
ds_read_b64_tr_b16 v[54:55], v12 offset:8704
s_waitcnt lgkmcnt(2)
v_mfma_f32_32x32x16_bf16 v[128:143], v[48:51], a[224:227], v[128:143]
ds_read_b64_tr_b16 v[56:57], v11 offset:12288
v_mfma_f32_16x16x32_bf16 v[44:47], v[20:23], v[48:51], v[44:47]
v_mfma_f32_32x32x16_bf16 v[144:159], v[48:51], a[228:231], v[144:159]
buffer_load_dwordx4 v9, s[16:19], s60 offen offset:2048  lds
ds_read_b64_tr_b16 v[58:59], v11 offset:12800
s_waitcnt lgkmcnt(2)
v_mfma_f32_32x32x16_bf16 v[128:143], v[52:55], a[232:235], v[128:143]
v_mfma_f32_32x32x8bf16_1k v[160:175], v[24:25], v[26:27], v[160:175]
ds_read_b64_tr_b16 v[60:61], v12 offset:12288
v_mfma_f32_32x32x16_bf16 v[144:159], v[52:55], a[236:239], v[144:159]
ds_read_b64_tr_b16 v[62:63], v12 offset:12800
s_waitcnt lgkmcnt(2)
v_mfma_f32_32x32x16_bf16 v[128:143], v[56:59], a[240:243], v[128:143]
buffer_load_dwordx4 v10, s[16:19], s60 offen offset:3072  lds
v_add_u32 v11, 0x10000, v11
v_add_u32 v12, 0x10000, v12
ds_read_b64_tr_b16 v[48:49], v11 offset:0
v_mfma_f32_16x16x32_bf16 v[44:47], v[20:23], v[56:59], v[44:47]
v_mfma_f32_32x32x16_bf16 v[144:159], v[56:59], a[244:247], v[144:159]
ds_read_b64_tr_b16 v[50:51], v11 offset:512
s_waitcnt lgkmcnt(2)
v_mfma_f32_32x32x16_bf16 v[128:143], v[60:63], a[248:251], v[128:143]
ds_read_b64_tr_b16 v[52:53], v12 offset:0
v_mfma_f32_32x32x16_bf16 v[144:159], v[60:63], a[252:255], v[144:159]
ds_read_b64_tr_b16 v[54:55], v12 offset:512
s_barrier
s_waitcnt lgkmcnt(2)
v_mfma_f32_32x32x16_bf16 v[128:143], v[48:51], v[64:67], v[128:143]
s_lshl_b32 s60, s69, 7
ds_read_b64_tr_b16 v[56:57], v11 offset:4096
v_mfma_f32_16x16x32_bf16 v[44:47], v[20:23], v[48:51], v[44:47]
v_mfma_f32_32x32x16_bf16 v[144:159], v[48:51], v[68:71], v[144:159]
s_add_u32 s60, s60, 0
ds_read_b64_tr_b16 v[58:59], v11 offset:4608
s_waitcnt lgkmcnt(2)
v_mfma_f32_32x32x16_bf16 v[128:143], v[52:55], v[72:75], v[128:143]
s_add_u32 m0, s59, 16384
ds_read_b64_tr_b16 v[60:61], v12 offset:4096
v_mfma_f32_32x32x16_bf16 v[144:159], v[52:55], v[76:79], v[144:159]
ds_read_b64_tr_b16 v[62:63], v12 offset:4608
s_waitcnt lgkmcnt(2)
v_mfma_f32_32x32x16_bf16 v[128:143], v[56:59], v[80:83], v[128:143]
ds_read_b64_tr_b16 v[48:49], v11 offset:8192
v_mfma_f32_16x16x32_bf16 v[44:47], v[20:23], v[56:59], v[44:47]
buffer_load_dwordx4 v7, s[20:23], s60 offen offset:0  lds
v_mfma_f32_32x32x16_bf16 v[144:159], v[56:59], v[84:87], v[144:159]
ds_read_b64_tr_b16 v[50:51], v11 offset:8704
s_waitcnt lgkmcnt(2)
v_mfma_f32_32x32x16_bf16 v[128:143], v[60:63], v[88:91], v[128:143]
v_mfma_f32_32x32x8bf16_1k v[176:191], v[24:25], v[28:29], v[176:191]
ds_read_b64_tr_b16 v[52:53], v12 offset:8192
v_mfma_f32_32x32x16_bf16 v[144:159], v[60:63], v[92:95], v[144:159]
buffer_load_dwordx4 v8, s[20:23], s60 offen offset:1024  lds
ds_read_b64_tr_b16 v[54:55], v12 offset:8704
s_waitcnt lgkmcnt(2)
v_mfma_f32_32x32x16_bf16 v[128:143], v[48:51], v[96:99], v[128:143]
ds_read_b64_tr_b16 v[56:57], v11 offset:12288
v_mfma_f32_16x16x32_bf16 v[44:47], v[20:23], v[48:51], v[44:47]
v_mfma_f32_32x32x16_bf16 v[144:159], v[48:51], v[100:103], v[144:159]
buffer_load_dwordx4 v9, s[20:23], s60 offen offset:2048  lds
ds_read_b64_tr_b16 v[58:59], v11 offset:12800
s_waitcnt lgkmcnt(2)
v_mfma_f32_32x32x16_bf16 v[128:143], v[52:55], v[104:107], v[128:143]
ds_read_b64_tr_b16 v[60:61], v12 offset:12288
v_mfma_f32_32x32x16_bf16 v[144:159], v[52:55], v[108:111], v[144:159]
ds_read_b64_tr_b16 v[62:63], v12 offset:12800
s_waitcnt lgkmcnt(2)
v_mfma_f32_32x32x16_bf16 v[128:143], v[56:59], v[112:115], v[128:143]
buffer_load_dwordx4 v10, s[20:23], s60 offen offset:3072  lds
v_add_u32 v11, 0x4000, v11
v_add_u32 v12, 0x4000, v12
ds_read_b64_tr_b16 v[48:49], v11 offset:0
v_mfma_f32_16x16x32_bf16 v[44:47], v[20:23], v[56:59], v[44:47]
v_mfma_f32_32x32x16_bf16 v[144:159], v[56:59], v[116:119], v[144:159]
ds_read_b64_tr_b16 v[50:51], v11 offset:512
s_waitcnt lgkmcnt(2)
v_mfma_f32_32x32x16_bf16 v[128:143], v[60:63], v[120:123], v[128:143]
ds_read_b64_tr_b16 v[52:53], v12 offset:0
s_nop 2
ds_write_b32 v18, v44 offset:512
ds_write_b32 v18, v45 offset:576
v_mfma_f32_32x32x16_bf16 v[144:159], v[60:63], v[124:127], v[144:159]
ds_read_b64_tr_b16 v[54:55], v12 offset:512
s_waitcnt vmcnt(16) lgkmcnt(1)
s_barrier
v_mfma_f32_32x32x16_bf16 v[192:207], v[48:51], a[0:3], 0
s_lshl_b32 s60, s69, 7
ds_read_b64_tr_b16 v[56:57], v11 offset:4096
v_mfma_f32_16x16x32_bf16 v[44:47], v[20:23], v[48:51], 0
v_mfma_f32_32x32x16_bf16 v[208:223], v[48:51], a[4:7], 0
s_add_u32 s60, s60, 442368
ds_read_b32 v38, v19 offset:512
ds_read_b32 v39, v19 offset:640
ds_read_b64_tr_b16 v[58:59], v11 offset:4608
s_waitcnt lgkmcnt(4)
v_mfma_f32_32x32x16_bf16 v[192:207], v[52:55], a[8:11], v[192:207]
s_add_u32 m0, s59, 81920
s_waitcnt lgkmcnt(1)
v_add_f32 v38, v38, v39
ds_read_b64_tr_b16 v[60:61], v12 offset:4096
v_mfma_f32_32x32x16_bf16 v[208:223], v[52:55], a[12:15], v[208:223]
v_cvt_pk_bf16_f32 v39, v38, v38
v_lshlrev_b32 v39, 16, v39
v_sub_f32 v39, v38, v39
ds_read_b64_tr_b16 v[62:63], v12 offset:4608
s_waitcnt lgkmcnt(2)
v_mfma_f32_32x32x16_bf16 v[192:207], v[56:59], a[16:19], v[192:207]
v_cvt_pk_bf16_f32 v24, v38, v39
s_nop 1
v_mfma_f32_32x32x8bf16_1k v[128:143], v[24:25], v[26:27], v[128:143]
ds_read_b64_tr_b16 v[48:49], v11 offset:8192
v_mfma_f32_16x16x32_bf16 v[44:47], v[20:23], v[56:59], v[44:47]
buffer_load_dwordx4 v7, s[20:23], s60 offen offset:0  lds
v_mfma_f32_32x32x16_bf16 v[208:223], v[56:59], a[20:23], v[208:223]
v_mfma_f32_32x32x8bf16_1k v[144:159], v[24:25], v[28:29], v[144:159]
ds_read_b64_tr_b16 v[50:51], v11 offset:8704
s_waitcnt lgkmcnt(2)
v_mfma_f32_32x32x16_bf16 v[192:207], v[60:63], a[24:27], v[192:207]
s_lshl_b32 s52, s67, 1
s_add_u32 s52, s52, s44
s_lshl_b32 s52, s52, 10
ds_read_b64_tr_b16 v[52:53], v12 offset:8192
v_mfma_f32_32x32x16_bf16 v[208:223], v[60:63], a[28:31], v[208:223]
buffer_load_dwordx4 v8, s[20:23], s60 offen offset:1024  lds
s_add_u32 s52, s52, 8388608
ds_read_b64_tr_b16 v[54:55], v12 offset:8704
s_waitcnt lgkmcnt(2)
v_mfma_f32_32x32x16_bf16 v[192:207], v[48:51], a[32:35], v[192:207]
s_mul_i32 s53, s55, 110592
s_add_u32 s61, s52, s53
s_mul_i32 s53, s56, 110592
ds_read_b64_tr_b16 v[56:57], v11 offset:12288
v_mfma_f32_16x16x32_bf16 v[44:47], v[20:23], v[48:51], v[44:47]
s_add_u32 s62, s52, s53
v_mfma_f32_32x32x16_bf16 v[208:223], v[48:51], a[36:39], v[208:223]
buffer_load_dwordx4 v9, s[20:23], s60 offen offset:2048  lds
v_mul_f32 v40, v160, v160
v_mul_f32 v41, v161, v161
ds_read_b64_tr_b16 v[58:59], v11 offset:12800
s_waitcnt lgkmcnt(2)
v_mfma_f32_32x32x16_bf16 v[192:207], v[52:55], a[40:43], v[192:207]
v_mul_f32 v42, v162, v162
v_mul_f32 v43, v163, v163
v_fma_f32 v40, v40, v33, v32
ds_read_b64_tr_b16 v[60:61], v12 offset:12288
v_mfma_f32_32x32x16_bf16 v[208:223], v[52:55], a[44:47], v[208:223]
v_fma_f32 v41, v41, v33, v32
v_fma_f32 v42, v42, v33, v32
ds_read_b64_tr_b16 v[62:63], v12 offset:12800
s_waitcnt lgkmcnt(2)
v_mfma_f32_32x32x16_bf16 v[192:207], v[56:59], a[48:51], v[192:207]
buffer_load_dwordx4 v10, s[20:23], s60 offen offset:3072  lds
v_fma_f32 v43, v43, v33, v32
v_add_u32 v11, 0xffff0000, v11
v_add_u32 v12, 0xffff0000, v12
ds_read_b64_tr_b16 v[48:49], v11 offset:0
v_mfma_f32_16x16x32_bf16 v[44:47], v[20:23], v[56:59], v[44:47]
v_mul_f32 v40, v160, v40
v_mfma_f32_32x32x16_bf16 v[208:223], v[56:59], a[52:55], v[208:223]
v_mul_f32 v41, v161, v41
v_mul_f32 v42, v162, v42
ds_read_b64_tr_b16 v[50:51], v11 offset:512
s_waitcnt lgkmcnt(2)
v_mfma_f32_32x32x16_bf16 v[192:207], v[60:63], a[56:59], v[192:207]
v_mul_f32 v43, v163, v43
v_exp_f32 v40, v40
ds_read_b64_tr_b16 v[52:53], v12 offset:0
v_mfma_f32_32x32x16_bf16 v[208:223], v[60:63], a[60:63], v[208:223]
v_exp_f32 v41, v41
ds_read_b64_tr_b16 v[54:55], v12 offset:512
s_waitcnt vmcnt(16)
s_barrier
s_waitcnt lgkmcnt(2)
v_mfma_f32_32x32x16_bf16 v[192:207], v[48:51], a[64:67], v[192:207]
s_lshl_b32 s60, s69, 7
v_exp_f32 v42, v42
ds_read_b64_tr_b16 v[56:57], v11 offset:4096
v_mfma_f32_16x16x32_bf16 v[44:47], v[20:23], v[48:51], v[44:47]
v_exp_f32 v43, v43
v_mfma_f32_32x32x16_bf16 v[208:223], v[48:51], a[68:71], v[208:223]
s_add_u32 s60, s60, 884736
v_mul_f32 v160, v160, v128
ds_read_b64_tr_b16 v[58:59], v11 offset:4608
s_waitcnt lgkmcnt(2)
v_mfma_f32_32x32x16_bf16 v[192:207], v[52:55], a[72:75], v[192:207]
s_add_u32 m0, s59, 98304
v_mul_f32 v161, v161, v129
v_mul_f32 v162, v162, v130
ds_read_b64_tr_b16 v[60:61], v12 offset:4096
v_mfma_f32_32x32x16_bf16 v[208:223], v[52:55], a[76:79], v[208:223]
v_mul_f32 v163, v163, v131
v_fma_f32 v40, v40, v34, v34
v_fma_f32 v41, v41, v34, v34
ds_read_b64_tr_b16 v[62:63], v12 offset:4608
s_waitcnt lgkmcnt(2)
v_mfma_f32_32x32x16_bf16 v[192:207], v[56:59], a[80:83], v[192:207]
v_fma_f32 v42, v42, v34, v34
v_fma_f32 v43, v43, v34, v34
ds_read_b64_tr_b16 v[48:49], v11 offset:8192
v_mfma_f32_16x16x32_bf16 v[44:47], v[20:23], v[56:59], v[44:47]
buffer_load_dwordx4 v7, s[20:23], s60 offen offset:0  lds
v_mfma_f32_32x32x16_bf16 v[208:223], v[56:59], a[84:87], v[208:223]
v_rcp_f32 v40, v40
v_rcp_f32 v41, v41
ds_read_b64_tr_b16 v[50:51], v11 offset:8704
s_waitcnt lgkmcnt(2)
v_mfma_f32_32x32x16_bf16 v[192:207], v[60:63], a[88:91], v[192:207]
v_rcp_f32 v42, v42
ds_read_b64_tr_b16 v[52:53], v12 offset:8192
v_mfma_f32_32x32x16_bf16 v[208:223], v[60:63], a[92:95], v[208:223]
buffer_load_dwordx4 v8, s[20:23], s60 offen offset:1024  lds
v_rcp_f32 v43, v43
ds_read_b64_tr_b16 v[54:55], v12 offset:8704
s_waitcnt lgkmcnt(2)
v_mfma_f32_32x32x16_bf16 v[192:207], v[48:51], a[96:99], v[192:207]
v_mul_f32 v160, v160, v40
v_mul_f32 v161, v161, v41
ds_read_b64_tr_b16 v[56:57], v11 offset:12288
v_mfma_f32_16x16x32_bf16 v[44:47], v[20:23], v[48:51], v[44:47]
v_mul_f32 v162, v162, v42
v_mul_f32 v163, v163, v43
v_mfma_f32_32x32x16_bf16 v[208:223], v[48:51], a[100:103], v[208:223]
buffer_load_dwordx4 v9, s[20:23], s60 offen offset:2048  lds
v_cvt_pk_bf16_f32 v128, v160, v161
ds_read_b64_tr_b16 v[58:59], v11 offset:12800
s_waitcnt lgkmcnt(2)
v_mfma_f32_32x32x16_bf16 v[192:207], v[52:55], a[104:107], v[192:207]
v_cvt_pk_bf16_f32 v129, v162, v163
v_mul_f32 v40, v164, v164
v_mul_f32 v41, v165, v165
ds_read_b64_tr_b16 v[60:61], v12 offset:12288
v_mfma_f32_32x32x16_bf16 v[208:223], v[52:55], a[108:111], v[208:223]
v_mul_f32 v42, v166, v166
v_mul_f32 v43, v167, v167
ds_read_b64_tr_b16 v[62:63], v12 offset:12800
s_waitcnt lgkmcnt(2)
v_mfma_f32_32x32x16_bf16 v[192:207], v[56:59], a[112:115], v[192:207]
buffer_load_dwordx4 v10, s[20:23], s60 offen offset:3072  lds
v_fma_f32 v40, v40, v33, v32
v_add_u32 v11, 0xffff8000, v11
v_add_u32 v12, 0xffff8000, v12
ds_read_b64_tr_b16 v[48:49], v11 offset:0
v_mfma_f32_16x16x32_bf16 v[44:47], v[20:23], v[56:59], v[44:47]
v_fma_f32 v41, v41, v33, v32
v_mfma_f32_32x32x16_bf16 v[208:223], v[56:59], a[116:119], v[208:223]
v_fma_f32 v42, v42, v33, v32
v_fma_f32 v43, v43, v33, v32
ds_read_b64_tr_b16 v[50:51], v11 offset:512
s_waitcnt lgkmcnt(2)
v_mfma_f32_32x32x16_bf16 v[192:207], v[60:63], a[120:123], v[192:207]
v_mul_f32 v40, v164, v40
v_mul_f32 v41, v165, v41
v_mul_f32 v42, v166, v42
ds_read_b64_tr_b16 v[52:53], v12 offset:0
v_mfma_f32_32x32x16_bf16 v[208:223], v[60:63], a[124:127], v[208:223]
v_mul_f32 v43, v167, v43
ds_read_b64_tr_b16 v[54:55], v12 offset:512
s_waitcnt vmcnt(16)
s_barrier
s_waitcnt lgkmcnt(2)
v_mfma_f32_32x32x16_bf16 v[192:207], v[48:51], a[128:131], v[192:207]
s_lshl_b32 s60, s69, 7
v_exp_f32 v40, v40
v_exp_f32 v41, v41
ds_read_b64_tr_b16 v[56:57], v11 offset:4096
v_mfma_f32_16x16x32_bf16 v[44:47], v[20:23], v[48:51], v[44:47]
v_mfma_f32_32x32x16_bf16 v[208:223], v[48:51], a[132:135], v[208:223]
s_add_u32 s60, s60, 1327104
v_exp_f32 v42, v42
ds_read_b64_tr_b16 v[58:59], v11 offset:4608
s_waitcnt lgkmcnt(2)
v_mfma_f32_32x32x16_bf16 v[192:207], v[52:55], a[136:139], v[192:207]
s_add_u32 m0, s59, 32768
v_exp_f32 v43, v43
v_mul_f32 v164, v164, v132
ds_read_b64_tr_b16 v[60:61], v12 offset:4096
v_mfma_f32_32x32x16_bf16 v[208:223], v[52:55], a[140:143], v[208:223]
v_mul_f32 v165, v165, v133
v_mul_f32 v166, v166, v134
ds_read_b64_tr_b16 v[62:63], v12 offset:4608
s_waitcnt lgkmcnt(2)
v_mfma_f32_32x32x16_bf16 v[192:207], v[56:59], a[144:147], v[192:207]
v_mul_f32 v167, v167, v135
v_fma_f32 v40, v40, v34, v34
v_fma_f32 v41, v41, v34, v34
ds_read_b64_tr_b16 v[48:49], v11 offset:8192
v_mfma_f32_16x16x32_bf16 v[44:47], v[20:23], v[56:59], v[44:47]
buffer_load_dwordx4 v7, s[20:23], s60 offen offset:0  lds
v_mfma_f32_32x32x16_bf16 v[208:223], v[56:59], a[148:151], v[208:223]
v_fma_f32 v42, v42, v34, v34
v_fma_f32 v43, v43, v34, v34
ds_read_b64_tr_b16 v[50:51], v11 offset:8704
s_waitcnt lgkmcnt(2)
v_mfma_f32_32x32x16_bf16 v[192:207], v[60:63], a[152:155], v[192:207]
v_rcp_f32 v40, v40
v_rcp_f32 v41, v41
ds_read_b64_tr_b16 v[52:53], v12 offset:8192
v_mfma_f32_32x32x16_bf16 v[208:223], v[60:63], a[156:159], v[208:223]
buffer_load_dwordx4 v8, s[20:23], s60 offen offset:1024  lds
ds_read_b64_tr_b16 v[54:55], v12 offset:8704
s_waitcnt lgkmcnt(2)
v_mfma_f32_32x32x16_bf16 v[192:207], v[48:51], a[160:163], v[192:207]
v_rcp_f32 v42, v42
v_rcp_f32 v43, v43
ds_read_b64_tr_b16 v[56:57], v11 offset:12288
v_mfma_f32_16x16x32_bf16 v[44:47], v[20:23], v[48:51], v[44:47]
v_mul_f32 v164, v164, v40
v_mfma_f32_32x32x16_bf16 v[208:223], v[48:51], a[164:167], v[208:223]
buffer_load_dwordx4 v9, s[20:23], s60 offen offset:2048  lds
v_mul_f32 v165, v165, v41
ds_read_b64_tr_b16 v[58:59], v11 offset:12800
s_waitcnt lgkmcnt(2)
v_mfma_f32_32x32x16_bf16 v[192:207], v[52:55], a[168:171], v[192:207]
v_mul_f32 v166, v166, v42
v_mul_f32 v167, v167, v43
v_cvt_pk_bf16_f32 v130, v164, v165
ds_read_b64_tr_b16 v[60:61], v12 offset:12288
v_mfma_f32_32x32x16_bf16 v[208:223], v[52:55], a[172:175], v[208:223]
v_cvt_pk_bf16_f32 v131, v166, v167
v_mul_f32 v40, v168, v168
ds_read_b64_tr_b16 v[62:63], v12 offset:12800
s_waitcnt lgkmcnt(2)
v_mfma_f32_32x32x16_bf16 v[192:207], v[56:59], a[176:179], v[192:207]
buffer_load_dwordx4 v10, s[20:23], s60 offen offset:3072  lds
v_mul_f32 v41, v169, v169
v_add_u32 v11, 0xc000, v11
v_add_u32 v12, 0xc000, v12
ds_read_b64_tr_b16 v[48:49], v11 offset:0
v_mfma_f32_16x16x32_bf16 v[44:47], v[20:23], v[56:59], v[44:47]
v_mul_f32 v42, v170, v170
v_mfma_f32_32x32x16_bf16 v[208:223], v[56:59], a[180:183], v[208:223]
v_mul_f32 v43, v171, v171
v_fma_f32 v40, v40, v33, v32
v_fma_f32 v41, v41, v33, v32
ds_read_b64_tr_b16 v[50:51], v11 offset:512
s_waitcnt lgkmcnt(2)
v_mfma_f32_32x32x16_bf16 v[192:207], v[60:63], a[184:187], v[192:207]
v_fma_f32 v42, v42, v33, v32
v_fma_f32 v43, v43, v33, v32
v_mul_f32 v40, v168, v40
ds_read_b64_tr_b16 v[52:53], v12 offset:0
v_mfma_f32_32x32x16_bf16 v[208:223], v[60:63], a[188:191], v[208:223]
v_mul_f32 v41, v169, v41
ds_read_b64_tr_b16 v[54:55], v12 offset:512
s_waitcnt vmcnt(16)
s_barrier
s_waitcnt lgkmcnt(2)
v_mfma_f32_32x32x16_bf16 v[192:207], v[48:51], a[192:195], v[192:207]
s_lshl_b32 s60, s69, 7
v_mul_f32 v42, v170, v42
v_mul_f32 v43, v171, v43
ds_read_b64_tr_b16 v[56:57], v11 offset:4096
v_mfma_f32_16x16x32_bf16 v[44:47], v[20:23], v[48:51], v[44:47]
v_exp_f32 v40, v40
v_mfma_f32_32x32x16_bf16 v[208:223], v[48:51], a[196:199], v[208:223]
s_add_u32 s60, s60, 1769472
v_exp_f32 v41, v41
ds_read_b64_tr_b16 v[58:59], v11 offset:4608
s_waitcnt lgkmcnt(2)
v_mfma_f32_32x32x16_bf16 v[192:207], v[52:55], a[200:203], v[192:207]
s_add_u32 m0, s59, 0
v_exp_f32 v42, v42
ds_read_b64_tr_b16 v[60:61], v12 offset:4096
v_mfma_f32_32x32x16_bf16 v[208:223], v[52:55], a[204:207], v[208:223]
v_exp_f32 v43, v43
ds_read_b64_tr_b16 v[62:63], v12 offset:4608
s_waitcnt lgkmcnt(2)
v_mfma_f32_32x32x16_bf16 v[192:207], v[56:59], a[208:211], v[192:207]
v_mul_f32 v168, v168, v136
v_mul_f32 v169, v169, v137
v_mul_f32 v170, v170, v138
ds_read_b64_tr_b16 v[48:49], v11 offset:8192
v_mfma_f32_16x16x32_bf16 v[44:47], v[20:23], v[56:59], v[44:47]
buffer_load_dwordx4 v7, s[20:23], s60 offen offset:0  lds
v_mfma_f32_32x32x16_bf16 v[208:223], v[56:59], a[212:215], v[208:223]
v_mul_f32 v171, v171, v139
v_fma_f32 v40, v40, v34, v34
ds_read_b64_tr_b16 v[50:51], v11 offset:8704
s_waitcnt lgkmcnt(2)
v_mfma_f32_32x32x16_bf16 v[192:207], v[60:63], a[216:219], v[192:207]
v_fma_f32 v41, v41, v34, v34
v_fma_f32 v42, v42, v34, v34
v_fma_f32 v43, v43, v34, v34
ds_read_b64_tr_b16 v[52:53], v12 offset:8192
v_mfma_f32_32x32x16_bf16 v[208:223], v[60:63], a[220:223], v[208:223]
buffer_load_dwordx4 v8, s[20:23], s60 offen offset:1024  lds
v_rcp_f32 v40, v40
ds_read_b64_tr_b16 v[54:55], v12 offset:8704
s_waitcnt lgkmcnt(2)
v_mfma_f32_32x32x16_bf16 v[192:207], v[48:51], a[224:227], v[192:207]
v_rcp_f32 v41, v41
ds_read_b64_tr_b16 v[56:57], v11 offset:12288
v_mfma_f32_16x16x32_bf16 v[44:47], v[20:23], v[48:51], v[44:47]
v_rcp_f32 v42, v42
v_mfma_f32_32x32x16_bf16 v[208:223], v[48:51], a[228:231], v[208:223]
buffer_load_dwordx4 v9, s[20:23], s60 offen offset:2048  lds
v_rcp_f32 v43, v43
ds_read_b64_tr_b16 v[58:59], v11 offset:12800
s_waitcnt lgkmcnt(2)
v_mfma_f32_32x32x16_bf16 v[192:207], v[52:55], a[232:235], v[192:207]
v_mul_f32 v168, v168, v40
v_mul_f32 v169, v169, v41
ds_read_b64_tr_b16 v[60:61], v12 offset:12288
v_mfma_f32_32x32x16_bf16 v[208:223], v[52:55], a[236:239], v[208:223]
v_mul_f32 v170, v170, v42
v_mul_f32 v171, v171, v43
v_cvt_pk_bf16_f32 v132, v168, v169
ds_read_b64_tr_b16 v[62:63], v12 offset:12800
s_waitcnt lgkmcnt(2)
v_mfma_f32_32x32x16_bf16 v[192:207], v[56:59], a[240:243], v[192:207]
buffer_load_dwordx4 v10, s[20:23], s60 offen offset:3072  lds
v_add_u32 v11, 0x4000, v11
v_add_u32 v12, 0x4000, v12
ds_read_b64_tr_b16 v[48:49], v11 offset:0
v_mfma_f32_16x16x32_bf16 v[44:47], v[20:23], v[56:59], v[44:47]
v_cvt_pk_bf16_f32 v133, v170, v171
v_mfma_f32_32x32x16_bf16 v[208:223], v[56:59], a[244:247], v[208:223]
v_mul_f32 v40, v172, v172
v_mul_f32 v41, v173, v173
v_mul_f32 v42, v174, v174
ds_read_b64_tr_b16 v[50:51], v11 offset:512
s_waitcnt lgkmcnt(2)
v_mfma_f32_32x32x16_bf16 v[192:207], v[60:63], a[248:251], v[192:207]
v_mul_f32 v43, v175, v175
v_fma_f32 v40, v40, v33, v32
v_fma_f32 v41, v41, v33, v32
ds_read_b64_tr_b16 v[52:53], v12 offset:0
v_mfma_f32_32x32x16_bf16 v[208:223], v[60:63], a[252:255], v[208:223]
v_fma_f32 v42, v42, v33, v32
ds_read_b64_tr_b16 v[54:55], v12 offset:512
s_waitcnt vmcnt(16)
s_barrier
s_waitcnt lgkmcnt(2)
v_mfma_f32_32x32x16_bf16 v[192:207], v[48:51], v[64:67], v[192:207]
v_fma_f32 v43, v43, v33, v32
v_mul_f32 v40, v172, v40
v_mul_f32 v41, v173, v41
ds_read_b64_tr_b16 v[56:57], v11 offset:4096
v_mfma_f32_16x16x32_bf16 v[44:47], v[20:23], v[48:51], v[44:47]
v_mul_f32 v42, v174, v42
v_mfma_f32_32x32x16_bf16 v[208:223], v[48:51], v[68:71], v[208:223]
v_mul_f32 v43, v175, v43
v_exp_f32 v40, v40
ds_read_b64_tr_b16 v[58:59], v11 offset:4608
s_waitcnt lgkmcnt(2)
v_mfma_f32_32x32x16_bf16 v[192:207], v[52:55], v[72:75], v[192:207]
v_exp_f32 v41, v41
ds_read_b64_tr_b16 v[60:61], v12 offset:4096
v_mfma_f32_32x32x16_bf16 v[208:223], v[52:55], v[76:79], v[208:223]
v_exp_f32 v42, v42
ds_read_b64_tr_b16 v[62:63], v12 offset:4608
s_waitcnt lgkmcnt(2)
v_mfma_f32_32x32x16_bf16 v[192:207], v[56:59], v[80:83], v[192:207]
v_exp_f32 v43, v43
v_mul_f32 v172, v172, v140
v_mul_f32 v173, v173, v141
ds_read_b64_tr_b16 v[48:49], v11 offset:8192
v_mfma_f32_16x16x32_bf16 v[44:47], v[20:23], v[56:59], v[44:47]
v_mul_f32 v174, v174, v142
v_mfma_f32_32x32x16_bf16 v[208:223], v[56:59], v[84:87], v[208:223]
v_mul_f32 v175, v175, v143
v_fma_f32 v40, v40, v34, v34
v_fma_f32 v41, v41, v34, v34
ds_read_b64_tr_b16 v[50:51], v11 offset:8704
s_waitcnt lgkmcnt(2)
v_mfma_f32_32x32x16_bf16 v[192:207], v[60:63], v[88:91], v[192:207]
v_fma_f32 v42, v42, v34, v34
v_fma_f32 v43, v43, v34, v34
ds_read_b64_tr_b16 v[52:53], v12 offset:8192
v_mfma_f32_32x32x16_bf16 v[208:223], v[60:63], v[92:95], v[208:223]
v_rcp_f32 v40, v40
ds_read_b64_tr_b16 v[54:55], v12 offset:8704
s_waitcnt lgkmcnt(2)
v_mfma_f32_32x32x16_bf16 v[192:207], v[48:51], v[96:99], v[192:207]
v_rcp_f32 v41, v41
v_rcp_f32 v42, v42
ds_read_b64_tr_b16 v[56:57], v11 offset:12288
v_mfma_f32_16x16x32_bf16 v[44:47], v[20:23], v[48:51], v[44:47]
v_rcp_f32 v43, v43
v_mfma_f32_32x32x16_bf16 v[208:223], v[48:51], v[100:103], v[208:223]
v_mul_f32 v172, v172, v40
v_mul_f32 v173, v173, v41
ds_read_b64_tr_b16 v[58:59], v11 offset:12800
s_waitcnt lgkmcnt(2)
v_mfma_f32_32x32x16_bf16 v[192:207], v[52:55], v[104:107], v[192:207]
v_mul_f32 v174, v174, v42
v_mul_f32 v175, v175, v43
v_cvt_pk_bf16_f32 v134, v172, v173
ds_read_b64_tr_b16 v[60:61], v12 offset:12288
v_mfma_f32_32x32x16_bf16 v[208:223], v[52:55], v[108:111], v[208:223]
v_cvt_pk_bf16_f32 v135, v174, v175
ds_read_b64_tr_b16 v[62:63], v12 offset:12800
s_waitcnt lgkmcnt(2)
v_mfma_f32_32x32x16_bf16 v[192:207], v[56:59], v[112:115], v[192:207]
buffer_store_dwordx4 v[128:131], v17, s[24:27], s61 offen sc1
v_add_u32 v11, 0xffff4000, v11
v_add_u32 v12, 0xffff4000, v12
ds_read_b64_tr_b16 v[48:49], v11 offset:0
v_mfma_f32_16x16x32_bf16 v[44:47], v[20:23], v[56:59], v[44:47]
buffer_store_dwordx4 v[132:135], v17, s[24:27], s61 offen offset:512 sc1
v_mfma_f32_32x32x16_bf16 v[208:223], v[56:59], v[116:119], v[208:223]
ds_read_b64_tr_b16 v[50:51], v11 offset:512
s_waitcnt lgkmcnt(2)
v_mfma_f32_32x32x16_bf16 v[192:207], v[60:63], v[120:123], v[192:207]
ds_read_b64_tr_b16 v[52:53], v12 offset:0
s_nop 1
ds_write_b32 v18, v44 offset:0
ds_write_b32 v18, v45 offset:64
v_mfma_f32_32x32x16_bf16 v[208:223], v[60:63], v[124:127], v[208:223]
ds_read_b64_tr_b16 v[54:55], v12 offset:512
s_waitcnt vmcnt(14) lgkmcnt(1)
s_barrier
v_mfma_f32_32x32x16_bf16 v[224:239], v[48:51], a[0:3], 0
ds_read_b64_tr_b16 v[56:57], v11 offset:4096
v_mfma_f32_16x16x32_bf16 v[44:47], v[20:23], v[48:51], 0
v_mfma_f32_32x32x16_bf16 v[240:255], v[48:51], a[4:7], 0
ds_read_b32 v38, v19 offset:0
ds_read_b32 v39, v19 offset:128
s_waitcnt lgkmcnt(0)
ds_read_b64_tr_b16 v[58:59], v11 offset:4608
v_mfma_f32_32x32x16_bf16 v[224:239], v[52:55], a[8:11], v[224:239]
v_add_f32 v38, v38, v39
v_cvt_pk_bf16_f32 v39, v38, v38
v_lshlrev_b32 v39, 16, v39
v_sub_f32 v39, v38, v39
ds_read_b64_tr_b16 v[60:61], v12 offset:4096
v_mfma_f32_32x32x16_bf16 v[240:255], v[52:55], a[12:15], v[240:255]
v_cvt_pk_bf16_f32 v24, v38, v39
s_nop 1
v_mfma_f32_32x32x8bf16_1k v[192:207], v[24:25], v[26:27], v[192:207]
ds_read_b64_tr_b16 v[62:63], v12 offset:4608
s_waitcnt lgkmcnt(2)
v_mfma_f32_32x32x16_bf16 v[224:239], v[56:59], a[16:19], v[224:239]
v_mfma_f32_32x32x8bf16_1k v[208:223], v[24:25], v[28:29], v[208:223]
v_mul_f32 v40, v176, v176
ds_read_b64_tr_b16 v[48:49], v11 offset:8192
v_mfma_f32_16x16x32_bf16 v[44:47], v[20:23], v[56:59], v[44:47]
v_mul_f32 v41, v177, v177
v_mul_f32 v42, v178, v178
v_mfma_f32_32x32x16_bf16 v[240:255], v[56:59], a[20:23], v[240:255]
v_mul_f32 v43, v179, v179
v_fma_f32 v40, v40, v36, v35
ds_read_b64_tr_b16 v[50:51], v11 offset:8704
s_waitcnt lgkmcnt(2)
v_mfma_f32_32x32x16_bf16 v[224:239], v[60:63], a[24:27], v[224:239]
v_fma_f32 v41, v41, v36, v35
v_fma_f32 v42, v42, v36, v35
v_fma_f32 v43, v43, v36, v35
v_mul_f32 v40, v176, v40
ds_read_b64_tr_b16 v[52:53], v12 offset:8192
v_mfma_f32_32x32x16_bf16 v[240:255], v[60:63], a[28:31], v[240:255]
v_mul_f32 v41, v177, v41
v_mul_f32 v42, v178, v42
v_mul_f32 v43, v179, v43
ds_read_b64_tr_b16 v[54:55], v12 offset:8704
s_waitcnt lgkmcnt(2)
v_mfma_f32_32x32x16_bf16 v[224:239], v[48:51], a[32:35], v[224:239]
v_exp_f32 v40, v40
v_exp_f32 v41, v41
ds_read_b64_tr_b16 v[56:57], v11 offset:12288
v_mfma_f32_16x16x32_bf16 v[44:47], v[20:23], v[48:51], v[44:47]
v_exp_f32 v42, v42
v_mfma_f32_32x32x16_bf16 v[240:255], v[48:51], a[36:39], v[240:255]
v_exp_f32 v43, v43
ds_read_b64_tr_b16 v[58:59], v11 offset:12800
s_waitcnt lgkmcnt(2)
v_mfma_f32_32x32x16_bf16 v[224:239], v[52:55], a[40:43], v[224:239]
v_mul_f32 v176, v176, v144
v_mul_f32 v177, v177, v145
v_mul_f32 v178, v178, v146
v_mul_f32 v179, v179, v147
ds_read_b64_tr_b16 v[60:61], v12 offset:12288
v_mfma_f32_32x32x16_bf16 v[240:255], v[52:55], a[44:47], v[240:255]
v_fma_f32 v40, v40, v37, v37
v_fma_f32 v41, v41, v37, v37
v_fma_f32 v42, v42, v37, v37
ds_read_b64_tr_b16 v[62:63], v12 offset:12800
s_waitcnt lgkmcnt(2)
v_mfma_f32_32x32x16_bf16 v[224:239], v[56:59], a[48:51], v[224:239]
v_fma_f32 v43, v43, v37, v37
v_add_u32 v11, 0x10000, v11
v_add_u32 v12, 0x10000, v12
ds_read_b64_tr_b16 v[48:49], v11 offset:0
v_mfma_f32_16x16x32_bf16 v[44:47], v[20:23], v[56:59], v[44:47]
v_rcp_f32 v40, v40
v_mfma_f32_32x32x16_bf16 v[240:255], v[56:59], a[52:55], v[240:255]
v_rcp_f32 v41, v41
v_rcp_f32 v42, v42
ds_read_b64_tr_b16 v[50:51], v11 offset:512
s_waitcnt lgkmcnt(2)
v_mfma_f32_32x32x16_bf16 v[224:239], v[60:63], a[56:59], v[224:239]
v_rcp_f32 v43, v43
v_mul_f32 v176, v176, v40
ds_read_b64_tr_b16 v[52:53], v12 offset:0
v_mfma_f32_32x32x16_bf16 v[240:255], v[60:63], a[60:63], v[240:255]
v_mul_f32 v177, v177, v41
ds_read_b64_tr_b16 v[54:55], v12 offset:512
s_waitcnt vmcnt(10)
s_barrier
s_waitcnt lgkmcnt(2)
v_mfma_f32_32x32x16_bf16 v[224:239], v[48:51], a[64:67], v[224:239]
v_mul_f32 v178, v178, v42
v_mul_f32 v179, v179, v43
v_cvt_pk_bf16_f32 v144, v176, v177
v_cvt_pk_bf16_f32 v145, v178, v179
ds_read_b64_tr_b16 v[56:57], v11 offset:4096
v_mfma_f32_16x16x32_bf16 v[44:47], v[20:23], v[48:51], v[44:47]
v_mul_f32 v40, v180, v180
v_mfma_f32_32x32x16_bf16 v[240:255], v[48:51], a[68:71], v[240:255]
v_mul_f32 v41, v181, v181
v_mul_f32 v42, v182, v182
v_mul_f32 v43, v183, v183
ds_read_b64_tr_b16 v[58:59], v11 offset:4608
s_waitcnt lgkmcnt(2)
v_mfma_f32_32x32x16_bf16 v[224:239], v[52:55], a[72:75], v[224:239]
v_fma_f32 v40, v40, v36, v35
v_fma_f32 v41, v41, v36, v35
v_fma_f32 v42, v42, v36, v35
v_fma_f32 v43, v43, v36, v35
ds_read_b64_tr_b16 v[60:61], v12 offset:4096
v_mfma_f32_32x32x16_bf16 v[240:255], v[52:55], a[76:79], v[240:255]
v_mul_f32 v40, v180, v40
v_mul_f32 v41, v181, v41
v_mul_f32 v42, v182, v42
ds_read_b64_tr_b16 v[62:63], v12 offset:4608
s_waitcnt lgkmcnt(2)
v_mfma_f32_32x32x16_bf16 v[224:239], v[56:59], a[80:83], v[224:239]
v_mul_f32 v43, v183, v43
v_exp_f32 v40, v40
ds_read_b64_tr_b16 v[48:49], v11 offset:8192
v_mfma_f32_16x16x32_bf16 v[44:47], v[20:23], v[56:59], v[44:47]
v_exp_f32 v41, v41
v_mfma_f32_32x32x16_bf16 v[240:255], v[56:59], a[84:87], v[240:255]
v_exp_f32 v42, v42
ds_read_b64_tr_b16 v[50:51], v11 offset:8704
s_waitcnt lgkmcnt(2)
v_mfma_f32_32x32x16_bf16 v[224:239], v[60:63], a[88:91], v[224:239]
v_exp_f32 v43, v43
v_mul_f32 v180, v180, v148
v_mul_f32 v181, v181, v149
ds_read_b64_tr_b16 v[52:53], v12 offset:8192
v_mfma_f32_32x32x16_bf16 v[240:255], v[60:63], a[92:95], v[240:255]
v_mul_f32 v182, v182, v150
v_mul_f32 v183, v183, v151
v_fma_f32 v40, v40, v37, v37
ds_read_b64_tr_b16 v[54:55], v12 offset:8704
s_waitcnt lgkmcnt(2)
v_mfma_f32_32x32x16_bf16 v[224:239], v[48:51], a[96:99], v[224:239]
v_fma_f32 v41, v41, v37, v37
v_fma_f32 v42, v42, v37, v37
v_fma_f32 v43, v43, v37, v37
ds_read_b64_tr_b16 v[56:57], v11 offset:12288
v_mfma_f32_16x16x32_bf16 v[44:47], v[20:23], v[48:51], v[44:47]
v_rcp_f32 v40, v40
v_mfma_f32_32x32x16_bf16 v[240:255], v[48:51], a[100:103], v[240:255]
v_rcp_f32 v41, v41
v_rcp_f32 v42, v42
ds_read_b64_tr_b16 v[58:59], v11 offset:12800
s_waitcnt lgkmcnt(2)
v_mfma_f32_32x32x16_bf16 v[224:239], v[52:55], a[104:107], v[224:239]
v_rcp_f32 v43, v43
v_mul_f32 v180, v180, v40
ds_read_b64_tr_b16 v[60:61], v12 offset:12288
v_mfma_f32_32x32x16_bf16 v[240:255], v[52:55], a[108:111], v[240:255]
v_mul_f32 v181, v181, v41
v_mul_f32 v182, v182, v42
v_mul_f32 v183, v183, v43
ds_read_b64_tr_b16 v[62:63], v12 offset:12800
s_waitcnt lgkmcnt(2)
v_mfma_f32_32x32x16_bf16 v[224:239], v[56:59], a[112:115], v[224:239]
v_cvt_pk_bf16_f32 v146, v180, v181
v_cvt_pk_bf16_f32 v147, v182, v183
v_add_u32 v11, 0x4000, v11
v_add_u32 v12, 0x4000, v12
ds_read_b64_tr_b16 v[48:49], v11 offset:0
v_mfma_f32_16x16x32_bf16 v[44:47], v[20:23], v[56:59], v[44:47]
v_mul_f32 v40, v184, v184
v_mul_f32 v41, v185, v185
v_mfma_f32_32x32x16_bf16 v[240:255], v[56:59], a[116:119], v[240:255]
v_mul_f32 v42, v186, v186
v_mul_f32 v43, v187, v187
ds_read_b64_tr_b16 v[50:51], v11 offset:512
s_waitcnt lgkmcnt(2)
v_mfma_f32_32x32x16_bf16 v[224:239], v[60:63], a[120:123], v[224:239]
v_fma_f32 v40, v40, v36, v35
v_fma_f32 v41, v41, v36, v35
v_fma_f32 v42, v42, v36, v35
v_fma_f32 v43, v43, v36, v35
ds_read_b64_tr_b16 v[52:53], v12 offset:0
v_mfma_f32_32x32x16_bf16 v[240:255], v[60:63], a[124:127], v[240:255]
v_mul_f32 v40, v184, v40
v_mul_f32 v41, v185, v41
ds_read_b64_tr_b16 v[54:55], v12 offset:512
s_waitcnt vmcnt(6)
s_barrier
s_waitcnt lgkmcnt(2)
v_mfma_f32_32x32x16_bf16 v[224:239], v[48:51], a[128:131], v[224:239]
s_and_b32 s45, s2, 7
s_lshr_b32 s46, s2, 3
s_lshl_b32 s45, s45, 1
s_lshr_b32 s47, s46, 4
ds_read_b64_tr_b16 v[56:57], v11 offset:4096
v_mfma_f32_16x16x32_bf16 v[44:47], v[20:23], v[48:51], v[44:47]
s_add_u32 s81, s45, s47
s_and_b32 s80, s46, 15
v_mfma_f32_32x32x16_bf16 v[240:255], v[48:51], a[132:135], v[240:255]
s_lshl_b32 s45, s80, 2
s_add_u32 s82, s45, s42
s_sub_u32 s83, 8, s82
v_mul_f32 v42, v186, v42
ds_read_b64_tr_b16 v[58:59], v11 offset:4608
s_waitcnt lgkmcnt(2)
v_mfma_f32_32x32x16_bf16 v[224:239], v[52:55], a[136:139], v[224:239]
s_max_i32 s83, s83, 0
v_min_u32 v0, 47, v1
v_lshrrev_b32 v13, 4, v0
s_sub_u32 s45, s80, 2
v_mul_f32 v43, v187, v43
ds_read_b64_tr_b16 v[60:61], v12 offset:4096
v_mfma_f32_32x32x16_bf16 v[240:255], v[52:55], a[140:143], v[240:255]
v_add_u32 v13, s45, v13
v_max_i32 v13, 0, v13
v_and_b32 v0, 15, v0
v_lshlrev_b32 v0, 2, v0
ds_read_b64_tr_b16 v[62:63], v12 offset:4608
s_waitcnt lgkmcnt(2)
v_mfma_f32_32x32x16_bf16 v[224:239], v[56:59], a[144:147], v[224:239]
v_lshl_add_u32 v0, v13, 7, v0
v_add_u32 v0, 25165824, v0
s_lshl_b32 s45, s2, 2
s_add_u32 s45, s45, s42
ds_read_b64_tr_b16 v[48:49], v11 offset:8192
v_mfma_f32_16x16x32_bf16 v[44:47], v[20:23], v[56:59], v[44:47]
s_lshl_b32 s45, s45, 7
s_add_u32 s45, s45, 27262976
v_mfma_f32_32x32x16_bf16 v[240:255], v[56:59], a[148:151], v[240:255]
s_cmp_eq_u32 s42, 0
s_cselect_b64 s[48:49], -1, 0
v_mov_b32 v13, s45
v_exp_f32 v40, v40
ds_read_b64_tr_b16 v[50:51], v11 offset:8704
s_waitcnt lgkmcnt(2)
v_mfma_f32_32x32x16_bf16 v[224:239], v[60:63], a[152:155], v[224:239]
v_cndmask_b32_e64 v0, v13, v0, s[48:49]
buffer_load_dword v13, v0, s[24:27], 0 offen sc1
s_and_b32 s45, s2, 7
ds_read_b64_tr_b16 v[52:53], v12 offset:8192
v_mfma_f32_32x32x16_bf16 v[240:255], v[60:63], a[156:159], v[240:255]
s_lshr_b32 s46, s2, 3
s_and_b32 s47, s45, 3
s_lshl_b32 s47, s47, 3
ds_read_b64_tr_b16 v[54:55], v12 offset:8704
s_waitcnt lgkmcnt(2)
v_mfma_f32_32x32x16_bf16 v[224:239], v[48:51], a[160:163], v[224:239]
s_and_b32 s48, s46, 7
s_add_u32 s84, s47, s48
s_lshr_b32 s47, s45, 2
s_lshl_b32 s47, s47, 2
s_lshr_b32 s48, s46, 3
v_exp_f32 v41, v41
ds_read_b64_tr_b16 v[56:57], v11 offset:12288
v_mfma_f32_16x16x32_bf16 v[44:47], v[20:23], v[48:51], v[44:47]
s_add_u32 s85, s47, s48
v_mfma_f32_32x32x16_bf16 v[240:255], v[48:51], a[164:167], v[240:255]
s_lshl_b32 s45, s84, 2
s_add_u32 s86, s45, s42
s_lshr_b32 s87, s84, 1
s_mul_i32 s88, s85, 378880
ds_read_b64_tr_b16 v[58:59], v11 offset:12800
s_waitcnt lgkmcnt(2)
v_mfma_f32_32x32x16_bf16 v[224:239], v[52:55], a[168:171], v[224:239]
s_mul_i32 s89, s42, 5120
s_add_u32 s88, s88, s89
s_add_u32 s88, s88, 20971520
s_and_b32 s45, s42, 1
ds_read_b64_tr_b16 v[60:61], v12 offset:12288
v_mfma_f32_32x32x16_bf16 v[240:255], v[52:55], a[172:175], v[240:255]
s_lshl_b32 s45, s45, 10
s_mul_i32 s91, s86, 55296
s_add_u32 s91, s91, s45
v_exp_f32 v42, v42
ds_read_b64_tr_b16 v[62:63], v12 offset:12800
s_waitcnt lgkmcnt(2)
v_mfma_f32_32x32x16_bf16 v[224:239], v[56:59], a[176:179], v[224:239]
s_add_u32 s91, s91, 8388608
s_mul_i32 s92, s86, 20480
s_add_u32 s92, s92, s45
v_add_u32 v11, 0xffff0000, v11
v_add_u32 v12, 0xffff0000, v12
ds_read_b64_tr_b16 v[48:49], v11 offset:0
v_mfma_f32_16x16x32_bf16 v[44:47], v[20:23], v[56:59], v[44:47]
s_add_u32 s92, s92, 16777216
v_mfma_f32_32x32x16_bf16 v[240:255], v[56:59], a[180:183], v[240:255]
s_sub_u32 s90, s92, s45
s_xor_b32 s46, s86, 1
s_mul_i32 s94, s46, 55296
s_add_u32 s94, s94, s45
ds_read_b64_tr_b16 v[50:51], v11 offset:512
s_waitcnt lgkmcnt(2)
v_mfma_f32_32x32x16_bf16 v[224:239], v[60:63], a[184:187], v[224:239]
s_add_u32 s94, s94, 8388608
s_mul_i32 s95, s46, 20480
s_add_u32 s95, s95, s45
s_add_u32 s95, s95, 16777216
ds_read_b64_tr_b16 v[52:53], v12 offset:0
v_mfma_f32_32x32x16_bf16 v[240:255], v[60:63], a[188:191], v[240:255]
v_exp_f32 v43, v43
ds_read_b64_tr_b16 v[54:55], v12 offset:512
s_waitcnt vmcnt(3)
s_barrier
s_waitcnt lgkmcnt(2)
v_mfma_f32_32x32x16_bf16 v[224:239], v[48:51], a[192:195], v[224:239]
s_mul_i32 s63, s82, 122880
s_mul_i32 s50, s81, 2560
s_add_u32 s63, s63, s50
v_lshlrev_b32 v5, 4, v1
v_mul_f32 v184, v184, v152
ds_read_b64_tr_b16 v[56:57], v11 offset:4096
v_mfma_f32_16x16x32_bf16 v[44:47], v[20:23], v[48:51], v[44:47]
v_and_b32 v10, 31, v1
v_mul_f32 v185, v185, v153
v_mfma_f32_32x32x16_bf16 v[240:255], v[48:51], a[196:199], v[240:255]
v_lshrrev_b32 v14, 5, v1
v_lshlrev_b32 v9, 4, v10
v_lshl_add_u32 v9, v14, 3, v9
v_mul_f32 v186, v186, v154
ds_read_b64_tr_b16 v[58:59], v11 offset:4608
s_waitcnt lgkmcnt(2)
v_mfma_f32_32x32x16_bf16 v[224:239], v[52:55], a[200:203], v[224:239]
v_lshlrev_b32 v6, 2, v14
v_xor_b32 v6, v10, v6
v_lshlrev_b32 v6, 4, v6
v_mul_f32 v187, v187, v155
ds_read_b64_tr_b16 v[60:61], v12 offset:4096
v_mfma_f32_32x32x16_bf16 v[240:255], v[52:55], a[204:207], v[240:255]
v_lshl_add_u32 v6, v14, 9, v6
v_sub_u32 v7, 1, v14
v_lshlrev_b32 v7, 3, v7
v_fma_f32 v40, v40, v37, v37
ds_read_b64_tr_b16 v[62:63], v12 offset:4608
s_waitcnt lgkmcnt(2)
v_mfma_f32_32x32x16_bf16 v[224:239], v[56:59], a[208:211], v[224:239]
v_xor_b32 v7, v10, v7
v_lshlrev_b32 v7, 4, v7
v_lshl_add_u32 v7, v14, 9, v7
v_xor_b32 v8, 4, v10
v_fma_f32 v41, v41, v37, v37
ds_read_b64_tr_b16 v[48:49], v11 offset:8192
v_mfma_f32_16x16x32_bf16 v[44:47], v[20:23], v[56:59], v[44:47]
v_lshlrev_b32 v8, 4, v8
v_fma_f32 v42, v42, v37, v37
v_mfma_f32_32x32x16_bf16 v[240:255], v[56:59], a[212:215], v[240:255]
v_lshl_add_u32 v8, v14, 9, v8
s_mul_i32 s72, s42, 3
s_add_u32 s72, s72, 0
ds_read_b64_tr_b16 v[50:51], v11 offset:8704
s_waitcnt lgkmcnt(2)
v_mfma_f32_32x32x16_bf16 v[224:239], v[60:63], a[216:219], v[224:239]
s_lshl_b32 s70, s80, 2
s_add_u32 s70, s70, s72
s_sub_u32 s70, s70, 8
s_max_i32 s70, s70, 0
v_fma_f32 v43, v43, v37, v37
ds_read_b64_tr_b16 v[52:53], v12 offset:8192
v_mfma_f32_32x32x16_bf16 v[240:255], v[60:63], a[220:223], v[240:255]
s_mul_i32 s70, s70, 122880
s_add_u32 s70, s70, s50
s_add_u32 s71, s70, 81920
ds_read_b64_tr_b16 v[54:55], v12 offset:8704
s_waitcnt lgkmcnt(2)
v_mfma_f32_32x32x16_bf16 v[224:239], v[48:51], a[224:227], v[224:239]
s_add_u32 s70, s70, 40960
s_mul_i32 s72, s72, 3072
s_mul_i32 s75, s42, 3
v_rcp_f32 v40, v40
ds_read_b64_tr_b16 v[56:57], v11 offset:12288
v_mfma_f32_16x16x32_bf16 v[44:47], v[20:23], v[48:51], v[44:47]
s_add_u32 s75, s75, 1
s_lshl_b32 s73, s80, 2
v_mfma_f32_32x32x16_bf16 v[240:255], v[48:51], a[228:231], v[240:255]
s_add_u32 s73, s73, s75
s_sub_u32 s73, s73, 8
s_max_i32 s73, s73, 0
v_rcp_f32 v41, v41
ds_read_b64_tr_b16 v[58:59], v11 offset:12800
s_waitcnt lgkmcnt(2)
v_mfma_f32_32x32x16_bf16 v[224:239], v[52:55], a[232:235], v[224:239]
s_mul_i32 s73, s73, 122880
s_add_u32 s73, s73, s50
s_add_u32 s74, s73, 81920
ds_read_b64_tr_b16 v[60:61], v12 offset:12288
v_mfma_f32_32x32x16_bf16 v[240:255], v[52:55], a[236:239], v[240:255]
s_add_u32 s73, s73, 40960
s_mul_i32 s75, s75, 3072
s_mul_i32 s58, s42, 3
v_rcp_f32 v42, v42
ds_read_b64_tr_b16 v[62:63], v12 offset:12800
s_waitcnt lgkmcnt(2)
v_mfma_f32_32x32x16_bf16 v[224:239], v[56:59], a[240:243], v[224:239]
s_add_u32 s58, s58, 2
s_lshl_b32 s76, s80, 2
v_add_u32 v11, 0xffff8000, v11
v_add_u32 v12, 0xffff8000, v12
ds_read_b64_tr_b16 v[48:49], v11 offset:0
v_mfma_f32_16x16x32_bf16 v[44:47], v[20:23], v[56:59], v[44:47]
s_add_u32 s76, s76, s58
s_sub_u32 s76, s76, 8
v_mfma_f32_32x32x16_bf16 v[240:255], v[56:59], a[244:247], v[240:255]
s_max_i32 s76, s76, 0
s_mul_i32 s76, s76, 122880
v_rcp_f32 v43, v43
ds_read_b64_tr_b16 v[50:51], v11 offset:512
s_waitcnt lgkmcnt(2)
v_mfma_f32_32x32x16_bf16 v[224:239], v[60:63], a[248:251], v[224:239]
s_add_u32 s76, s76, s50
s_add_u32 s57, s76, 81920
s_add_u32 s76, s76, 40960
s_mul_i32 s58, s58, 3072
ds_read_b64_tr_b16 v[52:53], v12 offset:0
v_mfma_f32_32x32x16_bf16 v[240:255], v[60:63], a[252:255], v[240:255]
v_mul_f32 v184, v184, v40
v_mul_f32 v185, v185, v41
v_mul_f32 v186, v186, v42
ds_read_b64_tr_b16 v[54:55], v12 offset:512
s_barrier
s_waitcnt lgkmcnt(2)
v_mfma_f32_32x32x16_bf16 v[224:239], v[48:51], v[64:67], v[224:239]
v_mul_f32 v187, v187, v43
v_cvt_pk_bf16_f32 v148, v184, v185
v_cvt_pk_bf16_f32 v149, v186, v187
ds_read_b64_tr_b16 v[56:57], v11 offset:4096
v_mfma_f32_16x16x32_bf16 v[44:47], v[20:23], v[48:51], v[44:47]
v_mul_f32 v40, v188, v188
v_mul_f32 v41, v189, v189
v_mfma_f32_32x32x16_bf16 v[240:255], v[48:51], v[68:71], v[240:255]
v_mul_f32 v42, v190, v190
v_mul_f32 v43, v191, v191
v_fma_f32 v40, v40, v36, v35
ds_read_b64_tr_b16 v[58:59], v11 offset:4608
s_waitcnt lgkmcnt(2)
v_mfma_f32_32x32x16_bf16 v[224:239], v[52:55], v[72:75], v[224:239]
v_fma_f32 v41, v41, v36, v35
v_fma_f32 v42, v42, v36, v35
v_fma_f32 v43, v43, v36, v35
ds_read_b64_tr_b16 v[60:61], v12 offset:4096
v_mfma_f32_32x32x16_bf16 v[240:255], v[52:55], v[76:79], v[240:255]
v_mul_f32 v40, v188, v40
v_mul_f32 v41, v189, v41
v_mul_f32 v42, v190, v42
ds_read_b64_tr_b16 v[62:63], v12 offset:4608
s_waitcnt lgkmcnt(2)
v_mfma_f32_32x32x16_bf16 v[224:239], v[56:59], v[80:83], v[224:239]
v_mul_f32 v43, v191, v43
v_exp_f32 v40, v40
ds_read_b64_tr_b16 v[48:49], v11 offset:8192
v_mfma_f32_16x16x32_bf16 v[44:47], v[20:23], v[56:59], v[44:47]
v_exp_f32 v41, v41
v_mfma_f32_32x32x16_bf16 v[240:255], v[56:59], v[84:87], v[240:255]
v_exp_f32 v42, v42
v_exp_f32 v43, v43
ds_read_b64_tr_b16 v[50:51], v11 offset:8704
s_waitcnt lgkmcnt(2)
v_mfma_f32_32x32x16_bf16 v[224:239], v[60:63], v[88:91], v[224:239]
v_mul_f32 v188, v188, v156
v_mul_f32 v189, v189, v157
v_mul_f32 v190, v190, v158
ds_read_b64_tr_b16 v[52:53], v12 offset:8192
v_mfma_f32_32x32x16_bf16 v[240:255], v[60:63], v[92:95], v[240:255]
v_mul_f32 v191, v191, v159
v_fma_f32 v40, v40, v37, v37
v_fma_f32 v41, v41, v37, v37
ds_read_b64_tr_b16 v[54:55], v12 offset:8704
s_waitcnt lgkmcnt(2)
v_mfma_f32_32x32x16_bf16 v[224:239], v[48:51], v[96:99], v[224:239]
v_fma_f32 v42, v42, v37, v37
v_fma_f32 v43, v43, v37, v37
v_rcp_f32 v40, v40
ds_read_b64_tr_b16 v[56:57], v11 offset:12288
v_mfma_f32_16x16x32_bf16 v[44:47], v[20:23], v[48:51], v[44:47]
v_mfma_f32_32x32x16_bf16 v[240:255], v[48:51], v[100:103], v[240:255]
v_rcp_f32 v41, v41
v_rcp_f32 v42, v42
ds_read_b64_tr_b16 v[58:59], v11 offset:12800
s_waitcnt lgkmcnt(2)
v_mfma_f32_32x32x16_bf16 v[224:239], v[52:55], v[104:107], v[224:239]
v_rcp_f32 v43, v43
v_mul_f32 v188, v188, v40
ds_read_b64_tr_b16 v[60:61], v12 offset:12288
v_mfma_f32_32x32x16_bf16 v[240:255], v[52:55], v[108:111], v[240:255]
v_mul_f32 v189, v189, v41
v_mul_f32 v190, v190, v42
v_mul_f32 v191, v191, v43
ds_read_b64_tr_b16 v[62:63], v12 offset:12800
s_waitcnt lgkmcnt(2)
v_mfma_f32_32x32x16_bf16 v[224:239], v[56:59], v[112:115], v[224:239]
v_cvt_pk_bf16_f32 v150, v188, v189
v_cvt_pk_bf16_f32 v151, v190, v191
buffer_store_dwordx4 v[144:147], v17, s[24:27], s62 offen sc1
v_mfma_f32_16x16x32_bf16 v[44:47], v[20:23], v[56:59], v[44:47]
buffer_store_dwordx4 v[148:151], v17, s[24:27], s62 offen offset:512 sc1
v_mfma_f32_32x32x16_bf16 v[240:255], v[56:59], v[116:119], v[240:255]
s_waitcnt lgkmcnt(0)
v_mfma_f32_32x32x16_bf16 v[224:239], v[60:63], v[120:123], v[224:239]
s_nop 3
ds_write_b32 v18, v44 offset:512
ds_write_b32 v18, v45 offset:576
v_mfma_f32_32x32x16_bf16 v[240:255], v[60:63], v[124:127], v[240:255]
s_waitcnt lgkmcnt(0)
s_waitcnt vmcnt(2)
s_cmp_lg_u32 s42, 0
s_cbranch_scc1 L_pc_7
v_cmp_ne_u32 s[48:49], s79, v13
s_nop 1
s_cmp_eq_u64 s[48:49], 0
s_cbranch_scc1 L_pc_7
s_cmp_lg_u32 s42, 0
s_cbranch_scc1 L_poll_8_ok
s_mov_b32 s46, 0x40000
L_poll_8:
buffer_load_dword v13, v0, s[24:27], 0 offen sc1
s_waitcnt vmcnt(0)
v_cmp_ne_u32 s[48:49], s79, v13
s_nop 1
s_cmp_eq_u64 s[48:49], 0
s_cbranch_scc1 L_poll_8_ok
s_sleep 1
s_sub_u32 s46, s46, 1
s_cmp_lg_u32 s46, 0
s_cbranch_scc1 L_poll_8
L_poll_8_ok:
L_pc_7:
s_barrier
ds_read_b32 v38, v19 offset:512
ds_read_b32 v39, v19 offset:640
s_waitcnt lgkmcnt(0)
v_add_f32 v38, v38, v39
v_cvt_pk_bf16_f32 v39, v38, v38
v_lshlrev_b32 v39, 16, v39
v_sub_f32 v39, v38, v39
s_add_u32 m0, s72, 0
s_nop 0
buffer_load_dwordx4 v5, s[24:27], s70 offen sc1 lds
v_cvt_pk_bf16_f32 v24, v38, v39
s_nop 1
v_mfma_f32_32x32x8bf16_1k v[224:239], v[24:25], v[26:27], v[224:239]
v_mfma_f32_32x32x8bf16_1k v[240:255], v[24:25], v[28:29], v[240:255]
s_lshl_b32 s52, s69, 1
s_add_u32 s52, s52, s44
s_lshl_b32 s52, s52, 10
s_add_u32 s52, s52, 8388608
buffer_load_dwordx4 v5, s[24:27], s70 offen offset:1024 sc1 lds
s_mul_i32 s53, s55, 110592
s_add_u32 s61, s52, s53
s_mul_i32 s53, s56, 110592
s_add_u32 s62, s52, s53
v_pk_mul_f32 v[44:45], v[192:193], v[192:193]
v_pk_mul_f32 v[46:47], v[194:195], v[194:195]
v_pk_mul_f32 v[48:49], v[196:197], v[196:197]
s_mov_b32 exec_hi, 0
buffer_load_dwordx4 v5, s[24:27], s70 offen offset:2048 sc1 lds
s_mov_b32 exec_hi, -1
v_pk_mul_f32 v[50:51], v[198:199], v[198:199]
v_pk_fma_f32 v[44:45], v[44:45], v[32:33], v[32:33] op_sel:[0,1,0] op_sel_hi:[1,1,0]
v_pk_fma_f32 v[46:47], v[46:47], v[32:33], v[32:33] op_sel:[0,1,0] op_sel_hi:[1,1,0]
v_pk_fma_f32 v[48:49], v[48:49], v[32:33], v[32:33] op_sel:[0,1,0] op_sel_hi:[1,1,0]
v_pk_fma_f32 v[50:51], v[50:51], v[32:33], v[32:33] op_sel:[0,1,0] op_sel_hi:[1,1,0]
v_pk_mul_f32 v[44:45], v[192:193], v[44:45]
s_add_u32 m0, s72, 36864
s_nop 0
buffer_load_dwordx4 v6, s[24:27], s71 offen sc1 lds
v_pk_mul_f32 v[46:47], v[194:195], v[46:47]
v_pk_mul_f32 v[48:49], v[196:197], v[48:49]
v_pk_mul_f32 v[50:51], v[198:199], v[50:51]
v_exp_f32 v44, v44
v_exp_f32 v45, v45
v_exp_f32 v46, v46
v_exp_f32 v47, v47
buffer_load_dwordx4 v7, s[24:27], s71 offen offset:1024 sc1 lds
v_exp_f32 v48, v48
v_exp_f32 v49, v49
v_exp_f32 v50, v50
v_exp_f32 v51, v51
v_pk_mul_f32 v[192:193], v[192:193], v[224:225]
v_pk_mul_f32 v[194:195], v[194:195], v[226:227]
v_pk_mul_f32 v[196:197], v[196:197], v[228:229]
s_mov_b32 exec_hi, 0
buffer_load_dwordx4 v8, s[24:27], s71 offen offset:2048 sc1 lds
s_mov_b32 exec_hi, -1
v_pk_mul_f32 v[198:199], v[198:199], v[230:231]
v_pk_fma_f32 v[44:45], v[44:45], v[34:35], v[34:35] op_sel:[0,0,0] op_sel_hi:[1,0,0]
v_pk_fma_f32 v[46:47], v[46:47], v[34:35], v[34:35] op_sel:[0,0,0] op_sel_hi:[1,0,0]
v_pk_fma_f32 v[48:49], v[48:49], v[34:35], v[34:35] op_sel:[0,0,0] op_sel_hi:[1,0,0]
v_pk_fma_f32 v[50:51], v[50:51], v[34:35], v[34:35] op_sel:[0,0,0] op_sel_hi:[1,0,0]
v_rcp_f32 v44, v44
v_rcp_f32 v45, v45
s_add_u32 m0, s75, 0
s_nop 0
buffer_load_dwordx4 v5, s[24:27], s73 offen sc1 lds
v_rcp_f32 v46, v46
v_rcp_f32 v47, v47
v_rcp_f32 v48, v48
v_rcp_f32 v49, v49
v_rcp_f32 v50, v50
v_rcp_f32 v51, v51
buffer_load_dwordx4 v5, s[24:27], s73 offen offset:1024 sc1 lds
v_pk_mul_f32 v[192:193], v[192:193], v[44:45]
v_pk_mul_f32 v[194:195], v[194:195], v[46:47]
v_pk_mul_f32 v[196:197], v[196:197], v[48:49]
v_pk_mul_f32 v[198:199], v[198:199], v[50:51]
v_cvt_pk_bf16_f32 v224, v192, v193
v_cvt_pk_bf16_f32 v225, v194, v195
v_cvt_pk_bf16_f32 v226, v196, v197
s_mov_b32 exec_hi, 0
buffer_load_dwordx4 v5, s[24:27], s73 offen offset:2048 sc1 lds
s_mov_b32 exec_hi, -1
v_cvt_pk_bf16_f32 v227, v198, v199
v_pk_mul_f32 v[44:45], v[200:201], v[200:201]
v_pk_mul_f32 v[46:47], v[202:203], v[202:203]
v_pk_mul_f32 v[48:49], v[204:205], v[204:205]
v_pk_mul_f32 v[50:51], v[206:207], v[206:207]
v_pk_fma_f32 v[44:45], v[44:45], v[32:33], v[32:33] op_sel:[0,1,0] op_sel_hi:[1,1,0]
v_pk_fma_f32 v[46:47], v[46:47], v[32:33], v[32:33] op_sel:[0,1,0] op_sel_hi:[1,1,0]
s_add_u32 m0, s75, 36864
s_nop 0
buffer_load_dwordx4 v6, s[24:27], s74 offen sc1 lds
v_pk_fma_f32 v[48:49], v[48:49], v[32:33], v[32:33] op_sel:[0,1,0] op_sel_hi:[1,1,0]
v_pk_fma_f32 v[50:51], v[50:51], v[32:33], v[32:33] op_sel:[0,1,0] op_sel_hi:[1,1,0]
v_pk_mul_f32 v[44:45], v[200:201], v[44:45]
v_pk_mul_f32 v[46:47], v[202:203], v[46:47]
v_pk_mul_f32 v[48:49], v[204:205], v[48:49]
v_pk_mul_f32 v[50:51], v[206:207], v[50:51]
buffer_load_dwordx4 v7, s[24:27], s74 offen offset:1024 sc1 lds
v_exp_f32 v44, v44
v_exp_f32 v45, v45
v_exp_f32 v46, v46
v_exp_f32 v47, v47
v_exp_f32 v48, v48
v_exp_f32 v49, v49
v_exp_f32 v50, v50
s_mov_b32 exec_hi, 0
buffer_load_dwordx4 v8, s[24:27], s74 offen offset:2048 sc1 lds
s_mov_b32 exec_hi, -1
v_exp_f32 v51, v51
v_pk_mul_f32 v[200:201], v[200:201], v[232:233]
v_pk_mul_f32 v[202:203], v[202:203], v[234:235]
v_pk_mul_f32 v[204:205], v[204:205], v[236:237]
v_pk_mul_f32 v[206:207], v[206:207], v[238:239]
v_pk_fma_f32 v[44:45], v[44:45], v[34:35], v[34:35] op_sel:[0,0,0] op_sel_hi:[1,0,0]
v_pk_fma_f32 v[46:47], v[46:47], v[34:35], v[34:35] op_sel:[0,0,0] op_sel_hi:[1,0,0]
s_add_u32 m0, s58, 0
s_nop 0
buffer_load_dwordx4 v5, s[24:27], s76 offen sc1 lds
v_pk_fma_f32 v[48:49], v[48:49], v[34:35], v[34:35] op_sel:[0,0,0] op_sel_hi:[1,0,0]
v_pk_fma_f32 v[50:51], v[50:51], v[34:35], v[34:35] op_sel:[0,0,0] op_sel_hi:[1,0,0]
v_rcp_f32 v44, v44
v_rcp_f32 v45, v45
v_rcp_f32 v46, v46
v_rcp_f32 v47, v47
v_rcp_f32 v48, v48
buffer_load_dwordx4 v5, s[24:27], s76 offen offset:1024 sc1 lds
v_rcp_f32 v49, v49
v_rcp_f32 v50, v50
v_rcp_f32 v51, v51
v_pk_mul_f32 v[200:201], v[200:201], v[44:45]
v_pk_mul_f32 v[202:203], v[202:203], v[46:47]
v_pk_mul_f32 v[204:205], v[204:205], v[48:49]
s_mov_b32 exec_hi, 0
buffer_load_dwordx4 v5, s[24:27], s76 offen offset:2048 sc1 lds
s_mov_b32 exec_hi, -1
v_pk_mul_f32 v[206:207], v[206:207], v[50:51]
v_cvt_pk_bf16_f32 v228, v200, v201
v_cvt_pk_bf16_f32 v229, v202, v203
v_cvt_pk_bf16_f32 v230, v204, v205
v_cvt_pk_bf16_f32 v231, v206, v207
buffer_store_dwordx4 v[224:227], v17, s[24:27], s61 offen sc1
buffer_store_dwordx4 v[228:231], v17, s[24:27], s61 offen offset:512 sc1
s_add_u32 m0, s58, 36864
s_nop 0
buffer_load_dwordx4 v6, s[24:27], s57 offen sc1 lds
v_pk_mul_f32 v[44:45], v[208:209], v[208:209]
v_pk_mul_f32 v[46:47], v[210:211], v[210:211]
v_pk_mul_f32 v[48:49], v[212:213], v[212:213]
v_pk_mul_f32 v[50:51], v[214:215], v[214:215]
v_pk_fma_f32 v[44:45], v[44:45], v[36:37], v[34:35] op_sel:[0,0,1] op_sel_hi:[1,0,1]
v_pk_fma_f32 v[46:47], v[46:47], v[36:37], v[34:35] op_sel:[0,0,1] op_sel_hi:[1,0,1]
v_pk_fma_f32 v[48:49], v[48:49], v[36:37], v[34:35] op_sel:[0,0,1] op_sel_hi:[1,0,1]
buffer_load_dwordx4 v7, s[24:27], s57 offen offset:1024 sc1 lds
v_pk_fma_f32 v[50:51], v[50:51], v[36:37], v[34:35] op_sel:[0,0,1] op_sel_hi:[1,0,1]
v_pk_mul_f32 v[44:45], v[208:209], v[44:45]
v_pk_mul_f32 v[46:47], v[210:211], v[46:47]
v_pk_mul_f32 v[48:49], v[212:213], v[48:49]
v_pk_mul_f32 v[50:51], v[214:215], v[50:51]
v_exp_f32 v44, v44
v_exp_f32 v45, v45
s_mov_b32 exec_hi, 0
buffer_load_dwordx4 v8, s[24:27], s57 offen offset:2048 sc1 lds
s_mov_b32 exec_hi, -1
v_exp_f32 v46, v46
v_exp_f32 v47, v47
v_exp_f32 v48, v48
v_exp_f32 v49, v49
v_exp_f32 v50, v50
v_exp_f32 v51, v51
buffer_load_dwordx4 v[64:67], v5, s[24:27], s63 offen sc1
v_pk_mul_f32 v[208:209], v[208:209], v[240:241]
v_pk_mul_f32 v[210:211], v[210:211], v[242:243]
v_pk_mul_f32 v[212:213], v[212:213], v[244:245]
v_pk_mul_f32 v[214:215], v[214:215], v[246:247]
v_pk_fma_f32 v[44:45], v[44:45], v[36:37], v[36:37] op_sel:[0,1,1] op_sel_hi:[1,1,1]
v_pk_fma_f32 v[46:47], v[46:47], v[36:37], v[36:37] op_sel:[0,1,1] op_sel_hi:[1,1,1]
v_pk_fma_f32 v[48:49], v[48:49], v[36:37], v[36:37] op_sel:[0,1,1] op_sel_hi:[1,1,1]
buffer_load_dwordx4 v[68:71], v5, s[24:27], s63 offen offset:1536 sc1
v_pk_fma_f32 v[50:51], v[50:51], v[36:37], v[36:37] op_sel:[0,1,1] op_sel_hi:[1,1,1]
v_rcp_f32 v44, v44
v_rcp_f32 v45, v45
v_rcp_f32 v46, v46
v_rcp_f32 v47, v47
v_rcp_f32 v48, v48
v_rcp_f32 v49, v49
buffer_load_dwordx2 v[72:73], v9, s[24:27], s63 offen offset:1024 sc1
v_rcp_f32 v50, v50
v_rcp_f32 v51, v51
v_pk_mul_f32 v[208:209], v[208:209], v[44:45]
v_pk_mul_f32 v[210:211], v[210:211], v[46:47]
v_pk_mul_f32 v[212:213], v[212:213], v[48:49]
v_pk_mul_f32 v[214:215], v[214:215], v[50:51]
s_add_u32 s45, s85, 48
s_lshl_b32 s45, s45, 7
s_add_u32 s45, s45, 25165824
v_min_u32 v78, 15, v1
v_lshl_add_u32 v78, v78, 2, s45
s_lshl_b32 s45, s2, 2
s_add_u32 s45, s45, s42
s_lshl_b32 s45, s45, 7
s_add_u32 s45, s45, 27262976
s_cmp_eq_u32 s42, 0
s_cselect_b64 s[48:49], -1, 0
v_mov_b32 v79, s45
v_cndmask_b32_e64 v78, v79, v78, s[48:49]
buffer_load_dword v79, v78, s[24:27], 0 offen sc1
v_cvt_pk_bf16_f32 v240, v208, v209
v_cvt_pk_bf16_f32 v241, v210, v211
v_cvt_pk_bf16_f32 v242, v212, v213
v_cvt_pk_bf16_f32 v243, v214, v215
v_pk_mul_f32 v[44:45], v[216:217], v[216:217]
v_pk_mul_f32 v[46:47], v[218:219], v[218:219]
v_pk_mul_f32 v[48:49], v[220:221], v[220:221]
v_pk_mul_f32 v[50:51], v[222:223], v[222:223]
v_pk_fma_f32 v[44:45], v[44:45], v[36:37], v[34:35] op_sel:[0,0,1] op_sel_hi:[1,0,1]
v_pk_fma_f32 v[46:47], v[46:47], v[36:37], v[34:35] op_sel:[0,0,1] op_sel_hi:[1,0,1]
v_pk_fma_f32 v[48:49], v[48:49], v[36:37], v[34:35] op_sel:[0,0,1] op_sel_hi:[1,0,1]
v_pk_fma_f32 v[50:51], v[50:51], v[36:37], v[34:35] op_sel:[0,0,1] op_sel_hi:[1,0,1]
v_pk_mul_f32 v[44:45], v[216:217], v[44:45]
v_pk_mul_f32 v[46:47], v[218:219], v[46:47]
v_pk_mul_f32 v[48:49], v[220:221], v[48:49]
v_pk_mul_f32 v[50:51], v[222:223], v[50:51]
v_exp_f32 v44, v44
v_exp_f32 v45, v45
v_exp_f32 v46, v46
v_exp_f32 v47, v47
v_exp_f32 v48, v48
v_exp_f32 v49, v49
v_exp_f32 v50, v50
v_exp_f32 v51, v51
v_pk_mul_f32 v[216:217], v[216:217], v[248:249]
v_pk_mul_f32 v[218:219], v[218:219], v[250:251]
v_pk_mul_f32 v[220:221], v[220:221], v[252:253]
v_pk_mul_f32 v[222:223], v[222:223], v[254:255]
v_pk_fma_f32 v[44:45], v[44:45], v[36:37], v[36:37] op_sel:[0,1,1] op_sel_hi:[1,1,1]
v_pk_fma_f32 v[46:47], v[46:47], v[36:37], v[36:37] op_sel:[0,1,1] op_sel_hi:[1,1,1]
v_pk_fma_f32 v[48:49], v[48:49], v[36:37], v[36:37] op_sel:[0,1,1] op_sel_hi:[1,1,1]
v_pk_fma_f32 v[50:51], v[50:51], v[36:37], v[36:37] op_sel:[0,1,1] op_sel_hi:[1,1,1]
v_rcp_f32 v44, v44
v_rcp_f32 v45, v45
v_rcp_f32 v46, v46
v_rcp_f32 v47, v47
v_rcp_f32 v48, v48
v_rcp_f32 v49, v49
v_rcp_f32 v50, v50
v_rcp_f32 v51, v51
v_pk_mul_f32 v[216:217], v[216:217], v[44:45]
v_pk_mul_f32 v[218:219], v[218:219], v[46:47]
v_pk_mul_f32 v[220:221], v[220:221], v[48:49]
v_pk_mul_f32 v[222:223], v[222:223], v[50:51]
v_cvt_pk_bf16_f32 v244, v216, v217
v_cvt_pk_bf16_f32 v245, v218, v219
v_cvt_pk_bf16_f32 v246, v220, v221
v_cvt_pk_bf16_f32 v247, v222, v223
buffer_store_dwordx4 v[240:243], v17, s[24:27], s62 offen sc1
buffer_store_dwordx4 v[244:247], v17, s[24:27], s62 offen offset:512 sc1
s_branch L_common
L_p1_D:
s_waitcnt vmcnt(15)
s_barrier
ds_read_b128 a[0:3], v168 offset:0
ds_read_b128 a[4:7], v176 offset:0
ds_read_b64_tr_b16 v[48:49], v11 offset:0
ds_read_b64_tr_b16 v[50:51], v11 offset:512
ds_read_b128 a[8:11], v169 offset:0
ds_read_b128 a[12:15], v177 offset:0
ds_read_b64_tr_b16 v[52:53], v12 offset:0
ds_read_b64_tr_b16 v[54:55], v12 offset:512
s_waitcnt lgkmcnt(4)
v_mfma_f32_32x32x16_bf16 v[224:239], v[48:51], a[0:3], 0
s_add_u32 s65, s50, 5
s_mov_b32 s66, s65
s_add_u32 s67, s50, 6
s_mov_b32 s68, s67
ds_read_b64_tr_b16 v[56:57], v11 offset:4096
ds_read_b128 a[16:19], v170 offset:0
v_mfma_f32_32x32x16_bf16 v[240:255], v[48:51], a[4:7], 0
s_mov_b32 s16, s88
s_mov_b32 s17, s89
s_mov_b32 s18, 2211840
s_mov_b32 s19, 0x00020000
s_mov_b32 s20, s90
ds_read_b64_tr_b16 v[58:59], v11 offset:4608
ds_read_b128 a[20:23], v178 offset:0
ds_read_b128 v[136:139], v168 offset:0
ds_read_b128 v[140:143], v169 offset:0
ds_read_b128 v[144:147], v170 offset:0
v_mfma_f32_16x16x32_bf16 v[44:47], v[20:23], v[48:51], 0
s_mov_b32 s21, s91
s_mov_b32 s22, 2211840
s_mov_b32 s23, 0x00020000
s_mov_b32 s24, s6
s_waitcnt lgkmcnt(7)
v_mfma_f32_32x32x16_bf16 v[224:239], v[52:55], a[8:11], v[224:239]
s_mov_b32 s25, s7
s_mov_b32 s26, 33554432
s_mov_b32 s27, 0x00020000
s_mov_b32 s32, s84
s_mov_b32 s33, s85
ds_read_b64_tr_b16 v[60:61], v12 offset:4096
ds_read_b128 a[24:27], v171 offset:0
v_mfma_f32_32x32x16_bf16 v[240:255], v[52:55], a[12:15], v[240:255]
s_mov_b32 s34, 819200
s_mov_b32 s35, 0x00020000
s_mov_b32 s28, s92
s_mov_b32 s29, s93
s_mov_b32 s30, 2211840
ds_read_b64_tr_b16 v[62:63], v12 offset:4608
ds_read_b128 a[28:31], v179 offset:0
ds_read_b128 v[148:151], v171 offset:0
s_waitcnt lgkmcnt(8)
v_mfma_f32_32x32x16_bf16 v[224:239], v[56:59], a[16:19], v[224:239]
s_mov_b32 s31, 0x00020000
s_mov_b32 s36, s94
s_mov_b32 s37, s95
s_mov_b32 s38, 2621440
ds_read_b64_tr_b16 v[48:49], v11 offset:8192
ds_read_b128 a[32:35], v172 offset:0
v_mfma_f32_32x32x16_bf16 v[240:255], v[56:59], a[20:23], v[240:255]
s_mov_b32 s39, 0x00020000
v_mul_u32_u24 v42, 3456, v41
v_add_u32 v7, v42, v40
v_add_u32 v8, 26624, v7
v_add_u32 v9, 26624, v8
ds_read_b64_tr_b16 v[50:51], v11 offset:8704
ds_read_b128 a[36:39], v180 offset:0
ds_read_b128 v[152:155], v172 offset:0
v_mfma_f32_16x16x32_bf16 v[44:47], v[20:23], v[56:59], v[44:47]
v_add_u32 v10, 26624, v9
v_lshlrev_b32 v42, 4, v43
v_lshl_add_u32 v16, v35, 9, v42
v_lshrrev_b32 v42, 4, v43
s_waitcnt lgkmcnt(6)
v_mfma_f32_32x32x16_bf16 v[224:239], v[60:63], a[24:27], v[224:239]
v_mul_u32_u24 v42, 55296, v42
v_and_b32 v41, 15, v43
v_lshl_add_u32 v42, v41, 4, v42
v_lshl_add_u32 v17, v35, 8, v42
s_lshl_b32 s52, s44, 8
ds_read_b64_tr_b16 v[52:53], v12 offset:8192
ds_read_b128 a[40:43], v173 offset:0
v_mfma_f32_32x32x16_bf16 v[240:255], v[60:63], a[28:31], v[240:255]
s_add_u32 s52, s52, 149504
v_lshl_add_u32 v19, v43, 2, s52
s_lshl_b32 s53, s43, 7
s_add_u32 s52, s52, s53
v_lshl_add_u32 v18, v1, 2, s52
ds_read_b64_tr_b16 v[54:55], v12 offset:8704
ds_read_b128 a[44:47], v181 offset:0
ds_read_b128 v[156:159], v173 offset:0
s_waitcnt lgkmcnt(6)
v_mfma_f32_32x32x16_bf16 v[224:239], v[48:51], a[32:35], v[224:239]
v_cmp_gt_u32 s[52:53], 16, v1
v_mov_b32 v42, 151040
s_nop 0
v_cndmask_b32_e64 v18, v42, v18, s[52:53]
s_lshl_b32 s52, s40, 2
ds_read_b64_tr_b16 v[56:57], v11 offset:12288
ds_read_b128 a[48:51], v174 offset:0
v_mfma_f32_32x32x16_bf16 v[240:255], v[48:51], a[36:39], v[240:255]
s_add_u32 s55, s52, s42
s_xor_b32 s54, s42, 1
s_add_u32 s56, s52, s54
s_and_b32 s52, s40, 7
s_mul_i32 s52, s52, 80
ds_read_b64_tr_b16 v[58:59], v11 offset:12800
ds_read_b128 a[52:55], v182 offset:0
ds_read_b128 v[160:163], v174 offset:0
v_mfma_f32_16x16x32_bf16 v[44:47], v[20:23], v[48:51], v[44:47]
s_mul_i32 s53, s42, 20
s_add_u32 s52, s52, s53
v_add_u32 v15, s52, v1
v_cmp_gt_u32 s[52:53], 20, v1
s_waitcnt lgkmcnt(6)
v_mfma_f32_32x32x16_bf16 v[224:239], v[52:55], a[40:43], v[224:239]
v_mov_b32 v14, 0x100000
v_cndmask_b32_e64 v15, v14, v15, s[52:53]
s_add_u32 m0, s74, 114688
s_add_u32 s75, s73, 512
buffer_load_dwordx4 v128, s[8:11], s75 offen offset:0  lds
ds_read_b64_tr_b16 v[60:61], v12 offset:12288
ds_read_b128 a[56:59], v175 offset:0
v_mfma_f32_32x32x16_bf16 v[240:255], v[52:55], a[44:47], v[240:255]
buffer_load_dwordx4 v129, s[8:11], s75 offen offset:1024  lds
buffer_load_dwordx4 v130, s[8:11], s75 offen offset:2048  lds
buffer_load_dwordx4 v131, s[8:11], s75 offen offset:3072  lds
s_add_u32 m0, s74, 118784
s_add_u32 s75, s73, 20992
ds_read_b64_tr_b16 v[62:63], v12 offset:12800
ds_read_b128 a[60:63], v183 offset:0
ds_read_b128 v[164:167], v175 offset:0
s_waitcnt lgkmcnt(6)
v_mfma_f32_32x32x16_bf16 v[224:239], v[56:59], a[48:51], v[224:239]
buffer_load_dwordx4 v128, s[8:11], s75 offen offset:0  lds
buffer_load_dwordx4 v129, s[8:11], s75 offen offset:1024  lds
buffer_load_dwordx4 v130, s[8:11], s75 offen offset:2048  lds
buffer_load_dwordx4 v131, s[8:11], s75 offen offset:3072  lds
v_mfma_f32_32x32x16_bf16 v[240:255], v[56:59], a[52:55], v[240:255]
s_lshl_b32 s60, s64, 7
s_add_u32 s60, s60, 983040
s_add_u32 m0, s59, 32768
s_nop 0
buffer_load_dwordx4 v3, s[12:15], s60 offen offset:0  lds
buffer_load_dwordx4 v4, s[12:15], s60 offen offset:1024  lds
v_mfma_f32_16x16x32_bf16 v[44:47], v[20:23], v[56:59], v[44:47]
buffer_load_dwordx4 v5, s[12:15], s60 offen offset:2048  lds
buffer_load_dwordx4 v6, s[12:15], s60 offen offset:3072  lds
v_mul_u32_u24 v190, 3456, v15
s_lshl_b32 s97, s65, 7
buffer_load_dword v190, v190, s[16:19], s97 offen
s_waitcnt lgkmcnt(1)
v_mfma_f32_32x32x16_bf16 v[224:239], v[60:63], a[56:59], v[224:239]
v_mfma_f32_32x32x16_bf16 v[240:255], v[60:63], a[60:63], v[240:255]
s_waitcnt vmcnt(16) lgkmcnt(0)
s_barrier
v_add_u32 v11, 0x4000, v11
v_add_u32 v12, 0x4000, v12
ds_read_b128 a[64:67], v168 offset:32768
ds_read_b128 a[68:71], v176 offset:32768
ds_read_b64_tr_b16 v[48:49], v11 offset:0
ds_read_b64_tr_b16 v[50:51], v11 offset:512
ds_read_b128 a[72:75], v169 offset:32768
ds_read_b128 a[76:79], v177 offset:32768
ds_read_b64_tr_b16 v[52:53], v12 offset:0
ds_read_b64_tr_b16 v[54:55], v12 offset:512
v_dot2c_f32_bf16 v24, 0x3f803f80, v136
v_dot2c_f32_bf16 v28, v136, v136
v_dot2c_f32_bf16 v25, 0x3f803f80, v137
v_dot2c_f32_bf16 v29, v137, v137
v_dot2c_f32_bf16 v26, 0x3f803f80, v138
v_dot2c_f32_bf16 v30, v138, v138
v_dot2c_f32_bf16 v27, 0x3f803f80, v139
v_dot2c_f32_bf16 v31, v139, v139
v_dot2c_f32_bf16 v24, 0x3f803f80, v140
v_dot2c_f32_bf16 v28, v140, v140
v_dot2c_f32_bf16 v25, 0x3f803f80, v141
v_dot2c_f32_bf16 v29, v141, v141
v_dot2c_f32_bf16 v26, 0x3f803f80, v142
v_dot2c_f32_bf16 v30, v142, v142
v_dot2c_f32_bf16 v27, 0x3f803f80, v143
v_dot2c_f32_bf16 v31, v143, v143
v_dot2c_f32_bf16 v24, 0x3f803f80, v144
v_dot2c_f32_bf16 v28, v144, v144
v_dot2c_f32_bf16 v25, 0x3f803f80, v145
v_dot2c_f32_bf16 v29, v145, v145
v_dot2c_f32_bf16 v26, 0x3f803f80, v146
v_dot2c_f32_bf16 v30, v146, v146
v_dot2c_f32_bf16 v27, 0x3f803f80, v147
v_dot2c_f32_bf16 v31, v147, v147
v_dot2c_f32_bf16 v24, 0x3f803f80, v148
v_dot2c_f32_bf16 v28, v148, v148
v_dot2c_f32_bf16 v25, 0x3f803f80, v149
v_dot2c_f32_bf16 v29, v149, v149
v_dot2c_f32_bf16 v26, 0x3f803f80, v150
v_dot2c_f32_bf16 v30, v150, v150
v_dot2c_f32_bf16 v27, 0x3f803f80, v151
v_dot2c_f32_bf16 v31, v151, v151
v_dot2c_f32_bf16 v24, 0x3f803f80, v152
v_dot2c_f32_bf16 v28, v152, v152
v_dot2c_f32_bf16 v25, 0x3f803f80, v153
v_dot2c_f32_bf16 v29, v153, v153
v_dot2c_f32_bf16 v26, 0x3f803f80, v154
v_dot2c_f32_bf16 v30, v154, v154
v_dot2c_f32_bf16 v27, 0x3f803f80, v155
v_dot2c_f32_bf16 v31, v155, v155
v_dot2c_f32_bf16 v24, 0x3f803f80, v156
v_dot2c_f32_bf16 v28, v156, v156
v_dot2c_f32_bf16 v25, 0x3f803f80, v157
v_dot2c_f32_bf16 v29, v157, v157
v_dot2c_f32_bf16 v26, 0x3f803f80, v158
v_dot2c_f32_bf16 v30, v158, v158
v_dot2c_f32_bf16 v27, 0x3f803f80, v159
v_dot2c_f32_bf16 v31, v159, v159
v_dot2c_f32_bf16 v24, 0x3f803f80, v160
v_dot2c_f32_bf16 v28, v160, v160
v_dot2c_f32_bf16 v25, 0x3f803f80, v161
v_dot2c_f32_bf16 v29, v161, v161
v_dot2c_f32_bf16 v26, 0x3f803f80, v162
v_dot2c_f32_bf16 v30, v162, v162
v_dot2c_f32_bf16 v27, 0x3f803f80, v163
v_dot2c_f32_bf16 v31, v163, v163
v_dot2c_f32_bf16 v24, 0x3f803f80, v164
v_dot2c_f32_bf16 v28, v164, v164
v_dot2c_f32_bf16 v25, 0x3f803f80, v165
v_dot2c_f32_bf16 v29, v165, v165
v_dot2c_f32_bf16 v26, 0x3f803f80, v166
v_dot2c_f32_bf16 v30, v166, v166
v_dot2c_f32_bf16 v27, 0x3f803f80, v167
v_dot2c_f32_bf16 v31, v167, v167
s_cmp_lg_u32 s42, 0
s_cbranch_scc1 L_w0_10
v_mov_b32 v0, 0
global_load_dword v13, v0, s[4:5] sc0 sc1
L_w0_10:
s_waitcnt lgkmcnt(4)
v_mfma_f32_32x32x16_bf16 v[224:239], v[48:51], a[64:67], v[224:239]
s_add_u32 m0, s74, 49152
ds_read_b64_tr_b16 v[56:57], v11 offset:4096
ds_read_b128 a[80:83], v170 offset:32768
v_mfma_f32_32x32x16_bf16 v[240:255], v[48:51], a[68:71], v[240:255]
s_add_u32 s75, s73, 768
ds_read_b64_tr_b16 v[58:59], v11 offset:4608
ds_read_b128 a[84:87], v178 offset:32768
ds_read_b128 v[136:139], v168 offset:32768
v_add_u32 v168, 0x10000, v168
v_add_u32 v176, 0x10000, v176
ds_read_b128 v[140:143], v169 offset:32768
v_add_u32 v169, 0x10000, v169
v_add_u32 v177, 0x10000, v177
ds_read_b128 v[144:147], v170 offset:32768
v_add_u32 v170, 0x10000, v170
v_add_u32 v178, 0x10000, v178
v_mfma_f32_16x16x32_bf16 v[44:47], v[20:23], v[48:51], v[44:47]
buffer_load_dwordx4 v128, s[8:11], s75 offen offset:0  lds
s_waitcnt lgkmcnt(7)
v_mfma_f32_32x32x16_bf16 v[224:239], v[52:55], a[72:75], v[224:239]
buffer_load_dwordx4 v129, s[8:11], s75 offen offset:1024  lds
ds_read_b64_tr_b16 v[60:61], v12 offset:4096
ds_read_b128 a[88:91], v171 offset:32768
v_mfma_f32_32x32x16_bf16 v[240:255], v[52:55], a[76:79], v[240:255]
buffer_load_dwordx4 v130, s[8:11], s75 offen offset:2048  lds
ds_read_b64_tr_b16 v[62:63], v12 offset:4608
ds_read_b128 a[92:95], v179 offset:32768
ds_read_b128 v[148:151], v171 offset:32768
v_add_u32 v171, 0x10000, v171
v_add_u32 v179, 0x10000, v179
s_waitcnt lgkmcnt(8)
v_mfma_f32_32x32x16_bf16 v[224:239], v[56:59], a[80:83], v[224:239]
buffer_load_dwordx4 v131, s[8:11], s75 offen offset:3072  lds
ds_read_b64_tr_b16 v[48:49], v11 offset:8192
ds_read_b128 a[96:99], v172 offset:32768
v_mfma_f32_32x32x16_bf16 v[240:255], v[56:59], a[84:87], v[240:255]
s_add_u32 m0, s74, 53248
ds_read_b64_tr_b16 v[50:51], v11 offset:8704
ds_read_b128 a[100:103], v180 offset:32768
ds_read_b128 v[152:155], v172 offset:32768
v_add_u32 v172, 0x10000, v172
v_add_u32 v180, 0x10000, v180
v_mfma_f32_16x16x32_bf16 v[44:47], v[20:23], v[56:59], v[44:47]
s_add_u32 s75, s73, 21248
s_waitcnt lgkmcnt(6)
v_mfma_f32_32x32x16_bf16 v[224:239], v[60:63], a[88:91], v[224:239]
buffer_load_dwordx4 v128, s[8:11], s75 offen offset:0  lds
ds_read_b64_tr_b16 v[52:53], v12 offset:8192
ds_read_b128 a[104:107], v173 offset:32768
v_mfma_f32_32x32x16_bf16 v[240:255], v[60:63], a[92:95], v[240:255]
buffer_load_dwordx4 v129, s[8:11], s75 offen offset:1024  lds
ds_read_b64_tr_b16 v[54:55], v12 offset:8704
ds_read_b128 a[108:111], v181 offset:32768
ds_read_b128 v[156:159], v173 offset:32768
v_add_u32 v173, 0x10000, v173
v_add_u32 v181, 0x10000, v181
s_waitcnt lgkmcnt(6)
v_mfma_f32_32x32x16_bf16 v[224:239], v[48:51], a[96:99], v[224:239]
buffer_load_dwordx4 v130, s[8:11], s75 offen offset:2048  lds
ds_read_b64_tr_b16 v[56:57], v11 offset:12288
ds_read_b128 a[112:115], v174 offset:32768
v_mfma_f32_32x32x16_bf16 v[240:255], v[48:51], a[100:103], v[240:255]
buffer_load_dwordx4 v131, s[8:11], s75 offen offset:3072  lds
ds_read_b64_tr_b16 v[58:59], v11 offset:12800
ds_read_b128 a[116:119], v182 offset:32768
ds_read_b128 v[160:163], v174 offset:32768
v_add_u32 v174, 0x10000, v174
v_add_u32 v182, 0x10000, v182
v_mfma_f32_16x16x32_bf16 v[44:47], v[20:23], v[48:51], v[44:47]
s_lshl_b32 s60, s64, 7
s_waitcnt lgkmcnt(6)
v_mfma_f32_32x32x16_bf16 v[224:239], v[52:55], a[104:107], v[224:239]
s_add_u32 s60, s60, 1474560
ds_read_b64_tr_b16 v[60:61], v12 offset:12288
ds_read_b128 a[120:123], v175 offset:32768
v_mfma_f32_32x32x16_bf16 v[240:255], v[52:55], a[108:111], v[240:255]
s_add_u32 m0, s59, 0
ds_read_b64_tr_b16 v[62:63], v12 offset:12800
ds_read_b128 a[124:127], v183 offset:32768
ds_read_b128 v[164:167], v175 offset:32768
v_add_u32 v175, 0x10000, v175
v_add_u32 v183, 0x10000, v183
s_waitcnt lgkmcnt(6)
v_mfma_f32_32x32x16_bf16 v[224:239], v[56:59], a[112:115], v[224:239]
buffer_load_dwordx4 v3, s[12:15], s60 offen offset:0  lds
v_mfma_f32_32x32x16_bf16 v[240:255], v[56:59], a[116:119], v[240:255]
buffer_load_dwordx4 v4, s[12:15], s60 offen offset:1024  lds
v_mfma_f32_16x16x32_bf16 v[44:47], v[20:23], v[56:59], v[44:47]
buffer_load_dwordx4 v5, s[12:15], s60 offen offset:2048  lds
buffer_load_dwordx4 v6, s[12:15], s60 offen offset:3072  lds
s_waitcnt lgkmcnt(1)
v_mfma_f32_32x32x16_bf16 v[224:239], v[60:63], a[120:123], v[224:239]
v_mfma_f32_32x32x16_bf16 v[240:255], v[60:63], a[124:127], v[240:255]
s_waitcnt vmcnt(13) lgkmcnt(0)
s_barrier
v_add_u32 v11, 0x4000, v11
v_add_u32 v12, 0x4000, v12
ds_read_b128 a[128:131], v168 offset:0
ds_read_b128 a[132:135], v176 offset:0
ds_read_b64_tr_b16 v[48:49], v11 offset:0
ds_read_b64_tr_b16 v[50:51], v11 offset:512
ds_read_b128 a[136:139], v169 offset:0
ds_read_b128 a[140:143], v177 offset:0
ds_read_b64_tr_b16 v[52:53], v12 offset:0
ds_read_b64_tr_b16 v[54:55], v12 offset:512
v_dot2c_f32_bf16 v24, 0x3f803f80, v136
v_dot2c_f32_bf16 v28, v136, v136
v_dot2c_f32_bf16 v25, 0x3f803f80, v137
v_dot2c_f32_bf16 v29, v137, v137
v_dot2c_f32_bf16 v26, 0x3f803f80, v138
v_dot2c_f32_bf16 v30, v138, v138
v_dot2c_f32_bf16 v27, 0x3f803f80, v139
v_dot2c_f32_bf16 v31, v139, v139
v_dot2c_f32_bf16 v24, 0x3f803f80, v140
v_dot2c_f32_bf16 v28, v140, v140
v_dot2c_f32_bf16 v25, 0x3f803f80, v141
v_dot2c_f32_bf16 v29, v141, v141
v_dot2c_f32_bf16 v26, 0x3f803f80, v142
v_dot2c_f32_bf16 v30, v142, v142
v_dot2c_f32_bf16 v27, 0x3f803f80, v143
v_dot2c_f32_bf16 v31, v143, v143
v_dot2c_f32_bf16 v24, 0x3f803f80, v144
v_dot2c_f32_bf16 v28, v144, v144
v_dot2c_f32_bf16 v25, 0x3f803f80, v145
v_dot2c_f32_bf16 v29, v145, v145
v_dot2c_f32_bf16 v26, 0x3f803f80, v146
v_dot2c_f32_bf16 v30, v146, v146
v_dot2c_f32_bf16 v27, 0x3f803f80, v147
v_dot2c_f32_bf16 v31, v147, v147
v_dot2c_f32_bf16 v24, 0x3f803f80, v148
v_dot2c_f32_bf16 v28, v148, v148
v_dot2c_f32_bf16 v25, 0x3f803f80, v149
v_dot2c_f32_bf16 v29, v149, v149
v_dot2c_f32_bf16 v26, 0x3f803f80, v150
v_dot2c_f32_bf16 v30, v150, v150
v_dot2c_f32_bf16 v27, 0x3f803f80, v151
v_dot2c_f32_bf16 v31, v151, v151
v_dot2c_f32_bf16 v24, 0x3f803f80, v152
v_dot2c_f32_bf16 v28, v152, v152
v_dot2c_f32_bf16 v25, 0x3f803f80, v153
v_dot2c_f32_bf16 v29, v153, v153
v_dot2c_f32_bf16 v26, 0x3f803f80, v154
v_dot2c_f32_bf16 v30, v154, v154
v_dot2c_f32_bf16 v27, 0x3f803f80, v155
v_dot2c_f32_bf16 v31, v155, v155
v_dot2c_f32_bf16 v24, 0x3f803f80, v156
v_dot2c_f32_bf16 v28, v156, v156
v_dot2c_f32_bf16 v25, 0x3f803f80, v157
v_dot2c_f32_bf16 v29, v157, v157
v_dot2c_f32_bf16 v26, 0x3f803f80, v158
v_dot2c_f32_bf16 v30, v158, v158
v_dot2c_f32_bf16 v27, 0x3f803f80, v159
v_dot2c_f32_bf16 v31, v159, v159
v_dot2c_f32_bf16 v24, 0x3f803f80, v160
v_dot2c_f32_bf16 v28, v160, v160
v_dot2c_f32_bf16 v25, 0x3f803f80, v161
v_dot2c_f32_bf16 v29, v161, v161
v_dot2c_f32_bf16 v26, 0x3f803f80, v162
v_dot2c_f32_bf16 v30, v162, v162
v_dot2c_f32_bf16 v27, 0x3f803f80, v163
v_dot2c_f32_bf16 v31, v163, v163
v_dot2c_f32_bf16 v24, 0x3f803f80, v164
v_dot2c_f32_bf16 v28, v164, v164
v_dot2c_f32_bf16 v25, 0x3f803f80, v165
v_dot2c_f32_bf16 v29, v165, v165
v_dot2c_f32_bf16 v26, 0x3f803f80, v166
v_dot2c_f32_bf16 v30, v166, v166
v_dot2c_f32_bf16 v27, 0x3f803f80, v167
v_dot2c_f32_bf16 v31, v167, v167
s_waitcnt lgkmcnt(4)
v_mfma_f32_32x32x16_bf16 v[224:239], v[48:51], a[128:131], v[224:239]
s_add_u32 m0, s74, 81920
ds_read_b64_tr_b16 v[56:57], v11 offset:4096
ds_read_b128 a[144:147], v170 offset:0
v_mfma_f32_32x32x16_bf16 v[240:255], v[48:51], a[132:135], v[240:255]
s_add_u32 s75, s73, 1024
ds_read_b64_tr_b16 v[58:59], v11 offset:4608
ds_read_b128 a[148:151], v178 offset:0
ds_read_b128 v[136:139], v168 offset:0
v_add_u32 v168, 0xffff0000, v168
v_add_u32 v176, 0xffff0000, v176
ds_read_b128 v[140:143], v169 offset:0
v_add_u32 v169, 0xffff0000, v169
v_add_u32 v177, 0xffff0000, v177
ds_read_b128 v[144:147], v170 offset:0
v_add_u32 v170, 0xffff0000, v170
v_add_u32 v178, 0xffff0000, v178
v_mfma_f32_16x16x32_bf16 v[44:47], v[20:23], v[48:51], v[44:47]
buffer_load_dwordx4 v128, s[8:11], s75 offen offset:0  lds
s_waitcnt lgkmcnt(7)
v_mfma_f32_32x32x16_bf16 v[224:239], v[52:55], a[136:139], v[224:239]
buffer_load_dwordx4 v129, s[8:11], s75 offen offset:1024  lds
ds_read_b64_tr_b16 v[60:61], v12 offset:4096
ds_read_b128 a[152:155], v171 offset:0
v_mfma_f32_32x32x16_bf16 v[240:255], v[52:55], a[140:143], v[240:255]
buffer_load_dwordx4 v130, s[8:11], s75 offen offset:2048  lds
ds_read_b64_tr_b16 v[62:63], v12 offset:4608
ds_read_b128 a[156:159], v179 offset:0
ds_read_b128 v[148:151], v171 offset:0
v_add_u32 v171, 0xffff0000, v171
v_add_u32 v179, 0xffff0000, v179
s_waitcnt lgkmcnt(8)
v_mfma_f32_32x32x16_bf16 v[224:239], v[56:59], a[144:147], v[224:239]
buffer_load_dwordx4 v131, s[8:11], s75 offen offset:3072  lds
ds_read_b64_tr_b16 v[48:49], v11 offset:8192
ds_read_b128 a[160:163], v172 offset:0
v_mfma_f32_32x32x16_bf16 v[240:255], v[56:59], a[148:151], v[240:255]
s_add_u32 m0, s74, 86016
ds_read_b64_tr_b16 v[50:51], v11 offset:8704
ds_read_b128 a[164:167], v180 offset:0
ds_read_b128 v[152:155], v172 offset:0
v_add_u32 v172, 0xffff0000, v172
v_add_u32 v180, 0xffff0000, v180
v_mfma_f32_16x16x32_bf16 v[44:47], v[20:23], v[56:59], v[44:47]
s_add_u32 s75, s73, 21504
s_waitcnt lgkmcnt(6)
v_mfma_f32_32x32x16_bf16 v[224:239], v[60:63], a[152:155], v[224:239]
buffer_load_dwordx4 v128, s[8:11], s75 offen offset:0  lds
ds_read_b64_tr_b16 v[52:53], v12 offset:8192
ds_read_b128 a[168:171], v173 offset:0
v_mfma_f32_32x32x16_bf16 v[240:255], v[60:63], a[156:159], v[240:255]
buffer_load_dwordx4 v129, s[8:11], s75 offen offset:1024  lds
ds_read_b64_tr_b16 v[54:55], v12 offset:8704
ds_read_b128 a[172:175], v181 offset:0
ds_read_b128 v[156:159], v173 offset:0
v_add_u32 v173, 0xffff0000, v173
v_add_u32 v181, 0xffff0000, v181
s_waitcnt lgkmcnt(6)
v_mfma_f32_32x32x16_bf16 v[224:239], v[48:51], a[160:163], v[224:239]
buffer_load_dwordx4 v130, s[8:11], s75 offen offset:2048  lds
ds_read_b64_tr_b16 v[56:57], v11 offset:12288
ds_read_b128 a[176:179], v174 offset:0
v_mfma_f32_32x32x16_bf16 v[240:255], v[48:51], a[164:167], v[240:255]
buffer_load_dwordx4 v131, s[8:11], s75 offen offset:3072  lds
ds_read_b64_tr_b16 v[58:59], v11 offset:12800
ds_read_b128 a[180:183], v182 offset:0
ds_read_b128 v[160:163], v174 offset:0
v_add_u32 v174, 0xffff0000, v174
v_add_u32 v182, 0xffff0000, v182
v_mfma_f32_16x16x32_bf16 v[44:47], v[20:23], v[48:51], v[44:47]
s_lshl_b32 s60, s64, 7
s_waitcnt lgkmcnt(6)
v_mfma_f32_32x32x16_bf16 v[224:239], v[52:55], a[168:171], v[224:239]
s_add_u32 s60, s60, 1966080
ds_read_b64_tr_b16 v[60:61], v12 offset:12288
ds_read_b128 a[184:187], v175 offset:0
v_mfma_f32_32x32x16_bf16 v[240:255], v[52:55], a[172:175], v[240:255]
s_add_u32 m0, s59, 16384
ds_read_b64_tr_b16 v[62:63], v12 offset:12800
ds_read_b128 a[188:191], v183 offset:0
ds_read_b128 v[164:167], v175 offset:0
v_add_u32 v175, 0xffff0000, v175
v_add_u32 v183, 0xffff0000, v183
s_waitcnt lgkmcnt(6)
v_mfma_f32_32x32x16_bf16 v[224:239], v[56:59], a[176:179], v[224:239]
buffer_load_dwordx4 v3, s[12:15], s60 offen offset:0  lds
v_mfma_f32_32x32x16_bf16 v[240:255], v[56:59], a[180:183], v[240:255]
buffer_load_dwordx4 v4, s[12:15], s60 offen offset:1024  lds
v_mfma_f32_16x16x32_bf16 v[44:47], v[20:23], v[56:59], v[44:47]
buffer_load_dwordx4 v5, s[12:15], s60 offen offset:2048  lds
buffer_load_dwordx4 v6, s[12:15], s60 offen offset:3072  lds
s_waitcnt lgkmcnt(1)
v_mfma_f32_32x32x16_bf16 v[224:239], v[60:63], a[184:187], v[224:239]
v_mfma_f32_32x32x16_bf16 v[240:255], v[60:63], a[188:191], v[240:255]
s_waitcnt vmcnt(12) lgkmcnt(0)
s_barrier
v_add_u32 v11, 0xffff8000, v11
v_add_u32 v12, 0xffff8000, v12
ds_read_b128 a[192:195], v168 offset:0
ds_read_b128 a[196:199], v176 offset:0
ds_read_b64_tr_b16 v[48:49], v11 offset:0
ds_read_b64_tr_b16 v[50:51], v11 offset:512
ds_read_b128 a[200:203], v169 offset:0
ds_read_b128 a[204:207], v177 offset:0
ds_read_b64_tr_b16 v[52:53], v12 offset:0
ds_read_b64_tr_b16 v[54:55], v12 offset:512
v_dot2c_f32_bf16 v24, 0x3f803f80, v136
v_dot2c_f32_bf16 v28, v136, v136
v_dot2c_f32_bf16 v25, 0x3f803f80, v137
v_dot2c_f32_bf16 v29, v137, v137
v_dot2c_f32_bf16 v26, 0x3f803f80, v138
v_dot2c_f32_bf16 v30, v138, v138
v_dot2c_f32_bf16 v27, 0x3f803f80, v139
v_dot2c_f32_bf16 v31, v139, v139
v_dot2c_f32_bf16 v24, 0x3f803f80, v140
v_dot2c_f32_bf16 v28, v140, v140
v_dot2c_f32_bf16 v25, 0x3f803f80, v141
v_dot2c_f32_bf16 v29, v141, v141
v_dot2c_f32_bf16 v26, 0x3f803f80, v142
v_dot2c_f32_bf16 v30, v142, v142
v_dot2c_f32_bf16 v27, 0x3f803f80, v143
v_dot2c_f32_bf16 v31, v143, v143
v_dot2c_f32_bf16 v24, 0x3f803f80, v144
v_dot2c_f32_bf16 v28, v144, v144
v_dot2c_f32_bf16 v25, 0x3f803f80, v145
v_dot2c_f32_bf16 v29, v145, v145
v_dot2c_f32_bf16 v26, 0x3f803f80, v146
v_dot2c_f32_bf16 v30, v146, v146
v_dot2c_f32_bf16 v27, 0x3f803f80, v147
v_dot2c_f32_bf16 v31, v147, v147
v_dot2c_f32_bf16 v24, 0x3f803f80, v148
v_dot2c_f32_bf16 v28, v148, v148
v_dot2c_f32_bf16 v25, 0x3f803f80, v149
v_dot2c_f32_bf16 v29, v149, v149
v_dot2c_f32_bf16 v26, 0x3f803f80, v150
v_dot2c_f32_bf16 v30, v150, v150
v_dot2c_f32_bf16 v27, 0x3f803f80, v151
v_dot2c_f32_bf16 v31, v151, v151
v_dot2c_f32_bf16 v24, 0x3f803f80, v152
v_dot2c_f32_bf16 v28, v152, v152
v_dot2c_f32_bf16 v25, 0x3f803f80, v153
v_dot2c_f32_bf16 v29, v153, v153
v_dot2c_f32_bf16 v26, 0x3f803f80, v154
v_dot2c_f32_bf16 v30, v154, v154
v_dot2c_f32_bf16 v27, 0x3f803f80, v155
v_dot2c_f32_bf16 v31, v155, v155
v_dot2c_f32_bf16 v24, 0x3f803f80, v156
v_dot2c_f32_bf16 v28, v156, v156
v_dot2c_f32_bf16 v25, 0x3f803f80, v157
v_dot2c_f32_bf16 v29, v157, v157
v_dot2c_f32_bf16 v26, 0x3f803f80, v158
v_dot2c_f32_bf16 v30, v158, v158
v_dot2c_f32_bf16 v27, 0x3f803f80, v159
v_dot2c_f32_bf16 v31, v159, v159
v_dot2c_f32_bf16 v24, 0x3f803f80, v160
v_dot2c_f32_bf16 v28, v160, v160
v_dot2c_f32_bf16 v25, 0x3f803f80, v161
v_dot2c_f32_bf16 v29, v161, v161
v_dot2c_f32_bf16 v26, 0x3f803f80, v162
v_dot2c_f32_bf16 v30, v162, v162
v_dot2c_f32_bf16 v27, 0x3f803f80, v163
v_dot2c_f32_bf16 v31, v163, v163
v_dot2c_f32_bf16 v24, 0x3f803f80, v164
v_dot2c_f32_bf16 v28, v164, v164
v_dot2c_f32_bf16 v25, 0x3f803f80, v165
v_dot2c_f32_bf16 v29, v165, v165
v_dot2c_f32_bf16 v26, 0x3f803f80, v166
v_dot2c_f32_bf16 v30, v166, v166
v_dot2c_f32_bf16 v27, 0x3f803f80, v167
v_dot2c_f32_bf16 v31, v167, v167
s_waitcnt lgkmcnt(4)
v_mfma_f32_32x32x16_bf16 v[224:239], v[48:51], a[192:195], v[224:239]
ds_read_b64_tr_b16 v[56:57], v11 offset:4096
ds_read_b128 a[208:211], v170 offset:0
v_mfma_f32_32x32x16_bf16 v[240:255], v[48:51], a[196:199], v[240:255]
s_lshl_b32 s60, s65, 7
ds_read_b64_tr_b16 v[58:59], v11 offset:4608
ds_read_b128 a[212:215], v178 offset:0
ds_read_b128 v[136:139], v168 offset:0
ds_read_b128 v[140:143], v169 offset:0
ds_read_b128 v[144:147], v170 offset:0
v_mfma_f32_16x16x32_bf16 v[44:47], v[20:23], v[48:51], v[44:47]
s_add_u32 s60, s60, 0
s_waitcnt lgkmcnt(7)
v_mfma_f32_32x32x16_bf16 v[224:239], v[52:55], a[200:203], v[224:239]
s_add_u32 m0, s59, 32768
ds_read_b64_tr_b16 v[60:61], v12 offset:4096
ds_read_b128 a[216:219], v171 offset:0
v_mfma_f32_32x32x16_bf16 v[240:255], v[52:55], a[204:207], v[240:255]
buffer_load_dwordx4 v7, s[16:19], s60 offen offset:0  lds
ds_read_b64_tr_b16 v[62:63], v12 offset:4608
ds_read_b128 a[220:223], v179 offset:0
ds_read_b128 v[148:151], v171 offset:0
s_waitcnt lgkmcnt(8)
v_mfma_f32_32x32x16_bf16 v[224:239], v[56:59], a[208:211], v[224:239]
buffer_load_dwordx4 v8, s[16:19], s60 offen offset:1024  lds
ds_read_b64_tr_b16 v[48:49], v11 offset:8192
ds_read_b128 a[224:227], v172 offset:0
v_mfma_f32_32x32x16_bf16 v[240:255], v[56:59], a[212:215], v[240:255]
buffer_load_dwordx4 v9, s[16:19], s60 offen offset:2048  lds
ds_read_b64_tr_b16 v[50:51], v11 offset:8704
ds_read_b128 a[228:231], v180 offset:0
ds_read_b128 v[152:155], v172 offset:0
v_mfma_f32_16x16x32_bf16 v[44:47], v[20:23], v[56:59], v[44:47]
buffer_load_dwordx4 v10, s[16:19], s60 offen offset:3072  lds
s_waitcnt lgkmcnt(6)
v_mfma_f32_32x32x16_bf16 v[224:239], v[60:63], a[216:219], v[224:239]
s_lshl_b32 s60, s65, 7
ds_read_b64_tr_b16 v[52:53], v12 offset:8192
ds_read_b128 a[232:235], v173 offset:0
v_mfma_f32_32x32x16_bf16 v[240:255], v[60:63], a[220:223], v[240:255]
s_add_u32 s60, s60, 442368
ds_read_b64_tr_b16 v[54:55], v12 offset:8704
ds_read_b128 a[236:239], v181 offset:0
ds_read_b128 v[156:159], v173 offset:0
s_waitcnt lgkmcnt(6)
v_mfma_f32_32x32x16_bf16 v[224:239], v[48:51], a[224:227], v[224:239]
s_add_u32 m0, s59, 114688
ds_read_b64_tr_b16 v[56:57], v11 offset:12288
ds_read_b128 a[240:243], v174 offset:0
v_mfma_f32_32x32x16_bf16 v[240:255], v[48:51], a[228:231], v[240:255]
buffer_load_dwordx4 v7, s[16:19], s60 offen offset:0  lds
ds_read_b64_tr_b16 v[58:59], v11 offset:12800
ds_read_b128 a[244:247], v182 offset:0
ds_read_b128 v[160:163], v174 offset:0
v_mfma_f32_16x16x32_bf16 v[44:47], v[20:23], v[48:51], v[44:47]
buffer_load_dwordx4 v8, s[16:19], s60 offen offset:1024  lds
s_waitcnt lgkmcnt(6)
v_mfma_f32_32x32x16_bf16 v[224:239], v[52:55], a[232:235], v[224:239]
buffer_load_dwordx4 v9, s[16:19], s60 offen offset:2048  lds
ds_read_b64_tr_b16 v[60:61], v12 offset:12288
ds_read_b128 a[248:251], v175 offset:0
v_mfma_f32_32x32x16_bf16 v[240:255], v[52:55], a[236:239], v[240:255]
buffer_load_dwordx4 v10, s[16:19], s60 offen offset:3072  lds
ds_read_b64_tr_b16 v[62:63], v12 offset:12800
ds_read_b128 a[252:255], v183 offset:0
ds_read_b128 v[164:167], v175 offset:0
s_waitcnt lgkmcnt(6)
v_mfma_f32_32x32x16_bf16 v[224:239], v[56:59], a[240:243], v[224:239]
v_mul_u32_u24 v191, 3456, v15
v_mfma_f32_32x32x16_bf16 v[240:255], v[56:59], a[244:247], v[240:255]
s_lshl_b32 s97, s66, 7
v_mfma_f32_16x16x32_bf16 v[44:47], v[20:23], v[56:59], v[44:47]
buffer_load_dword v191, v191, s[20:23], s97 offen
s_waitcnt lgkmcnt(1)
v_mfma_f32_32x32x16_bf16 v[224:239], v[60:63], a[248:251], v[224:239]
v_mfma_f32_32x32x16_bf16 v[240:255], v[60:63], a[252:255], v[240:255]
s_waitcnt vmcnt(9) lgkmcnt(0)
s_barrier
v_add_u32 v11, 0x4000, v11
v_add_u32 v12, 0x4000, v12
ds_read_b128 v[64:67], v168 offset:32768
ds_read_b128 v[68:71], v176 offset:32768
ds_read_b64_tr_b16 v[48:49], v11 offset:0
ds_read_b64_tr_b16 v[50:51], v11 offset:512
ds_read_b128 v[72:75], v169 offset:32768
ds_read_b128 v[76:79], v177 offset:32768
ds_read_b64_tr_b16 v[52:53], v12 offset:0
ds_read_b64_tr_b16 v[54:55], v12 offset:512
v_dot2c_f32_bf16 v24, 0x3f803f80, v136
v_dot2c_f32_bf16 v28, v136, v136
v_dot2c_f32_bf16 v25, 0x3f803f80, v137
v_dot2c_f32_bf16 v29, v137, v137
v_dot2c_f32_bf16 v26, 0x3f803f80, v138
v_dot2c_f32_bf16 v30, v138, v138
v_dot2c_f32_bf16 v27, 0x3f803f80, v139
v_dot2c_f32_bf16 v31, v139, v139
v_dot2c_f32_bf16 v24, 0x3f803f80, v140
v_dot2c_f32_bf16 v28, v140, v140
v_dot2c_f32_bf16 v25, 0x3f803f80, v141
v_dot2c_f32_bf16 v29, v141, v141
v_dot2c_f32_bf16 v26, 0x3f803f80, v142
v_dot2c_f32_bf16 v30, v142, v142
v_dot2c_f32_bf16 v27, 0x3f803f80, v143
v_dot2c_f32_bf16 v31, v143, v143
v_dot2c_f32_bf16 v24, 0x3f803f80, v144
v_dot2c_f32_bf16 v28, v144, v144
v_dot2c_f32_bf16 v25, 0x3f803f80, v145
v_dot2c_f32_bf16 v29, v145, v145
v_dot2c_f32_bf16 v26, 0x3f803f80, v146
v_dot2c_f32_bf16 v30, v146, v146
v_dot2c_f32_bf16 v27, 0x3f803f80, v147
v_dot2c_f32_bf16 v31, v147, v147
v_dot2c_f32_bf16 v24, 0x3f803f80, v148
v_dot2c_f32_bf16 v28, v148, v148
v_dot2c_f32_bf16 v25, 0x3f803f80, v149
v_dot2c_f32_bf16 v29, v149, v149
v_dot2c_f32_bf16 v26, 0x3f803f80, v150
v_dot2c_f32_bf16 v30, v150, v150
v_dot2c_f32_bf16 v27, 0x3f803f80, v151
v_dot2c_f32_bf16 v31, v151, v151
v_dot2c_f32_bf16 v24, 0x3f803f80, v152
v_dot2c_f32_bf16 v28, v152, v152
v_dot2c_f32_bf16 v25, 0x3f803f80, v153
v_dot2c_f32_bf16 v29, v153, v153
v_dot2c_f32_bf16 v26, 0x3f803f80, v154
v_dot2c_f32_bf16 v30, v154, v154
v_dot2c_f32_bf16 v27, 0x3f803f80, v155
v_dot2c_f32_bf16 v31, v155, v155
v_dot2c_f32_bf16 v24, 0x3f803f80, v156
v_dot2c_f32_bf16 v28, v156, v156
v_dot2c_f32_bf16 v25, 0x3f803f80, v157
v_dot2c_f32_bf16 v29, v157, v157
v_dot2c_f32_bf16 v26, 0x3f803f80, v158
v_dot2c_f32_bf16 v30, v158, v158
v_dot2c_f32_bf16 v27, 0x3f803f80, v159
v_dot2c_f32_bf16 v31, v159, v159
v_dot2c_f32_bf16 v24, 0x3f803f80, v160
v_dot2c_f32_bf16 v28, v160, v160
v_dot2c_f32_bf16 v25, 0x3f803f80, v161
v_dot2c_f32_bf16 v29, v161, v161
v_dot2c_f32_bf16 v26, 0x3f803f80, v162
v_dot2c_f32_bf16 v30, v162, v162
v_dot2c_f32_bf16 v27, 0x3f803f80, v163
v_dot2c_f32_bf16 v31, v163, v163
v_dot2c_f32_bf16 v24, 0x3f803f80, v164
v_dot2c_f32_bf16 v28, v164, v164
v_dot2c_f32_bf16 v25, 0x3f803f80, v165
v_dot2c_f32_bf16 v29, v165, v165
v_dot2c_f32_bf16 v26, 0x3f803f80, v166
v_dot2c_f32_bf16 v30, v166, v166
v_dot2c_f32_bf16 v27, 0x3f803f80, v167
v_dot2c_f32_bf16 v31, v167, v167
s_waitcnt lgkmcnt(4)
v_mfma_f32_32x32x16_bf16 v[224:239], v[48:51], v[64:67], v[224:239]
ds_read_b64_tr_b16 v[56:57], v11 offset:4096
ds_read_b128 v[80:83], v170 offset:32768
v_mfma_f32_32x32x16_bf16 v[240:255], v[48:51], v[68:71], v[240:255]
s_lshl_b32 s60, s65, 7
ds_read_b64_tr_b16 v[58:59], v11 offset:4608
ds_read_b128 v[84:87], v178 offset:32768
ds_read_b128 v[136:139], v168 offset:32768
ds_read_b128 v[140:143], v169 offset:32768
ds_read_b128 v[144:147], v170 offset:32768
v_mfma_f32_16x16x32_bf16 v[44:47], v[20:23], v[48:51], v[44:47]
s_add_u32 s60, s60, 884736
s_waitcnt lgkmcnt(7)
v_mfma_f32_32x32x16_bf16 v[224:239], v[52:55], v[72:75], v[224:239]
s_add_u32 m0, s59, 131072
ds_read_b64_tr_b16 v[60:61], v12 offset:4096
ds_read_b128 v[88:91], v171 offset:32768
v_mfma_f32_32x32x16_bf16 v[240:255], v[52:55], v[76:79], v[240:255]
ds_read_b64_tr_b16 v[62:63], v12 offset:4608
ds_read_b128 v[92:95], v179 offset:32768
ds_read_b128 v[148:151], v171 offset:32768
s_waitcnt lgkmcnt(8)
v_mfma_f32_32x32x16_bf16 v[224:239], v[56:59], v[80:83], v[224:239]
buffer_load_dwordx4 v7, s[16:19], s60 offen offset:0  lds
ds_read_b64_tr_b16 v[48:49], v11 offset:8192
ds_read_b128 v[96:99], v172 offset:32768
v_mfma_f32_32x32x16_bf16 v[240:255], v[56:59], v[84:87], v[240:255]
buffer_load_dwordx4 v8, s[16:19], s60 offen offset:1024  lds
ds_read_b64_tr_b16 v[50:51], v11 offset:8704
ds_read_b128 v[100:103], v180 offset:32768
ds_read_b128 v[152:155], v172 offset:32768
v_mfma_f32_16x16x32_bf16 v[44:47], v[20:23], v[56:59], v[44:47]
buffer_load_dwordx4 v9, s[16:19], s60 offen offset:2048  lds
s_waitcnt lgkmcnt(6)
v_mfma_f32_32x32x16_bf16 v[224:239], v[60:63], v[88:91], v[224:239]
buffer_load_dwordx4 v10, s[16:19], s60 offen offset:3072  lds
ds_read_b64_tr_b16 v[52:53], v12 offset:8192
ds_read_b128 v[104:107], v173 offset:32768
v_mfma_f32_32x32x16_bf16 v[240:255], v[60:63], v[92:95], v[240:255]
ds_read_b64_tr_b16 v[54:55], v12 offset:8704
ds_read_b128 v[108:111], v181 offset:32768
ds_read_b128 v[156:159], v173 offset:32768
s_waitcnt lgkmcnt(6)
v_mfma_f32_32x32x16_bf16 v[224:239], v[48:51], v[96:99], v[224:239]
s_lshl_b32 s60, s65, 7
ds_read_b64_tr_b16 v[56:57], v11 offset:12288
ds_read_b128 v[112:115], v174 offset:32768
v_mfma_f32_32x32x16_bf16 v[240:255], v[48:51], v[100:103], v[240:255]
s_add_u32 s60, s60, 1327104
ds_read_b64_tr_b16 v[58:59], v11 offset:12800
ds_read_b128 v[116:119], v182 offset:32768
ds_read_b128 v[160:163], v174 offset:32768
v_mfma_f32_16x16x32_bf16 v[44:47], v[20:23], v[48:51], v[44:47]
s_add_u32 m0, s59, 0
s_waitcnt lgkmcnt(6)
v_mfma_f32_32x32x16_bf16 v[224:239], v[52:55], v[104:107], v[224:239]
ds_read_b64_tr_b16 v[60:61], v12 offset:12288
ds_read_b128 v[120:123], v175 offset:32768
v_mfma_f32_32x32x16_bf16 v[240:255], v[52:55], v[108:111], v[240:255]
buffer_load_dwordx4 v7, s[16:19], s60 offen offset:0  lds
ds_read_b64_tr_b16 v[62:63], v12 offset:12800
ds_read_b128 v[124:127], v183 offset:32768
ds_read_b128 v[164:167], v175 offset:32768
s_waitcnt lgkmcnt(6)
v_mfma_f32_32x32x16_bf16 v[224:239], v[56:59], v[112:115], v[224:239]
buffer_load_dwordx4 v8, s[16:19], s60 offen offset:1024  lds
v_mfma_f32_32x32x16_bf16 v[240:255], v[56:59], v[116:119], v[240:255]
buffer_load_dwordx4 v9, s[16:19], s60 offen offset:2048  lds
v_mfma_f32_16x16x32_bf16 v[44:47], v[20:23], v[56:59], v[44:47]
buffer_load_dwordx4 v10, s[16:19], s60 offen offset:3072  lds
s_waitcnt lgkmcnt(1)
v_mfma_f32_32x32x16_bf16 v[224:239], v[60:63], v[120:123], v[224:239]
s_nop 4
ds_write_b32 v18, v44 offset:0
ds_write_b32 v18, v45 offset:64
v_mfma_f32_32x32x16_bf16 v[240:255], v[60:63], v[124:127], v[240:255]
s_waitcnt vmcnt(9) lgkmcnt(0)
s_cmp_lg_u32 s42, 0
s_cbranch_scc1 L_nc_11
v_readfirstlane_b32 s79, v13
s_nop 1
s_cmp_lg_u32 s79, 0
s_cbranch_scc1 L_nc_11
s_cmp_lg_u32 s42, 0
s_cbranch_scc1 L_ng_12_ok
s_mov_b32 s46, 0x40000
v_mov_b32 v0, 0
L_ng_12:
global_load_dword v13, v0, s[4:5] sc0 sc1
s_waitcnt vmcnt(0)
v_readfirstlane_b32 s79, v13
s_nop 1
s_cmp_lg_u32 s79, 0
s_cbranch_scc1 L_ng_12_ok
s_sleep 1
s_sub_u32 s46, s46, 1
s_cmp_lg_u32 s46, 0
s_cbranch_scc1 L_ng_12
L_ng_12_ok:
L_nc_11:
s_barrier
v_add_u32 v11, 0x4000, v11
v_add_u32 v12, 0x4000, v12
ds_read_b64_tr_b16 v[48:49], v11 offset:0
ds_read_b64_tr_b16 v[50:51], v11 offset:512
ds_read_b64_tr_b16 v[52:53], v12 offset:0
ds_read_b64_tr_b16 v[54:55], v12 offset:512
v_dot2c_f32_bf16 v24, 0x3f803f80, v136
v_dot2c_f32_bf16 v28, v136, v136
v_dot2c_f32_bf16 v25, 0x3f803f80, v137
v_dot2c_f32_bf16 v29, v137, v137
v_dot2c_f32_bf16 v26, 0x3f803f80, v138
v_dot2c_f32_bf16 v30, v138, v138
v_dot2c_f32_bf16 v27, 0x3f803f80, v139
v_dot2c_f32_bf16 v31, v139, v139
v_dot2c_f32_bf16 v24, 0x3f803f80, v140
v_dot2c_f32_bf16 v28, v140, v140
v_dot2c_f32_bf16 v25, 0x3f803f80, v141
v_dot2c_f32_bf16 v29, v141, v141
v_dot2c_f32_bf16 v26, 0x3f803f80, v142
v_dot2c_f32_bf16 v30, v142, v142
v_dot2c_f32_bf16 v27, 0x3f803f80, v143
v_dot2c_f32_bf16 v31, v143, v143
v_dot2c_f32_bf16 v24, 0x3f803f80, v144
v_dot2c_f32_bf16 v28, v144, v144
v_dot2c_f32_bf16 v25, 0x3f803f80, v145
v_dot2c_f32_bf16 v29, v145, v145
v_dot2c_f32_bf16 v26, 0x3f803f80, v146
v_dot2c_f32_bf16 v30, v146, v146
v_dot2c_f32_bf16 v27, 0x3f803f80, v147
v_dot2c_f32_bf16 v31, v147, v147
v_dot2c_f32_bf16 v24, 0x3f803f80, v148
v_dot2c_f32_bf16 v28, v148, v148
v_dot2c_f32_bf16 v25, 0x3f803f80, v149
v_dot2c_f32_bf16 v29, v149, v149
v_dot2c_f32_bf16 v26, 0x3f803f80, v150
v_dot2c_f32_bf16 v30, v150, v150
v_dot2c_f32_bf16 v27, 0x3f803f80, v151
v_dot2c_f32_bf16 v31, v151, v151
v_dot2c_f32_bf16 v24, 0x3f803f80, v152
v_dot2c_f32_bf16 v28, v152, v152
v_dot2c_f32_bf16 v25, 0x3f803f80, v153
v_dot2c_f32_bf16 v29, v153, v153
v_dot2c_f32_bf16 v26, 0x3f803f80, v154
v_dot2c_f32_bf16 v30, v154, v154
v_dot2c_f32_bf16 v27, 0x3f803f80, v155
v_dot2c_f32_bf16 v31, v155, v155
v_dot2c_f32_bf16 v24, 0x3f803f80, v156
v_dot2c_f32_bf16 v28, v156, v156
v_dot2c_f32_bf16 v25, 0x3f803f80, v157
v_dot2c_f32_bf16 v29, v157, v157
v_dot2c_f32_bf16 v26, 0x3f803f80, v158
v_dot2c_f32_bf16 v30, v158, v158
v_dot2c_f32_bf16 v27, 0x3f803f80, v159
v_dot2c_f32_bf16 v31, v159, v159
v_dot2c_f32_bf16 v24, 0x3f803f80, v160
v_dot2c_f32_bf16 v28, v160, v160
v_dot2c_f32_bf16 v25, 0x3f803f80, v161
v_dot2c_f32_bf16 v29, v161, v161
v_dot2c_f32_bf16 v26, 0x3f803f80, v162
v_dot2c_f32_bf16 v30, v162, v162
v_dot2c_f32_bf16 v27, 0x3f803f80, v163
v_dot2c_f32_bf16 v31, v163, v163
v_dot2c_f32_bf16 v24, 0x3f803f80, v164
v_dot2c_f32_bf16 v28, v164, v164
v_dot2c_f32_bf16 v25, 0x3f803f80, v165
v_dot2c_f32_bf16 v29, v165, v165
v_dot2c_f32_bf16 v26, 0x3f803f80, v166
v_dot2c_f32_bf16 v30, v166, v166
v_dot2c_f32_bf16 v27, 0x3f803f80, v167
v_dot2c_f32_bf16 v31, v167, v167
v_add_f32 v24, v24, v25
s_nop 0
v_add_f32 v26, v26, v27
v_add_f32 v28, v28, v29
v_add_f32 v30, v30, v31
v_add_f32 v24, v24, v26
v_add_f32 v28, v28, v30
v_mov_b32 v25, v24
v_mov_b32 v29, v28
s_nop 0
v_permlane32_swap_b32 v24, v25
v_permlane32_swap_b32 v28, v29
v_add_f32 v24, v24, v25
v_add_f32 v28, v28, v29
v_mul_f32 v24, 0x3acccccd, v24
v_mul_f32 v28, 0x3acccccd, v28
v_fma_f32 v28, -v24, v24, v28
v_max_f32 v28, 0, v28
v_cvt_pk_bf16_f32 v184, -v24, -v24
v_cvt_pk_bf16_f32 v185, v28, v28
v_lshlrev_b32 v185, 16, v185
v_add_f32 v185, 0x3727c5ac, v185
v_cvt_pk_bf16_f32 v185, v185, v185
v_lshlrev_b32 v185, 16, v185
v_sqrt_f32 v185, v185
s_nop 0
v_cvt_pk_bf16_f32 v185, v185, v185
v_lshlrev_b32 v186, 16, v185
v_rcp_f32 v185, v186
v_mul_f32 v186, v186, v186
v_mov_b32 v187, 0
v_and_b32 v24, 31, v1
s_lshl_b32 s52, s42, 5
v_add_u32 v24, s52, v24
v_lshlrev_b32 v24, 4, v24
v_add_u32 v24, 147456, v24
ds_write_b128 v24, v[184:187]
s_waitcnt lgkmcnt(3)
v_mfma_f32_32x32x16_bf16 v[128:143], v[48:51], a[0:3], 0
v_mul_u32_u24 v14, 3456, v15
s_lshl_b32 s97, s67, 7
ds_read_b64_tr_b16 v[56:57], v11 offset:4096
v_mfma_f32_16x16x32_bf16 v[44:47], v[20:23], v[48:51], 0
v_mfma_f32_32x32x16_bf16 v[144:159], v[48:51], a[4:7], 0
buffer_load_dword v14, v14, s[16:19], s97 offen
ds_read_b64_tr_b16 v[58:59], v11 offset:4608
s_waitcnt lgkmcnt(3)
v_mfma_f32_32x32x16_bf16 v[128:143], v[52:55], a[8:11], v[128:143]
s_lshl_b32 s60, s65, 7
s_add_u32 s60, s60, 1769472
ds_read_b64_tr_b16 v[60:61], v12 offset:4096
v_mfma_f32_32x32x16_bf16 v[144:159], v[52:55], a[12:15], v[144:159]
s_add_u32 m0, s59, 49152
ds_read_b64_tr_b16 v[62:63], v12 offset:4608
s_waitcnt lgkmcnt(2)
v_mfma_f32_32x32x16_bf16 v[128:143], v[56:59], a[16:19], v[128:143]
buffer_load_dwordx4 v7, s[16:19], s60 offen offset:0  lds
ds_read_b64_tr_b16 v[48:49], v11 offset:8192
v_mfma_f32_16x16x32_bf16 v[44:47], v[20:23], v[56:59], v[44:47]
buffer_load_dwordx4 v8, s[16:19], s60 offen offset:1024  lds
v_mfma_f32_32x32x16_bf16 v[144:159], v[56:59], a[20:23], v[144:159]
ds_read_b64_tr_b16 v[50:51], v11 offset:8704
s_waitcnt lgkmcnt(2)
v_mfma_f32_32x32x16_bf16 v[128:143], v[60:63], a[24:27], v[128:143]
buffer_load_dwordx4 v9, s[16:19], s60 offen offset:2048  lds
ds_read_b64_tr_b16 v[52:53], v12 offset:8192
v_mfma_f32_32x32x16_bf16 v[144:159], v[60:63], a[28:31], v[144:159]
buffer_load_dwordx4 v10, s[16:19], s60 offen offset:3072  lds
ds_read_b64_tr_b16 v[54:55], v12 offset:8704
s_waitcnt lgkmcnt(2)
v_mfma_f32_32x32x16_bf16 v[128:143], v[48:51], a[32:35], v[128:143]
s_lshl_b32 s60, s66, 7
s_add_u32 s60, s60, 0
ds_read_b64_tr_b16 v[56:57], v11 offset:12288
v_mfma_f32_16x16x32_bf16 v[44:47], v[20:23], v[48:51], v[44:47]
s_add_u32 m0, s59, 65536
v_mfma_f32_32x32x16_bf16 v[144:159], v[48:51], a[36:39], v[144:159]
buffer_load_dwordx4 v7, s[20:23], s60 offen offset:0  lds
ds_read_b64_tr_b16 v[58:59], v11 offset:12800
s_waitcnt lgkmcnt(2)
v_mfma_f32_32x32x16_bf16 v[128:143], v[52:55], a[40:43], v[128:143]
buffer_load_dwordx4 v8, s[20:23], s60 offen offset:1024  lds
ds_read_b64_tr_b16 v[60:61], v12 offset:12288
v_mfma_f32_32x32x16_bf16 v[144:159], v[52:55], a[44:47], v[144:159]
ds_read_b64_tr_b16 v[62:63], v12 offset:12800
s_waitcnt lgkmcnt(2)
v_mfma_f32_32x32x16_bf16 v[128:143], v[56:59], a[48:51], v[128:143]
buffer_load_dwordx4 v9, s[20:23], s60 offen offset:2048  lds
v_add_u32 v11, 0x14000, v11
v_add_u32 v12, 0x14000, v12
ds_read_b64_tr_b16 v[48:49], v11 offset:0
v_mfma_f32_16x16x32_bf16 v[44:47], v[20:23], v[56:59], v[44:47]
v_mfma_f32_32x32x16_bf16 v[144:159], v[56:59], a[52:55], v[144:159]
buffer_load_dwordx4 v10, s[20:23], s60 offen offset:3072  lds
ds_read_b64_tr_b16 v[50:51], v11 offset:512
s_waitcnt lgkmcnt(2)
v_mfma_f32_32x32x16_bf16 v[128:143], v[60:63], a[56:59], v[128:143]
ds_read_b64_tr_b16 v[52:53], v12 offset:0
v_mfma_f32_32x32x16_bf16 v[144:159], v[60:63], a[60:63], v[144:159]
ds_read_b64_tr_b16 v[54:55], v12 offset:512
s_waitcnt vmcnt(13)
s_barrier
s_waitcnt lgkmcnt(2)
v_mfma_f32_32x32x16_bf16 v[128:143], v[48:51], a[64:67], v[128:143]
s_lshl_b32 s60, s66, 7
s_add_u32 s60, s60, 442368
ds_read_b64_tr_b16 v[56:57], v11 offset:4096
v_mfma_f32_16x16x32_bf16 v[44:47], v[20:23], v[48:51], v[44:47]
v_and_b32 v38, 31, v1
v_mfma_f32_32x32x16_bf16 v[144:159], v[48:51], a[68:71], v[144:159]
s_add_u32 m0, s59, 16384
s_lshl_b32 s52, s42, 5
ds_read_b64_tr_b16 v[58:59], v11 offset:4608
s_waitcnt lgkmcnt(2)
v_mfma_f32_32x32x16_bf16 v[128:143], v[52:55], a[72:75], v[128:143]
buffer_load_dwordx4 v7, s[20:23], s60 offen offset:0  lds
v_add_u32 v38, s52, v38
v_lshlrev_b32 v38, 4, v38
ds_read_b64_tr_b16 v[60:61], v12 offset:4096
v_mfma_f32_32x32x16_bf16 v[144:159], v[52:55], a[76:79], v[144:159]
buffer_load_dwordx4 v8, s[20:23], s60 offen offset:1024  lds
v_add_u32 v38, 147456, v38
ds_read_b64_tr_b16 v[62:63], v12 offset:4608
s_waitcnt lgkmcnt(2)
v_mfma_f32_32x32x16_bf16 v[128:143], v[56:59], a[80:83], v[128:143]
v_xor_b32 v39, 512, v38
ds_read_b128 v[160:163], v38
ds_read_b64_tr_b16 v[48:49], v11 offset:8192
v_mfma_f32_16x16x32_bf16 v[44:47], v[20:23], v[56:59], v[44:47]
buffer_load_dwordx4 v9, s[20:23], s60 offen offset:2048  lds
v_mfma_f32_32x32x16_bf16 v[144:159], v[56:59], a[84:87], v[144:159]
ds_read_b128 v[164:167], v39
v_cmp_gt_u32 s[52:53], 32, v1
ds_read_b64_tr_b16 v[50:51], v11 offset:8704
s_waitcnt lgkmcnt(4)
v_mfma_f32_32x32x16_bf16 v[128:143], v[60:63], a[88:91], v[128:143]
buffer_load_dwordx4 v10, s[20:23], s60 offen offset:3072  lds
v_mov_b32 v25, 0
ds_read_b64_tr_b16 v[52:53], v12 offset:8192
v_mfma_f32_32x32x16_bf16 v[144:159], v[60:63], a[92:95], v[144:159]
s_lshl_b32 s60, s66, 7
s_add_u32 s60, s60, 884736
v_mov_b32 v27, 0
ds_read_b64_tr_b16 v[54:55], v12 offset:8704
s_waitcnt lgkmcnt(2)
v_mfma_f32_32x32x16_bf16 v[128:143], v[48:51], a[96:99], v[128:143]
s_add_u32 m0, s59, 81920
v_mov_b32 v29, 0
ds_read_b64_tr_b16 v[56:57], v11 offset:12288
v_mfma_f32_16x16x32_bf16 v[44:47], v[20:23], v[48:51], v[44:47]
v_cndmask_b32_e64 v26, 0, v160, s[52:53]
v_mfma_f32_32x32x16_bf16 v[144:159], v[48:51], a[100:103], v[144:159]
buffer_load_dwordx4 v7, s[20:23], s60 offen offset:0  lds
ds_read_b64_tr_b16 v[58:59], v11 offset:12800
s_waitcnt lgkmcnt(2)
v_mfma_f32_32x32x16_bf16 v[128:143], v[52:55], a[104:107], v[128:143]
buffer_load_dwordx4 v8, s[20:23], s60 offen offset:1024  lds
v_mov_b32 v30, v161
v_mul_f32 v32, 0xc0135761, v161
ds_read_b64_tr_b16 v[60:61], v12 offset:12288
v_mfma_f32_32x32x16_bf16 v[144:159], v[52:55], a[108:111], v[144:159]
buffer_load_dwordx4 v9, s[20:23], s60 offen offset:2048  lds
v_mul_f32 v33, v161, v161
ds_read_b64_tr_b16 v[62:63], v12 offset:12800
s_waitcnt lgkmcnt(2)
v_mfma_f32_32x32x16_bf16 v[128:143], v[56:59], a[112:115], v[128:143]
v_mul_f32 v33, v33, v161
v_add_u32 v11, 0x4000, v11
v_add_u32 v12, 0x4000, v12
ds_read_b64_tr_b16 v[48:49], v11 offset:0
v_mfma_f32_16x16x32_bf16 v[44:47], v[20:23], v[56:59], v[44:47]
v_mul_f32 v33, 0xbdd2d3e8, v33
v_mfma_f32_32x32x16_bf16 v[144:159], v[56:59], a[116:119], v[144:159]
buffer_load_dwordx4 v10, s[20:23], s60 offen offset:3072  lds
v_mov_b32 v34, v162
ds_read_b64_tr_b16 v[50:51], v11 offset:512
s_waitcnt lgkmcnt(2)
v_mfma_f32_32x32x16_bf16 v[128:143], v[60:63], a[120:123], v[128:143]
v_cndmask_b32_e64 v28, 0, v164, s[52:53]
v_mov_b32 v31, v165
ds_read_b64_tr_b16 v[52:53], v12 offset:0
v_mfma_f32_32x32x16_bf16 v[144:159], v[60:63], a[124:127], v[144:159]
v_mul_f32 v35, 0xc0135761, v165
ds_read_b64_tr_b16 v[54:55], v12 offset:512
s_waitcnt vmcnt(17)
s_barrier
s_waitcnt lgkmcnt(2)
v_mfma_f32_32x32x16_bf16 v[128:143], v[48:51], a[128:131], v[128:143]
s_lshl_b32 s60, s66, 7
s_add_u32 s60, s60, 1327104
v_mul_f32 v36, v165, v165
ds_read_b64_tr_b16 v[56:57], v11 offset:4096
v_mfma_f32_16x16x32_bf16 v[44:47], v[20:23], v[48:51], v[44:47]
v_mul_f32 v36, v36, v165
v_mfma_f32_32x32x16_bf16 v[144:159], v[48:51], a[132:135], v[144:159]
s_add_u32 m0, s59, 98304
v_mul_f32 v36, 0xbdd2d3e8, v36
v_mov_b32 v37, v166
ds_read_b64_tr_b16 v[58:59], v11 offset:4608
s_waitcnt lgkmcnt(2)
v_mfma_f32_32x32x16_bf16 v[128:143], v[52:55], a[136:139], v[128:143]
buffer_load_dwordx4 v7, s[20:23], s60 offen offset:0  lds
ds_read_b32 v38, v19 offset:0
ds_read_b64_tr_b16 v[60:61], v12 offset:4096
v_mfma_f32_32x32x16_bf16 v[144:159], v[52:55], a[140:143], v[144:159]
buffer_load_dwordx4 v8, s[20:23], s60 offen offset:1024  lds
ds_read_b32 v39, v19 offset:128
ds_read_b64_tr_b16 v[62:63], v12 offset:4608
s_waitcnt lgkmcnt(4)
v_mfma_f32_32x32x16_bf16 v[128:143], v[56:59], a[144:147], v[128:143]
s_waitcnt lgkmcnt(1)
v_add_f32 v38, v38, v39
ds_read_b64_tr_b16 v[48:49], v11 offset:8192
v_mfma_f32_16x16x32_bf16 v[44:47], v[20:23], v[56:59], v[44:47]
buffer_load_dwordx4 v9, s[20:23], s60 offen offset:2048  lds
v_mfma_f32_32x32x16_bf16 v[144:159], v[56:59], a[148:151], v[144:159]
v_cvt_pk_bf16_f32 v39, v38, v38
v_lshlrev_b32 v39, 16, v39
ds_read_b64_tr_b16 v[50:51], v11 offset:8704
s_waitcnt lgkmcnt(2)
v_mfma_f32_32x32x16_bf16 v[128:143], v[60:63], a[152:155], v[128:143]
buffer_load_dwordx4 v10, s[20:23], s60 offen offset:3072  lds
v_sub_f32 v39, v38, v39
ds_read_b64_tr_b16 v[52:53], v12 offset:8192
v_mfma_f32_32x32x16_bf16 v[144:159], v[60:63], a[156:159], v[144:159]
s_lshl_b32 s60, s66, 7
s_add_u32 s60, s60, 1769472
v_cvt_pk_bf16_f32 v24, v38, v39
ds_read_b64_tr_b16 v[54:55], v12 offset:8704
s_waitcnt lgkmcnt(2)
v_mfma_f32_32x32x16_bf16 v[128:143], v[48:51], a[160:163], v[128:143]
s_add_u32 m0, s59, 32768
v_mfma_f32_32x32x8bf16_1k v[224:239], v[24:25], v[26:27], v[224:239]
ds_read_b64_tr_b16 v[56:57], v11 offset:12288
v_mfma_f32_16x16x32_bf16 v[44:47], v[20:23], v[48:51], v[44:47]
v_mfma_f32_32x32x16_bf16 v[144:159], v[48:51], a[164:167], v[144:159]
buffer_load_dwordx4 v7, s[20:23], s60 offen offset:0  lds
v_mfma_f32_32x32x8bf16_1k v[240:255], v[24:25], v[28:29], v[240:255]
ds_read_b64_tr_b16 v[58:59], v11 offset:12800
s_waitcnt lgkmcnt(2)
v_mfma_f32_32x32x16_bf16 v[128:143], v[52:55], a[168:171], v[128:143]
buffer_load_dwordx4 v8, s[20:23], s60 offen offset:1024  lds
s_cmp_lt_u32 s64, 10
s_cselect_b32 s63, 0x3ea52b5c, 1.0
ds_read_b64_tr_b16 v[60:61], v12 offset:12288
v_mfma_f32_32x32x16_bf16 v[144:159], v[52:55], a[172:175], v[144:159]
buffer_load_dwordx4 v9, s[20:23], s60 offen offset:2048  lds
ds_read_b64_tr_b16 v[62:63], v12 offset:12800
s_waitcnt lgkmcnt(2)
v_mfma_f32_32x32x16_bf16 v[128:143], v[56:59], a[176:179], v[128:143]
s_lshl_b32 s52, s64, 12
s_lshl_b32 s53, s44, 11
v_add_u32 v11, 0xfffe0000, v11
v_add_u32 v12, 0xfffe0000, v12
ds_read_b64_tr_b16 v[48:49], v11 offset:0
v_mfma_f32_16x16x32_bf16 v[44:47], v[20:23], v[56:59], v[44:47]
v_mfma_f32_32x32x16_bf16 v[144:159], v[56:59], a[180:183], v[144:159]
buffer_load_dwordx4 v10, s[20:23], s60 offen offset:3072  lds
s_add_u32 s52, s52, s53
ds_read_b64_tr_b16 v[50:51], v11 offset:512
s_waitcnt lgkmcnt(2)
v_mfma_f32_32x32x16_bf16 v[128:143], v[60:63], a[184:187], v[128:143]
s_mul_i32 s53, s55, 122880
s_add_u32 s61, s52, s53
s_mul_i32 s53, s56, 122880
ds_read_b64_tr_b16 v[52:53], v12 offset:0
v_mfma_f32_32x32x16_bf16 v[144:159], v[60:63], a[188:191], v[144:159]
s_add_u32 s62, s52, s53
ds_read_b64_tr_b16 v[54:55], v12 offset:512
s_waitcnt vmcnt(20)
s_barrier
s_waitcnt lgkmcnt(2)
v_mfma_f32_32x32x16_bf16 v[128:143], v[48:51], a[192:195], v[128:143]
v_mul_f32 v40, s63, v30
v_mul_f32 v41, s63, v31
ds_read_b64_tr_b16 v[56:57], v11 offset:4096
v_mfma_f32_16x16x32_bf16 v[44:47], v[20:23], v[48:51], v[44:47]
v_mul_f32 v224, v224, v40
v_mfma_f32_32x32x16_bf16 v[144:159], v[48:51], a[196:199], v[144:159]
v_mul_f32 v225, v225, v40
ds_read_b64_tr_b16 v[58:59], v11 offset:4608
s_waitcnt lgkmcnt(2)
v_mfma_f32_32x32x16_bf16 v[128:143], v[52:55], a[200:203], v[128:143]
v_cvt_pk_bf16_f32 v224, v224, v225
v_mul_f32 v226, v226, v40
v_mul_f32 v227, v227, v40
ds_read_b64_tr_b16 v[60:61], v12 offset:4096
v_mfma_f32_32x32x16_bf16 v[144:159], v[52:55], a[204:207], v[144:159]
v_cvt_pk_bf16_f32 v225, v226, v227
ds_read_b64_tr_b16 v[62:63], v12 offset:4608
s_waitcnt lgkmcnt(2)
v_mfma_f32_32x32x16_bf16 v[128:143], v[56:59], a[208:211], v[128:143]
v_mul_f32 v228, v228, v40
v_mul_f32 v229, v229, v40
v_cvt_pk_bf16_f32 v226, v228, v229
ds_read_b64_tr_b16 v[48:49], v11 offset:8192
v_mfma_f32_16x16x32_bf16 v[44:47], v[20:23], v[56:59], v[44:47]
v_mul_f32 v230, v230, v40
v_mfma_f32_32x32x16_bf16 v[144:159], v[56:59], a[212:215], v[144:159]
v_mul_f32 v231, v231, v40
ds_read_b64_tr_b16 v[50:51], v11 offset:8704
s_waitcnt lgkmcnt(2)
v_mfma_f32_32x32x16_bf16 v[128:143], v[60:63], a[216:219], v[128:143]
v_cvt_pk_bf16_f32 v227, v230, v231
v_mul_f32 v232, v232, v40
v_mul_f32 v233, v233, v40
ds_read_b64_tr_b16 v[52:53], v12 offset:8192
v_mfma_f32_32x32x16_bf16 v[144:159], v[60:63], a[220:223], v[144:159]
v_cvt_pk_bf16_f32 v228, v232, v233
ds_read_b64_tr_b16 v[54:55], v12 offset:8704
s_waitcnt lgkmcnt(2)
v_mfma_f32_32x32x16_bf16 v[128:143], v[48:51], a[224:227], v[128:143]
v_mul_f32 v234, v234, v40
v_mul_f32 v235, v235, v40
v_cvt_pk_bf16_f32 v229, v234, v235
ds_read_b64_tr_b16 v[56:57], v11 offset:12288
v_mfma_f32_16x16x32_bf16 v[44:47], v[20:23], v[48:51], v[44:47]
v_mul_f32 v236, v236, v40
v_mfma_f32_32x32x16_bf16 v[144:159], v[48:51], a[228:231], v[144:159]
v_mul_f32 v237, v237, v40
ds_read_b64_tr_b16 v[58:59], v11 offset:12800
s_waitcnt lgkmcnt(2)
v_mfma_f32_32x32x16_bf16 v[128:143], v[52:55], a[232:235], v[128:143]
v_cvt_pk_bf16_f32 v230, v236, v237
v_mul_f32 v238, v238, v40
v_mul_f32 v239, v239, v40
ds_read_b64_tr_b16 v[60:61], v12 offset:12288
v_mfma_f32_32x32x16_bf16 v[144:159], v[52:55], a[236:239], v[144:159]
v_cvt_pk_bf16_f32 v231, v238, v239
ds_read_b64_tr_b16 v[62:63], v12 offset:12800
s_waitcnt lgkmcnt(2)
v_mfma_f32_32x32x16_bf16 v[128:143], v[56:59], a[240:243], v[128:143]
buffer_store_dwordx4 v[224:227], v16, s[24:27], s61 offen sc1
v_add_u32 v11, 0xc000, v11
v_add_u32 v12, 0xc000, v12
ds_read_b64_tr_b16 v[48:49], v11 offset:0
v_mfma_f32_16x16x32_bf16 v[44:47], v[20:23], v[56:59], v[44:47]
v_mfma_f32_32x32x16_bf16 v[144:159], v[56:59], a[244:247], v[144:159]
buffer_store_dwordx4 v[228:231], v16, s[24:27], s61 offen offset:1024 sc1
v_mul_f32 v240, v240, v41
ds_read_b64_tr_b16 v[50:51], v11 offset:512
s_waitcnt lgkmcnt(2)
v_mfma_f32_32x32x16_bf16 v[128:143], v[60:63], a[248:251], v[128:143]
v_mul_f32 v241, v241, v41
v_cvt_pk_bf16_f32 v240, v240, v241
ds_read_b64_tr_b16 v[52:53], v12 offset:0
v_mfma_f32_32x32x16_bf16 v[144:159], v[60:63], a[252:255], v[144:159]
v_mul_f32 v242, v242, v41
ds_read_b64_tr_b16 v[54:55], v12 offset:512
s_waitcnt vmcnt(18)
s_barrier
s_waitcnt lgkmcnt(2)
v_mfma_f32_32x32x16_bf16 v[128:143], v[48:51], v[64:67], v[128:143]
s_lshl_b32 s60, s67, 7
v_mul_f32 v243, v243, v41
ds_read_b64_tr_b16 v[56:57], v11 offset:4096
v_mfma_f32_16x16x32_bf16 v[44:47], v[20:23], v[48:51], v[44:47]
v_cvt_pk_bf16_f32 v241, v242, v243
v_mfma_f32_32x32x16_bf16 v[144:159], v[48:51], v[68:71], v[144:159]
s_add_u32 s60, s60, 0
v_mul_f32 v244, v244, v41
v_mul_f32 v245, v245, v41
ds_read_b64_tr_b16 v[58:59], v11 offset:4608
s_waitcnt lgkmcnt(2)
v_mfma_f32_32x32x16_bf16 v[128:143], v[52:55], v[72:75], v[128:143]
s_add_u32 m0, s59, 0
v_cvt_pk_bf16_f32 v242, v244, v245
v_mul_f32 v246, v246, v41
ds_read_b64_tr_b16 v[60:61], v12 offset:4096
v_mfma_f32_32x32x16_bf16 v[144:159], v[52:55], v[76:79], v[144:159]
v_mul_f32 v247, v247, v41
ds_read_b64_tr_b16 v[62:63], v12 offset:4608
s_waitcnt lgkmcnt(2)
v_mfma_f32_32x32x16_bf16 v[128:143], v[56:59], v[80:83], v[128:143]
v_cvt_pk_bf16_f32 v243, v246, v247
v_mul_f32 v248, v248, v41
v_mul_f32 v249, v249, v41
ds_read_b64_tr_b16 v[48:49], v11 offset:8192
v_mfma_f32_16x16x32_bf16 v[44:47], v[20:23], v[56:59], v[44:47]
buffer_load_dwordx4 v7, s[16:19], s60 offen offset:0  lds
v_mfma_f32_32x32x16_bf16 v[144:159], v[56:59], v[84:87], v[144:159]
v_cvt_pk_bf16_f32 v244, v248, v249
ds_read_b64_tr_b16 v[50:51], v11 offset:8704
s_waitcnt lgkmcnt(2)
v_mfma_f32_32x32x16_bf16 v[128:143], v[60:63], v[88:91], v[128:143]
v_mul_f32 v250, v250, v41
v_mul_f32 v251, v251, v41
v_cvt_pk_bf16_f32 v245, v250, v251
ds_read_b64_tr_b16 v[52:53], v12 offset:8192
v_mfma_f32_32x32x16_bf16 v[144:159], v[60:63], v[92:95], v[144:159]
buffer_load_dwordx4 v8, s[16:19], s60 offen offset:1024  lds
v_mul_f32 v252, v252, v41
ds_read_b64_tr_b16 v[54:55], v12 offset:8704
s_waitcnt lgkmcnt(2)
v_mfma_f32_32x32x16_bf16 v[128:143], v[48:51], v[96:99], v[128:143]
v_mul_f32 v253, v253, v41
v_cvt_pk_bf16_f32 v246, v252, v253
ds_read_b64_tr_b16 v[56:57], v11 offset:12288
v_mfma_f32_16x16x32_bf16 v[44:47], v[20:23], v[48:51], v[44:47]
v_mul_f32 v254, v254, v41
v_mfma_f32_32x32x16_bf16 v[144:159], v[48:51], v[100:103], v[144:159]
buffer_load_dwordx4 v9, s[16:19], s60 offen offset:2048  lds
v_mul_f32 v255, v255, v41
ds_read_b64_tr_b16 v[58:59], v11 offset:12800
s_waitcnt lgkmcnt(2)
v_mfma_f32_32x32x16_bf16 v[128:143], v[52:55], v[104:107], v[128:143]
v_cvt_pk_bf16_f32 v247, v254, v255
ds_read_b64_tr_b16 v[60:61], v12 offset:12288
v_mfma_f32_32x32x16_bf16 v[144:159], v[52:55], v[108:111], v[144:159]
buffer_store_dwordx4 v[240:243], v16, s[24:27], s62 offen sc1
ds_read_b64_tr_b16 v[62:63], v12 offset:12800
s_waitcnt lgkmcnt(2)
v_mfma_f32_32x32x16_bf16 v[128:143], v[56:59], v[112:115], v[128:143]
buffer_load_dwordx4 v10, s[16:19], s60 offen offset:3072  lds
buffer_store_dwordx4 v[244:247], v16, s[24:27], s62 offen offset:1024 sc1
v_add_u32 v11, 0x4000, v11
v_add_u32 v12, 0x4000, v12
ds_read_b64_tr_b16 v[48:49], v11 offset:0
v_mfma_f32_16x16x32_bf16 v[44:47], v[20:23], v[56:59], v[44:47]
v_mfma_f32_32x32x16_bf16 v[144:159], v[56:59], v[116:119], v[144:159]
ds_read_b64_tr_b16 v[50:51], v11 offset:512
s_waitcnt lgkmcnt(2)
v_mfma_f32_32x32x16_bf16 v[128:143], v[60:63], v[120:123], v[128:143]
ds_read_b64_tr_b16 v[52:53], v12 offset:0
s_nop 2
ds_write_b32 v18, v44 offset:512
ds_write_b32 v18, v45 offset:576
v_mfma_f32_32x32x16_bf16 v[144:159], v[60:63], v[124:127], v[144:159]
ds_read_b64_tr_b16 v[54:55], v12 offset:512
s_waitcnt vmcnt(20) lgkmcnt(1)
s_barrier
v_mfma_f32_32x32x16_bf16 v[160:175], v[48:51], a[0:3], 0
v_mul_u32_u24 v14, 3456, v15
s_lshl_b32 s97, s68, 7
buffer_load_dword v14, v14, s[20:23], s97 offen
ds_read_b64_tr_b16 v[56:57], v11 offset:4096
v_mfma_f32_16x16x32_bf16 v[44:47], v[20:23], v[48:51], 0
s_lshl_b32 s60, s67, 7
s_add_u32 s60, s60, 442368
v_mfma_f32_32x32x16_bf16 v[176:191], v[48:51], a[4:7], 0
s_add_u32 m0, s59, 49152
s_nop 0
buffer_load_dwordx4 v7, s[16:19], s60 offen offset:0  lds
ds_read_b64_tr_b16 v[58:59], v11 offset:4608
s_waitcnt lgkmcnt(2)
v_mfma_f32_32x32x16_bf16 v[160:175], v[52:55], a[8:11], v[160:175]
buffer_load_dwordx4 v8, s[16:19], s60 offen offset:1024  lds
buffer_load_dwordx4 v9, s[16:19], s60 offen offset:2048  lds
ds_read_b64_tr_b16 v[60:61], v12 offset:4096
v_mfma_f32_32x32x16_bf16 v[176:191], v[52:55], a[12:15], v[176:191]
buffer_load_dwordx4 v10, s[16:19], s60 offen offset:3072  lds
s_sub_u32 s84, s2, 128
ds_read_b64_tr_b16 v[62:63], v12 offset:4608
s_waitcnt lgkmcnt(2)
v_mfma_f32_32x32x16_bf16 v[160:175], v[56:59], a[16:19], v[160:175]
s_lshr_b32 s84, s84, 3
s_lshl_b32 s84, s84, 2
s_add_u32 s84, s84, s42
s_add_u32 s84, s84, 0
ds_read_b64_tr_b16 v[48:49], v11 offset:8192
v_mfma_f32_16x16x32_bf16 v[44:47], v[20:23], v[56:59], v[44:47]
s_and_b32 s85, s2, 7
s_cmp_lt_u32 s84, 74
s_cselect_b32 s86, 0, 0x40000000
v_mfma_f32_32x32x16_bf16 v[176:191], v[56:59], a[20:23], v[176:191]
s_min_u32 s84, s84, 73
s_mul_i32 s87, s85, 160
ds_read_b64_tr_b16 v[50:51], v11 offset:8704
s_waitcnt lgkmcnt(2)
v_mfma_f32_32x32x16_bf16 v[160:175], v[60:63], a[24:27], v[160:175]
s_lshr_b32 s88, s87, 7
s_lshl_b32 s88, s88, 7
s_sub_u32 s87, s87, s88
s_cmp_lt_u32 s84, 54
s_cselect_b32 s89, 0, 54
s_cselect_b32 s28, s28, s32
s_cselect_b32 s29, s29, s33
s_cselect_b32 s30, s30, s34
ds_read_b64_tr_b16 v[52:53], v12 offset:8192
v_mfma_f32_32x32x16_bf16 v[176:191], v[60:63], a[28:31], v[176:191]
ds_read_b64_tr_b16 v[54:55], v12 offset:8704
s_waitcnt lgkmcnt(2)
v_mfma_f32_32x32x16_bf16 v[160:175], v[48:51], a[32:35], v[160:175]
s_sub_u32 s89, s84, s89
s_mul_i32 s89, s89, 40960
s_add_u32 s89, s89, s88
ds_read_b32 v38, v19 offset:512
ds_read_b64_tr_b16 v[56:57], v11 offset:12288
v_mfma_f32_16x16x32_bf16 v[44:47], v[20:23], v[48:51], v[44:47]
v_lshrrev_b32 v244, 4, v1
v_mfma_f32_32x32x16_bf16 v[176:191], v[48:51], a[36:39], v[176:191]
v_and_b32 v245, 15, v1
v_mul_u32_u24 v244, 1280, v244
v_lshl_add_u32 v244, v245, 4, v244
v_add_u32 v244, s86, v244
ds_read_b64_tr_b16 v[58:59], v11 offset:12800
s_waitcnt lgkmcnt(3)
v_mfma_f32_32x32x16_bf16 v[160:175], v[52:55], a[40:43], v[160:175]
s_lshl_b32 s88, s42, 13
s_add_u32 s88, s88, 114688
s_add_u32 m0, s88, 0
s_add_u32 s90, s89, 0
ds_read_b64_tr_b16 v[60:61], v12 offset:12288
v_mfma_f32_32x32x16_bf16 v[176:191], v[52:55], a[44:47], v[176:191]
buffer_load_dwordx4 v244, s[28:31], s90 offen  lds
s_add_u32 m0, s88, 1024
ds_read_b64_tr_b16 v[62:63], v12 offset:12800
s_waitcnt lgkmcnt(2)
v_mfma_f32_32x32x16_bf16 v[160:175], v[56:59], a[48:51], v[160:175]
s_add_u32 s90, s89, 5120
buffer_load_dwordx4 v244, s[28:31], s90 offen  lds
v_add_u32 v11, 0xffff4000, v11
v_add_u32 v12, 0xffff4000, v12
ds_read_b64_tr_b16 v[48:49], v11 offset:0
v_mfma_f32_16x16x32_bf16 v[44:47], v[20:23], v[56:59], v[44:47]
s_add_u32 m0, s88, 2048
v_mfma_f32_32x32x16_bf16 v[176:191], v[56:59], a[52:55], v[176:191]
s_add_u32 s90, s89, 10240
buffer_load_dwordx4 v244, s[28:31], s90 offen  lds
ds_read_b64_tr_b16 v[50:51], v11 offset:512
s_waitcnt lgkmcnt(2)
v_mfma_f32_32x32x16_bf16 v[160:175], v[60:63], a[56:59], v[160:175]
ds_read_b64_tr_b16 v[52:53], v12 offset:0
v_mfma_f32_32x32x16_bf16 v[176:191], v[60:63], a[60:63], v[176:191]
ds_read_b64_tr_b16 v[54:55], v12 offset:512
s_waitcnt vmcnt(24)
s_barrier
s_waitcnt lgkmcnt(2)
v_mfma_f32_32x32x16_bf16 v[160:175], v[48:51], a[64:67], v[160:175]
s_lshl_b32 s60, s67, 7
s_add_u32 s60, s60, 884736
ds_read_b64_tr_b16 v[56:57], v11 offset:4096
v_mfma_f32_16x16x32_bf16 v[44:47], v[20:23], v[48:51], v[44:47]
v_mfma_f32_32x32x16_bf16 v[176:191], v[48:51], a[68:71], v[176:191]
s_add_u32 m0, s59, 65536
ds_read_b32 v39, v19 offset:640
ds_read_b64_tr_b16 v[58:59], v11 offset:4608
s_waitcnt lgkmcnt(3)
v_mfma_f32_32x32x16_bf16 v[160:175], v[52:55], a[72:75], v[160:175]
buffer_load_dwordx4 v7, s[16:19], s60 offen offset:0  lds
ds_read_b64_tr_b16 v[60:61], v12 offset:4096
v_mfma_f32_32x32x16_bf16 v[176:191], v[52:55], a[76:79], v[176:191]
buffer_load_dwordx4 v8, s[16:19], s60 offen offset:1024  lds
ds_read_b64_tr_b16 v[62:63], v12 offset:4608
s_waitcnt lgkmcnt(2)
v_mfma_f32_32x32x16_bf16 v[160:175], v[56:59], a[80:83], v[160:175]
buffer_load_dwordx4 v9, s[16:19], s60 offen offset:2048  lds
ds_read_b64_tr_b16 v[48:49], v11 offset:8192
v_mfma_f32_16x16x32_bf16 v[44:47], v[20:23], v[56:59], v[44:47]
v_mfma_f32_32x32x16_bf16 v[176:191], v[56:59], a[84:87], v[176:191]
buffer_load_dwordx4 v10, s[16:19], s60 offen offset:3072  lds
ds_read_b64_tr_b16 v[50:51], v11 offset:8704
s_waitcnt lgkmcnt(2)
v_mfma_f32_32x32x16_bf16 v[160:175], v[60:63], a[88:91], v[160:175]
s_add_u32 m0, s88, 3072
ds_read_b64_tr_b16 v[52:53], v12 offset:8192
v_mfma_f32_32x32x16_bf16 v[176:191], v[60:63], a[92:95], v[176:191]
s_add_u32 s90, s89, 15360
ds_read_b64_tr_b16 v[54:55], v12 offset:8704
s_waitcnt lgkmcnt(2)
v_mfma_f32_32x32x16_bf16 v[160:175], v[48:51], a[96:99], v[160:175]
buffer_load_dwordx4 v244, s[28:31], s90 offen  lds
ds_read_b64_tr_b16 v[56:57], v11 offset:12288
v_mfma_f32_16x16x32_bf16 v[44:47], v[20:23], v[48:51], v[44:47]
s_add_u32 m0, s88, 4096
v_mfma_f32_32x32x16_bf16 v[176:191], v[48:51], a[100:103], v[176:191]
s_add_u32 s90, s89, 20480
ds_read_b64_tr_b16 v[58:59], v11 offset:12800
s_waitcnt lgkmcnt(2)
v_mfma_f32_32x32x16_bf16 v[160:175], v[52:55], a[104:107], v[160:175]
buffer_load_dwordx4 v244, s[28:31], s90 offen  lds
ds_read_b64_tr_b16 v[60:61], v12 offset:12288
v_mfma_f32_32x32x16_bf16 v[176:191], v[52:55], a[108:111], v[176:191]
s_add_u32 m0, s88, 5120
ds_read_b64_tr_b16 v[62:63], v12 offset:12800
s_waitcnt lgkmcnt(2)
v_mfma_f32_32x32x16_bf16 v[160:175], v[56:59], a[112:115], v[160:175]
s_add_u32 s90, s89, 25600
v_add_u32 v11, 0x10000, v11
v_add_u32 v12, 0x10000, v12
ds_read_b64_tr_b16 v[48:49], v11 offset:0
v_mfma_f32_16x16x32_bf16 v[44:47], v[20:23], v[56:59], v[44:47]
v_mfma_f32_32x32x16_bf16 v[176:191], v[56:59], a[116:119], v[176:191]
buffer_load_dwordx4 v244, s[28:31], s90 offen  lds
ds_read_b64_tr_b16 v[50:51], v11 offset:512
s_waitcnt lgkmcnt(2)
v_mfma_f32_32x32x16_bf16 v[160:175], v[60:63], a[120:123], v[160:175]
v_add_f32 v38, v38, v39
ds_read_b64_tr_b16 v[52:53], v12 offset:0
v_mfma_f32_32x32x16_bf16 v[176:191], v[60:63], a[124:127], v[176:191]
ds_read_b64_tr_b16 v[54:55], v12 offset:512
s_waitcnt vmcnt(15)
s_barrier
s_cmp_lg_u32 s42, 0
s_cbranch_scc1 L_sig_13
s_add_u32 s46, s40, 0
s_lshl_b32 s46, s46, 5
s_add_u32 s46, s46, s41
s_lshl_b32 s46, s46, 2
s_add_u32 s46, s46, 25165824
s_mov_b64 exec, 1
v_mov_b32 v0, s46
v_mov_b32 v13, s79
buffer_store_dword v13, v0, s[24:27], 0 offen sc1
s_mov_b64 exec, -1
L_sig_13:
s_waitcnt lgkmcnt(2)
v_mfma_f32_32x32x16_bf16 v[160:175], v[48:51], a[128:131], v[160:175]
s_lshl_b32 s60, s67, 7
ds_read_b64_tr_b16 v[56:57], v11 offset:4096
v_mfma_f32_16x16x32_bf16 v[44:47], v[20:23], v[48:51], v[44:47]
s_add_u32 s60, s60, 1327104
v_mfma_f32_32x32x16_bf16 v[176:191], v[48:51], a[132:135], v[176:191]
s_add_u32 m0, s59, 16384
ds_read_b64_tr_b16 v[58:59], v11 offset:4608
s_waitcnt lgkmcnt(2)
v_mfma_f32_32x32x16_bf16 v[160:175], v[52:55], a[136:139], v[160:175]
buffer_load_dwordx4 v7, s[16:19], s60 offen offset:0  lds
ds_read_b64_tr_b16 v[60:61], v12 offset:4096
v_mfma_f32_32x32x16_bf16 v[176:191], v[52:55], a[140:143], v[176:191]
ds_read_b64_tr_b16 v[62:63], v12 offset:4608
s_waitcnt lgkmcnt(2)
v_mfma_f32_32x32x16_bf16 v[160:175], v[56:59], a[144:147], v[160:175]
buffer_load_dwordx4 v8, s[16:19], s60 offen offset:1024  lds
ds_read_b64_tr_b16 v[48:49], v11 offset:8192
v_mfma_f32_16x16x32_bf16 v[44:47], v[20:23], v[56:59], v[44:47]
v_cvt_pk_bf16_f32 v39, v38, v38
v_mfma_f32_32x32x16_bf16 v[176:191], v[56:59], a[148:151], v[176:191]
buffer_load_dwordx4 v9, s[16:19], s60 offen offset:2048  lds
ds_read_b64_tr_b16 v[50:51], v11 offset:8704
s_waitcnt lgkmcnt(2)
v_mfma_f32_32x32x16_bf16 v[160:175], v[60:63], a[152:155], v[160:175]
ds_read_b64_tr_b16 v[52:53], v12 offset:8192
v_mfma_f32_32x32x16_bf16 v[176:191], v[60:63], a[156:159], v[176:191]
buffer_load_dwordx4 v10, s[16:19], s60 offen offset:3072  lds
ds_read_b64_tr_b16 v[54:55], v12 offset:8704
s_waitcnt lgkmcnt(2)
v_mfma_f32_32x32x16_bf16 v[160:175], v[48:51], a[160:163], v[160:175]
s_add_u32 m0, s88, 6144
ds_read_b64_tr_b16 v[56:57], v11 offset:12288
v_mfma_f32_16x16x32_bf16 v[44:47], v[20:23], v[48:51], v[44:47]
s_add_u32 s90, s89, 30720
v_mfma_f32_32x32x16_bf16 v[176:191], v[48:51], a[164:167], v[176:191]
buffer_load_dwordx4 v244, s[28:31], s90 offen  lds
ds_read_b64_tr_b16 v[58:59], v11 offset:12800
s_waitcnt lgkmcnt(2)
v_mfma_f32_32x32x16_bf16 v[160:175], v[52:55], a[168:171], v[160:175]
v_lshlrev_b32 v39, 16, v39
ds_read_b64_tr_b16 v[60:61], v12 offset:12288
v_mfma_f32_32x32x16_bf16 v[176:191], v[52:55], a[172:175], v[176:191]
s_add_u32 m0, s88, 7168
s_add_u32 s90, s89, 35840
ds_read_b64_tr_b16 v[62:63], v12 offset:12800
s_waitcnt lgkmcnt(2)
v_mfma_f32_32x32x16_bf16 v[160:175], v[56:59], a[176:179], v[160:175]
v_add_u32 v11, 0x4000, v11
v_add_u32 v12, 0x4000, v12
ds_read_b64_tr_b16 v[48:49], v11 offset:0
v_mfma_f32_16x16x32_bf16 v[44:47], v[20:23], v[56:59], v[44:47]
v_mfma_f32_32x32x16_bf16 v[176:191], v[56:59], a[180:183], v[176:191]
buffer_load_dwordx4 v244, s[28:31], s90 offen  lds
ds_read_b64_tr_b16 v[50:51], v11 offset:512
s_waitcnt lgkmcnt(2)
v_mfma_f32_32x32x16_bf16 v[160:175], v[60:63], a[184:187], v[160:175]
ds_read_b64_tr_b16 v[52:53], v12 offset:0
v_mfma_f32_32x32x16_bf16 v[176:191], v[60:63], a[188:191], v[176:191]
ds_read_b64_tr_b16 v[54:55], v12 offset:512
s_barrier
s_waitcnt lgkmcnt(2)
v_mfma_f32_32x32x16_bf16 v[160:175], v[48:51], a[192:195], v[160:175]
s_lshl_b32 s60, s67, 7
v_sub_f32 v39, v38, v39
ds_read_b64_tr_b16 v[56:57], v11 offset:4096
v_mfma_f32_16x16x32_bf16 v[44:47], v[20:23], v[48:51], v[44:47]
v_mfma_f32_32x32x16_bf16 v[176:191], v[48:51], a[196:199], v[176:191]
s_add_u32 s60, s60, 1769472
ds_read_b64_tr_b16 v[58:59], v11 offset:4608
s_waitcnt lgkmcnt(2)
v_mfma_f32_32x32x16_bf16 v[160:175], v[52:55], a[200:203], v[160:175]
s_add_u32 m0, s59, 81920
ds_read_b64_tr_b16 v[60:61], v12 offset:4096
v_mfma_f32_32x32x16_bf16 v[176:191], v[52:55], a[204:207], v[176:191]
ds_read_b64_tr_b16 v[62:63], v12 offset:4608
s_waitcnt lgkmcnt(2)
v_mfma_f32_32x32x16_bf16 v[160:175], v[56:59], a[208:211], v[160:175]
ds_read_b64_tr_b16 v[48:49], v11 offset:8192
v_mfma_f32_16x16x32_bf16 v[44:47], v[20:23], v[56:59], v[44:47]
buffer_load_dwordx4 v7, s[16:19], s60 offen offset:0  lds
v_mfma_f32_32x32x16_bf16 v[176:191], v[56:59], a[212:215], v[176:191]
v_cvt_pk_bf16_f32 v24, v38, v39
ds_read_b64_tr_b16 v[50:51], v11 offset:8704
s_waitcnt lgkmcnt(2)
v_mfma_f32_32x32x16_bf16 v[160:175], v[60:63], a[216:219], v[160:175]
ds_read_b64_tr_b16 v[52:53], v12 offset:8192
v_mfma_f32_32x32x16_bf16 v[176:191], v[60:63], a[220:223], v[176:191]
buffer_load_dwordx4 v8, s[16:19], s60 offen offset:1024  lds
ds_read_b64_tr_b16 v[54:55], v12 offset:8704
s_waitcnt lgkmcnt(2)
v_mfma_f32_32x32x16_bf16 v[160:175], v[48:51], a[224:227], v[160:175]
ds_read_b64_tr_b16 v[56:57], v11 offset:12288
v_mfma_f32_16x16x32_bf16 v[44:47], v[20:23], v[48:51], v[44:47]
v_mfma_f32_32x32x16_bf16 v[176:191], v[48:51], a[228:231], v[176:191]
buffer_load_dwordx4 v9, s[16:19], s60 offen offset:2048  lds
ds_read_b64_tr_b16 v[58:59], v11 offset:12800
s_waitcnt lgkmcnt(2)
v_mfma_f32_32x32x16_bf16 v[160:175], v[52:55], a[232:235], v[160:175]
ds_read_b64_tr_b16 v[60:61], v12 offset:12288
v_mfma_f32_32x32x16_bf16 v[176:191], v[52:55], a[236:239], v[176:191]
ds_read_b64_tr_b16 v[62:63], v12 offset:12800
s_waitcnt lgkmcnt(2)
v_mfma_f32_32x32x16_bf16 v[160:175], v[56:59], a[240:243], v[160:175]
buffer_load_dwordx4 v10, s[16:19], s60 offen offset:3072  lds
v_add_u32 v11, 0xffff0000, v11
v_add_u32 v12, 0xffff0000, v12
ds_read_b64_tr_b16 v[48:49], v11 offset:0
v_mfma_f32_16x16x32_bf16 v[44:47], v[20:23], v[56:59], v[44:47]
v_mfma_f32_32x32x16_bf16 v[176:191], v[56:59], a[244:247], v[176:191]
v_mfma_f32_32x32x8bf16_1k v[128:143], v[24:25], v[26:27], v[128:143]
ds_read_b64_tr_b16 v[50:51], v11 offset:512
s_waitcnt lgkmcnt(2)
v_mfma_f32_32x32x16_bf16 v[160:175], v[60:63], a[248:251], v[160:175]
ds_read_b64_tr_b16 v[52:53], v12 offset:0
v_mfma_f32_32x32x16_bf16 v[176:191], v[60:63], a[252:255], v[176:191]
ds_read_b64_tr_b16 v[54:55], v12 offset:512
s_barrier
s_waitcnt lgkmcnt(2)
v_mfma_f32_32x32x16_bf16 v[160:175], v[48:51], v[64:67], v[160:175]
s_lshl_b32 s60, s68, 7
ds_read_b64_tr_b16 v[56:57], v11 offset:4096
v_mfma_f32_16x16x32_bf16 v[44:47], v[20:23], v[48:51], v[44:47]
v_mfma_f32_32x32x16_bf16 v[176:191], v[48:51], v[68:71], v[176:191]
s_add_u32 s60, s60, 0
ds_read_b64_tr_b16 v[58:59], v11 offset:4608
s_waitcnt lgkmcnt(2)
v_mfma_f32_32x32x16_bf16 v[160:175], v[52:55], v[72:75], v[160:175]
s_add_u32 m0, s59, 98304
ds_read_b64_tr_b16 v[60:61], v12 offset:4096
v_mfma_f32_32x32x16_bf16 v[176:191], v[52:55], v[76:79], v[176:191]
ds_read_b64_tr_b16 v[62:63], v12 offset:4608
s_waitcnt lgkmcnt(2)
v_mfma_f32_32x32x16_bf16 v[160:175], v[56:59], v[80:83], v[160:175]
ds_read_b64_tr_b16 v[48:49], v11 offset:8192
v_mfma_f32_16x16x32_bf16 v[44:47], v[20:23], v[56:59], v[44:47]
buffer_load_dwordx4 v7, s[20:23], s60 offen offset:0  lds
v_mfma_f32_32x32x16_bf16 v[176:191], v[56:59], v[84:87], v[176:191]
ds_read_b64_tr_b16 v[50:51], v11 offset:8704
s_waitcnt lgkmcnt(2)
v_mfma_f32_32x32x16_bf16 v[160:175], v[60:63], v[88:91], v[160:175]
ds_read_b64_tr_b16 v[52:53], v12 offset:8192
v_mfma_f32_32x32x16_bf16 v[176:191], v[60:63], v[92:95], v[176:191]
buffer_load_dwordx4 v8, s[20:23], s60 offen offset:1024  lds
ds_read_b64_tr_b16 v[54:55], v12 offset:8704
s_waitcnt lgkmcnt(2)
v_mfma_f32_32x32x16_bf16 v[160:175], v[48:51], v[96:99], v[160:175]
v_mfma_f32_32x32x8bf16_1k v[144:159], v[24:25], v[28:29], v[144:159]
ds_read_b64_tr_b16 v[56:57], v11 offset:12288
v_mfma_f32_16x16x32_bf16 v[44:47], v[20:23], v[48:51], v[44:47]
v_mfma_f32_32x32x16_bf16 v[176:191], v[48:51], v[100:103], v[176:191]
buffer_load_dwordx4 v9, s[20:23], s60 offen offset:2048  lds
ds_read_b64_tr_b16 v[58:59], v11 offset:12800
s_waitcnt lgkmcnt(2)
v_mfma_f32_32x32x16_bf16 v[160:175], v[52:55], v[104:107], v[160:175]
ds_read_b64_tr_b16 v[60:61], v12 offset:12288
v_mfma_f32_32x32x16_bf16 v[176:191], v[52:55], v[108:111], v[176:191]
ds_read_b64_tr_b16 v[62:63], v12 offset:12800
s_waitcnt lgkmcnt(2)
v_mfma_f32_32x32x16_bf16 v[160:175], v[56:59], v[112:115], v[160:175]
buffer_load_dwordx4 v10, s[20:23], s60 offen offset:3072  lds
v_add_u32 v11, 0xffff8000, v11
v_add_u32 v12, 0xffff8000, v12
ds_read_b64_tr_b16 v[48:49], v11 offset:0
v_mfma_f32_16x16x32_bf16 v[44:47], v[20:23], v[56:59], v[44:47]
v_mfma_f32_32x32x16_bf16 v[176:191], v[56:59], v[116:119], v[176:191]
ds_read_b64_tr_b16 v[50:51], v11 offset:512
s_waitcnt lgkmcnt(2)
v_mfma_f32_32x32x16_bf16 v[160:175], v[60:63], v[120:123], v[160:175]
ds_read_b64_tr_b16 v[52:53], v12 offset:0
s_nop 2
ds_write_b32 v18, v44 offset:0
ds_write_b32 v18, v45 offset:64
v_mfma_f32_32x32x16_bf16 v[176:191], v[60:63], v[124:127], v[176:191]
ds_read_b64_tr_b16 v[54:55], v12 offset:512
s_waitcnt vmcnt(24) lgkmcnt(1)
s_barrier
v_mfma_f32_32x32x16_bf16 v[192:207], v[48:51], a[0:3], 0
s_lshl_b32 s60, s68, 7
ds_read_b64_tr_b16 v[56:57], v11 offset:4096
v_mfma_f32_16x16x32_bf16 v[44:47], v[20:23], v[48:51], 0
v_mfma_f32_32x32x16_bf16 v[208:223], v[48:51], a[4:7], 0
s_add_u32 s60, s60, 442368
v_lshrrev_b32 v244, 4, v1
ds_read_b32 v38, v19 offset:0
ds_read_b64_tr_b16 v[58:59], v11 offset:4608
s_waitcnt lgkmcnt(3)
v_mfma_f32_32x32x16_bf16 v[192:207], v[52:55], a[8:11], v[192:207]
s_add_u32 m0, s59, 32768
v_bfe_u32 v245, v1, 2, 2
ds_read_b32 v39, v19 offset:128
s_waitcnt lgkmcnt(0)
ds_read_b64_tr_b16 v[60:61], v12 offset:4096
v_mfma_f32_32x32x16_bf16 v[208:223], v[52:55], a[12:15], v[208:223]
v_lshl_add_u32 v244, v244, 3, v245
v_add_f32 v38, v38, v39
v_cvt_pk_bf16_f32 v39, v38, v38
ds_read_b64_tr_b16 v[62:63], v12 offset:4608
v_mfma_f32_32x32x16_bf16 v[192:207], v[56:59], a[16:19], v[192:207]
v_lshlrev_b32 v244, 8, v244
v_and_b32 v245, 3, v1
v_lshlrev_b32 v39, 16, v39
v_sub_f32 v39, v38, v39
v_cvt_pk_bf16_f32 v24, v38, v39
ds_read_b64_tr_b16 v[48:49], v11 offset:8192
v_mfma_f32_16x16x32_bf16 v[44:47], v[20:23], v[56:59], v[44:47]
buffer_load_dwordx4 v7, s[20:23], s60 offen offset:0  lds
v_mfma_f32_32x32x16_bf16 v[208:223], v[56:59], a[20:23], v[208:223]
v_mul_u32_u24 v245, 40, v245
v_mfma_f32_32x32x8bf16_1k v[160:175], v[24:25], v[26:27], v[160:175]
ds_read_b64_tr_b16 v[50:51], v11 offset:8704
s_waitcnt lgkmcnt(2)
v_mfma_f32_32x32x16_bf16 v[192:207], v[60:63], a[24:27], v[192:207]
v_add_u32 v244, v244, v245
s_add_u32 s88, s88, s87
v_mfma_f32_32x32x8bf16_1k v[176:191], v[24:25], v[28:29], v[176:191]
ds_read_b64_tr_b16 v[52:53], v12 offset:8192
v_mfma_f32_32x32x16_bf16 v[208:223], v[60:63], a[28:31], v[208:223]
buffer_load_dwordx4 v8, s[20:23], s60 offen offset:1024  lds
s_lshl_b32 s52, s66, 1
ds_read_b64_tr_b16 v[54:55], v12 offset:8704
s_waitcnt lgkmcnt(2)
v_mfma_f32_32x32x16_bf16 v[192:207], v[48:51], a[32:35], v[192:207]
v_add_u32 v244, s88, v244
s_mul_i32 s89, s85, 74
s_add_u32 s52, s52, s44
s_lshl_b32 s52, s52, 10
ds_read_b64_tr_b16 v[56:57], v11 offset:12288
v_mfma_f32_16x16x32_bf16 v[44:47], v[20:23], v[48:51], v[44:47]
s_add_u32 s89, s89, s84
s_add_u32 s52, s52, 8388608
v_mfma_f32_32x32x16_bf16 v[208:223], v[48:51], a[36:39], v[208:223]
buffer_load_dwordx4 v9, s[20:23], s60 offen offset:2048  lds
s_mul_i32 s53, s55, 110592
ds_read_b64_tr_b16 v[58:59], v11 offset:12800
s_waitcnt lgkmcnt(2)
v_mfma_f32_32x32x16_bf16 v[192:207], v[52:55], a[40:43], v[192:207]
s_mul_i32 s89, s89, 5120
s_add_u32 s89, s89, 20971520
s_add_u32 s61, s52, s53
s_mul_i32 s53, s56, 110592
ds_read_b64_tr_b16 v[60:61], v12 offset:12288
v_mfma_f32_32x32x16_bf16 v[208:223], v[52:55], a[44:47], v[208:223]
v_lshlrev_b32 v245, 4, v1
s_add_u32 s62, s52, s53
v_mul_f32 v40, v128, v128
ds_read_b64_tr_b16 v[62:63], v12 offset:12800
s_waitcnt lgkmcnt(2)
v_mfma_f32_32x32x16_bf16 v[192:207], v[56:59], a[48:51], v[192:207]
buffer_load_dwordx4 v10, s[20:23], s60 offen offset:3072  lds
v_mul_f32 v41, v129, v129
v_add_u32 v11, 0xc000, v11
v_add_u32 v12, 0xc000, v12
ds_read_b64_tr_b16 v[48:49], v11 offset:0
v_mfma_f32_16x16x32_bf16 v[44:47], v[20:23], v[56:59], v[44:47]
v_add_u32 v245, s86, v245
v_mul_f32 v42, v130, v130
v_mfma_f32_32x32x16_bf16 v[208:223], v[56:59], a[52:55], v[208:223]
s_waitcnt vmcnt(12)
v_mul_f32 v43, v131, v131
v_fma_f32 v40, v40, v33, v32
ds_read_b64_tr_b16 v[50:51], v11 offset:512
s_waitcnt lgkmcnt(2)
v_mfma_f32_32x32x16_bf16 v[192:207], v[60:63], a[56:59], v[192:207]
ds_read_b64_tr_b16 v[224:225], v244 offset:0
ds_read_b64_tr_b16 v[226:227], v244 offset:1024
v_fma_f32 v41, v41, v33, v32
v_fma_f32 v42, v42, v33, v32
ds_read_b64_tr_b16 v[52:53], v12 offset:0
v_mfma_f32_32x32x16_bf16 v[208:223], v[60:63], a[60:63], v[208:223]
v_fma_f32 v43, v43, v33, v32
ds_read_b64_tr_b16 v[54:55], v12 offset:512
s_barrier
s_waitcnt lgkmcnt(4)
v_mfma_f32_32x32x16_bf16 v[192:207], v[48:51], a[64:67], v[192:207]
s_lshl_b32 s60, s68, 7
ds_read_b64_tr_b16 v[228:229], v244 offset:8
ds_read_b64_tr_b16 v[230:231], v244 offset:1032
v_mul_f32 v40, v128, v40
v_mul_f32 v41, v129, v41
ds_read_b64_tr_b16 v[56:57], v11 offset:4096
v_mfma_f32_16x16x32_bf16 v[44:47], v[20:23], v[48:51], v[44:47]
v_mul_f32 v42, v130, v42
v_mfma_f32_32x32x16_bf16 v[208:223], v[48:51], a[68:71], v[208:223]
s_add_u32 s60, s60, 884736
ds_read_b64_tr_b16 v[232:233], v244 offset:16
v_mul_f32 v43, v131, v43
ds_read_b64_tr_b16 v[58:59], v11 offset:4608
s_waitcnt lgkmcnt(5)
v_mfma_f32_32x32x16_bf16 v[192:207], v[52:55], a[72:75], v[192:207]
s_add_u32 m0, s59, 0
ds_read_b64_tr_b16 v[234:235], v244 offset:1040
v_exp_f32 v40, v40
ds_read_b64_tr_b16 v[60:61], v12 offset:4096
v_mfma_f32_32x32x16_bf16 v[208:223], v[52:55], a[76:79], v[208:223]
ds_read_b64_tr_b16 v[236:237], v244 offset:24
ds_read_b64_tr_b16 v[238:239], v244 offset:1048
v_exp_f32 v41, v41
ds_read_b64_tr_b16 v[62:63], v12 offset:4608
s_waitcnt lgkmcnt(5)
v_mfma_f32_32x32x16_bf16 v[192:207], v[56:59], a[80:83], v[192:207]
ds_read_b64_tr_b16 v[240:241], v244 offset:32
v_exp_f32 v42, v42
ds_read_b64_tr_b16 v[48:49], v11 offset:8192
v_mfma_f32_16x16x32_bf16 v[44:47], v[20:23], v[56:59], v[44:47]
buffer_load_dwordx4 v7, s[20:23], s60 offen offset:0  lds
v_mfma_f32_32x32x16_bf16 v[208:223], v[56:59], a[84:87], v[208:223]
ds_read_b64_tr_b16 v[242:243], v244 offset:1056
v_exp_f32 v43, v43
v_mul_f32 v128, v128, v160
ds_read_b64_tr_b16 v[50:51], v11 offset:8704
s_waitcnt lgkmcnt(4)
v_mfma_f32_32x32x16_bf16 v[192:207], v[60:63], a[88:91], v[192:207]
s_waitcnt lgkmcnt(1)
buffer_store_dwordx4 v[224:227], v245, s[24:27], s89 offen offset:0 sc1
v_mul_f32 v129, v129, v161
ds_read_b64_tr_b16 v[52:53], v12 offset:8192
v_mfma_f32_32x32x16_bf16 v[208:223], v[60:63], a[92:95], v[208:223]
buffer_load_dwordx4 v8, s[20:23], s60 offen offset:1024  lds
v_mul_f32 v130, v130, v162
ds_read_b64_tr_b16 v[54:55], v12 offset:8704
s_waitcnt lgkmcnt(2)
v_mfma_f32_32x32x16_bf16 v[192:207], v[48:51], a[96:99], v[192:207]
buffer_store_dwordx4 v[228:231], v245, s[24:27], s89 offen offset:1024 sc1
v_mul_f32 v131, v131, v163
v_fma_f32 v40, v40, v34, v34
ds_read_b64_tr_b16 v[56:57], v11 offset:12288
v_mfma_f32_16x16x32_bf16 v[44:47], v[20:23], v[48:51], v[44:47]
v_fma_f32 v41, v41, v34, v34
v_fma_f32 v42, v42, v34, v34
v_mfma_f32_32x32x16_bf16 v[208:223], v[48:51], a[100:103], v[208:223]
buffer_load_dwordx4 v9, s[20:23], s60 offen offset:2048  lds
v_fma_f32 v43, v43, v34, v34
ds_read_b64_tr_b16 v[58:59], v11 offset:12800
s_waitcnt lgkmcnt(2)
v_mfma_f32_32x32x16_bf16 v[192:207], v[52:55], a[104:107], v[192:207]
buffer_store_dwordx4 v[232:235], v245, s[24:27], s89 offen offset:2048 sc1
v_rcp_f32 v40, v40
ds_read_b64_tr_b16 v[60:61], v12 offset:12288
v_mfma_f32_32x32x16_bf16 v[208:223], v[52:55], a[108:111], v[208:223]
buffer_store_dwordx4 v[236:239], v245, s[24:27], s89 offen offset:3072 sc1
v_rcp_f32 v41, v41
ds_read_b64_tr_b16 v[62:63], v12 offset:12800
s_waitcnt lgkmcnt(2)
v_mfma_f32_32x32x16_bf16 v[192:207], v[56:59], a[112:115], v[192:207]
buffer_load_dwordx4 v10, s[20:23], s60 offen offset:3072  lds
v_add_u32 v11, 0x4000, v11
v_add_u32 v12, 0x4000, v12
ds_read_b64_tr_b16 v[48:49], v11 offset:0
v_mfma_f32_16x16x32_bf16 v[44:47], v[20:23], v[56:59], v[44:47]
v_rcp_f32 v42, v42
v_mfma_f32_32x32x16_bf16 v[208:223], v[56:59], a[116:119], v[208:223]
s_add_u32 s89, s89, 4096
v_rcp_f32 v43, v43
ds_read_b64_tr_b16 v[50:51], v11 offset:512
s_waitcnt lgkmcnt(2)
v_mfma_f32_32x32x16_bf16 v[192:207], v[60:63], a[120:123], v[192:207]
buffer_store_dwordx4 v[240:243], v245, s[24:27], s89 offen offset:0 sc1
v_mul_f32 v128, v128, v40
v_mul_f32 v129, v129, v41
ds_read_b64_tr_b16 v[52:53], v12 offset:0
v_mfma_f32_32x32x16_bf16 v[208:223], v[60:63], a[124:127], v[208:223]
v_mul_f32 v130, v130, v42
ds_read_b64_tr_b16 v[54:55], v12 offset:512
s_barrier
s_waitcnt lgkmcnt(2)
v_mfma_f32_32x32x16_bf16 v[192:207], v[48:51], a[128:131], v[192:207]
s_lshl_b32 s60, s68, 7
v_mul_f32 v131, v131, v43
v_cvt_pk_bf16_f32 v160, v128, v129
v_cvt_pk_bf16_f32 v161, v130, v131
ds_read_b64_tr_b16 v[56:57], v11 offset:4096
v_mfma_f32_16x16x32_bf16 v[44:47], v[20:23], v[48:51], v[44:47]
v_mul_f32 v40, v132, v132
v_mfma_f32_32x32x16_bf16 v[208:223], v[48:51], a[132:135], v[208:223]
s_add_u32 s60, s60, 1327104
v_mul_f32 v41, v133, v133
v_mul_f32 v42, v134, v134
ds_read_b64_tr_b16 v[58:59], v11 offset:4608
s_waitcnt lgkmcnt(2)
v_mfma_f32_32x32x16_bf16 v[192:207], v[52:55], a[136:139], v[192:207]
s_add_u32 m0, s59, 49152
v_mul_f32 v43, v135, v135
v_fma_f32 v40, v40, v33, v32
v_fma_f32 v41, v41, v33, v32
ds_read_b64_tr_b16 v[60:61], v12 offset:4096
v_mfma_f32_32x32x16_bf16 v[208:223], v[52:55], a[140:143], v[208:223]
v_fma_f32 v42, v42, v33, v32
v_fma_f32 v43, v43, v33, v32
v_mul_f32 v40, v132, v40
ds_read_b64_tr_b16 v[62:63], v12 offset:4608
s_waitcnt lgkmcnt(2)
v_mfma_f32_32x32x16_bf16 v[192:207], v[56:59], a[144:147], v[192:207]
v_mul_f32 v41, v133, v41
v_mul_f32 v42, v134, v42
v_mul_f32 v43, v135, v43
ds_read_b64_tr_b16 v[48:49], v11 offset:8192
v_mfma_f32_16x16x32_bf16 v[44:47], v[20:23], v[56:59], v[44:47]
buffer_load_dwordx4 v7, s[20:23], s60 offen offset:0  lds
v_mfma_f32_32x32x16_bf16 v[208:223], v[56:59], a[148:151], v[208:223]
v_exp_f32 v40, v40
ds_read_b64_tr_b16 v[50:51], v11 offset:8704
s_waitcnt lgkmcnt(2)
v_mfma_f32_32x32x16_bf16 v[192:207], v[60:63], a[152:155], v[192:207]
v_exp_f32 v41, v41
v_exp_f32 v42, v42
ds_read_b64_tr_b16 v[52:53], v12 offset:8192
v_mfma_f32_32x32x16_bf16 v[208:223], v[60:63], a[156:159], v[208:223]
buffer_load_dwordx4 v8, s[20:23], s60 offen offset:1024  lds
v_exp_f32 v43, v43
ds_read_b64_tr_b16 v[54:55], v12 offset:8704
s_waitcnt lgkmcnt(2)
v_mfma_f32_32x32x16_bf16 v[192:207], v[48:51], a[160:163], v[192:207]
v_mul_f32 v132, v132, v164
v_mul_f32 v133, v133, v165
v_mul_f32 v134, v134, v166
ds_read_b64_tr_b16 v[56:57], v11 offset:12288
v_mfma_f32_16x16x32_bf16 v[44:47], v[20:23], v[48:51], v[44:47]
v_mul_f32 v135, v135, v167
v_mfma_f32_32x32x16_bf16 v[208:223], v[48:51], a[164:167], v[208:223]
buffer_load_dwordx4 v9, s[20:23], s60 offen offset:2048  lds
v_fma_f32 v40, v40, v34, v34
v_fma_f32 v41, v41, v34, v34
ds_read_b64_tr_b16 v[58:59], v11 offset:12800
s_waitcnt lgkmcnt(2)
v_mfma_f32_32x32x16_bf16 v[192:207], v[52:55], a[168:171], v[192:207]
v_fma_f32 v42, v42, v34, v34
v_fma_f32 v43, v43, v34, v34
v_rcp_f32 v40, v40
ds_read_b64_tr_b16 v[60:61], v12 offset:12288
v_mfma_f32_32x32x16_bf16 v[208:223], v[52:55], a[172:175], v[208:223]
v_rcp_f32 v41, v41
ds_read_b64_tr_b16 v[62:63], v12 offset:12800
s_waitcnt lgkmcnt(2)
v_mfma_f32_32x32x16_bf16 v[192:207], v[56:59], a[176:179], v[192:207]
buffer_load_dwordx4 v10, s[20:23], s60 offen offset:3072  lds
v_add_u32 v11, 0xffff4000, v11
v_add_u32 v12, 0xffff4000, v12
ds_read_b64_tr_b16 v[48:49], v11 offset:0
v_mfma_f32_16x16x32_bf16 v[44:47], v[20:23], v[56:59], v[44:47]
v_rcp_f32 v42, v42
v_mfma_f32_32x32x16_bf16 v[208:223], v[56:59], a[180:183], v[208:223]
v_rcp_f32 v43, v43
v_mul_f32 v132, v132, v40
ds_read_b64_tr_b16 v[50:51], v11 offset:512
s_waitcnt lgkmcnt(2)
v_mfma_f32_32x32x16_bf16 v[192:207], v[60:63], a[184:187], v[192:207]
v_mul_f32 v133, v133, v41
v_mul_f32 v134, v134, v42
v_mul_f32 v135, v135, v43
ds_read_b64_tr_b16 v[52:53], v12 offset:0
v_mfma_f32_32x32x16_bf16 v[208:223], v[60:63], a[188:191], v[208:223]
v_cvt_pk_bf16_f32 v162, v132, v133
ds_read_b64_tr_b16 v[54:55], v12 offset:512
s_waitcnt vmcnt(21)
s_barrier
s_waitcnt lgkmcnt(2)
v_mfma_f32_32x32x16_bf16 v[192:207], v[48:51], a[192:195], v[192:207]
s_lshl_b32 s60, s68, 7
v_cvt_pk_bf16_f32 v163, v134, v135
v_mul_f32 v40, v136, v136
v_mul_f32 v41, v137, v137
ds_read_b64_tr_b16 v[56:57], v11 offset:4096
v_mfma_f32_16x16x32_bf16 v[44:47], v[20:23], v[48:51], v[44:47]
v_mul_f32 v42, v138, v138
v_mul_f32 v43, v139, v139
v_mfma_f32_32x32x16_bf16 v[208:223], v[48:51], a[196:199], v[208:223]
s_add_u32 s60, s60, 1769472
v_fma_f32 v40, v40, v33, v32
v_fma_f32 v41, v41, v33, v32
ds_read_b64_tr_b16 v[58:59], v11 offset:4608
s_waitcnt lgkmcnt(2)
v_mfma_f32_32x32x16_bf16 v[192:207], v[52:55], a[200:203], v[192:207]
s_add_u32 m0, s59, 65536
v_fma_f32 v42, v42, v33, v32
v_fma_f32 v43, v43, v33, v32
ds_read_b64_tr_b16 v[60:61], v12 offset:4096
v_mfma_f32_32x32x16_bf16 v[208:223], v[52:55], a[204:207], v[208:223]
v_mul_f32 v40, v136, v40
v_mul_f32 v41, v137, v41
v_mul_f32 v42, v138, v42
ds_read_b64_tr_b16 v[62:63], v12 offset:4608
s_waitcnt lgkmcnt(2)
v_mfma_f32_32x32x16_bf16 v[192:207], v[56:59], a[208:211], v[192:207]
v_mul_f32 v43, v139, v43
v_exp_f32 v40, v40
ds_read_b64_tr_b16 v[48:49], v11 offset:8192
v_mfma_f32_16x16x32_bf16 v[44:47], v[20:23], v[56:59], v[44:47]
buffer_load_dwordx4 v7, s[20:23], s60 offen offset:0  lds
v_mfma_f32_32x32x16_bf16 v[208:223], v[56:59], a[212:215], v[208:223]
v_exp_f32 v41, v41
v_exp_f32 v42, v42
ds_read_b64_tr_b16 v[50:51], v11 offset:8704
s_waitcnt lgkmcnt(2)
v_mfma_f32_32x32x16_bf16 v[192:207], v[60:63], a[216:219], v[192:207]
v_exp_f32 v43, v43
v_mul_f32 v136, v136, v168
ds_read_b64_tr_b16 v[52:53], v12 offset:8192
v_mfma_f32_32x32x16_bf16 v[208:223], v[60:63], a[220:223], v[208:223]
buffer_load_dwordx4 v8, s[20:23], s60 offen offset:1024  lds
v_mul_f32 v137, v137, v169
ds_read_b64_tr_b16 v[54:55], v12 offset:8704
s_waitcnt lgkmcnt(2)
v_mfma_f32_32x32x16_bf16 v[192:207], v[48:51], a[224:227], v[192:207]
v_mul_f32 v138, v138, v170
v_mul_f32 v139, v139, v171
v_fma_f32 v40, v40, v34, v34
ds_read_b64_tr_b16 v[56:57], v11 offset:12288
v_mfma_f32_16x16x32_bf16 v[44:47], v[20:23], v[48:51], v[44:47]
v_fma_f32 v41, v41, v34, v34
v_fma_f32 v42, v42, v34, v34
v_mfma_f32_32x32x16_bf16 v[208:223], v[48:51], a[228:231], v[208:223]
buffer_load_dwordx4 v9, s[20:23], s60 offen offset:2048  lds
v_fma_f32 v43, v43, v34, v34
ds_read_b64_tr_b16 v[58:59], v11 offset:12800
s_waitcnt lgkmcnt(2)
v_mfma_f32_32x32x16_bf16 v[192:207], v[52:55], a[232:235], v[192:207]
v_rcp_f32 v40, v40
v_rcp_f32 v41, v41
ds_read_b64_tr_b16 v[60:61], v12 offset:12288
v_mfma_f32_32x32x16_bf16 v[208:223], v[52:55], a[236:239], v[208:223]
v_rcp_f32 v42, v42
ds_read_b64_tr_b16 v[62:63], v12 offset:12800
s_waitcnt lgkmcnt(2)
v_mfma_f32_32x32x16_bf16 v[192:207], v[56:59], a[240:243], v[192:207]
buffer_load_dwordx4 v10, s[20:23], s60 offen offset:3072  lds
v_add_u32 v11, 0x10000, v11
v_add_u32 v12, 0x10000, v12
ds_read_b64_tr_b16 v[48:49], v11 offset:0
v_mfma_f32_16x16x32_bf16 v[44:47], v[20:23], v[56:59], v[44:47]
v_rcp_f32 v43, v43
v_mfma_f32_32x32x16_bf16 v[208:223], v[56:59], a[244:247], v[208:223]
v_mul_f32 v136, v136, v40
v_mul_f32 v137, v137, v41
v_mul_f32 v138, v138, v42
ds_read_b64_tr_b16 v[50:51], v11 offset:512
s_waitcnt lgkmcnt(2)
v_mfma_f32_32x32x16_bf16 v[192:207], v[60:63], a[248:251], v[192:207]
v_mul_f32 v139, v139, v43
v_cvt_pk_bf16_f32 v164, v136, v137
v_cvt_pk_bf16_f32 v165, v138, v139
ds_read_b64_tr_b16 v[52:53], v12 offset:0
v_mfma_f32_32x32x16_bf16 v[208:223], v[60:63], a[252:255], v[208:223]
v_mul_f32 v40, v140, v140
v_mul_f32 v41, v141, v141
ds_read_b64_tr_b16 v[54:55], v12 offset:512
s_waitcnt vmcnt(21)
s_barrier
s_waitcnt lgkmcnt(2)
v_mfma_f32_32x32x16_bf16 v[192:207], v[48:51], v[64:67], v[192:207]
v_mul_f32 v42, v142, v142
v_mul_f32 v43, v143, v143
v_fma_f32 v40, v40, v33, v32
ds_read_b64_tr_b16 v[56:57], v11 offset:4096
v_mfma_f32_16x16x32_bf16 v[44:47], v[20:23], v[48:51], v[44:47]
v_fma_f32 v41, v41, v33, v32
v_fma_f32 v42, v42, v33, v32
v_mfma_f32_32x32x16_bf16 v[208:223], v[48:51], v[68:71], v[208:223]
v_fma_f32 v43, v43, v33, v32
v_mul_f32 v40, v140, v40
ds_read_b64_tr_b16 v[58:59], v11 offset:4608
s_waitcnt lgkmcnt(2)
v_mfma_f32_32x32x16_bf16 v[192:207], v[52:55], v[72:75], v[192:207]
v_mul_f32 v41, v141, v41
v_mul_f32 v42, v142, v42
v_mul_f32 v43, v143, v43
ds_read_b64_tr_b16 v[60:61], v12 offset:4096
v_mfma_f32_32x32x16_bf16 v[208:223], v[52:55], v[76:79], v[208:223]
v_exp_f32 v40, v40
v_exp_f32 v41, v41
ds_read_b64_tr_b16 v[62:63], v12 offset:4608
s_waitcnt lgkmcnt(2)
v_mfma_f32_32x32x16_bf16 v[192:207], v[56:59], v[80:83], v[192:207]
v_exp_f32 v42, v42
ds_read_b64_tr_b16 v[48:49], v11 offset:8192
v_mfma_f32_16x16x32_bf16 v[44:47], v[20:23], v[56:59], v[44:47]
v_exp_f32 v43, v43
v_mfma_f32_32x32x16_bf16 v[208:223], v[56:59], v[84:87], v[208:223]
v_mul_f32 v140, v140, v172
v_mul_f32 v141, v141, v173
v_mul_f32 v142, v142, v174
ds_read_b64_tr_b16 v[50:51], v11 offset:8704
s_waitcnt lgkmcnt(2)
v_mfma_f32_32x32x16_bf16 v[192:207], v[60:63], v[88:91], v[192:207]
v_mul_f32 v143, v143, v175
v_fma_f32 v40, v40, v34, v34
v_fma_f32 v41, v41, v34, v34
ds_read_b64_tr_b16 v[52:53], v12 offset:8192
v_mfma_f32_32x32x16_bf16 v[208:223], v[60:63], v[92:95], v[208:223]
v_fma_f32 v42, v42, v34, v34
v_fma_f32 v43, v43, v34, v34
ds_read_b64_tr_b16 v[54:55], v12 offset:8704
s_waitcnt lgkmcnt(2)
v_mfma_f32_32x32x16_bf16 v[192:207], v[48:51], v[96:99], v[192:207]
v_rcp_f32 v40, v40
v_rcp_f32 v41, v41
ds_read_b64_tr_b16 v[56:57], v11 offset:12288
v_mfma_f32_16x16x32_bf16 v[44:47], v[20:23], v[48:51], v[44:47]
v_rcp_f32 v42, v42
v_mfma_f32_32x32x16_bf16 v[208:223], v[48:51], v[100:103], v[208:223]
v_rcp_f32 v43, v43
ds_read_b64_tr_b16 v[58:59], v11 offset:12800
s_waitcnt lgkmcnt(2)
v_mfma_f32_32x32x16_bf16 v[192:207], v[52:55], v[104:107], v[192:207]
v_mul_f32 v140, v140, v40
v_mul_f32 v141, v141, v41
v_mul_f32 v142, v142, v42
v_mul_f32 v143, v143, v43
ds_read_b64_tr_b16 v[60:61], v12 offset:12288
v_mfma_f32_32x32x16_bf16 v[208:223], v[52:55], v[108:111], v[208:223]
v_cvt_pk_bf16_f32 v166, v140, v141
v_cvt_pk_bf16_f32 v167, v142, v143
ds_read_b64_tr_b16 v[62:63], v12 offset:12800
s_waitcnt lgkmcnt(2)
v_mfma_f32_32x32x16_bf16 v[192:207], v[56:59], v[112:115], v[192:207]
buffer_store_dwordx4 v[160:163], v17, s[24:27], s61 offen sc1
v_add_u32 v11, 0x4000, v11
v_add_u32 v12, 0x4000, v12
ds_read_b64_tr_b16 v[48:49], v11 offset:0
v_mfma_f32_16x16x32_bf16 v[44:47], v[20:23], v[56:59], v[44:47]
buffer_store_dwordx4 v[164:167], v17, s[24:27], s61 offen offset:512 sc1
v_mfma_f32_32x32x16_bf16 v[208:223], v[56:59], v[116:119], v[208:223]
ds_read_b64_tr_b16 v[50:51], v11 offset:512
s_waitcnt lgkmcnt(2)
v_mfma_f32_32x32x16_bf16 v[192:207], v[60:63], v[120:123], v[192:207]
ds_read_b64_tr_b16 v[52:53], v12 offset:0
s_nop 1
ds_write_b32 v18, v44 offset:512
ds_write_b32 v18, v45 offset:576
v_mfma_f32_32x32x16_bf16 v[208:223], v[60:63], v[124:127], v[208:223]
ds_read_b64_tr_b16 v[54:55], v12 offset:512
s_waitcnt vmcnt(19) lgkmcnt(1)
s_barrier
v_mfma_f32_32x32x16_bf16 v[224:239], v[48:51], a[0:3], 0
ds_read_b64_tr_b16 v[56:57], v11 offset:4096
v_mfma_f32_16x16x32_bf16 v[44:47], v[20:23], v[48:51], 0
v_mfma_f32_32x32x16_bf16 v[240:255], v[48:51], a[4:7], 0
ds_read_b32 v38, v19 offset:512
ds_read_b32 v39, v19 offset:640
s_waitcnt lgkmcnt(0)
ds_read_b64_tr_b16 v[58:59], v11 offset:4608
v_mfma_f32_32x32x16_bf16 v[224:239], v[52:55], a[8:11], v[224:239]
v_add_f32 v38, v38, v39
v_cvt_pk_bf16_f32 v39, v38, v38
v_lshlrev_b32 v39, 16, v39
v_sub_f32 v39, v38, v39
ds_read_b64_tr_b16 v[60:61], v12 offset:4096
v_mfma_f32_32x32x16_bf16 v[240:255], v[52:55], a[12:15], v[240:255]
v_cvt_pk_bf16_f32 v24, v38, v39
s_nop 1
v_mfma_f32_32x32x8bf16_1k v[192:207], v[24:25], v[26:27], v[192:207]
ds_read_b64_tr_b16 v[62:63], v12 offset:4608
s_waitcnt lgkmcnt(2)
v_mfma_f32_32x32x16_bf16 v[224:239], v[56:59], a[16:19], v[224:239]
v_mfma_f32_32x32x8bf16_1k v[208:223], v[24:25], v[28:29], v[208:223]
v_mul_f32 v40, v144, v144
ds_read_b64_tr_b16 v[48:49], v11 offset:8192
v_mfma_f32_16x16x32_bf16 v[44:47], v[20:23], v[56:59], v[44:47]
v_mul_f32 v41, v145, v145
v_mul_f32 v42, v146, v146
v_mfma_f32_32x32x16_bf16 v[240:255], v[56:59], a[20:23], v[240:255]
v_mul_f32 v43, v147, v147
v_fma_f32 v40, v40, v36, v35
v_fma_f32 v41, v41, v36, v35
ds_read_b64_tr_b16 v[50:51], v11 offset:8704
s_waitcnt lgkmcnt(2)
v_mfma_f32_32x32x16_bf16 v[224:239], v[60:63], a[24:27], v[224:239]
v_fma_f32 v42, v42, v36, v35
v_fma_f32 v43, v43, v36, v35
v_mul_f32 v40, v144, v40
ds_read_b64_tr_b16 v[52:53], v12 offset:8192
v_mfma_f32_32x32x16_bf16 v[240:255], v[60:63], a[28:31], v[240:255]
v_mul_f32 v41, v145, v41
v_mul_f32 v42, v146, v42
v_mul_f32 v43, v147, v43
ds_read_b64_tr_b16 v[54:55], v12 offset:8704
s_waitcnt lgkmcnt(2)
v_mfma_f32_32x32x16_bf16 v[224:239], v[48:51], a[32:35], v[224:239]
v_exp_f32 v40, v40
v_exp_f32 v41, v41
ds_read_b64_tr_b16 v[56:57], v11 offset:12288
v_mfma_f32_16x16x32_bf16 v[44:47], v[20:23], v[48:51], v[44:47]
v_exp_f32 v42, v42
v_mfma_f32_32x32x16_bf16 v[240:255], v[48:51], a[36:39], v[240:255]
v_exp_f32 v43, v43
ds_read_b64_tr_b16 v[58:59], v11 offset:12800
s_waitcnt lgkmcnt(2)
v_mfma_f32_32x32x16_bf16 v[224:239], v[52:55], a[40:43], v[224:239]
v_mul_f32 v144, v144, v176
v_mul_f32 v145, v145, v177
v_mul_f32 v146, v146, v178
v_mul_f32 v147, v147, v179
ds_read_b64_tr_b16 v[60:61], v12 offset:12288
v_mfma_f32_32x32x16_bf16 v[240:255], v[52:55], a[44:47], v[240:255]
v_fma_f32 v40, v40, v37, v37
v_fma_f32 v41, v41, v37, v37
v_fma_f32 v42, v42, v37, v37
ds_read_b64_tr_b16 v[62:63], v12 offset:12800
s_waitcnt lgkmcnt(2)
v_mfma_f32_32x32x16_bf16 v[224:239], v[56:59], a[48:51], v[224:239]
v_fma_f32 v43, v43, v37, v37
v_rcp_f32 v40, v40
v_add_u32 v11, 0xffff0000, v11
v_add_u32 v12, 0xffff0000, v12
ds_read_b64_tr_b16 v[48:49], v11 offset:0
v_mfma_f32_16x16x32_bf16 v[44:47], v[20:23], v[56:59], v[44:47]
v_mfma_f32_32x32x16_bf16 v[240:255], v[56:59], a[52:55], v[240:255]
v_rcp_f32 v41, v41
v_rcp_f32 v42, v42
ds_read_b64_tr_b16 v[50:51], v11 offset:512
s_waitcnt lgkmcnt(2)
v_mfma_f32_32x32x16_bf16 v[224:239], v[60:63], a[56:59], v[224:239]
v_rcp_f32 v43, v43
v_mul_f32 v144, v144, v40
ds_read_b64_tr_b16 v[52:53], v12 offset:0
v_mfma_f32_32x32x16_bf16 v[240:255], v[60:63], a[60:63], v[240:255]
v_mul_f32 v145, v145, v41
v_mul_f32 v146, v146, v42
ds_read_b64_tr_b16 v[54:55], v12 offset:512
s_waitcnt vmcnt(11)
s_barrier
s_waitcnt lgkmcnt(2)
v_mfma_f32_32x32x16_bf16 v[224:239], v[48:51], a[64:67], v[224:239]
v_mul_f32 v147, v147, v43
v_cvt_pk_bf16_f32 v176, v144, v145
v_cvt_pk_bf16_f32 v177, v146, v147
ds_read_b64_tr_b16 v[56:57], v11 offset:4096
v_mfma_f32_16x16x32_bf16 v[44:47], v[20:23], v[48:51], v[44:47]
v_mul_f32 v40, v148, v148
v_mul_f32 v41, v149, v149
v_mfma_f32_32x32x16_bf16 v[240:255], v[48:51], a[68:71], v[240:255]
v_mul_f32 v42, v150, v150
v_mul_f32 v43, v151, v151
v_fma_f32 v40, v40, v36, v35
ds_read_b64_tr_b16 v[58:59], v11 offset:4608
s_waitcnt lgkmcnt(2)
v_mfma_f32_32x32x16_bf16 v[224:239], v[52:55], a[72:75], v[224:239]
v_fma_f32 v41, v41, v36, v35
v_fma_f32 v42, v42, v36, v35
v_fma_f32 v43, v43, v36, v35
ds_read_b64_tr_b16 v[60:61], v12 offset:4096
v_mfma_f32_32x32x16_bf16 v[240:255], v[52:55], a[76:79], v[240:255]
v_mul_f32 v40, v148, v40
v_mul_f32 v41, v149, v41
v_mul_f32 v42, v150, v42
ds_read_b64_tr_b16 v[62:63], v12 offset:4608
s_waitcnt lgkmcnt(2)
v_mfma_f32_32x32x16_bf16 v[224:239], v[56:59], a[80:83], v[224:239]
v_mul_f32 v43, v151, v43
v_exp_f32 v40, v40
ds_read_b64_tr_b16 v[48:49], v11 offset:8192
v_mfma_f32_16x16x32_bf16 v[44:47], v[20:23], v[56:59], v[44:47]
v_exp_f32 v41, v41
v_mfma_f32_32x32x16_bf16 v[240:255], v[56:59], a[84:87], v[240:255]
v_exp_f32 v42, v42
v_exp_f32 v43, v43
ds_read_b64_tr_b16 v[50:51], v11 offset:8704
s_waitcnt lgkmcnt(2)
v_mfma_f32_32x32x16_bf16 v[224:239], v[60:63], a[88:91], v[224:239]
v_mul_f32 v148, v148, v180
v_mul_f32 v149, v149, v181
v_mul_f32 v150, v150, v182
ds_read_b64_tr_b16 v[52:53], v12 offset:8192
v_mfma_f32_32x32x16_bf16 v[240:255], v[60:63], a[92:95], v[240:255]
v_mul_f32 v151, v151, v183
v_fma_f32 v40, v40, v37, v37
v_fma_f32 v41, v41, v37, v37
ds_read_b64_tr_b16 v[54:55], v12 offset:8704
s_waitcnt lgkmcnt(2)
v_mfma_f32_32x32x16_bf16 v[224:239], v[48:51], a[96:99], v[224:239]
v_fma_f32 v42, v42, v37, v37
v_fma_f32 v43, v43, v37, v37
v_rcp_f32 v40, v40
ds_read_b64_tr_b16 v[56:57], v11 offset:12288
v_mfma_f32_16x16x32_bf16 v[44:47], v[20:23], v[48:51], v[44:47]
v_rcp_f32 v41, v41
v_mfma_f32_32x32x16_bf16 v[240:255], v[48:51], a[100:103], v[240:255]
v_rcp_f32 v42, v42
ds_read_b64_tr_b16 v[58:59], v11 offset:12800
s_waitcnt lgkmcnt(2)
v_mfma_f32_32x32x16_bf16 v[224:239], v[52:55], a[104:107], v[224:239]
v_rcp_f32 v43, v43
v_mul_f32 v148, v148, v40
v_mul_f32 v149, v149, v41
ds_read_b64_tr_b16 v[60:61], v12 offset:12288
v_mfma_f32_32x32x16_bf16 v[240:255], v[52:55], a[108:111], v[240:255]
v_mul_f32 v150, v150, v42
v_mul_f32 v151, v151, v43
v_cvt_pk_bf16_f32 v178, v148, v149
ds_read_b64_tr_b16 v[62:63], v12 offset:12800
s_waitcnt lgkmcnt(2)
v_mfma_f32_32x32x16_bf16 v[224:239], v[56:59], a[112:115], v[224:239]
v_cvt_pk_bf16_f32 v179, v150, v151
v_mul_f32 v40, v152, v152
v_add_u32 v11, 0xffff8000, v11
v_add_u32 v12, 0xffff8000, v12
ds_read_b64_tr_b16 v[48:49], v11 offset:0
v_mfma_f32_16x16x32_bf16 v[44:47], v[20:23], v[56:59], v[44:47]
v_mul_f32 v41, v153, v153
v_mfma_f32_32x32x16_bf16 v[240:255], v[56:59], a[116:119], v[240:255]
v_mul_f32 v42, v154, v154
v_mul_f32 v43, v155, v155
v_fma_f32 v40, v40, v36, v35
ds_read_b64_tr_b16 v[50:51], v11 offset:512
s_waitcnt lgkmcnt(2)
v_mfma_f32_32x32x16_bf16 v[224:239], v[60:63], a[120:123], v[224:239]
v_fma_f32 v41, v41, v36, v35
v_fma_f32 v42, v42, v36, v35
v_fma_f32 v43, v43, v36, v35
v_mul_f32 v40, v152, v40
ds_read_b64_tr_b16 v[52:53], v12 offset:0
v_mfma_f32_32x32x16_bf16 v[240:255], v[60:63], a[124:127], v[240:255]
ds_read_b64_tr_b16 v[54:55], v12 offset:512
s_waitcnt vmcnt(6)
s_barrier
s_and_b32 s47, s2, 7
s_sub_u32 s48, s2, 128
s_lshr_b32 s48, s48, 3
s_cmp_lg_u32 s42, 0
s_cbranch_scc1 L_sig_14
s_add_u32 s46, s47, 48
s_lshl_b32 s46, s46, 5
s_add_u32 s46, s46, s48
s_lshl_b32 s46, s46, 2
s_add_u32 s46, s46, 25165824
s_mov_b64 exec, 1
v_mov_b32 v3, s46
v_mov_b32 v4, s79
buffer_store_dword v4, v3, s[24:27], 0 offen sc1
s_mov_b64 exec, -1
L_sig_14:
s_waitcnt lgkmcnt(2)
v_mfma_f32_32x32x16_bf16 v[224:239], v[48:51], a[128:131], v[224:239]
s_and_b32 s45, s2, 7
s_lshr_b32 s46, s2, 3
s_lshl_b32 s45, s45, 1
s_lshr_b32 s47, s46, 4
v_mul_f32 v41, v153, v41
ds_read_b64_tr_b16 v[56:57], v11 offset:4096
v_mfma_f32_16x16x32_bf16 v[44:47], v[20:23], v[48:51], v[44:47]
s_add_u32 s81, s45, s47
s_and_b32 s80, s46, 15
v_mfma_f32_32x32x16_bf16 v[240:255], v[48:51], a[132:135], v[240:255]
s_lshl_b32 s45, s80, 2
s_add_u32 s82, s45, s42
s_sub_u32 s83, 8, s82
v_mul_f32 v42, v154, v42
ds_read_b64_tr_b16 v[58:59], v11 offset:4608
s_waitcnt lgkmcnt(2)
v_mfma_f32_32x32x16_bf16 v[224:239], v[52:55], a[136:139], v[224:239]
s_max_i32 s83, s83, 0
v_min_u32 v0, 47, v1
v_lshrrev_b32 v13, 4, v0
s_sub_u32 s45, s80, 2
ds_read_b64_tr_b16 v[60:61], v12 offset:4096
v_mfma_f32_32x32x16_bf16 v[240:255], v[52:55], a[140:143], v[240:255]
v_add_u32 v13, s45, v13
v_max_i32 v13, 0, v13
v_and_b32 v0, 15, v0
v_lshlrev_b32 v0, 2, v0
ds_read_b64_tr_b16 v[62:63], v12 offset:4608
s_waitcnt lgkmcnt(2)
v_mfma_f32_32x32x16_bf16 v[224:239], v[56:59], a[144:147], v[224:239]
v_lshl_add_u32 v0, v13, 7, v0
v_add_u32 v0, 25165824, v0
s_lshl_b32 s45, s2, 2
s_add_u32 s45, s45, s42
v_mul_f32 v43, v155, v43
ds_read_b64_tr_b16 v[48:49], v11 offset:8192
v_mfma_f32_16x16x32_bf16 v[44:47], v[20:23], v[56:59], v[44:47]
s_lshl_b32 s45, s45, 7
s_add_u32 s45, s45, 27262976
v_mfma_f32_32x32x16_bf16 v[240:255], v[56:59], a[148:151], v[240:255]
s_cmp_eq_u32 s42, 0
s_cselect_b64 s[48:49], -1, 0
v_mov_b32 v13, s45
ds_read_b64_tr_b16 v[50:51], v11 offset:8704
s_waitcnt lgkmcnt(2)
v_mfma_f32_32x32x16_bf16 v[224:239], v[60:63], a[152:155], v[224:239]
v_cndmask_b32_e64 v0, v13, v0, s[48:49]
buffer_load_dword v13, v0, s[24:27], 0 offen sc1
s_and_b32 s45, s2, 7
v_exp_f32 v40, v40
ds_read_b64_tr_b16 v[52:53], v12 offset:8192
v_mfma_f32_32x32x16_bf16 v[240:255], v[60:63], a[156:159], v[240:255]
s_lshr_b32 s46, s2, 3
s_and_b32 s47, s45, 3
s_lshl_b32 s47, s47, 3
ds_read_b64_tr_b16 v[54:55], v12 offset:8704
s_waitcnt lgkmcnt(2)
v_mfma_f32_32x32x16_bf16 v[224:239], v[48:51], a[160:163], v[224:239]
s_and_b32 s48, s46, 7
s_add_u32 s84, s47, s48
s_lshr_b32 s47, s45, 2
s_lshl_b32 s47, s47, 2
s_lshr_b32 s48, s46, 3
ds_read_b64_tr_b16 v[56:57], v11 offset:12288
v_mfma_f32_16x16x32_bf16 v[44:47], v[20:23], v[48:51], v[44:47]
s_add_u32 s85, s47, s48
v_exp_f32 v41, v41
v_mfma_f32_32x32x16_bf16 v[240:255], v[48:51], a[164:167], v[240:255]
s_lshl_b32 s45, s84, 2
s_add_u32 s86, s45, s42
s_lshr_b32 s87, s84, 1
s_mul_i32 s88, s85, 378880
ds_read_b64_tr_b16 v[58:59], v11 offset:12800
s_waitcnt lgkmcnt(2)
v_mfma_f32_32x32x16_bf16 v[224:239], v[52:55], a[168:171], v[224:239]
s_mul_i32 s89, s42, 5120
s_add_u32 s88, s88, s89
s_add_u32 s88, s88, 20971520
s_and_b32 s45, s42, 1
ds_read_b64_tr_b16 v[60:61], v12 offset:12288
v_mfma_f32_32x32x16_bf16 v[240:255], v[52:55], a[172:175], v[240:255]
s_lshl_b32 s45, s45, 10
s_mul_i32 s91, s86, 55296
s_add_u32 s91, s91, s45
ds_read_b64_tr_b16 v[62:63], v12 offset:12800
s_waitcnt lgkmcnt(2)
v_mfma_f32_32x32x16_bf16 v[224:239], v[56:59], a[176:179], v[224:239]
s_add_u32 s91, s91, 8388608
s_mul_i32 s92, s86, 20480
s_add_u32 s92, s92, s45
v_add_u32 v11, 0xc000, v11
v_add_u32 v12, 0xc000, v12
ds_read_b64_tr_b16 v[48:49], v11 offset:0
v_mfma_f32_16x16x32_bf16 v[44:47], v[20:23], v[56:59], v[44:47]
s_add_u32 s92, s92, 16777216
v_exp_f32 v42, v42
v_mfma_f32_32x32x16_bf16 v[240:255], v[56:59], a[180:183], v[240:255]
s_sub_u32 s90, s92, s45
s_xor_b32 s46, s86, 1
s_mul_i32 s94, s46, 55296
s_add_u32 s94, s94, s45
ds_read_b64_tr_b16 v[50:51], v11 offset:512
s_waitcnt lgkmcnt(2)
v_mfma_f32_32x32x16_bf16 v[224:239], v[60:63], a[184:187], v[224:239]
s_add_u32 s94, s94, 8388608
s_mul_i32 s95, s46, 20480
s_add_u32 s95, s95, s45
s_add_u32 s95, s95, 16777216
ds_read_b64_tr_b16 v[52:53], v12 offset:0
v_mfma_f32_32x32x16_bf16 v[240:255], v[60:63], a[188:191], v[240:255]
v_exp_f32 v43, v43
ds_read_b64_tr_b16 v[54:55], v12 offset:512
s_waitcnt vmcnt(3)
s_barrier
s_waitcnt lgkmcnt(2)
v_mfma_f32_32x32x16_bf16 v[224:239], v[48:51], a[192:195], v[224:239]
s_mul_i32 s63, s82, 122880
s_mul_i32 s50, s81, 2560
s_add_u32 s63, s63, s50
v_lshlrev_b32 v5, 4, v1
v_mul_f32 v152, v152, v184
ds_read_b64_tr_b16 v[56:57], v11 offset:4096
v_mfma_f32_16x16x32_bf16 v[44:47], v[20:23], v[48:51], v[44:47]
v_and_b32 v10, 31, v1
v_mfma_f32_32x32x16_bf16 v[240:255], v[48:51], a[196:199], v[240:255]
v_lshrrev_b32 v14, 5, v1
v_lshlrev_b32 v9, 4, v10
v_lshl_add_u32 v9, v14, 3, v9
v_mul_f32 v153, v153, v185
ds_read_b64_tr_b16 v[58:59], v11 offset:4608
s_waitcnt lgkmcnt(2)
v_mfma_f32_32x32x16_bf16 v[224:239], v[52:55], a[200:203], v[224:239]
v_lshlrev_b32 v6, 2, v14
v_xor_b32 v6, v10, v6
v_lshlrev_b32 v6, 4, v6
v_mul_f32 v154, v154, v186
v_mul_f32 v155, v155, v187
ds_read_b64_tr_b16 v[60:61], v12 offset:4096
v_mfma_f32_32x32x16_bf16 v[240:255], v[52:55], a[204:207], v[240:255]
v_lshl_add_u32 v6, v14, 9, v6
v_sub_u32 v7, 1, v14
v_lshlrev_b32 v7, 3, v7
ds_read_b64_tr_b16 v[62:63], v12 offset:4608
s_waitcnt lgkmcnt(2)
v_mfma_f32_32x32x16_bf16 v[224:239], v[56:59], a[208:211], v[224:239]
v_xor_b32 v7, v10, v7
v_lshlrev_b32 v7, 4, v7
v_lshl_add_u32 v7, v14, 9, v7
v_xor_b32 v8, 4, v10
v_fma_f32 v40, v40, v37, v37
ds_read_b64_tr_b16 v[48:49], v11 offset:8192
v_mfma_f32_16x16x32_bf16 v[44:47], v[20:23], v[56:59], v[44:47]
v_lshlrev_b32 v8, 4, v8
v_fma_f32 v41, v41, v37, v37
v_mfma_f32_32x32x16_bf16 v[240:255], v[56:59], a[212:215], v[240:255]
v_lshl_add_u32 v8, v14, 9, v8
s_mul_i32 s72, s42, 3
s_add_u32 s72, s72, 0
v_fma_f32 v42, v42, v37, v37
ds_read_b64_tr_b16 v[50:51], v11 offset:8704
s_waitcnt lgkmcnt(2)
v_mfma_f32_32x32x16_bf16 v[224:239], v[60:63], a[216:219], v[224:239]
s_lshl_b32 s70, s80, 2
s_add_u32 s70, s70, s72
s_sub_u32 s70, s70, 8
s_max_i32 s70, s70, 0
v_fma_f32 v43, v43, v37, v37
ds_read_b64_tr_b16 v[52:53], v12 offset:8192
v_mfma_f32_32x32x16_bf16 v[240:255], v[60:63], a[220:223], v[240:255]
s_mul_i32 s70, s70, 122880
s_add_u32 s70, s70, s50
s_add_u32 s71, s70, 81920
ds_read_b64_tr_b16 v[54:55], v12 offset:8704
s_waitcnt lgkmcnt(2)
v_mfma_f32_32x32x16_bf16 v[224:239], v[48:51], a[224:227], v[224:239]
s_add_u32 s70, s70, 40960
s_mul_i32 s72, s72, 3072
s_mul_i32 s75, s42, 3
v_rcp_f32 v40, v40
ds_read_b64_tr_b16 v[56:57], v11 offset:12288
v_mfma_f32_16x16x32_bf16 v[44:47], v[20:23], v[48:51], v[44:47]
s_add_u32 s75, s75, 1
s_lshl_b32 s73, s80, 2
v_mfma_f32_32x32x16_bf16 v[240:255], v[48:51], a[228:231], v[240:255]
s_add_u32 s73, s73, s75
s_sub_u32 s73, s73, 8
s_max_i32 s73, s73, 0
ds_read_b64_tr_b16 v[58:59], v11 offset:12800
s_waitcnt lgkmcnt(2)
v_mfma_f32_32x32x16_bf16 v[224:239], v[52:55], a[232:235], v[224:239]
s_mul_i32 s73, s73, 122880
s_add_u32 s73, s73, s50
s_add_u32 s74, s73, 81920
v_rcp_f32 v41, v41
ds_read_b64_tr_b16 v[60:61], v12 offset:12288
v_mfma_f32_32x32x16_bf16 v[240:255], v[52:55], a[236:239], v[240:255]
s_add_u32 s73, s73, 40960
s_mul_i32 s75, s75, 3072
s_mul_i32 s58, s42, 3
ds_read_b64_tr_b16 v[62:63], v12 offset:12800
s_waitcnt lgkmcnt(2)
v_mfma_f32_32x32x16_bf16 v[224:239], v[56:59], a[240:243], v[224:239]
s_add_u32 s58, s58, 2
s_lshl_b32 s76, s80, 2
v_rcp_f32 v42, v42
v_add_u32 v11, 0x4000, v11
v_add_u32 v12, 0x4000, v12
ds_read_b64_tr_b16 v[48:49], v11 offset:0
v_mfma_f32_16x16x32_bf16 v[44:47], v[20:23], v[56:59], v[44:47]
s_add_u32 s76, s76, s58
s_sub_u32 s76, s76, 8
v_mfma_f32_32x32x16_bf16 v[240:255], v[56:59], a[244:247], v[240:255]
s_max_i32 s76, s76, 0
s_mul_i32 s76, s76, 122880
v_rcp_f32 v43, v43
ds_read_b64_tr_b16 v[50:51], v11 offset:512
s_waitcnt lgkmcnt(2)
v_mfma_f32_32x32x16_bf16 v[224:239], v[60:63], a[248:251], v[224:239]
s_add_u32 s76, s76, s50
s_add_u32 s57, s76, 81920
s_add_u32 s76, s76, 40960
s_mul_i32 s58, s58, 3072
ds_read_b64_tr_b16 v[52:53], v12 offset:0
v_mfma_f32_32x32x16_bf16 v[240:255], v[60:63], a[252:255], v[240:255]
v_mul_f32 v152, v152, v40
v_mul_f32 v153, v153, v41
ds_read_b64_tr_b16 v[54:55], v12 offset:512
s_barrier
s_waitcnt lgkmcnt(2)
v_mfma_f32_32x32x16_bf16 v[224:239], v[48:51], v[64:67], v[224:239]
v_mul_f32 v154, v154, v42
v_mul_f32 v155, v155, v43
v_cvt_pk_bf16_f32 v180, v152, v153
v_cvt_pk_bf16_f32 v181, v154, v155
ds_read_b64_tr_b16 v[56:57], v11 offset:4096
v_mfma_f32_16x16x32_bf16 v[44:47], v[20:23], v[48:51], v[44:47]
v_mul_f32 v40, v156, v156
v_mfma_f32_32x32x16_bf16 v[240:255], v[48:51], v[68:71], v[240:255]
v_mul_f32 v41, v157, v157
v_mul_f32 v42, v158, v158
v_mul_f32 v43, v159, v159
ds_read_b64_tr_b16 v[58:59], v11 offset:4608
s_waitcnt lgkmcnt(2)
v_mfma_f32_32x32x16_bf16 v[224:239], v[52:55], v[72:75], v[224:239]
v_fma_f32 v40, v40, v36, v35
v_fma_f32 v41, v41, v36, v35
v_fma_f32 v42, v42, v36, v35
v_fma_f32 v43, v43, v36, v35
ds_read_b64_tr_b16 v[60:61], v12 offset:4096
v_mfma_f32_32x32x16_bf16 v[240:255], v[52:55], v[76:79], v[240:255]
v_mul_f32 v40, v156, v40
v_mul_f32 v41, v157, v41
v_mul_f32 v42, v158, v42
ds_read_b64_tr_b16 v[62:63], v12 offset:4608
s_waitcnt lgkmcnt(2)
v_mfma_f32_32x32x16_bf16 v[224:239], v[56:59], v[80:83], v[224:239]
v_mul_f32 v43, v159, v43
v_exp_f32 v40, v40
ds_read_b64_tr_b16 v[48:49], v11 offset:8192
v_mfma_f32_16x16x32_bf16 v[44:47], v[20:23], v[56:59], v[44:47]
v_exp_f32 v41, v41
v_mfma_f32_32x32x16_bf16 v[240:255], v[56:59], v[84:87], v[240:255]
v_exp_f32 v42, v42
ds_read_b64_tr_b16 v[50:51], v11 offset:8704
s_waitcnt lgkmcnt(2)
v_mfma_f32_32x32x16_bf16 v[224:239], v[60:63], v[88:91], v[224:239]
v_exp_f32 v43, v43
v_mul_f32 v156, v156, v188
v_mul_f32 v157, v157, v189
v_mul_f32 v158, v158, v190
ds_read_b64_tr_b16 v[52:53], v12 offset:8192
v_mfma_f32_32x32x16_bf16 v[240:255], v[60:63], v[92:95], v[240:255]
v_mul_f32 v159, v159, v191
v_fma_f32 v40, v40, v37, v37
ds_read_b64_tr_b16 v[54:55], v12 offset:8704
s_waitcnt lgkmcnt(2)
v_mfma_f32_32x32x16_bf16 v[224:239], v[48:51], v[96:99], v[224:239]
v_fma_f32 v41, v41, v37, v37
v_fma_f32 v42, v42, v37, v37
v_fma_f32 v43, v43, v37, v37
v_rcp_f32 v40, v40
ds_read_b64_tr_b16 v[56:57], v11 offset:12288
v_mfma_f32_16x16x32_bf16 v[44:47], v[20:23], v[48:51], v[44:47]
v_mfma_f32_32x32x16_bf16 v[240:255], v[48:51], v[100:103], v[240:255]
v_rcp_f32 v41, v41
v_rcp_f32 v42, v42
ds_read_b64_tr_b16 v[58:59], v11 offset:12800
s_waitcnt lgkmcnt(2)
v_mfma_f32_32x32x16_bf16 v[224:239], v[52:55], v[104:107], v[224:239]
v_rcp_f32 v43, v43
v_mul_f32 v156, v156, v40
ds_read_b64_tr_b16 v[60:61], v12 offset:12288
v_mfma_f32_32x32x16_bf16 v[240:255], v[52:55], v[108:111], v[240:255]
v_mul_f32 v157, v157, v41
v_mul_f32 v158, v158, v42
v_mul_f32 v159, v159, v43
ds_read_b64_tr_b16 v[62:63], v12 offset:12800
s_waitcnt lgkmcnt(2)
v_mfma_f32_32x32x16_bf16 v[224:239], v[56:59], v[112:115], v[224:239]
v_cvt_pk_bf16_f32 v182, v156, v157
v_cvt_pk_bf16_f32 v183, v158, v159
buffer_store_dwordx4 v[176:179], v17, s[24:27], s62 offen sc1
v_mfma_f32_16x16x32_bf16 v[44:47], v[20:23], v[56:59], v[44:47]
buffer_store_dwordx4 v[180:183], v17, s[24:27], s62 offen offset:512 sc1
v_mfma_f32_32x32x16_bf16 v[240:255], v[56:59], v[116:119], v[240:255]
s_waitcnt lgkmcnt(0)
v_mfma_f32_32x32x16_bf16 v[224:239], v[60:63], v[120:123], v[224:239]
s_nop 3
ds_write_b32 v18, v44 offset:0
ds_write_b32 v18, v45 offset:64
v_mfma_f32_32x32x16_bf16 v[240:255], v[60:63], v[124:127], v[240:255]
s_waitcnt lgkmcnt(0)
s_waitcnt vmcnt(2)
s_cmp_lg_u32 s42, 0
s_cbranch_scc1 L_pc_15
v_cmp_ne_u32 s[48:49], s79, v13
s_nop 1
s_cmp_eq_u64 s[48:49], 0
s_cbranch_scc1 L_pc_15
s_cmp_lg_u32 s42, 0
s_cbranch_scc1 L_poll_16_ok
s_mov_b32 s46, 0x40000
L_poll_16:
buffer_load_dword v13, v0, s[24:27], 0 offen sc1
s_waitcnt vmcnt(0)
v_cmp_ne_u32 s[48:49], s79, v13
s_nop 1
s_cmp_eq_u64 s[48:49], 0
s_cbranch_scc1 L_poll_16_ok
s_sleep 1
s_sub_u32 s46, s46, 1
s_cmp_lg_u32 s46, 0
s_cbranch_scc1 L_poll_16
L_poll_16_ok:
L_pc_15:
s_barrier
ds_read_b32 v38, v19 offset:0
ds_read_b32 v39, v19 offset:128
s_waitcnt lgkmcnt(0)
v_add_f32 v38, v38, v39
v_cvt_pk_bf16_f32 v39, v38, v38
v_lshlrev_b32 v39, 16, v39
v_sub_f32 v39, v38, v39
s_add_u32 m0, s72, 0
s_nop 0
buffer_load_dwordx4 v5, s[24:27], s70 offen sc1 lds
v_cvt_pk_bf16_f32 v24, v38, v39
s_nop 1
v_mfma_f32_32x32x8bf16_1k v[224:239], v[24:25], v[26:27], v[224:239]
v_mfma_f32_32x32x8bf16_1k v[240:255], v[24:25], v[28:29], v[240:255]
s_lshl_b32 s52, s68, 1
s_add_u32 s52, s52, s44
s_lshl_b32 s52, s52, 10
s_add_u32 s52, s52, 8388608
buffer_load_dwordx4 v5, s[24:27], s70 offen offset:1024 sc1 lds
s_mul_i32 s53, s55, 110592
s_add_u32 s61, s52, s53
s_mul_i32 s53, s56, 110592
s_add_u32 s62, s52, s53
v_pk_mul_f32 v[44:45], v[192:193], v[192:193]
v_pk_mul_f32 v[46:47], v[194:195], v[194:195]
v_pk_mul_f32 v[48:49], v[196:197], v[196:197]
s_mov_b32 exec_hi, 0
buffer_load_dwordx4 v5, s[24:27], s70 offen offset:2048 sc1 lds
s_mov_b32 exec_hi, -1
v_pk_mul_f32 v[50:51], v[198:199], v[198:199]
v_pk_fma_f32 v[44:45], v[44:45], v[32:33], v[32:33] op_sel:[0,1,0] op_sel_hi:[1,1,0]
v_pk_fma_f32 v[46:47], v[46:47], v[32:33], v[32:33] op_sel:[0,1,0] op_sel_hi:[1,1,0]
v_pk_fma_f32 v[48:49], v[48:49], v[32:33], v[32:33] op_sel:[0,1,0] op_sel_hi:[1,1,0]
v_pk_fma_f32 v[50:51], v[50:51], v[32:33], v[32:33] op_sel:[0,1,0] op_sel_hi:[1,1,0]
v_pk_mul_f32 v[44:45], v[192:193], v[44:45]
s_add_u32 m0, s72, 36864
s_nop 0
buffer_load_dwordx4 v6, s[24:27], s71 offen sc1 lds
v_pk_mul_f32 v[46:47], v[194:195], v[46:47]
v_pk_mul_f32 v[48:49], v[196:197], v[48:49]
v_pk_mul_f32 v[50:51], v[198:199], v[50:51]
v_exp_f32 v44, v44
v_exp_f32 v45, v45
v_exp_f32 v46, v46
v_exp_f32 v47, v47
buffer_load_dwordx4 v7, s[24:27], s71 offen offset:1024 sc1 lds
v_exp_f32 v48, v48
v_exp_f32 v49, v49
v_exp_f32 v50, v50
v_exp_f32 v51, v51
v_pk_mul_f32 v[192:193], v[192:193], v[224:225]
v_pk_mul_f32 v[194:195], v[194:195], v[226:227]
v_pk_mul_f32 v[196:197], v[196:197], v[228:229]
s_mov_b32 exec_hi, 0
buffer_load_dwordx4 v8, s[24:27], s71 offen offset:2048 sc1 lds
s_mov_b32 exec_hi, -1
v_pk_mul_f32 v[198:199], v[198:199], v[230:231]
v_pk_fma_f32 v[44:45], v[44:45], v[34:35], v[34:35] op_sel:[0,0,0] op_sel_hi:[1,0,0]
v_pk_fma_f32 v[46:47], v[46:47], v[34:35], v[34:35] op_sel:[0,0,0] op_sel_hi:[1,0,0]
v_pk_fma_f32 v[48:49], v[48:49], v[34:35], v[34:35] op_sel:[0,0,0] op_sel_hi:[1,0,0]
v_pk_fma_f32 v[50:51], v[50:51], v[34:35], v[34:35] op_sel:[0,0,0] op_sel_hi:[1,0,0]
v_rcp_f32 v44, v44
v_rcp_f32 v45, v45
s_add_u32 m0, s75, 0
s_nop 0
buffer_load_dwordx4 v5, s[24:27], s73 offen sc1 lds
v_rcp_f32 v46, v46
v_rcp_f32 v47, v47
v_rcp_f32 v48, v48
v_rcp_f32 v49, v49
v_rcp_f32 v50, v50
v_rcp_f32 v51, v51
buffer_load_dwordx4 v5, s[24:27], s73 offen offset:1024 sc1 lds
v_pk_mul_f32 v[192:193], v[192:193], v[44:45]
v_pk_mul_f32 v[194:195], v[194:195], v[46:47]
v_pk_mul_f32 v[196:197], v[196:197], v[48:49]
v_pk_mul_f32 v[198:199], v[198:199], v[50:51]
v_cvt_pk_bf16_f32 v224, v192, v193
v_cvt_pk_bf16_f32 v225, v194, v195
v_cvt_pk_bf16_f32 v226, v196, v197
s_mov_b32 exec_hi, 0
buffer_load_dwordx4 v5, s[24:27], s73 offen offset:2048 sc1 lds
s_mov_b32 exec_hi, -1
v_cvt_pk_bf16_f32 v227, v198, v199
v_pk_mul_f32 v[44:45], v[200:201], v[200:201]
v_pk_mul_f32 v[46:47], v[202:203], v[202:203]
v_pk_mul_f32 v[48:49], v[204:205], v[204:205]
v_pk_mul_f32 v[50:51], v[206:207], v[206:207]
v_pk_fma_f32 v[44:45], v[44:45], v[32:33], v[32:33] op_sel:[0,1,0] op_sel_hi:[1,1,0]
v_pk_fma_f32 v[46:47], v[46:47], v[32:33], v[32:33] op_sel:[0,1,0] op_sel_hi:[1,1,0]
s_add_u32 m0, s75, 36864
s_nop 0
buffer_load_dwordx4 v6, s[24:27], s74 offen sc1 lds
v_pk_fma_f32 v[48:49], v[48:49], v[32:33], v[32:33] op_sel:[0,1,0] op_sel_hi:[1,1,0]
v_pk_fma_f32 v[50:51], v[50:51], v[32:33], v[32:33] op_sel:[0,1,0] op_sel_hi:[1,1,0]
v_pk_mul_f32 v[44:45], v[200:201], v[44:45]
v_pk_mul_f32 v[46:47], v[202:203], v[46:47]
v_pk_mul_f32 v[48:49], v[204:205], v[48:49]
v_pk_mul_f32 v[50:51], v[206:207], v[50:51]
buffer_load_dwordx4 v7, s[24:27], s74 offen offset:1024 sc1 lds
v_exp_f32 v44, v44
v_exp_f32 v45, v45
v_exp_f32 v46, v46
v_exp_f32 v47, v47
v_exp_f32 v48, v48
v_exp_f32 v49, v49
v_exp_f32 v50, v50
s_mov_b32 exec_hi, 0
buffer_load_dwordx4 v8, s[24:27], s74 offen offset:2048 sc1 lds
s_mov_b32 exec_hi, -1
v_exp_f32 v51, v51
v_pk_mul_f32 v[200:201], v[200:201], v[232:233]
v_pk_mul_f32 v[202:203], v[202:203], v[234:235]
v_pk_mul_f32 v[204:205], v[204:205], v[236:237]
v_pk_mul_f32 v[206:207], v[206:207], v[238:239]
v_pk_fma_f32 v[44:45], v[44:45], v[34:35], v[34:35] op_sel:[0,0,0] op_sel_hi:[1,0,0]
v_pk_fma_f32 v[46:47], v[46:47], v[34:35], v[34:35] op_sel:[0,0,0] op_sel_hi:[1,0,0]
s_add_u32 m0, s58, 0
s_nop 0
buffer_load_dwordx4 v5, s[24:27], s76 offen sc1 lds
v_pk_fma_f32 v[48:49], v[48:49], v[34:35], v[34:35] op_sel:[0,0,0] op_sel_hi:[1,0,0]
v_pk_fma_f32 v[50:51], v[50:51], v[34:35], v[34:35] op_sel:[0,0,0] op_sel_hi:[1,0,0]
v_rcp_f32 v44, v44
v_rcp_f32 v45, v45
v_rcp_f32 v46, v46
v_rcp_f32 v47, v47
v_rcp_f32 v48, v48
buffer_load_dwordx4 v5, s[24:27], s76 offen offset:1024 sc1 lds
v_rcp_f32 v49, v49
v_rcp_f32 v50, v50
v_rcp_f32 v51, v51
v_pk_mul_f32 v[200:201], v[200:201], v[44:45]
v_pk_mul_f32 v[202:203], v[202:203], v[46:47]
v_pk_mul_f32 v[204:205], v[204:205], v[48:49]
s_mov_b32 exec_hi, 0
buffer_load_dwordx4 v5, s[24:27], s76 offen offset:2048 sc1 lds
s_mov_b32 exec_hi, -1
v_pk_mul_f32 v[206:207], v[206:207], v[50:51]
v_cvt_pk_bf16_f32 v228, v200, v201
v_cvt_pk_bf16_f32 v229, v202, v203
v_cvt_pk_bf16_f32 v230, v204, v205
v_cvt_pk_bf16_f32 v231, v206, v207
buffer_store_dwordx4 v[224:227], v17, s[24:27], s61 offen sc1
buffer_store_dwordx4 v[228:231], v17, s[24:27], s61 offen offset:512 sc1
s_add_u32 m0, s58, 36864
s_nop 0
buffer_load_dwordx4 v6, s[24:27], s57 offen sc1 lds
v_pk_mul_f32 v[44:45], v[208:209], v[208:209]
v_pk_mul_f32 v[46:47], v[210:211], v[210:211]
v_pk_mul_f32 v[48:49], v[212:213], v[212:213]
v_pk_mul_f32 v[50:51], v[214:215], v[214:215]
v_pk_fma_f32 v[44:45], v[44:45], v[36:37], v[34:35] op_sel:[0,0,1] op_sel_hi:[1,0,1]
v_pk_fma_f32 v[46:47], v[46:47], v[36:37], v[34:35] op_sel:[0,0,1] op_sel_hi:[1,0,1]
v_pk_fma_f32 v[48:49], v[48:49], v[36:37], v[34:35] op_sel:[0,0,1] op_sel_hi:[1,0,1]
buffer_load_dwordx4 v7, s[24:27], s57 offen offset:1024 sc1 lds
v_pk_fma_f32 v[50:51], v[50:51], v[36:37], v[34:35] op_sel:[0,0,1] op_sel_hi:[1,0,1]
v_pk_mul_f32 v[44:45], v[208:209], v[44:45]
v_pk_mul_f32 v[46:47], v[210:211], v[46:47]
v_pk_mul_f32 v[48:49], v[212:213], v[48:49]
v_pk_mul_f32 v[50:51], v[214:215], v[50:51]
v_exp_f32 v44, v44
v_exp_f32 v45, v45
s_mov_b32 exec_hi, 0
buffer_load_dwordx4 v8, s[24:27], s57 offen offset:2048 sc1 lds
s_mov_b32 exec_hi, -1
v_exp_f32 v46, v46
v_exp_f32 v47, v47
v_exp_f32 v48, v48
v_exp_f32 v49, v49
v_exp_f32 v50, v50
v_exp_f32 v51, v51
buffer_load_dwordx4 v[64:67], v5, s[24:27], s63 offen sc1
v_pk_mul_f32 v[208:209], v[208:209], v[240:241]
v_pk_mul_f32 v[210:211], v[210:211], v[242:243]
v_pk_mul_f32 v[212:213], v[212:213], v[244:245]
v_pk_mul_f32 v[214:215], v[214:215], v[246:247]
v_pk_fma_f32 v[44:45], v[44:45], v[36:37], v[36:37] op_sel:[0,1,1] op_sel_hi:[1,1,1]
v_pk_fma_f32 v[46:47], v[46:47], v[36:37], v[36:37] op_sel:[0,1,1] op_sel_hi:[1,1,1]
v_pk_fma_f32 v[48:49], v[48:49], v[36:37], v[36:37] op_sel:[0,1,1] op_sel_hi:[1,1,1]
buffer_load_dwordx4 v[68:71], v5, s[24:27], s63 offen offset:1536 sc1
v_pk_fma_f32 v[50:51], v[50:51], v[36:37], v[36:37] op_sel:[0,1,1] op_sel_hi:[1,1,1]
v_rcp_f32 v44, v44
v_rcp_f32 v45, v45
v_rcp_f32 v46, v46
v_rcp_f32 v47, v47
v_rcp_f32 v48, v48
v_rcp_f32 v49, v49
buffer_load_dwordx2 v[72:73], v9, s[24:27], s63 offen offset:1024 sc1
v_rcp_f32 v50, v50
v_rcp_f32 v51, v51
v_pk_mul_f32 v[208:209], v[208:209], v[44:45]
v_pk_mul_f32 v[210:211], v[210:211], v[46:47]
v_pk_mul_f32 v[212:213], v[212:213], v[48:49]
v_pk_mul_f32 v[214:215], v[214:215], v[50:51]
s_add_u32 s45, s85, 48
s_lshl_b32 s45, s45, 7
s_add_u32 s45, s45, 25165824
v_min_u32 v78, 15, v1
v_lshl_add_u32 v78, v78, 2, s45
s_lshl_b32 s45, s2, 2
s_add_u32 s45, s45, s42
s_lshl_b32 s45, s45, 7
s_add_u32 s45, s45, 27262976
s_cmp_eq_u32 s42, 0
s_cselect_b64 s[48:49], -1, 0
v_mov_b32 v79, s45
v_cndmask_b32_e64 v78, v79, v78, s[48:49]
buffer_load_dword v79, v78, s[24:27], 0 offen sc1
v_cvt_pk_bf16_f32 v240, v208, v209
v_cvt_pk_bf16_f32 v241, v210, v211
v_cvt_pk_bf16_f32 v242, v212, v213
v_cvt_pk_bf16_f32 v243, v214, v215
v_pk_mul_f32 v[44:45], v[216:217], v[216:217]
v_pk_mul_f32 v[46:47], v[218:219], v[218:219]
v_pk_mul_f32 v[48:49], v[220:221], v[220:221]
v_pk_mul_f32 v[50:51], v[222:223], v[222:223]
v_pk_fma_f32 v[44:45], v[44:45], v[36:37], v[34:35] op_sel:[0,0,1] op_sel_hi:[1,0,1]
v_pk_fma_f32 v[46:47], v[46:47], v[36:37], v[34:35] op_sel:[0,0,1] op_sel_hi:[1,0,1]
v_pk_fma_f32 v[48:49], v[48:49], v[36:37], v[34:35] op_sel:[0,0,1] op_sel_hi:[1,0,1]
v_pk_fma_f32 v[50:51], v[50:51], v[36:37], v[34:35] op_sel:[0,0,1] op_sel_hi:[1,0,1]
v_pk_mul_f32 v[44:45], v[216:217], v[44:45]
v_pk_mul_f32 v[46:47], v[218:219], v[46:47]
v_pk_mul_f32 v[48:49], v[220:221], v[48:49]
v_pk_mul_f32 v[50:51], v[222:223], v[50:51]
v_exp_f32 v44, v44
v_exp_f32 v45, v45
v_exp_f32 v46, v46
v_exp_f32 v47, v47
v_exp_f32 v48, v48
v_exp_f32 v49, v49
v_exp_f32 v50, v50
v_exp_f32 v51, v51
v_pk_mul_f32 v[216:217], v[216:217], v[248:249]
v_pk_mul_f32 v[218:219], v[218:219], v[250:251]
v_pk_mul_f32 v[220:221], v[220:221], v[252:253]
v_pk_mul_f32 v[222:223], v[222:223], v[254:255]
v_pk_fma_f32 v[44:45], v[44:45], v[36:37], v[36:37] op_sel:[0,1,1] op_sel_hi:[1,1,1]
v_pk_fma_f32 v[46:47], v[46:47], v[36:37], v[36:37] op_sel:[0,1,1] op_sel_hi:[1,1,1]
v_pk_fma_f32 v[48:49], v[48:49], v[36:37], v[36:37] op_sel:[0,1,1] op_sel_hi:[1,1,1]
v_pk_fma_f32 v[50:51], v[50:51], v[36:37], v[36:37] op_sel:[0,1,1] op_sel_hi:[1,1,1]
v_rcp_f32 v44, v44
v_rcp_f32 v45, v45
v_rcp_f32 v46, v46
v_rcp_f32 v47, v47
v_rcp_f32 v48, v48
v_rcp_f32 v49, v49
v_rcp_f32 v50, v50
v_rcp_f32 v51, v51
v_pk_mul_f32 v[216:217], v[216:217], v[44:45]
v_pk_mul_f32 v[218:219], v[218:219], v[46:47]
v_pk_mul_f32 v[220:221], v[220:221], v[48:49]
v_pk_mul_f32 v[222:223], v[222:223], v[50:51]
v_cvt_pk_bf16_f32 v244, v216, v217
v_cvt_pk_bf16_f32 v245, v218, v219
v_cvt_pk_bf16_f32 v246, v220, v221
v_cvt_pk_bf16_f32 v247, v222, v223
buffer_store_dwordx4 v[240:243], v17, s[24:27], s62 offen sc1
buffer_store_dwordx4 v[244:247], v17, s[24:27], s62 offen offset:512 sc1
s_branch L_common
L_p1_B:
s_waitcnt vmcnt(15)
s_barrier
ds_read_b128 a[0:3], v168 offset:0
ds_read_b128 a[4:7], v176 offset:0
ds_read_b64_tr_b16 v[48:49], v11 offset:0
ds_read_b64_tr_b16 v[50:51], v11 offset:512
ds_read_b128 a[8:11], v169 offset:0
ds_read_b128 a[12:15], v177 offset:0
ds_read_b64_tr_b16 v[52:53], v12 offset:0
ds_read_b64_tr_b16 v[54:55], v12 offset:512
s_waitcnt lgkmcnt(4)
v_mfma_f32_32x32x16_bf16 v[224:239], v[48:51], a[0:3], 0
s_cmp_eq_u32 s51, 2
s_cselect_b32 s53, 4, 5
s_add_u32 s65, s64, 1
s_add_u32 s66, s64, 2
ds_read_b64_tr_b16 v[56:57], v11 offset:4096
ds_read_b128 a[16:19], v170 offset:0
v_mfma_f32_32x32x16_bf16 v[240:255], v[48:51], a[4:7], 0
s_add_u32 s67, s50, s53
s_mov_b32 s68, s67
s_mov_b32 s16, s88
s_mov_b32 s17, s89
s_mov_b32 s18, 2211840
ds_read_b64_tr_b16 v[58:59], v11 offset:4608
ds_read_b128 a[20:23], v178 offset:0
ds_read_b128 v[136:139], v168 offset:0
ds_read_b128 v[140:143], v169 offset:0
ds_read_b128 v[144:147], v170 offset:0
v_mfma_f32_16x16x32_bf16 v[44:47], v[20:23], v[48:51], 0
s_mov_b32 s19, 0x00020000
s_mov_b32 s20, s90
s_mov_b32 s21, s91
s_mov_b32 s22, 2211840
s_mov_b32 s23, 0x00020000
s_waitcnt lgkmcnt(7)
v_mfma_f32_32x32x16_bf16 v[224:239], v[52:55], a[8:11], v[224:239]
s_mov_b32 s24, s6
s_mov_b32 s25, s7
s_mov_b32 s26, 33554432
s_mov_b32 s27, 0x00020000
ds_read_b64_tr_b16 v[60:61], v12 offset:4096
ds_read_b128 a[24:27], v171 offset:0
v_mfma_f32_32x32x16_bf16 v[240:255], v[52:55], a[12:15], v[240:255]
s_mov_b32 s32, s84
s_mov_b32 s33, s85
s_mov_b32 s34, 819200
s_mov_b32 s35, 0x00020000
s_mov_b32 s28, s92
ds_read_b64_tr_b16 v[62:63], v12 offset:4608
ds_read_b128 a[28:31], v179 offset:0
ds_read_b128 v[148:151], v171 offset:0
s_waitcnt lgkmcnt(8)
v_mfma_f32_32x32x16_bf16 v[224:239], v[56:59], a[16:19], v[224:239]
s_mov_b32 s29, s93
s_mov_b32 s30, 2211840
s_mov_b32 s31, 0x00020000
s_mov_b32 s36, s94
s_mov_b32 s37, s95
ds_read_b64_tr_b16 v[48:49], v11 offset:8192
ds_read_b128 a[32:35], v172 offset:0
v_mfma_f32_32x32x16_bf16 v[240:255], v[56:59], a[20:23], v[240:255]
s_mov_b32 s38, 2621440
s_mov_b32 s39, 0x00020000
v_mul_u32_u24 v42, 3456, v41
v_add_u32 v7, v42, v40
v_add_u32 v8, 26624, v7
ds_read_b64_tr_b16 v[50:51], v11 offset:8704
ds_read_b128 a[36:39], v180 offset:0
ds_read_b128 v[152:155], v172 offset:0
v_mfma_f32_16x16x32_bf16 v[44:47], v[20:23], v[56:59], v[44:47]
v_add_u32 v9, 26624, v8
v_add_u32 v10, 26624, v9
v_lshlrev_b32 v42, 4, v43
v_lshl_add_u32 v16, v35, 9, v42
s_waitcnt lgkmcnt(6)
v_mfma_f32_32x32x16_bf16 v[224:239], v[60:63], a[24:27], v[224:239]
v_lshrrev_b32 v42, 4, v43
v_mul_u32_u24 v42, 55296, v42
v_and_b32 v41, 15, v43
v_lshl_add_u32 v42, v41, 4, v42
v_lshl_add_u32 v17, v35, 8, v42
ds_read_b64_tr_b16 v[52:53], v12 offset:8192
ds_read_b128 a[40:43], v173 offset:0
v_mfma_f32_32x32x16_bf16 v[240:255], v[60:63], a[28:31], v[240:255]
s_lshl_b32 s52, s44, 8
s_add_u32 s52, s52, 149504
v_lshl_add_u32 v19, v43, 2, s52
s_lshl_b32 s53, s43, 7
s_add_u32 s52, s52, s53
ds_read_b64_tr_b16 v[54:55], v12 offset:8704
ds_read_b128 a[44:47], v181 offset:0
ds_read_b128 v[156:159], v173 offset:0
s_waitcnt lgkmcnt(6)
v_mfma_f32_32x32x16_bf16 v[224:239], v[48:51], a[32:35], v[224:239]
v_lshl_add_u32 v18, v1, 2, s52
v_cmp_gt_u32 s[52:53], 16, v1
v_mov_b32 v42, 151040
s_nop 0
v_cndmask_b32_e64 v18, v42, v18, s[52:53]
ds_read_b64_tr_b16 v[56:57], v11 offset:12288
ds_read_b128 a[48:51], v174 offset:0
v_mfma_f32_32x32x16_bf16 v[240:255], v[48:51], a[36:39], v[240:255]
s_lshl_b32 s52, s40, 2
s_add_u32 s55, s52, s42
s_xor_b32 s54, s42, 1
s_add_u32 s56, s52, s54
s_and_b32 s52, s40, 7
ds_read_b64_tr_b16 v[58:59], v11 offset:12800
ds_read_b128 a[52:55], v182 offset:0
ds_read_b128 v[160:163], v174 offset:0
v_mfma_f32_16x16x32_bf16 v[44:47], v[20:23], v[48:51], v[44:47]
s_mul_i32 s52, s52, 80
s_mul_i32 s53, s42, 20
s_add_u32 s52, s52, s53
v_add_u32 v15, s52, v1
v_cmp_gt_u32 s[52:53], 20, v1
s_waitcnt lgkmcnt(6)
v_mfma_f32_32x32x16_bf16 v[224:239], v[52:55], a[40:43], v[224:239]
v_mov_b32 v14, 0x100000
v_cndmask_b32_e64 v15, v14, v15, s[52:53]
s_add_u32 m0, s74, 114688
s_add_u32 s75, s73, 512
buffer_load_dwordx4 v128, s[8:11], s75 offen offset:0  lds
ds_read_b64_tr_b16 v[60:61], v12 offset:12288
ds_read_b128 a[56:59], v175 offset:0
v_mfma_f32_32x32x16_bf16 v[240:255], v[52:55], a[44:47], v[240:255]
buffer_load_dwordx4 v129, s[8:11], s75 offen offset:1024  lds
buffer_load_dwordx4 v130, s[8:11], s75 offen offset:2048  lds
buffer_load_dwordx4 v131, s[8:11], s75 offen offset:3072  lds
s_add_u32 m0, s74, 118784
ds_read_b64_tr_b16 v[62:63], v12 offset:12800
ds_read_b128 a[60:63], v183 offset:0
ds_read_b128 v[164:167], v175 offset:0
s_waitcnt lgkmcnt(6)
v_mfma_f32_32x32x16_bf16 v[224:239], v[56:59], a[48:51], v[224:239]
s_add_u32 s75, s73, 20992
buffer_load_dwordx4 v128, s[8:11], s75 offen offset:0  lds
buffer_load_dwordx4 v129, s[8:11], s75 offen offset:1024  lds
buffer_load_dwordx4 v130, s[8:11], s75 offen offset:2048  lds
buffer_load_dwordx4 v131, s[8:11], s75 offen offset:3072  lds
v_mfma_f32_32x32x16_bf16 v[240:255], v[56:59], a[52:55], v[240:255]
s_lshl_b32 s60, s64, 7
s_add_u32 s60, s60, 983040
s_add_u32 m0, s59, 32768
s_nop 0
buffer_load_dwordx4 v3, s[12:15], s60 offen offset:0  lds
buffer_load_dwordx4 v4, s[12:15], s60 offen offset:1024  lds
v_mfma_f32_16x16x32_bf16 v[44:47], v[20:23], v[56:59], v[44:47]
buffer_load_dwordx4 v5, s[12:15], s60 offen offset:2048  lds
buffer_load_dwordx4 v6, s[12:15], s60 offen offset:3072  lds
v_mul_u32_u24 v190, 3840, v15
s_lshl_b32 s97, s65, 7
buffer_load_dword v190, v190, s[12:15], s97 offen
s_waitcnt lgkmcnt(1)
v_mfma_f32_32x32x16_bf16 v[224:239], v[60:63], a[56:59], v[224:239]
v_mfma_f32_32x32x16_bf16 v[240:255], v[60:63], a[60:63], v[240:255]
s_waitcnt vmcnt(16) lgkmcnt(0)
s_barrier
v_add_u32 v11, 0x4000, v11
v_add_u32 v12, 0x4000, v12
ds_read_b128 a[64:67], v168 offset:32768
ds_read_b128 a[68:71], v176 offset:32768
ds_read_b64_tr_b16 v[48:49], v11 offset:0
ds_read_b64_tr_b16 v[50:51], v11 offset:512
ds_read_b128 a[72:75], v169 offset:32768
ds_read_b128 a[76:79], v177 offset:32768
ds_read_b64_tr_b16 v[52:53], v12 offset:0
ds_read_b64_tr_b16 v[54:55], v12 offset:512
v_dot2c_f32_bf16 v24, 0x3f803f80, v136
v_dot2c_f32_bf16 v28, v136, v136
v_dot2c_f32_bf16 v25, 0x3f803f80, v137
v_dot2c_f32_bf16 v29, v137, v137
v_dot2c_f32_bf16 v26, 0x3f803f80, v138
v_dot2c_f32_bf16 v30, v138, v138
v_dot2c_f32_bf16 v27, 0x3f803f80, v139
v_dot2c_f32_bf16 v31, v139, v139
v_dot2c_f32_bf16 v24, 0x3f803f80, v140
v_dot2c_f32_bf16 v28, v140, v140
v_dot2c_f32_bf16 v25, 0x3f803f80, v141
v_dot2c_f32_bf16 v29, v141, v141
v_dot2c_f32_bf16 v26, 0x3f803f80, v142
v_dot2c_f32_bf16 v30, v142, v142
v_dot2c_f32_bf16 v27, 0x3f803f80, v143
v_dot2c_f32_bf16 v31, v143, v143
v_dot2c_f32_bf16 v24, 0x3f803f80, v144
v_dot2c_f32_bf16 v28, v144, v144
v_dot2c_f32_bf16 v25, 0x3f803f80, v145
v_dot2c_f32_bf16 v29, v145, v145
v_dot2c_f32_bf16 v26, 0x3f803f80, v146
v_dot2c_f32_bf16 v30, v146, v146
v_dot2c_f32_bf16 v27, 0x3f803f80, v147
v_dot2c_f32_bf16 v31, v147, v147
v_dot2c_f32_bf16 v24, 0x3f803f80, v148
v_dot2c_f32_bf16 v28, v148, v148
v_dot2c_f32_bf16 v25, 0x3f803f80, v149
v_dot2c_f32_bf16 v29, v149, v149
v_dot2c_f32_bf16 v26, 0x3f803f80, v150
v_dot2c_f32_bf16 v30, v150, v150
v_dot2c_f32_bf16 v27, 0x3f803f80, v151
v_dot2c_f32_bf16 v31, v151, v151
v_dot2c_f32_bf16 v24, 0x3f803f80, v152
v_dot2c_f32_bf16 v28, v152, v152
v_dot2c_f32_bf16 v25, 0x3f803f80, v153
v_dot2c_f32_bf16 v29, v153, v153
v_dot2c_f32_bf16 v26, 0x3f803f80, v154
v_dot2c_f32_bf16 v30, v154, v154
v_dot2c_f32_bf16 v27, 0x3f803f80, v155
v_dot2c_f32_bf16 v31, v155, v155
v_dot2c_f32_bf16 v24, 0x3f803f80, v156
v_dot2c_f32_bf16 v28, v156, v156
v_dot2c_f32_bf16 v25, 0x3f803f80, v157
v_dot2c_f32_bf16 v29, v157, v157
v_dot2c_f32_bf16 v26, 0x3f803f80, v158
v_dot2c_f32_bf16 v30, v158, v158
v_dot2c_f32_bf16 v27, 0x3f803f80, v159
v_dot2c_f32_bf16 v31, v159, v159
v_dot2c_f32_bf16 v24, 0x3f803f80, v160
v_dot2c_f32_bf16 v28, v160, v160
v_dot2c_f32_bf16 v25, 0x3f803f80, v161
v_dot2c_f32_bf16 v29, v161, v161
v_dot2c_f32_bf16 v26, 0x3f803f80, v162
v_dot2c_f32_bf16 v30, v162, v162
v_dot2c_f32_bf16 v27, 0x3f803f80, v163
v_dot2c_f32_bf16 v31, v163, v163
v_dot2c_f32_bf16 v24, 0x3f803f80, v164
v_dot2c_f32_bf16 v28, v164, v164
v_dot2c_f32_bf16 v25, 0x3f803f80, v165
v_dot2c_f32_bf16 v29, v165, v165
v_dot2c_f32_bf16 v26, 0x3f803f80, v166
v_dot2c_f32_bf16 v30, v166, v166
v_dot2c_f32_bf16 v27, 0x3f803f80, v167
v_dot2c_f32_bf16 v31, v167, v167
s_cmp_lg_u32 s42, 0
s_cbranch_scc1 L_w0_18
v_mov_b32 v0, 0
global_load_dword v13, v0, s[4:5] sc0 sc1
L_w0_18:
s_waitcnt lgkmcnt(4)
v_mfma_f32_32x32x16_bf16 v[224:239], v[48:51], a[64:67], v[224:239]
s_add_u32 m0, s74, 49152
ds_read_b64_tr_b16 v[56:57], v11 offset:4096
ds_read_b128 a[80:83], v170 offset:32768
v_mfma_f32_32x32x16_bf16 v[240:255], v[48:51], a[68:71], v[240:255]
s_add_u32 s75, s73, 768
ds_read_b64_tr_b16 v[58:59], v11 offset:4608
ds_read_b128 a[84:87], v178 offset:32768
ds_read_b128 v[136:139], v168 offset:32768
v_add_u32 v168, 0x10000, v168
v_add_u32 v176, 0x10000, v176
ds_read_b128 v[140:143], v169 offset:32768
v_add_u32 v169, 0x10000, v169
v_add_u32 v177, 0x10000, v177
ds_read_b128 v[144:147], v170 offset:32768
v_add_u32 v170, 0x10000, v170
v_add_u32 v178, 0x10000, v178
v_mfma_f32_16x16x32_bf16 v[44:47], v[20:23], v[48:51], v[44:47]
buffer_load_dwordx4 v128, s[8:11], s75 offen offset:0  lds
s_waitcnt lgkmcnt(7)
v_mfma_f32_32x32x16_bf16 v[224:239], v[52:55], a[72:75], v[224:239]
buffer_load_dwordx4 v129, s[8:11], s75 offen offset:1024  lds
ds_read_b64_tr_b16 v[60:61], v12 offset:4096
ds_read_b128 a[88:91], v171 offset:32768
v_mfma_f32_32x32x16_bf16 v[240:255], v[52:55], a[76:79], v[240:255]
buffer_load_dwordx4 v130, s[8:11], s75 offen offset:2048  lds
ds_read_b64_tr_b16 v[62:63], v12 offset:4608
ds_read_b128 a[92:95], v179 offset:32768
ds_read_b128 v[148:151], v171 offset:32768
v_add_u32 v171, 0x10000, v171
v_add_u32 v179, 0x10000, v179
s_waitcnt lgkmcnt(8)
v_mfma_f32_32x32x16_bf16 v[224:239], v[56:59], a[80:83], v[224:239]
buffer_load_dwordx4 v131, s[8:11], s75 offen offset:3072  lds
ds_read_b64_tr_b16 v[48:49], v11 offset:8192
ds_read_b128 a[96:99], v172 offset:32768
v_mfma_f32_32x32x16_bf16 v[240:255], v[56:59], a[84:87], v[240:255]
s_add_u32 m0, s74, 53248
ds_read_b64_tr_b16 v[50:51], v11 offset:8704
ds_read_b128 a[100:103], v180 offset:32768
ds_read_b128 v[152:155], v172 offset:32768
v_add_u32 v172, 0x10000, v172
v_add_u32 v180, 0x10000, v180
v_mfma_f32_16x16x32_bf16 v[44:47], v[20:23], v[56:59], v[44:47]
s_add_u32 s75, s73, 21248
s_waitcnt lgkmcnt(6)
v_mfma_f32_32x32x16_bf16 v[224:239], v[60:63], a[88:91], v[224:239]
buffer_load_dwordx4 v128, s[8:11], s75 offen offset:0  lds
ds_read_b64_tr_b16 v[52:53], v12 offset:8192
ds_read_b128 a[104:107], v173 offset:32768
v_mfma_f32_32x32x16_bf16 v[240:255], v[60:63], a[92:95], v[240:255]
buffer_load_dwordx4 v129, s[8:11], s75 offen offset:1024  lds
ds_read_b64_tr_b16 v[54:55], v12 offset:8704
ds_read_b128 a[108:111], v181 offset:32768
ds_read_b128 v[156:159], v173 offset:32768
v_add_u32 v173, 0x10000, v173
v_add_u32 v181, 0x10000, v181
s_waitcnt lgkmcnt(6)
v_mfma_f32_32x32x16_bf16 v[224:239], v[48:51], a[96:99], v[224:239]
buffer_load_dwordx4 v130, s[8:11], s75 offen offset:2048  lds
ds_read_b64_tr_b16 v[56:57], v11 offset:12288
ds_read_b128 a[112:115], v174 offset:32768
v_mfma_f32_32x32x16_bf16 v[240:255], v[48:51], a[100:103], v[240:255]
buffer_load_dwordx4 v131, s[8:11], s75 offen offset:3072  lds
ds_read_b64_tr_b16 v[58:59], v11 offset:12800
ds_read_b128 a[116:119], v182 offset:32768
ds_read_b128 v[160:163], v174 offset:32768
v_add_u32 v174, 0x10000, v174
v_add_u32 v182, 0x10000, v182
v_mfma_f32_16x16x32_bf16 v[44:47], v[20:23], v[48:51], v[44:47]
s_lshl_b32 s60, s64, 7
s_waitcnt lgkmcnt(6)
v_mfma_f32_32x32x16_bf16 v[224:239], v[52:55], a[104:107], v[224:239]
s_add_u32 s60, s60, 1474560
ds_read_b64_tr_b16 v[60:61], v12 offset:12288
ds_read_b128 a[120:123], v175 offset:32768
v_mfma_f32_32x32x16_bf16 v[240:255], v[52:55], a[108:111], v[240:255]
s_add_u32 m0, s59, 0
ds_read_b64_tr_b16 v[62:63], v12 offset:12800
ds_read_b128 a[124:127], v183 offset:32768
ds_read_b128 v[164:167], v175 offset:32768
v_add_u32 v175, 0x10000, v175
v_add_u32 v183, 0x10000, v183
s_waitcnt lgkmcnt(6)
v_mfma_f32_32x32x16_bf16 v[224:239], v[56:59], a[112:115], v[224:239]
buffer_load_dwordx4 v3, s[12:15], s60 offen offset:0  lds
v_mfma_f32_32x32x16_bf16 v[240:255], v[56:59], a[116:119], v[240:255]
buffer_load_dwordx4 v4, s[12:15], s60 offen offset:1024  lds
v_mfma_f32_16x16x32_bf16 v[44:47], v[20:23], v[56:59], v[44:47]
buffer_load_dwordx4 v5, s[12:15], s60 offen offset:2048  lds
buffer_load_dwordx4 v6, s[12:15], s60 offen offset:3072  lds
s_waitcnt lgkmcnt(1)
v_mfma_f32_32x32x16_bf16 v[224:239], v[60:63], a[120:123], v[224:239]
v_mfma_f32_32x32x16_bf16 v[240:255], v[60:63], a[124:127], v[240:255]
s_waitcnt vmcnt(13) lgkmcnt(0)
s_barrier
v_add_u32 v11, 0x4000, v11
v_add_u32 v12, 0x4000, v12
ds_read_b128 a[128:131], v168 offset:0
ds_read_b128 a[132:135], v176 offset:0
ds_read_b64_tr_b16 v[48:49], v11 offset:0
ds_read_b64_tr_b16 v[50:51], v11 offset:512
ds_read_b128 a[136:139], v169 offset:0
ds_read_b128 a[140:143], v177 offset:0
ds_read_b64_tr_b16 v[52:53], v12 offset:0
ds_read_b64_tr_b16 v[54:55], v12 offset:512
v_dot2c_f32_bf16 v24, 0x3f803f80, v136
v_dot2c_f32_bf16 v28, v136, v136
v_dot2c_f32_bf16 v25, 0x3f803f80, v137
v_dot2c_f32_bf16 v29, v137, v137
v_dot2c_f32_bf16 v26, 0x3f803f80, v138
v_dot2c_f32_bf16 v30, v138, v138
v_dot2c_f32_bf16 v27, 0x3f803f80, v139
v_dot2c_f32_bf16 v31, v139, v139
v_dot2c_f32_bf16 v24, 0x3f803f80, v140
v_dot2c_f32_bf16 v28, v140, v140
v_dot2c_f32_bf16 v25, 0x3f803f80, v141
v_dot2c_f32_bf16 v29, v141, v141
v_dot2c_f32_bf16 v26, 0x3f803f80, v142
v_dot2c_f32_bf16 v30, v142, v142
v_dot2c_f32_bf16 v27, 0x3f803f80, v143
v_dot2c_f32_bf16 v31, v143, v143
v_dot2c_f32_bf16 v24, 0x3f803f80, v144
v_dot2c_f32_bf16 v28, v144, v144
v_dot2c_f32_bf16 v25, 0x3f803f80, v145
v_dot2c_f32_bf16 v29, v145, v145
v_dot2c_f32_bf16 v26, 0x3f803f80, v146
v_dot2c_f32_bf16 v30, v146, v146
v_dot2c_f32_bf16 v27, 0x3f803f80, v147
v_dot2c_f32_bf16 v31, v147, v147
v_dot2c_f32_bf16 v24, 0x3f803f80, v148
v_dot2c_f32_bf16 v28, v148, v148
v_dot2c_f32_bf16 v25, 0x3f803f80, v149
v_dot2c_f32_bf16 v29, v149, v149
v_dot2c_f32_bf16 v26, 0x3f803f80, v150
v_dot2c_f32_bf16 v30, v150, v150
v_dot2c_f32_bf16 v27, 0x3f803f80, v151
v_dot2c_f32_bf16 v31, v151, v151
v_dot2c_f32_bf16 v24, 0x3f803f80, v152
v_dot2c_f32_bf16 v28, v152, v152
v_dot2c_f32_bf16 v25, 0x3f803f80, v153
v_dot2c_f32_bf16 v29, v153, v153
v_dot2c_f32_bf16 v26, 0x3f803f80, v154
v_dot2c_f32_bf16 v30, v154, v154
v_dot2c_f32_bf16 v27, 0x3f803f80, v155
v_dot2c_f32_bf16 v31, v155, v155
v_dot2c_f32_bf16 v24, 0x3f803f80, v156
v_dot2c_f32_bf16 v28, v156, v156
v_dot2c_f32_bf16 v25, 0x3f803f80, v157
v_dot2c_f32_bf16 v29, v157, v157
v_dot2c_f32_bf16 v26, 0x3f803f80, v158
v_dot2c_f32_bf16 v30, v158, v158
v_dot2c_f32_bf16 v27, 0x3f803f80, v159
v_dot2c_f32_bf16 v31, v159, v159
v_dot2c_f32_bf16 v24, 0x3f803f80, v160
v_dot2c_f32_bf16 v28, v160, v160
v_dot2c_f32_bf16 v25, 0x3f803f80, v161
v_dot2c_f32_bf16 v29, v161, v161
v_dot2c_f32_bf16 v26, 0x3f803f80, v162
v_dot2c_f32_bf16 v30, v162, v162
v_dot2c_f32_bf16 v27, 0x3f803f80, v163
v_dot2c_f32_bf16 v31, v163, v163
v_dot2c_f32_bf16 v24, 0x3f803f80, v164
v_dot2c_f32_bf16 v28, v164, v164
v_dot2c_f32_bf16 v25, 0x3f803f80, v165
v_dot2c_f32_bf16 v29, v165, v165
v_dot2c_f32_bf16 v26, 0x3f803f80, v166
v_dot2c_f32_bf16 v30, v166, v166
v_dot2c_f32_bf16 v27, 0x3f803f80, v167
v_dot2c_f32_bf16 v31, v167, v167
s_waitcnt lgkmcnt(4)
v_mfma_f32_32x32x16_bf16 v[224:239], v[48:51], a[128:131], v[224:239]
s_add_u32 m0, s74, 81920
ds_read_b64_tr_b16 v[56:57], v11 offset:4096
ds_read_b128 a[144:147], v170 offset:0
v_mfma_f32_32x32x16_bf16 v[240:255], v[48:51], a[132:135], v[240:255]
s_add_u32 s75, s73, 1024
ds_read_b64_tr_b16 v[58:59], v11 offset:4608
ds_read_b128 a[148:151], v178 offset:0
ds_read_b128 v[136:139], v168 offset:0
v_add_u32 v168, 0xffff0000, v168
v_add_u32 v176, 0xffff0000, v176
ds_read_b128 v[140:143], v169 offset:0
v_add_u32 v169, 0xffff0000, v169
v_add_u32 v177, 0xffff0000, v177
ds_read_b128 v[144:147], v170 offset:0
v_add_u32 v170, 0xffff0000, v170
v_add_u32 v178, 0xffff0000, v178
v_mfma_f32_16x16x32_bf16 v[44:47], v[20:23], v[48:51], v[44:47]
buffer_load_dwordx4 v128, s[8:11], s75 offen offset:0  lds
s_waitcnt lgkmcnt(7)
v_mfma_f32_32x32x16_bf16 v[224:239], v[52:55], a[136:139], v[224:239]
buffer_load_dwordx4 v129, s[8:11], s75 offen offset:1024  lds
ds_read_b64_tr_b16 v[60:61], v12 offset:4096
ds_read_b128 a[152:155], v171 offset:0
v_mfma_f32_32x32x16_bf16 v[240:255], v[52:55], a[140:143], v[240:255]
buffer_load_dwordx4 v130, s[8:11], s75 offen offset:2048  lds
ds_read_b64_tr_b16 v[62:63], v12 offset:4608
ds_read_b128 a[156:159], v179 offset:0
ds_read_b128 v[148:151], v171 offset:0
v_add_u32 v171, 0xffff0000, v171
v_add_u32 v179, 0xffff0000, v179
s_waitcnt lgkmcnt(8)
v_mfma_f32_32x32x16_bf16 v[224:239], v[56:59], a[144:147], v[224:239]
buffer_load_dwordx4 v131, s[8:11], s75 offen offset:3072  lds
ds_read_b64_tr_b16 v[48:49], v11 offset:8192
ds_read_b128 a[160:163], v172 offset:0
v_mfma_f32_32x32x16_bf16 v[240:255], v[56:59], a[148:151], v[240:255]
s_add_u32 m0, s74, 86016
ds_read_b64_tr_b16 v[50:51], v11 offset:8704
ds_read_b128 a[164:167], v180 offset:0
ds_read_b128 v[152:155], v172 offset:0
v_add_u32 v172, 0xffff0000, v172
v_add_u32 v180, 0xffff0000, v180
v_mfma_f32_16x16x32_bf16 v[44:47], v[20:23], v[56:59], v[44:47]
s_add_u32 s75, s73, 21504
s_waitcnt lgkmcnt(6)
v_mfma_f32_32x32x16_bf16 v[224:239], v[60:63], a[152:155], v[224:239]
buffer_load_dwordx4 v128, s[8:11], s75 offen offset:0  lds
ds_read_b64_tr_b16 v[52:53], v12 offset:8192
ds_read_b128 a[168:171], v173 offset:0
v_mfma_f32_32x32x16_bf16 v[240:255], v[60:63], a[156:159], v[240:255]
buffer_load_dwordx4 v129, s[8:11], s75 offen offset:1024  lds
ds_read_b64_tr_b16 v[54:55], v12 offset:8704
ds_read_b128 a[172:175], v181 offset:0
ds_read_b128 v[156:159], v173 offset:0
v_add_u32 v173, 0xffff0000, v173
v_add_u32 v181, 0xffff0000, v181
s_waitcnt lgkmcnt(6)
v_mfma_f32_32x32x16_bf16 v[224:239], v[48:51], a[160:163], v[224:239]
buffer_load_dwordx4 v130, s[8:11], s75 offen offset:2048  lds
ds_read_b64_tr_b16 v[56:57], v11 offset:12288
ds_read_b128 a[176:179], v174 offset:0
v_mfma_f32_32x32x16_bf16 v[240:255], v[48:51], a[164:167], v[240:255]
buffer_load_dwordx4 v131, s[8:11], s75 offen offset:3072  lds
ds_read_b64_tr_b16 v[58:59], v11 offset:12800
ds_read_b128 a[180:183], v182 offset:0
ds_read_b128 v[160:163], v174 offset:0
v_add_u32 v174, 0xffff0000, v174
v_add_u32 v182, 0xffff0000, v182
v_mfma_f32_16x16x32_bf16 v[44:47], v[20:23], v[48:51], v[44:47]
s_lshl_b32 s60, s64, 7
s_waitcnt lgkmcnt(6)
v_mfma_f32_32x32x16_bf16 v[224:239], v[52:55], a[168:171], v[224:239]
s_add_u32 s60, s60, 1966080
ds_read_b64_tr_b16 v[60:61], v12 offset:12288
ds_read_b128 a[184:187], v175 offset:0
v_mfma_f32_32x32x16_bf16 v[240:255], v[52:55], a[172:175], v[240:255]
s_add_u32 m0, s59, 16384
ds_read_b64_tr_b16 v[62:63], v12 offset:12800
ds_read_b128 a[188:191], v183 offset:0
ds_read_b128 v[164:167], v175 offset:0
v_add_u32 v175, 0xffff0000, v175
v_add_u32 v183, 0xffff0000, v183
s_waitcnt lgkmcnt(6)
v_mfma_f32_32x32x16_bf16 v[224:239], v[56:59], a[176:179], v[224:239]
buffer_load_dwordx4 v3, s[12:15], s60 offen offset:0  lds
v_mfma_f32_32x32x16_bf16 v[240:255], v[56:59], a[180:183], v[240:255]
buffer_load_dwordx4 v4, s[12:15], s60 offen offset:1024  lds
v_mfma_f32_16x16x32_bf16 v[44:47], v[20:23], v[56:59], v[44:47]
buffer_load_dwordx4 v5, s[12:15], s60 offen offset:2048  lds
buffer_load_dwordx4 v6, s[12:15], s60 offen offset:3072  lds
s_waitcnt lgkmcnt(1)
v_mfma_f32_32x32x16_bf16 v[224:239], v[60:63], a[184:187], v[224:239]
v_mfma_f32_32x32x16_bf16 v[240:255], v[60:63], a[188:191], v[240:255]
s_waitcnt vmcnt(12) lgkmcnt(0)
s_barrier
v_add_u32 v11, 0xffff8000, v11
v_add_u32 v12, 0xffff8000, v12
ds_read_b128 a[192:195], v168 offset:0
ds_read_b128 a[196:199], v176 offset:0
ds_read_b64_tr_b16 v[48:49], v11 offset:0
ds_read_b64_tr_b16 v[50:51], v11 offset:512
ds_read_b128 a[200:203], v169 offset:0
ds_read_b128 a[204:207], v177 offset:0
ds_read_b64_tr_b16 v[52:53], v12 offset:0
ds_read_b64_tr_b16 v[54:55], v12 offset:512
v_dot2c_f32_bf16 v24, 0x3f803f80, v136
v_dot2c_f32_bf16 v28, v136, v136
v_dot2c_f32_bf16 v25, 0x3f803f80, v137
v_dot2c_f32_bf16 v29, v137, v137
v_dot2c_f32_bf16 v26, 0x3f803f80, v138
v_dot2c_f32_bf16 v30, v138, v138
v_dot2c_f32_bf16 v27, 0x3f803f80, v139
v_dot2c_f32_bf16 v31, v139, v139
v_dot2c_f32_bf16 v24, 0x3f803f80, v140
v_dot2c_f32_bf16 v28, v140, v140
v_dot2c_f32_bf16 v25, 0x3f803f80, v141
v_dot2c_f32_bf16 v29, v141, v141
v_dot2c_f32_bf16 v26, 0x3f803f80, v142
v_dot2c_f32_bf16 v30, v142, v142
v_dot2c_f32_bf16 v27, 0x3f803f80, v143
v_dot2c_f32_bf16 v31, v143, v143
v_dot2c_f32_bf16 v24, 0x3f803f80, v144
v_dot2c_f32_bf16 v28, v144, v144
v_dot2c_f32_bf16 v25, 0x3f803f80, v145
v_dot2c_f32_bf16 v29, v145, v145
v_dot2c_f32_bf16 v26, 0x3f803f80, v146
v_dot2c_f32_bf16 v30, v146, v146
v_dot2c_f32_bf16 v27, 0x3f803f80, v147
v_dot2c_f32_bf16 v31, v147, v147
v_dot2c_f32_bf16 v24, 0x3f803f80, v148
v_dot2c_f32_bf16 v28, v148, v148
v_dot2c_f32_bf16 v25, 0x3f803f80, v149
v_dot2c_f32_bf16 v29, v149, v149
v_dot2c_f32_bf16 v26, 0x3f803f80, v150
v_dot2c_f32_bf16 v30, v150, v150
v_dot2c_f32_bf16 v27, 0x3f803f80, v151
v_dot2c_f32_bf16 v31, v151, v151
v_dot2c_f32_bf16 v24, 0x3f803f80, v152
v_dot2c_f32_bf16 v28, v152, v152
v_dot2c_f32_bf16 v25, 0x3f803f80, v153
v_dot2c_f32_bf16 v29, v153, v153
v_dot2c_f32_bf16 v26, 0x3f803f80, v154
v_dot2c_f32_bf16 v30, v154, v154
v_dot2c_f32_bf16 v27, 0x3f803f80, v155
v_dot2c_f32_bf16 v31, v155, v155
v_dot2c_f32_bf16 v24, 0x3f803f80, v156
v_dot2c_f32_bf16 v28, v156, v156
v_dot2c_f32_bf16 v25, 0x3f803f80, v157
v_dot2c_f32_bf16 v29, v157, v157
v_dot2c_f32_bf16 v26, 0x3f803f80, v158
v_dot2c_f32_bf16 v30, v158, v158
v_dot2c_f32_bf16 v27, 0x3f803f80, v159
v_dot2c_f32_bf16 v31, v159, v159
v_dot2c_f32_bf16 v24, 0x3f803f80, v160
v_dot2c_f32_bf16 v28, v160, v160
v_dot2c_f32_bf16 v25, 0x3f803f80, v161
v_dot2c_f32_bf16 v29, v161, v161
v_dot2c_f32_bf16 v26, 0x3f803f80, v162
v_dot2c_f32_bf16 v30, v162, v162
v_dot2c_f32_bf16 v27, 0x3f803f80, v163
v_dot2c_f32_bf16 v31, v163, v163
v_dot2c_f32_bf16 v24, 0x3f803f80, v164
v_dot2c_f32_bf16 v28, v164, v164
v_dot2c_f32_bf16 v25, 0x3f803f80, v165
v_dot2c_f32_bf16 v29, v165, v165
v_dot2c_f32_bf16 v26, 0x3f803f80, v166
v_dot2c_f32_bf16 v30, v166, v166
v_dot2c_f32_bf16 v27, 0x3f803f80, v167
v_dot2c_f32_bf16 v31, v167, v167
s_waitcnt lgkmcnt(4)
v_mfma_f32_32x32x16_bf16 v[224:239], v[48:51], a[192:195], v[224:239]
ds_read_b64_tr_b16 v[56:57], v11 offset:4096
ds_read_b128 a[208:211], v170 offset:0
v_mfma_f32_32x32x16_bf16 v[240:255], v[48:51], a[196:199], v[240:255]
s_lshl_b32 s60, s65, 7
ds_read_b64_tr_b16 v[58:59], v11 offset:4608
ds_read_b128 a[212:215], v178 offset:0
ds_read_b128 v[136:139], v168 offset:0
ds_read_b128 v[140:143], v169 offset:0
ds_read_b128 v[144:147], v170 offset:0
v_mfma_f32_16x16x32_bf16 v[44:47], v[20:23], v[48:51], v[44:47]
s_add_u32 s60, s60, 0
s_waitcnt lgkmcnt(7)
v_mfma_f32_32x32x16_bf16 v[224:239], v[52:55], a[200:203], v[224:239]
s_add_u32 m0, s59, 32768
ds_read_b64_tr_b16 v[60:61], v12 offset:4096
ds_read_b128 a[216:219], v171 offset:0
v_mfma_f32_32x32x16_bf16 v[240:255], v[52:55], a[204:207], v[240:255]
buffer_load_dwordx4 v3, s[12:15], s60 offen offset:0  lds
ds_read_b64_tr_b16 v[62:63], v12 offset:4608
ds_read_b128 a[220:223], v179 offset:0
ds_read_b128 v[148:151], v171 offset:0
s_waitcnt lgkmcnt(8)
v_mfma_f32_32x32x16_bf16 v[224:239], v[56:59], a[208:211], v[224:239]
buffer_load_dwordx4 v4, s[12:15], s60 offen offset:1024  lds
ds_read_b64_tr_b16 v[48:49], v11 offset:8192
ds_read_b128 a[224:227], v172 offset:0
v_mfma_f32_32x32x16_bf16 v[240:255], v[56:59], a[212:215], v[240:255]
buffer_load_dwordx4 v5, s[12:15], s60 offen offset:2048  lds
ds_read_b64_tr_b16 v[50:51], v11 offset:8704
ds_read_b128 a[228:231], v180 offset:0
ds_read_b128 v[152:155], v172 offset:0
v_mfma_f32_16x16x32_bf16 v[44:47], v[20:23], v[56:59], v[44:47]
buffer_load_dwordx4 v6, s[12:15], s60 offen offset:3072  lds
s_waitcnt lgkmcnt(6)
v_mfma_f32_32x32x16_bf16 v[224:239], v[60:63], a[216:219], v[224:239]
s_lshl_b32 s60, s65, 7
ds_read_b64_tr_b16 v[52:53], v12 offset:8192
ds_read_b128 a[232:235], v173 offset:0
v_mfma_f32_32x32x16_bf16 v[240:255], v[60:63], a[220:223], v[240:255]
s_add_u32 s60, s60, 491520
ds_read_b64_tr_b16 v[54:55], v12 offset:8704
ds_read_b128 a[236:239], v181 offset:0
ds_read_b128 v[156:159], v173 offset:0
s_waitcnt lgkmcnt(6)
v_mfma_f32_32x32x16_bf16 v[224:239], v[48:51], a[224:227], v[224:239]
s_add_u32 m0, s59, 114688
ds_read_b64_tr_b16 v[56:57], v11 offset:12288
ds_read_b128 a[240:243], v174 offset:0
v_mfma_f32_32x32x16_bf16 v[240:255], v[48:51], a[228:231], v[240:255]
buffer_load_dwordx4 v3, s[12:15], s60 offen offset:0  lds
ds_read_b64_tr_b16 v[58:59], v11 offset:12800
ds_read_b128 a[244:247], v182 offset:0
ds_read_b128 v[160:163], v174 offset:0
v_mfma_f32_16x16x32_bf16 v[44:47], v[20:23], v[48:51], v[44:47]
buffer_load_dwordx4 v4, s[12:15], s60 offen offset:1024  lds
s_waitcnt lgkmcnt(6)
v_mfma_f32_32x32x16_bf16 v[224:239], v[52:55], a[232:235], v[224:239]
buffer_load_dwordx4 v5, s[12:15], s60 offen offset:2048  lds
ds_read_b64_tr_b16 v[60:61], v12 offset:12288
ds_read_b128 a[248:251], v175 offset:0
v_mfma_f32_32x32x16_bf16 v[240:255], v[52:55], a[236:239], v[240:255]
buffer_load_dwordx4 v6, s[12:15], s60 offen offset:3072  lds
ds_read_b64_tr_b16 v[62:63], v12 offset:12800
ds_read_b128 a[252:255], v183 offset:0
ds_read_b128 v[164:167], v175 offset:0
s_waitcnt lgkmcnt(6)
v_mfma_f32_32x32x16_bf16 v[224:239], v[56:59], a[240:243], v[224:239]
v_mul_u32_u24 v191, 3840, v15
v_mfma_f32_32x32x16_bf16 v[240:255], v[56:59], a[244:247], v[240:255]
s_lshl_b32 s97, s66, 7
v_mfma_f32_16x16x32_bf16 v[44:47], v[20:23], v[56:59], v[44:47]
buffer_load_dword v191, v191, s[12:15], s97 offen
s_waitcnt lgkmcnt(1)
v_mfma_f32_32x32x16_bf16 v[224:239], v[60:63], a[248:251], v[224:239]
v_mfma_f32_32x32x16_bf16 v[240:255], v[60:63], a[252:255], v[240:255]
s_waitcnt vmcnt(9) lgkmcnt(0)
s_barrier
v_add_u32 v11, 0x4000, v11
v_add_u32 v12, 0x4000, v12
ds_read_b128 v[64:67], v168 offset:32768
ds_read_b128 v[68:71], v176 offset:32768
ds_read_b64_tr_b16 v[48:49], v11 offset:0
ds_read_b64_tr_b16 v[50:51], v11 offset:512
ds_read_b128 v[72:75], v169 offset:32768
ds_read_b128 v[76:79], v177 offset:32768
ds_read_b64_tr_b16 v[52:53], v12 offset:0
ds_read_b64_tr_b16 v[54:55], v12 offset:512
v_dot2c_f32_bf16 v24, 0x3f803f80, v136
v_dot2c_f32_bf16 v28, v136, v136
v_dot2c_f32_bf16 v25, 0x3f803f80, v137
v_dot2c_f32_bf16 v29, v137, v137
v_dot2c_f32_bf16 v26, 0x3f803f80, v138
v_dot2c_f32_bf16 v30, v138, v138
v_dot2c_f32_bf16 v27, 0x3f803f80, v139
v_dot2c_f32_bf16 v31, v139, v139
v_dot2c_f32_bf16 v24, 0x3f803f80, v140
v_dot2c_f32_bf16 v28, v140, v140
v_dot2c_f32_bf16 v25, 0x3f803f80, v141
v_dot2c_f32_bf16 v29, v141, v141
v_dot2c_f32_bf16 v26, 0x3f803f80, v142
v_dot2c_f32_bf16 v30, v142, v142
v_dot2c_f32_bf16 v27, 0x3f803f80, v143
v_dot2c_f32_bf16 v31, v143, v143
v_dot2c_f32_bf16 v24, 0x3f803f80, v144
v_dot2c_f32_bf16 v28, v144, v144
v_dot2c_f32_bf16 v25, 0x3f803f80, v145
v_dot2c_f32_bf16 v29, v145, v145
v_dot2c_f32_bf16 v26, 0x3f803f80, v146
v_dot2c_f32_bf16 v30, v146, v146
v_dot2c_f32_bf16 v27, 0x3f803f80, v147
v_dot2c_f32_bf16 v31, v147, v147
v_dot2c_f32_bf16 v24, 0x3f803f80, v148
v_dot2c_f32_bf16 v28, v148, v148
v_dot2c_f32_bf16 v25, 0x3f803f80, v149
v_dot2c_f32_bf16 v29, v149, v149
v_dot2c_f32_bf16 v26, 0x3f803f80, v150
v_dot2c_f32_bf16 v30, v150, v150
v_dot2c_f32_bf16 v27, 0x3f803f80, v151
v_dot2c_f32_bf16 v31, v151, v151
v_dot2c_f32_bf16 v24, 0x3f803f80, v152
v_dot2c_f32_bf16 v28, v152, v152
v_dot2c_f32_bf16 v25, 0x3f803f80, v153
v_dot2c_f32_bf16 v29, v153, v153
v_dot2c_f32_bf16 v26, 0x3f803f80, v154
v_dot2c_f32_bf16 v30, v154, v154
v_dot2c_f32_bf16 v27, 0x3f803f80, v155
v_dot2c_f32_bf16 v31, v155, v155
v_dot2c_f32_bf16 v24, 0x3f803f80, v156
v_dot2c_f32_bf16 v28, v156, v156
v_dot2c_f32_bf16 v25, 0x3f803f80, v157
v_dot2c_f32_bf16 v29, v157, v157
v_dot2c_f32_bf16 v26, 0x3f803f80, v158
v_dot2c_f32_bf16 v30, v158, v158
v_dot2c_f32_bf16 v27, 0x3f803f80, v159
v_dot2c_f32_bf16 v31, v159, v159
v_dot2c_f32_bf16 v24, 0x3f803f80, v160
v_dot2c_f32_bf16 v28, v160, v160
v_dot2c_f32_bf16 v25, 0x3f803f80, v161
v_dot2c_f32_bf16 v29, v161, v161
v_dot2c_f32_bf16 v26, 0x3f803f80, v162
v_dot2c_f32_bf16 v30, v162, v162
v_dot2c_f32_bf16 v27, 0x3f803f80, v163
v_dot2c_f32_bf16 v31, v163, v163
v_dot2c_f32_bf16 v24, 0x3f803f80, v164
v_dot2c_f32_bf16 v28, v164, v164
v_dot2c_f32_bf16 v25, 0x3f803f80, v165
v_dot2c_f32_bf16 v29, v165, v165
v_dot2c_f32_bf16 v26, 0x3f803f80, v166
v_dot2c_f32_bf16 v30, v166, v166
v_dot2c_f32_bf16 v27, 0x3f803f80, v167
v_dot2c_f32_bf16 v31, v167, v167
s_waitcnt lgkmcnt(4)
v_mfma_f32_32x32x16_bf16 v[224:239], v[48:51], v[64:67], v[224:239]
ds_read_b64_tr_b16 v[56:57], v11 offset:4096
ds_read_b128 v[80:83], v170 offset:32768
v_mfma_f32_32x32x16_bf16 v[240:255], v[48:51], v[68:71], v[240:255]
s_lshl_b32 s60, s65, 7
ds_read_b64_tr_b16 v[58:59], v11 offset:4608
ds_read_b128 v[84:87], v178 offset:32768
ds_read_b128 v[136:139], v168 offset:32768
ds_read_b128 v[140:143], v169 offset:32768
ds_read_b128 v[144:147], v170 offset:32768
v_mfma_f32_16x16x32_bf16 v[44:47], v[20:23], v[48:51], v[44:47]
s_add_u32 s60, s60, 983040
s_waitcnt lgkmcnt(7)
v_mfma_f32_32x32x16_bf16 v[224:239], v[52:55], v[72:75], v[224:239]
s_add_u32 m0, s59, 131072
ds_read_b64_tr_b16 v[60:61], v12 offset:4096
ds_read_b128 v[88:91], v171 offset:32768
v_mfma_f32_32x32x16_bf16 v[240:255], v[52:55], v[76:79], v[240:255]
ds_read_b64_tr_b16 v[62:63], v12 offset:4608
ds_read_b128 v[92:95], v179 offset:32768
ds_read_b128 v[148:151], v171 offset:32768
s_waitcnt lgkmcnt(8)
v_mfma_f32_32x32x16_bf16 v[224:239], v[56:59], v[80:83], v[224:239]
buffer_load_dwordx4 v3, s[12:15], s60 offen offset:0  lds
ds_read_b64_tr_b16 v[48:49], v11 offset:8192
ds_read_b128 v[96:99], v172 offset:32768
v_mfma_f32_32x32x16_bf16 v[240:255], v[56:59], v[84:87], v[240:255]
buffer_load_dwordx4 v4, s[12:15], s60 offen offset:1024  lds
ds_read_b64_tr_b16 v[50:51], v11 offset:8704
ds_read_b128 v[100:103], v180 offset:32768
ds_read_b128 v[152:155], v172 offset:32768
v_mfma_f32_16x16x32_bf16 v[44:47], v[20:23], v[56:59], v[44:47]
buffer_load_dwordx4 v5, s[12:15], s60 offen offset:2048  lds
s_waitcnt lgkmcnt(6)
v_mfma_f32_32x32x16_bf16 v[224:239], v[60:63], v[88:91], v[224:239]
buffer_load_dwordx4 v6, s[12:15], s60 offen offset:3072  lds
ds_read_b64_tr_b16 v[52:53], v12 offset:8192
ds_read_b128 v[104:107], v173 offset:32768
v_mfma_f32_32x32x16_bf16 v[240:255], v[60:63], v[92:95], v[240:255]
ds_read_b64_tr_b16 v[54:55], v12 offset:8704
ds_read_b128 v[108:111], v181 offset:32768
ds_read_b128 v[156:159], v173 offset:32768
s_waitcnt lgkmcnt(6)
v_mfma_f32_32x32x16_bf16 v[224:239], v[48:51], v[96:99], v[224:239]
s_lshl_b32 s60, s65, 7
ds_read_b64_tr_b16 v[56:57], v11 offset:12288
ds_read_b128 v[112:115], v174 offset:32768
v_mfma_f32_32x32x16_bf16 v[240:255], v[48:51], v[100:103], v[240:255]
s_add_u32 s60, s60, 1474560
ds_read_b64_tr_b16 v[58:59], v11 offset:12800
ds_read_b128 v[116:119], v182 offset:32768
ds_read_b128 v[160:163], v174 offset:32768
v_mfma_f32_16x16x32_bf16 v[44:47], v[20:23], v[48:51], v[44:47]
s_add_u32 m0, s59, 0
s_waitcnt lgkmcnt(6)
v_mfma_f32_32x32x16_bf16 v[224:239], v[52:55], v[104:107], v[224:239]
ds_read_b64_tr_b16 v[60:61], v12 offset:12288
ds_read_b128 v[120:123], v175 offset:32768
v_mfma_f32_32x32x16_bf16 v[240:255], v[52:55], v[108:111], v[240:255]
buffer_load_dwordx4 v3, s[12:15], s60 offen offset:0  lds
ds_read_b64_tr_b16 v[62:63], v12 offset:12800
ds_read_b128 v[124:127], v183 offset:32768
ds_read_b128 v[164:167], v175 offset:32768
s_waitcnt lgkmcnt(6)
v_mfma_f32_32x32x16_bf16 v[224:239], v[56:59], v[112:115], v[224:239]
buffer_load_dwordx4 v4, s[12:15], s60 offen offset:1024  lds
v_mfma_f32_32x32x16_bf16 v[240:255], v[56:59], v[116:119], v[240:255]
buffer_load_dwordx4 v5, s[12:15], s60 offen offset:2048  lds
v_mfma_f32_16x16x32_bf16 v[44:47], v[20:23], v[56:59], v[44:47]
buffer_load_dwordx4 v6, s[12:15], s60 offen offset:3072  lds
s_waitcnt lgkmcnt(1)
v_mfma_f32_32x32x16_bf16 v[224:239], v[60:63], v[120:123], v[224:239]
s_nop 4
ds_write_b32 v18, v44 offset:0
ds_write_b32 v18, v45 offset:64
v_mfma_f32_32x32x16_bf16 v[240:255], v[60:63], v[124:127], v[240:255]
s_waitcnt vmcnt(9) lgkmcnt(0)
s_cmp_lg_u32 s42, 0
s_cbranch_scc1 L_nc_19
v_readfirstlane_b32 s79, v13
s_nop 1
s_cmp_lg_u32 s79, 0
s_cbranch_scc1 L_nc_19
s_cmp_lg_u32 s42, 0
s_cbranch_scc1 L_ng_20_ok
s_mov_b32 s46, 0x40000
v_mov_b32 v0, 0
L_ng_20:
global_load_dword v13, v0, s[4:5] sc0 sc1
s_waitcnt vmcnt(0)
v_readfirstlane_b32 s79, v13
s_nop 1
s_cmp_lg_u32 s79, 0
s_cbranch_scc1 L_ng_20_ok
s_sleep 1
s_sub_u32 s46, s46, 1
s_cmp_lg_u32 s46, 0
s_cbranch_scc1 L_ng_20
L_ng_20_ok:
L_nc_19:
s_barrier
v_add_u32 v11, 0x4000, v11
v_add_u32 v12, 0x4000, v12
ds_read_b64_tr_b16 v[48:49], v11 offset:0
ds_read_b64_tr_b16 v[50:51], v11 offset:512
ds_read_b64_tr_b16 v[52:53], v12 offset:0
ds_read_b64_tr_b16 v[54:55], v12 offset:512
v_dot2c_f32_bf16 v24, 0x3f803f80, v136
v_dot2c_f32_bf16 v28, v136, v136
v_dot2c_f32_bf16 v25, 0x3f803f80, v137
v_dot2c_f32_bf16 v29, v137, v137
v_dot2c_f32_bf16 v26, 0x3f803f80, v138
v_dot2c_f32_bf16 v30, v138, v138
v_dot2c_f32_bf16 v27, 0x3f803f80, v139
v_dot2c_f32_bf16 v31, v139, v139
v_dot2c_f32_bf16 v24, 0x3f803f80, v140
v_dot2c_f32_bf16 v28, v140, v140
v_dot2c_f32_bf16 v25, 0x3f803f80, v141
v_dot2c_f32_bf16 v29, v141, v141
v_dot2c_f32_bf16 v26, 0x3f803f80, v142
v_dot2c_f32_bf16 v30, v142, v142
v_dot2c_f32_bf16 v27, 0x3f803f80, v143
v_dot2c_f32_bf16 v31, v143, v143
v_dot2c_f32_bf16 v24, 0x3f803f80, v144
v_dot2c_f32_bf16 v28, v144, v144
v_dot2c_f32_bf16 v25, 0x3f803f80, v145
v_dot2c_f32_bf16 v29, v145, v145
v_dot2c_f32_bf16 v26, 0x3f803f80, v146
v_dot2c_f32_bf16 v30, v146, v146
v_dot2c_f32_bf16 v27, 0x3f803f80, v147
v_dot2c_f32_bf16 v31, v147, v147
v_dot2c_f32_bf16 v24, 0x3f803f80, v148
v_dot2c_f32_bf16 v28, v148, v148
v_dot2c_f32_bf16 v25, 0x3f803f80, v149
v_dot2c_f32_bf16 v29, v149, v149
v_dot2c_f32_bf16 v26, 0x3f803f80, v150
v_dot2c_f32_bf16 v30, v150, v150
v_dot2c_f32_bf16 v27, 0x3f803f80, v151
v_dot2c_f32_bf16 v31, v151, v151
v_dot2c_f32_bf16 v24, 0x3f803f80, v152
v_dot2c_f32_bf16 v28, v152, v152
v_dot2c_f32_bf16 v25, 0x3f803f80, v153
v_dot2c_f32_bf16 v29, v153, v153
v_dot2c_f32_bf16 v26, 0x3f803f80, v154
v_dot2c_f32_bf16 v30, v154, v154
v_dot2c_f32_bf16 v27, 0x3f803f80, v155
v_dot2c_f32_bf16 v31, v155, v155
v_dot2c_f32_bf16 v24, 0x3f803f80, v156
v_dot2c_f32_bf16 v28, v156, v156
v_dot2c_f32_bf16 v25, 0x3f803f80, v157
v_dot2c_f32_bf16 v29, v157, v157
v_dot2c_f32_bf16 v26, 0x3f803f80, v158
v_dot2c_f32_bf16 v30, v158, v158
v_dot2c_f32_bf16 v27, 0x3f803f80, v159
v_dot2c_f32_bf16 v31, v159, v159
v_dot2c_f32_bf16 v24, 0x3f803f80, v160
v_dot2c_f32_bf16 v28, v160, v160
v_dot2c_f32_bf16 v25, 0x3f803f80, v161
v_dot2c_f32_bf16 v29, v161, v161
v_dot2c_f32_bf16 v26, 0x3f803f80, v162
v_dot2c_f32_bf16 v30, v162, v162
v_dot2c_f32_bf16 v27, 0x3f803f80, v163
v_dot2c_f32_bf16 v31, v163, v163
v_dot2c_f32_bf16 v24, 0x3f803f80, v164
v_dot2c_f32_bf16 v28, v164, v164
v_dot2c_f32_bf16 v25, 0x3f803f80, v165
v_dot2c_f32_bf16 v29, v165, v165
v_dot2c_f32_bf16 v26, 0x3f803f80, v166
v_dot2c_f32_bf16 v30, v166, v166
v_dot2c_f32_bf16 v27, 0x3f803f80, v167
v_dot2c_f32_bf16 v31, v167, v167
v_add_f32 v24, v24, v25
s_nop 0
v_add_f32 v26, v26, v27
v_add_f32 v28, v28, v29
v_add_f32 v30, v30, v31
v_add_f32 v24, v24, v26
v_add_f32 v28, v28, v30
v_mov_b32 v25, v24
v_mov_b32 v29, v28
s_nop 0
v_permlane32_swap_b32 v24, v25
v_permlane32_swap_b32 v28, v29
v_add_f32 v24, v24, v25
v_add_f32 v28, v28, v29
v_mul_f32 v24, 0x3acccccd, v24
v_mul_f32 v28, 0x3acccccd, v28
v_fma_f32 v28, -v24, v24, v28
v_max_f32 v28, 0, v28
v_cvt_pk_bf16_f32 v184, -v24, -v24
v_cvt_pk_bf16_f32 v185, v28, v28
v_lshlrev_b32 v185, 16, v185
v_add_f32 v185, 0x3727c5ac, v185
v_cvt_pk_bf16_f32 v185, v185, v185
v_lshlrev_b32 v185, 16, v185
v_sqrt_f32 v185, v185
s_nop 0
v_cvt_pk_bf16_f32 v185, v185, v185
v_lshlrev_b32 v186, 16, v185
v_rcp_f32 v185, v186
v_mul_f32 v186, v186, v186
v_mov_b32 v187, 0
v_and_b32 v24, 31, v1
s_lshl_b32 s52, s42, 5
v_add_u32 v24, s52, v24
v_lshlrev_b32 v24, 4, v24
v_add_u32 v24, 147456, v24
ds_write_b128 v24, v[184:187]
s_waitcnt lgkmcnt(3)
v_mfma_f32_32x32x16_bf16 v[128:143], v[48:51], a[0:3], 0
v_mul_u32_u24 v14, 3456, v15
s_lshl_b32 s97, s67, 7
ds_read_b64_tr_b16 v[56:57], v11 offset:4096
v_mfma_f32_16x16x32_bf16 v[44:47], v[20:23], v[48:51], 0
v_mfma_f32_32x32x16_bf16 v[144:159], v[48:51], a[4:7], 0
buffer_load_dword v14, v14, s[16:19], s97 offen
ds_read_b64_tr_b16 v[58:59], v11 offset:4608
s_waitcnt lgkmcnt(3)
v_mfma_f32_32x32x16_bf16 v[128:143], v[52:55], a[8:11], v[128:143]
s_lshl_b32 s60, s65, 7
s_add_u32 s60, s60, 1966080
ds_read_b64_tr_b16 v[60:61], v12 offset:4096
v_mfma_f32_32x32x16_bf16 v[144:159], v[52:55], a[12:15], v[144:159]
s_add_u32 m0, s59, 49152
ds_read_b64_tr_b16 v[62:63], v12 offset:4608
s_waitcnt lgkmcnt(2)
v_mfma_f32_32x32x16_bf16 v[128:143], v[56:59], a[16:19], v[128:143]
buffer_load_dwordx4 v3, s[12:15], s60 offen offset:0  lds
ds_read_b64_tr_b16 v[48:49], v11 offset:8192
v_mfma_f32_16x16x32_bf16 v[44:47], v[20:23], v[56:59], v[44:47]
buffer_load_dwordx4 v4, s[12:15], s60 offen offset:1024  lds
v_mfma_f32_32x32x16_bf16 v[144:159], v[56:59], a[20:23], v[144:159]
ds_read_b64_tr_b16 v[50:51], v11 offset:8704
s_waitcnt lgkmcnt(2)
v_mfma_f32_32x32x16_bf16 v[128:143], v[60:63], a[24:27], v[128:143]
buffer_load_dwordx4 v5, s[12:15], s60 offen offset:2048  lds
ds_read_b64_tr_b16 v[52:53], v12 offset:8192
v_mfma_f32_32x32x16_bf16 v[144:159], v[60:63], a[28:31], v[144:159]
buffer_load_dwordx4 v6, s[12:15], s60 offen offset:3072  lds
ds_read_b64_tr_b16 v[54:55], v12 offset:8704
s_waitcnt lgkmcnt(2)
v_mfma_f32_32x32x16_bf16 v[128:143], v[48:51], a[32:35], v[128:143]
s_lshl_b32 s60, s66, 7
s_add_u32 s60, s60, 0
ds_read_b64_tr_b16 v[56:57], v11 offset:12288
v_mfma_f32_16x16x32_bf16 v[44:47], v[20:23], v[48:51], v[44:47]
s_add_u32 m0, s59, 65536
v_mfma_f32_32x32x16_bf16 v[144:159], v[48:51], a[36:39], v[144:159]
buffer_load_dwordx4 v3, s[12:15], s60 offen offset:0  lds
ds_read_b64_tr_b16 v[58:59], v11 offset:12800
s_waitcnt lgkmcnt(2)
v_mfma_f32_32x32x16_bf16 v[128:143], v[52:55], a[40:43], v[128:143]
buffer_load_dwordx4 v4, s[12:15], s60 offen offset:1024  lds
ds_read_b64_tr_b16 v[60:61], v12 offset:12288
v_mfma_f32_32x32x16_bf16 v[144:159], v[52:55], a[44:47], v[144:159]
ds_read_b64_tr_b16 v[62:63], v12 offset:12800
s_waitcnt lgkmcnt(2)
v_mfma_f32_32x32x16_bf16 v[128:143], v[56:59], a[48:51], v[128:143]
buffer_load_dwordx4 v5, s[12:15], s60 offen offset:2048  lds
v_add_u32 v11, 0x14000, v11
v_add_u32 v12, 0x14000, v12
ds_read_b64_tr_b16 v[48:49], v11 offset:0
v_mfma_f32_16x16x32_bf16 v[44:47], v[20:23], v[56:59], v[44:47]
v_mfma_f32_32x32x16_bf16 v[144:159], v[56:59], a[52:55], v[144:159]
buffer_load_dwordx4 v6, s[12:15], s60 offen offset:3072  lds
ds_read_b64_tr_b16 v[50:51], v11 offset:512
s_waitcnt lgkmcnt(2)
v_mfma_f32_32x32x16_bf16 v[128:143], v[60:63], a[56:59], v[128:143]
ds_read_b64_tr_b16 v[52:53], v12 offset:0
v_mfma_f32_32x32x16_bf16 v[144:159], v[60:63], a[60:63], v[144:159]
ds_read_b64_tr_b16 v[54:55], v12 offset:512
s_waitcnt vmcnt(13)
s_barrier
s_waitcnt lgkmcnt(2)
v_mfma_f32_32x32x16_bf16 v[128:143], v[48:51], a[64:67], v[128:143]
s_lshl_b32 s60, s66, 7
s_add_u32 s60, s60, 491520
ds_read_b64_tr_b16 v[56:57], v11 offset:4096
v_mfma_f32_16x16x32_bf16 v[44:47], v[20:23], v[48:51], v[44:47]
v_and_b32 v38, 31, v1
v_mfma_f32_32x32x16_bf16 v[144:159], v[48:51], a[68:71], v[144:159]
s_add_u32 m0, s59, 16384
s_lshl_b32 s52, s42, 5
ds_read_b64_tr_b16 v[58:59], v11 offset:4608
s_waitcnt lgkmcnt(2)
v_mfma_f32_32x32x16_bf16 v[128:143], v[52:55], a[72:75], v[128:143]
buffer_load_dwordx4 v3, s[12:15], s60 offen offset:0  lds
v_add_u32 v38, s52, v38
v_lshlrev_b32 v38, 4, v38
ds_read_b64_tr_b16 v[60:61], v12 offset:4096
v_mfma_f32_32x32x16_bf16 v[144:159], v[52:55], a[76:79], v[144:159]
buffer_load_dwordx4 v4, s[12:15], s60 offen offset:1024  lds
v_add_u32 v38, 147456, v38
ds_read_b64_tr_b16 v[62:63], v12 offset:4608
s_waitcnt lgkmcnt(2)
v_mfma_f32_32x32x16_bf16 v[128:143], v[56:59], a[80:83], v[128:143]
v_xor_b32 v39, 512, v38
ds_read_b128 v[160:163], v38
ds_read_b64_tr_b16 v[48:49], v11 offset:8192
v_mfma_f32_16x16x32_bf16 v[44:47], v[20:23], v[56:59], v[44:47]
buffer_load_dwordx4 v5, s[12:15], s60 offen offset:2048  lds
v_mfma_f32_32x32x16_bf16 v[144:159], v[56:59], a[84:87], v[144:159]
ds_read_b128 v[164:167], v39
v_cmp_gt_u32 s[52:53], 32, v1
ds_read_b64_tr_b16 v[50:51], v11 offset:8704
s_waitcnt lgkmcnt(4)
v_mfma_f32_32x32x16_bf16 v[128:143], v[60:63], a[88:91], v[128:143]
buffer_load_dwordx4 v6, s[12:15], s60 offen offset:3072  lds
v_mov_b32 v25, 0
ds_read_b64_tr_b16 v[52:53], v12 offset:8192
v_mfma_f32_32x32x16_bf16 v[144:159], v[60:63], a[92:95], v[144:159]
s_lshl_b32 s60, s66, 7
s_add_u32 s60, s60, 983040
v_mov_b32 v27, 0
ds_read_b64_tr_b16 v[54:55], v12 offset:8704
s_waitcnt lgkmcnt(2)
v_mfma_f32_32x32x16_bf16 v[128:143], v[48:51], a[96:99], v[128:143]
s_add_u32 m0, s59, 81920
v_mov_b32 v29, 0
ds_read_b64_tr_b16 v[56:57], v11 offset:12288
v_mfma_f32_16x16x32_bf16 v[44:47], v[20:23], v[48:51], v[44:47]
v_cndmask_b32_e64 v26, 0, v160, s[52:53]
v_mfma_f32_32x32x16_bf16 v[144:159], v[48:51], a[100:103], v[144:159]
buffer_load_dwordx4 v3, s[12:15], s60 offen offset:0  lds
ds_read_b64_tr_b16 v[58:59], v11 offset:12800
s_waitcnt lgkmcnt(2)
v_mfma_f32_32x32x16_bf16 v[128:143], v[52:55], a[104:107], v[128:143]
buffer_load_dwordx4 v4, s[12:15], s60 offen offset:1024  lds
v_mov_b32 v30, v161
v_mul_f32 v32, 0xc0135761, v161
ds_read_b64_tr_b16 v[60:61], v12 offset:12288
v_mfma_f32_32x32x16_bf16 v[144:159], v[52:55], a[108:111], v[144:159]
buffer_load_dwordx4 v5, s[12:15], s60 offen offset:2048  lds
v_mul_f32 v33, v161, v161
ds_read_b64_tr_b16 v[62:63], v12 offset:12800
s_waitcnt lgkmcnt(2)
v_mfma_f32_32x32x16_bf16 v[128:143], v[56:59], a[112:115], v[128:143]
v_mul_f32 v33, v33, v161
v_add_u32 v11, 0x4000, v11
v_add_u32 v12, 0x4000, v12
ds_read_b64_tr_b16 v[48:49], v11 offset:0
v_mfma_f32_16x16x32_bf16 v[44:47], v[20:23], v[56:59], v[44:47]
v_mul_f32 v33, 0xbdd2d3e8, v33
v_mfma_f32_32x32x16_bf16 v[144:159], v[56:59], a[116:119], v[144:159]
buffer_load_dwordx4 v6, s[12:15], s60 offen offset:3072  lds
v_mov_b32 v34, v162
ds_read_b64_tr_b16 v[50:51], v11 offset:512
s_waitcnt lgkmcnt(2)
v_mfma_f32_32x32x16_bf16 v[128:143], v[60:63], a[120:123], v[128:143]
v_cndmask_b32_e64 v28, 0, v164, s[52:53]
v_mov_b32 v31, v165
ds_read_b64_tr_b16 v[52:53], v12 offset:0
v_mfma_f32_32x32x16_bf16 v[144:159], v[60:63], a[124:127], v[144:159]
v_mul_f32 v35, 0xc0135761, v165
ds_read_b64_tr_b16 v[54:55], v12 offset:512
s_waitcnt vmcnt(17)
s_barrier
s_waitcnt lgkmcnt(2)
v_mfma_f32_32x32x16_bf16 v[128:143], v[48:51], a[128:131], v[128:143]
s_lshl_b32 s60, s66, 7
s_add_u32 s60, s60, 1474560
v_mul_f32 v36, v165, v165
ds_read_b64_tr_b16 v[56:57], v11 offset:4096
v_mfma_f32_16x16x32_bf16 v[44:47], v[20:23], v[48:51], v[44:47]
v_mul_f32 v36, v36, v165
v_mfma_f32_32x32x16_bf16 v[144:159], v[48:51], a[132:135], v[144:159]
s_add_u32 m0, s59, 98304
v_mul_f32 v36, 0xbdd2d3e8, v36
v_mov_b32 v37, v166
ds_read_b64_tr_b16 v[58:59], v11 offset:4608
s_waitcnt lgkmcnt(2)
v_mfma_f32_32x32x16_bf16 v[128:143], v[52:55], a[136:139], v[128:143]
buffer_load_dwordx4 v3, s[12:15], s60 offen offset:0  lds
ds_read_b32 v38, v19 offset:0
ds_read_b64_tr_b16 v[60:61], v12 offset:4096
v_mfma_f32_32x32x16_bf16 v[144:159], v[52:55], a[140:143], v[144:159]
buffer_load_dwordx4 v4, s[12:15], s60 offen offset:1024  lds
ds_read_b32 v39, v19 offset:128
ds_read_b64_tr_b16 v[62:63], v12 offset:4608
s_waitcnt lgkmcnt(4)
v_mfma_f32_32x32x16_bf16 v[128:143], v[56:59], a[144:147], v[128:143]
s_waitcnt lgkmcnt(1)
v_add_f32 v38, v38, v39
ds_read_b64_tr_b16 v[48:49], v11 offset:8192
v_mfma_f32_16x16x32_bf16 v[44:47], v[20:23], v[56:59], v[44:47]
buffer_load_dwordx4 v5, s[12:15], s60 offen offset:2048  lds
v_mfma_f32_32x32x16_bf16 v[144:159], v[56:59], a[148:151], v[144:159]
v_cvt_pk_bf16_f32 v39, v38, v38
v_lshlrev_b32 v39, 16, v39
ds_read_b64_tr_b16 v[50:51], v11 offset:8704
s_waitcnt lgkmcnt(2)
v_mfma_f32_32x32x16_bf16 v[128:143], v[60:63], a[152:155], v[128:143]
buffer_load_dwordx4 v6, s[12:15], s60 offen offset:3072  lds
v_sub_f32 v39, v38, v39
ds_read_b64_tr_b16 v[52:53], v12 offset:8192
v_mfma_f32_32x32x16_bf16 v[144:159], v[60:63], a[156:159], v[144:159]
s_lshl_b32 s60, s66, 7
s_add_u32 s60, s60, 1966080
v_cvt_pk_bf16_f32 v24, v38, v39
ds_read_b64_tr_b16 v[54:55], v12 offset:8704
s_waitcnt lgkmcnt(2)
v_mfma_f32_32x32x16_bf16 v[128:143], v[48:51], a[160:163], v[128:143]
s_add_u32 m0, s59, 32768
v_mfma_f32_32x32x8bf16_1k v[224:239], v[24:25], v[26:27], v[224:239]
ds_read_b64_tr_b16 v[56:57], v11 offset:12288
v_mfma_f32_16x16x32_bf16 v[44:47], v[20:23], v[48:51], v[44:47]
v_mfma_f32_32x32x16_bf16 v[144:159], v[48:51], a[164:167], v[144:159]
buffer_load_dwordx4 v3, s[12:15], s60 offen offset:0  lds
v_mfma_f32_32x32x8bf16_1k v[240:255], v[24:25], v[28:29], v[240:255]
ds_read_b64_tr_b16 v[58:59], v11 offset:12800
s_waitcnt lgkmcnt(2)
v_mfma_f32_32x32x16_bf16 v[128:143], v[52:55], a[168:171], v[128:143]
buffer_load_dwordx4 v4, s[12:15], s60 offen offset:1024  lds
s_cmp_lt_u32 s64, 10
s_cselect_b32 s63, 0x3ea52b5c, 1.0
ds_read_b64_tr_b16 v[60:61], v12 offset:12288
v_mfma_f32_32x32x16_bf16 v[144:159], v[52:55], a[172:175], v[144:159]
buffer_load_dwordx4 v5, s[12:15], s60 offen offset:2048  lds
ds_read_b64_tr_b16 v[62:63], v12 offset:12800
s_waitcnt lgkmcnt(2)
v_mfma_f32_32x32x16_bf16 v[128:143], v[56:59], a[176:179], v[128:143]
s_lshl_b32 s52, s64, 12
s_lshl_b32 s53, s44, 11
v_add_u32 v11, 0xfffe0000, v11
v_add_u32 v12, 0xfffe0000, v12
ds_read_b64_tr_b16 v[48:49], v11 offset:0
v_mfma_f32_16x16x32_bf16 v[44:47], v[20:23], v[56:59], v[44:47]
v_mfma_f32_32x32x16_bf16 v[144:159], v[56:59], a[180:183], v[144:159]
buffer_load_dwordx4 v6, s[12:15], s60 offen offset:3072  lds
s_add_u32 s52, s52, s53
ds_read_b64_tr_b16 v[50:51], v11 offset:512
s_waitcnt lgkmcnt(2)
v_mfma_f32_32x32x16_bf16 v[128:143], v[60:63], a[184:187], v[128:143]
s_mul_i32 s53, s55, 122880
s_add_u32 s61, s52, s53
s_mul_i32 s53, s56, 122880
ds_read_b64_tr_b16 v[52:53], v12 offset:0
v_mfma_f32_32x32x16_bf16 v[144:159], v[60:63], a[188:191], v[144:159]
s_add_u32 s62, s52, s53
ds_read_b64_tr_b16 v[54:55], v12 offset:512
s_waitcnt vmcnt(20)
s_barrier
s_waitcnt lgkmcnt(2)
v_mfma_f32_32x32x16_bf16 v[128:143], v[48:51], a[192:195], v[128:143]
v_mul_f32 v40, s63, v30
v_mul_f32 v41, s63, v31
ds_read_b64_tr_b16 v[56:57], v11 offset:4096
v_mfma_f32_16x16x32_bf16 v[44:47], v[20:23], v[48:51], v[44:47]
v_mul_f32 v224, v224, v40
v_mfma_f32_32x32x16_bf16 v[144:159], v[48:51], a[196:199], v[144:159]
v_mul_f32 v225, v225, v40
ds_read_b64_tr_b16 v[58:59], v11 offset:4608
s_waitcnt lgkmcnt(2)
v_mfma_f32_32x32x16_bf16 v[128:143], v[52:55], a[200:203], v[128:143]
v_cvt_pk_bf16_f32 v224, v224, v225
v_mul_f32 v226, v226, v40
v_mul_f32 v227, v227, v40
ds_read_b64_tr_b16 v[60:61], v12 offset:4096
v_mfma_f32_32x32x16_bf16 v[144:159], v[52:55], a[204:207], v[144:159]
v_cvt_pk_bf16_f32 v225, v226, v227
ds_read_b64_tr_b16 v[62:63], v12 offset:4608
s_waitcnt lgkmcnt(2)
v_mfma_f32_32x32x16_bf16 v[128:143], v[56:59], a[208:211], v[128:143]
v_mul_f32 v228, v228, v40
v_mul_f32 v229, v229, v40
v_cvt_pk_bf16_f32 v226, v228, v229
ds_read_b64_tr_b16 v[48:49], v11 offset:8192
v_mfma_f32_16x16x32_bf16 v[44:47], v[20:23], v[56:59], v[44:47]
v_mul_f32 v230, v230, v40
v_mfma_f32_32x32x16_bf16 v[144:159], v[56:59], a[212:215], v[144:159]
v_mul_f32 v231, v231, v40
ds_read_b64_tr_b16 v[50:51], v11 offset:8704
s_waitcnt lgkmcnt(2)
v_mfma_f32_32x32x16_bf16 v[128:143], v[60:63], a[216:219], v[128:143]
v_cvt_pk_bf16_f32 v227, v230, v231
v_mul_f32 v232, v232, v40
v_mul_f32 v233, v233, v40
ds_read_b64_tr_b16 v[52:53], v12 offset:8192
v_mfma_f32_32x32x16_bf16 v[144:159], v[60:63], a[220:223], v[144:159]
v_cvt_pk_bf16_f32 v228, v232, v233
ds_read_b64_tr_b16 v[54:55], v12 offset:8704
s_waitcnt lgkmcnt(2)
v_mfma_f32_32x32x16_bf16 v[128:143], v[48:51], a[224:227], v[128:143]
v_mul_f32 v234, v234, v40
v_mul_f32 v235, v235, v40
v_cvt_pk_bf16_f32 v229, v234, v235
ds_read_b64_tr_b16 v[56:57], v11 offset:12288
v_mfma_f32_16x16x32_bf16 v[44:47], v[20:23], v[48:51], v[44:47]
v_mul_f32 v236, v236, v40
v_mfma_f32_32x32x16_bf16 v[144:159], v[48:51], a[228:231], v[144:159]
v_mul_f32 v237, v237, v40
ds_read_b64_tr_b16 v[58:59], v11 offset:12800
s_waitcnt lgkmcnt(2)
v_mfma_f32_32x32x16_bf16 v[128:143], v[52:55], a[232:235], v[128:143]
v_cvt_pk_bf16_f32 v230, v236, v237
v_mul_f32 v238, v238, v40
v_mul_f32 v239, v239, v40
ds_read_b64_tr_b16 v[60:61], v12 offset:12288
v_mfma_f32_32x32x16_bf16 v[144:159], v[52:55], a[236:239], v[144:159]
v_cvt_pk_bf16_f32 v231, v238, v239
ds_read_b64_tr_b16 v[62:63], v12 offset:12800
s_waitcnt lgkmcnt(2)
v_mfma_f32_32x32x16_bf16 v[128:143], v[56:59], a[240:243], v[128:143]
buffer_store_dwordx4 v[224:227], v16, s[24:27], s61 offen sc1
v_add_u32 v11, 0xc000, v11
v_add_u32 v12, 0xc000, v12
ds_read_b64_tr_b16 v[48:49], v11 offset:0
v_mfma_f32_16x16x32_bf16 v[44:47], v[20:23], v[56:59], v[44:47]
v_mfma_f32_32x32x16_bf16 v[144:159], v[56:59], a[244:247], v[144:159]
buffer_store_dwordx4 v[228:231], v16, s[24:27], s61 offen offset:1024 sc1
v_mul_f32 v240, v240, v41
ds_read_b64_tr_b16 v[50:51], v11 offset:512
s_waitcnt lgkmcnt(2)
v_mfma_f32_32x32x16_bf16 v[128:143], v[60:63], a[248:251], v[128:143]
v_mul_f32 v241, v241, v41
v_cvt_pk_bf16_f32 v240, v240, v241
ds_read_b64_tr_b16 v[52:53], v12 offset:0
v_mfma_f32_32x32x16_bf16 v[144:159], v[60:63], a[252:255], v[144:159]
v_mul_f32 v242, v242, v41
ds_read_b64_tr_b16 v[54:55], v12 offset:512
s_waitcnt vmcnt(18)
s_barrier
s_waitcnt lgkmcnt(2)
v_mfma_f32_32x32x16_bf16 v[128:143], v[48:51], v[64:67], v[128:143]
s_lshl_b32 s60, s67, 7
v_mul_f32 v243, v243, v41
ds_read_b64_tr_b16 v[56:57], v11 offset:4096
v_mfma_f32_16x16x32_bf16 v[44:47], v[20:23], v[48:51], v[44:47]
v_cvt_pk_bf16_f32 v241, v242, v243
v_mfma_f32_32x32x16_bf16 v[144:159], v[48:51], v[68:71], v[144:159]
s_add_u32 s60, s60, 0
v_mul_f32 v244, v244, v41
v_mul_f32 v245, v245, v41
ds_read_b64_tr_b16 v[58:59], v11 offset:4608
s_waitcnt lgkmcnt(2)
v_mfma_f32_32x32x16_bf16 v[128:143], v[52:55], v[72:75], v[128:143]
s_add_u32 m0, s59, 0
v_cvt_pk_bf16_f32 v242, v244, v245
v_mul_f32 v246, v246, v41
ds_read_b64_tr_b16 v[60:61], v12 offset:4096
v_mfma_f32_32x32x16_bf16 v[144:159], v[52:55], v[76:79], v[144:159]
v_mul_f32 v247, v247, v41
ds_read_b64_tr_b16 v[62:63], v12 offset:4608
s_waitcnt lgkmcnt(2)
v_mfma_f32_32x32x16_bf16 v[128:143], v[56:59], v[80:83], v[128:143]
v_cvt_pk_bf16_f32 v243, v246, v247
v_mul_f32 v248, v248, v41
v_mul_f32 v249, v249, v41
ds_read_b64_tr_b16 v[48:49], v11 offset:8192
v_mfma_f32_16x16x32_bf16 v[44:47], v[20:23], v[56:59], v[44:47]
buffer_load_dwordx4 v7, s[16:19], s60 offen offset:0  lds
v_mfma_f32_32x32x16_bf16 v[144:159], v[56:59], v[84:87], v[144:159]
v_cvt_pk_bf16_f32 v244, v248, v249
ds_read_b64_tr_b16 v[50:51], v11 offset:8704
s_waitcnt lgkmcnt(2)
v_mfma_f32_32x32x16_bf16 v[128:143], v[60:63], v[88:91], v[128:143]
v_mul_f32 v250, v250, v41
v_mul_f32 v251, v251, v41
v_cvt_pk_bf16_f32 v245, v250, v251
ds_read_b64_tr_b16 v[52:53], v12 offset:8192
v_mfma_f32_32x32x16_bf16 v[144:159], v[60:63], v[92:95], v[144:159]
buffer_load_dwordx4 v8, s[16:19], s60 offen offset:1024  lds
v_mul_f32 v252, v252, v41
ds_read_b64_tr_b16 v[54:55], v12 offset:8704
s_waitcnt lgkmcnt(2)
v_mfma_f32_32x32x16_bf16 v[128:143], v[48:51], v[96:99], v[128:143]
v_mul_f32 v253, v253, v41
v_cvt_pk_bf16_f32 v246, v252, v253
ds_read_b64_tr_b16 v[56:57], v11 offset:12288
v_mfma_f32_16x16x32_bf16 v[44:47], v[20:23], v[48:51], v[44:47]
v_mul_f32 v254, v254, v41
v_mfma_f32_32x32x16_bf16 v[144:159], v[48:51], v[100:103], v[144:159]
buffer_load_dwordx4 v9, s[16:19], s60 offen offset:2048  lds
v_mul_f32 v255, v255, v41
ds_read_b64_tr_b16 v[58:59], v11 offset:12800
s_waitcnt lgkmcnt(2)
v_mfma_f32_32x32x16_bf16 v[128:143], v[52:55], v[104:107], v[128:143]
v_cvt_pk_bf16_f32 v247, v254, v255
ds_read_b64_tr_b16 v[60:61], v12 offset:12288
v_mfma_f32_32x32x16_bf16 v[144:159], v[52:55], v[108:111], v[144:159]
buffer_store_dwordx4 v[240:243], v16, s[24:27], s62 offen sc1
ds_read_b64_tr_b16 v[62:63], v12 offset:12800
s_waitcnt lgkmcnt(2)
v_mfma_f32_32x32x16_bf16 v[128:143], v[56:59], v[112:115], v[128:143]
buffer_load_dwordx4 v10, s[16:19], s60 offen offset:3072  lds
buffer_store_dwordx4 v[244:247], v16, s[24:27], s62 offen offset:1024 sc1
v_add_u32 v11, 0x4000, v11
v_add_u32 v12, 0x4000, v12
ds_read_b64_tr_b16 v[48:49], v11 offset:0
v_mfma_f32_16x16x32_bf16 v[44:47], v[20:23], v[56:59], v[44:47]
v_mfma_f32_32x32x16_bf16 v[144:159], v[56:59], v[116:119], v[144:159]
ds_read_b64_tr_b16 v[50:51], v11 offset:512
s_waitcnt lgkmcnt(2)
v_mfma_f32_32x32x16_bf16 v[128:143], v[60:63], v[120:123], v[128:143]
ds_read_b64_tr_b16 v[52:53], v12 offset:0
s_nop 2
ds_write_b32 v18, v44 offset:512
ds_write_b32 v18, v45 offset:576
v_mfma_f32_32x32x16_bf16 v[144:159], v[60:63], v[124:127], v[144:159]
ds_read_b64_tr_b16 v[54:55], v12 offset:512
s_waitcnt vmcnt(20) lgkmcnt(1)
s_barrier
v_mfma_f32_32x32x16_bf16 v[160:175], v[48:51], a[0:3], 0
v_mul_u32_u24 v14, 3456, v15
s_lshl_b32 s97, s68, 7
buffer_load_dword v14, v14, s[20:23], s97 offen
ds_read_b64_tr_b16 v[56:57], v11 offset:4096
v_mfma_f32_16x16x32_bf16 v[44:47], v[20:23], v[48:51], 0
s_lshl_b32 s60, s67, 7
s_add_u32 s60, s60, 442368
v_mfma_f32_32x32x16_bf16 v[176:191], v[48:51], a[4:7], 0
s_add_u32 m0, s59, 49152
s_nop 0
buffer_load_dwordx4 v7, s[16:19], s60 offen offset:0  lds
ds_read_b64_tr_b16 v[58:59], v11 offset:4608
s_waitcnt lgkmcnt(2)
v_mfma_f32_32x32x16_bf16 v[160:175], v[52:55], a[8:11], v[160:175]
buffer_load_dwordx4 v8, s[16:19], s60 offen offset:1024  lds
buffer_load_dwordx4 v9, s[16:19], s60 offen offset:2048  lds
ds_read_b32 v38, v19 offset:512
ds_read_b64_tr_b16 v[60:61], v12 offset:4096
v_mfma_f32_32x32x16_bf16 v[176:191], v[52:55], a[12:15], v[176:191]
buffer_load_dwordx4 v10, s[16:19], s60 offen offset:3072  lds
s_sub_u32 s84, s2, 128
ds_read_b64_tr_b16 v[62:63], v12 offset:4608
s_waitcnt lgkmcnt(3)
v_mfma_f32_32x32x16_bf16 v[160:175], v[56:59], a[16:19], v[160:175]
s_lshr_b32 s84, s84, 3
s_lshl_b32 s84, s84, 2
s_add_u32 s84, s84, s42
s_add_u32 s84, s84, 0
ds_read_b64_tr_b16 v[48:49], v11 offset:8192
v_mfma_f32_16x16x32_bf16 v[44:47], v[20:23], v[56:59], v[44:47]
s_and_b32 s85, s2, 7
s_cmp_lt_u32 s84, 74
s_cselect_b32 s86, 0, 0x40000000
v_mfma_f32_32x32x16_bf16 v[176:191], v[56:59], a[20:23], v[176:191]
s_min_u32 s84, s84, 73
s_mul_i32 s87, s85, 160
ds_read_b32 v39, v19 offset:640
ds_read_b64_tr_b16 v[50:51], v11 offset:8704
s_waitcnt lgkmcnt(3)
v_mfma_f32_32x32x16_bf16 v[160:175], v[60:63], a[24:27], v[160:175]
s_lshr_b32 s88, s87, 7
s_lshl_b32 s88, s88, 7
s_sub_u32 s87, s87, s88
s_cmp_lt_u32 s84, 54
s_cselect_b32 s89, 0, 54
s_cselect_b32 s28, s28, s32
s_cselect_b32 s29, s29, s33
s_cselect_b32 s30, s30, s34
ds_read_b64_tr_b16 v[52:53], v12 offset:8192
v_mfma_f32_32x32x16_bf16 v[176:191], v[60:63], a[28:31], v[176:191]
s_waitcnt lgkmcnt(2)
ds_read_b64_tr_b16 v[54:55], v12 offset:8704
s_waitcnt lgkmcnt(2)
v_mfma_f32_32x32x16_bf16 v[160:175], v[48:51], a[32:35], v[160:175]
s_sub_u32 s89, s84, s89
s_mul_i32 s89, s89, 40960
s_add_u32 s89, s89, s88
v_add_f32 v38, v38, v39
ds_read_b64_tr_b16 v[56:57], v11 offset:12288
v_mfma_f32_16x16x32_bf16 v[44:47], v[20:23], v[48:51], v[44:47]
v_lshrrev_b32 v212, 4, v1
v_mfma_f32_32x32x16_bf16 v[176:191], v[48:51], a[36:39], v[176:191]
v_and_b32 v213, 15, v1
v_mul_u32_u24 v212, 1280, v212
v_lshl_add_u32 v212, v213, 4, v212
v_add_u32 v212, s86, v212
ds_read_b64_tr_b16 v[58:59], v11 offset:12800
s_waitcnt lgkmcnt(2)
v_mfma_f32_32x32x16_bf16 v[160:175], v[52:55], a[40:43], v[160:175]
s_lshl_b32 s88, s42, 13
s_add_u32 s88, s88, 114688
s_add_u32 m0, s88, 0
s_add_u32 s90, s89, 0
v_cvt_pk_bf16_f32 v39, v38, v38
ds_read_b64_tr_b16 v[60:61], v12 offset:12288
v_mfma_f32_32x32x16_bf16 v[176:191], v[52:55], a[44:47], v[176:191]
buffer_load_dwordx4 v212, s[28:31], s90 offen  lds
s_add_u32 m0, s88, 1024
ds_read_b64_tr_b16 v[62:63], v12 offset:12800
s_waitcnt lgkmcnt(2)
v_mfma_f32_32x32x16_bf16 v[160:175], v[56:59], a[48:51], v[160:175]
s_add_u32 s90, s89, 5120
buffer_load_dwordx4 v212, s[28:31], s90 offen  lds
v_add_u32 v11, 0xffff4000, v11
v_add_u32 v12, 0xffff4000, v12
ds_read_b64_tr_b16 v[48:49], v11 offset:0
v_mfma_f32_16x16x32_bf16 v[44:47], v[20:23], v[56:59], v[44:47]
s_add_u32 m0, s88, 2048
v_mfma_f32_32x32x16_bf16 v[176:191], v[56:59], a[52:55], v[176:191]
s_add_u32 s90, s89, 10240
buffer_load_dwordx4 v212, s[28:31], s90 offen  lds
ds_read_b64_tr_b16 v[50:51], v11 offset:512
s_waitcnt lgkmcnt(2)
v_mfma_f32_32x32x16_bf16 v[160:175], v[60:63], a[56:59], v[160:175]
v_lshlrev_b32 v39, 16, v39
v_sub_f32 v39, v38, v39
ds_read_b64_tr_b16 v[52:53], v12 offset:0
v_mfma_f32_32x32x16_bf16 v[176:191], v[60:63], a[60:63], v[176:191]
v_cvt_pk_bf16_f32 v24, v38, v39
ds_read_b64_tr_b16 v[54:55], v12 offset:512
s_waitcnt vmcnt(24)
s_barrier
s_waitcnt lgkmcnt(2)
v_mfma_f32_32x32x16_bf16 v[160:175], v[48:51], a[64:67], v[160:175]
s_lshl_b32 s60, s67, 7
s_add_u32 s60, s60, 884736
ds_read_b64_tr_b16 v[56:57], v11 offset:4096
v_mfma_f32_16x16x32_bf16 v[44:47], v[20:23], v[48:51], v[44:47]
v_mfma_f32_32x32x8bf16_1k v[128:143], v[24:25], v[26:27], v[128:143]
v_mfma_f32_32x32x16_bf16 v[176:191], v[48:51], a[68:71], v[176:191]
s_add_u32 m0, s59, 65536
ds_read_b64_tr_b16 v[58:59], v11 offset:4608
s_waitcnt lgkmcnt(2)
v_mfma_f32_32x32x16_bf16 v[160:175], v[52:55], a[72:75], v[160:175]
buffer_load_dwordx4 v7, s[16:19], s60 offen offset:0  lds
v_mfma_f32_32x32x8bf16_1k v[144:159], v[24:25], v[28:29], v[144:159]
ds_read_b64_tr_b16 v[60:61], v12 offset:4096
v_mfma_f32_32x32x16_bf16 v[176:191], v[52:55], a[76:79], v[176:191]
buffer_load_dwordx4 v8, s[16:19], s60 offen offset:1024  lds
ds_read_b64_tr_b16 v[62:63], v12 offset:4608
s_waitcnt lgkmcnt(2)
v_mfma_f32_32x32x16_bf16 v[160:175], v[56:59], a[80:83], v[160:175]
buffer_load_dwordx4 v9, s[16:19], s60 offen offset:2048  lds
s_cmp_lt_u32 s65, 10
s_cselect_b32 s63, 0x3ea52b5c, 1.0
ds_read_b64_tr_b16 v[48:49], v11 offset:8192
v_mfma_f32_16x16x32_bf16 v[44:47], v[20:23], v[56:59], v[44:47]
v_mfma_f32_32x32x16_bf16 v[176:191], v[56:59], a[84:87], v[176:191]
buffer_load_dwordx4 v10, s[16:19], s60 offen offset:3072  lds
ds_read_b64_tr_b16 v[50:51], v11 offset:8704
s_waitcnt lgkmcnt(2)
v_mfma_f32_32x32x16_bf16 v[160:175], v[60:63], a[88:91], v[160:175]
s_add_u32 m0, s88, 3072
s_lshl_b32 s52, s65, 12
ds_read_b64_tr_b16 v[52:53], v12 offset:8192
v_mfma_f32_32x32x16_bf16 v[176:191], v[60:63], a[92:95], v[176:191]
s_add_u32 s90, s89, 15360
s_lshl_b32 s53, s44, 11
ds_read_b64_tr_b16 v[54:55], v12 offset:8704
s_waitcnt lgkmcnt(2)
v_mfma_f32_32x32x16_bf16 v[160:175], v[48:51], a[96:99], v[160:175]
buffer_load_dwordx4 v212, s[28:31], s90 offen  lds
s_add_u32 s52, s52, s53
ds_read_b64_tr_b16 v[56:57], v11 offset:12288
v_mfma_f32_16x16x32_bf16 v[44:47], v[20:23], v[48:51], v[44:47]
s_add_u32 m0, s88, 4096
v_mfma_f32_32x32x16_bf16 v[176:191], v[48:51], a[100:103], v[176:191]
s_add_u32 s90, s89, 20480
s_mul_i32 s53, s55, 122880
ds_read_b64_tr_b16 v[58:59], v11 offset:12800
s_waitcnt lgkmcnt(2)
v_mfma_f32_32x32x16_bf16 v[160:175], v[52:55], a[104:107], v[160:175]
buffer_load_dwordx4 v212, s[28:31], s90 offen  lds
s_add_u32 s61, s52, s53
ds_read_b64_tr_b16 v[60:61], v12 offset:12288
v_mfma_f32_32x32x16_bf16 v[176:191], v[52:55], a[108:111], v[176:191]
s_add_u32 m0, s88, 5120
s_mul_i32 s53, s56, 122880
ds_read_b64_tr_b16 v[62:63], v12 offset:12800
s_waitcnt lgkmcnt(2)
v_mfma_f32_32x32x16_bf16 v[160:175], v[56:59], a[112:115], v[160:175]
s_add_u32 s90, s89, 25600
s_add_u32 s62, s52, s53
v_add_u32 v11, 0x10000, v11
v_add_u32 v12, 0x10000, v12
ds_read_b64_tr_b16 v[48:49], v11 offset:0
v_mfma_f32_16x16x32_bf16 v[44:47], v[20:23], v[56:59], v[44:47]
v_mfma_f32_32x32x16_bf16 v[176:191], v[56:59], a[116:119], v[176:191]
buffer_load_dwordx4 v212, s[28:31], s90 offen  lds
v_mul_f32 v40, s63, v30
ds_read_b64_tr_b16 v[50:51], v11 offset:512
s_waitcnt lgkmcnt(2)
v_mfma_f32_32x32x16_bf16 v[160:175], v[60:63], a[120:123], v[160:175]
v_mul_f32 v41, s63, v31
v_mul_f32 v128, v128, v40
ds_read_b64_tr_b16 v[52:53], v12 offset:0
v_mfma_f32_32x32x16_bf16 v[176:191], v[60:63], a[124:127], v[176:191]
ds_read_b64_tr_b16 v[54:55], v12 offset:512
s_waitcnt vmcnt(27)
s_barrier
s_waitcnt lgkmcnt(2)
v_mfma_f32_32x32x16_bf16 v[160:175], v[48:51], a[128:131], v[160:175]
s_lshl_b32 s60, s67, 7
v_mul_f32 v129, v129, v40
ds_read_b64_tr_b16 v[56:57], v11 offset:4096
v_mfma_f32_16x16x32_bf16 v[44:47], v[20:23], v[48:51], v[44:47]
s_add_u32 s60, s60, 1327104
v_cvt_pk_bf16_f32 v128, v128, v129
v_mfma_f32_32x32x16_bf16 v[176:191], v[48:51], a[132:135], v[176:191]
s_add_u32 m0, s59, 16384
v_mul_f32 v130, v130, v40
ds_read_b64_tr_b16 v[58:59], v11 offset:4608
s_waitcnt lgkmcnt(2)
v_mfma_f32_32x32x16_bf16 v[160:175], v[52:55], a[136:139], v[160:175]
buffer_load_dwordx4 v7, s[16:19], s60 offen offset:0  lds
v_mul_f32 v131, v131, v40
ds_read_b64_tr_b16 v[60:61], v12 offset:4096
v_mfma_f32_32x32x16_bf16 v[176:191], v[52:55], a[140:143], v[176:191]
v_cvt_pk_bf16_f32 v129, v130, v131
ds_read_b64_tr_b16 v[62:63], v12 offset:4608
s_waitcnt lgkmcnt(2)
v_mfma_f32_32x32x16_bf16 v[160:175], v[56:59], a[144:147], v[160:175]
buffer_load_dwordx4 v8, s[16:19], s60 offen offset:1024  lds
v_mul_f32 v132, v132, v40
ds_read_b64_tr_b16 v[48:49], v11 offset:8192
v_mfma_f32_16x16x32_bf16 v[44:47], v[20:23], v[56:59], v[44:47]
v_mfma_f32_32x32x16_bf16 v[176:191], v[56:59], a[148:151], v[176:191]
buffer_load_dwordx4 v9, s[16:19], s60 offen offset:2048  lds
v_mul_f32 v133, v133, v40
ds_read_b64_tr_b16 v[50:51], v11 offset:8704
s_waitcnt lgkmcnt(2)
v_mfma_f32_32x32x16_bf16 v[160:175], v[60:63], a[152:155], v[160:175]
v_cvt_pk_bf16_f32 v130, v132, v133
v_mul_f32 v134, v134, v40
ds_read_b64_tr_b16 v[52:53], v12 offset:8192
v_mfma_f32_32x32x16_bf16 v[176:191], v[60:63], a[156:159], v[176:191]
buffer_load_dwordx4 v10, s[16:19], s60 offen offset:3072  lds
ds_read_b64_tr_b16 v[54:55], v12 offset:8704
s_waitcnt lgkmcnt(2)
v_mfma_f32_32x32x16_bf16 v[160:175], v[48:51], a[160:163], v[160:175]
s_add_u32 m0, s88, 6144
v_mul_f32 v135, v135, v40
ds_read_b64_tr_b16 v[56:57], v11 offset:12288
v_mfma_f32_16x16x32_bf16 v[44:47], v[20:23], v[48:51], v[44:47]
s_add_u32 s90, s89, 30720
v_cvt_pk_bf16_f32 v131, v134, v135
v_mfma_f32_32x32x16_bf16 v[176:191], v[48:51], a[164:167], v[176:191]
buffer_load_dwordx4 v212, s[28:31], s90 offen  lds
ds_read_b64_tr_b16 v[58:59], v11 offset:12800
s_waitcnt lgkmcnt(2)
v_mfma_f32_32x32x16_bf16 v[160:175], v[52:55], a[168:171], v[160:175]
v_mul_f32 v136, v136, v40
v_mul_f32 v137, v137, v40
ds_read_b64_tr_b16 v[60:61], v12 offset:12288
v_mfma_f32_32x32x16_bf16 v[176:191], v[52:55], a[172:175], v[176:191]
s_add_u32 m0, s88, 7168
s_add_u32 s90, s89, 35840
v_cvt_pk_bf16_f32 v132, v136, v137
ds_read_b64_tr_b16 v[62:63], v12 offset:12800
s_waitcnt lgkmcnt(2)
v_mfma_f32_32x32x16_bf16 v[160:175], v[56:59], a[176:179], v[160:175]
v_mul_f32 v138, v138, v40
v_add_u32 v11, 0x4000, v11
v_add_u32 v12, 0x4000, v12
ds_read_b64_tr_b16 v[48:49], v11 offset:0
v_mfma_f32_16x16x32_bf16 v[44:47], v[20:23], v[56:59], v[44:47]
v_mfma_f32_32x32x16_bf16 v[176:191], v[56:59], a[180:183], v[176:191]
buffer_load_dwordx4 v212, s[28:31], s90 offen  lds
v_mul_f32 v139, v139, v40
ds_read_b64_tr_b16 v[50:51], v11 offset:512
s_waitcnt lgkmcnt(2)
v_mfma_f32_32x32x16_bf16 v[160:175], v[60:63], a[184:187], v[160:175]
v_cvt_pk_bf16_f32 v133, v138, v139
ds_read_b64_tr_b16 v[52:53], v12 offset:0
v_mfma_f32_32x32x16_bf16 v[176:191], v[60:63], a[188:191], v[176:191]
v_mul_f32 v140, v140, v40
ds_read_b64_tr_b16 v[54:55], v12 offset:512
s_waitcnt vmcnt(29)
s_barrier
s_waitcnt lgkmcnt(2)
v_mfma_f32_32x32x16_bf16 v[160:175], v[48:51], a[192:195], v[160:175]
s_lshl_b32 s60, s67, 7
v_mul_f32 v141, v141, v40
ds_read_b64_tr_b16 v[56:57], v11 offset:4096
v_mfma_f32_16x16x32_bf16 v[44:47], v[20:23], v[48:51], v[44:47]
v_cvt_pk_bf16_f32 v134, v140, v141
v_mfma_f32_32x32x16_bf16 v[176:191], v[48:51], a[196:199], v[176:191]
s_add_u32 s60, s60, 1769472
v_mul_f32 v142, v142, v40
ds_read_b64_tr_b16 v[58:59], v11 offset:4608
s_waitcnt lgkmcnt(2)
v_mfma_f32_32x32x16_bf16 v[160:175], v[52:55], a[200:203], v[160:175]
s_add_u32 m0, s59, 81920
v_mul_f32 v143, v143, v40
ds_read_b64_tr_b16 v[60:61], v12 offset:4096
v_mfma_f32_32x32x16_bf16 v[176:191], v[52:55], a[204:207], v[176:191]
v_cvt_pk_bf16_f32 v135, v142, v143
ds_read_b64_tr_b16 v[62:63], v12 offset:4608
s_waitcnt lgkmcnt(2)
v_mfma_f32_32x32x16_bf16 v[160:175], v[56:59], a[208:211], v[160:175]
buffer_store_dwordx4 v[128:131], v16, s[24:27], s61 offen sc1
ds_read_b64_tr_b16 v[48:49], v11 offset:8192
v_mfma_f32_16x16x32_bf16 v[44:47], v[20:23], v[56:59], v[44:47]
buffer_load_dwordx4 v7, s[16:19], s60 offen offset:0  lds
v_mfma_f32_32x32x16_bf16 v[176:191], v[56:59], a[212:215], v[176:191]
buffer_store_dwordx4 v[132:135], v16, s[24:27], s61 offen offset:1024 sc1
ds_read_b64_tr_b16 v[50:51], v11 offset:8704
s_waitcnt lgkmcnt(2)
v_mfma_f32_32x32x16_bf16 v[160:175], v[60:63], a[216:219], v[160:175]
v_mul_f32 v144, v144, v41
ds_read_b64_tr_b16 v[52:53], v12 offset:8192
v_mfma_f32_32x32x16_bf16 v[176:191], v[60:63], a[220:223], v[176:191]
buffer_load_dwordx4 v8, s[16:19], s60 offen offset:1024  lds
ds_read_b64_tr_b16 v[54:55], v12 offset:8704
s_waitcnt lgkmcnt(2)
v_mfma_f32_32x32x16_bf16 v[160:175], v[48:51], a[224:227], v[160:175]
v_mul_f32 v145, v145, v41
v_cvt_pk_bf16_f32 v144, v144, v145
ds_read_b64_tr_b16 v[56:57], v11 offset:12288
v_mfma_f32_16x16x32_bf16 v[44:47], v[20:23], v[48:51], v[44:47]
v_mfma_f32_32x32x16_bf16 v[176:191], v[48:51], a[228:231], v[176:191]
buffer_load_dwordx4 v9, s[16:19], s60 offen offset:2048  lds
v_mul_f32 v146, v146, v41
ds_read_b64_tr_b16 v[58:59], v11 offset:12800
s_waitcnt lgkmcnt(2)
v_mfma_f32_32x32x16_bf16 v[160:175], v[52:55], a[232:235], v[160:175]
v_mul_f32 v147, v147, v41
v_cvt_pk_bf16_f32 v145, v146, v147
ds_read_b64_tr_b16 v[60:61], v12 offset:12288
v_mfma_f32_32x32x16_bf16 v[176:191], v[52:55], a[236:239], v[176:191]
v_mul_f32 v148, v148, v41
ds_read_b64_tr_b16 v[62:63], v12 offset:12800
s_waitcnt lgkmcnt(2)
v_mfma_f32_32x32x16_bf16 v[160:175], v[56:59], a[240:243], v[160:175]
buffer_load_dwordx4 v10, s[16:19], s60 offen offset:3072  lds
v_add_u32 v11, 0xffff0000, v11
v_add_u32 v12, 0xffff0000, v12
ds_read_b64_tr_b16 v[48:49], v11 offset:0
v_mfma_f32_16x16x32_bf16 v[44:47], v[20:23], v[56:59], v[44:47]
v_mul_f32 v149, v149, v41
v_mfma_f32_32x32x16_bf16 v[176:191], v[56:59], a[244:247], v[176:191]
v_cvt_pk_bf16_f32 v146, v148, v149
ds_read_b64_tr_b16 v[50:51], v11 offset:512
s_waitcnt lgkmcnt(2)
v_mfma_f32_32x32x16_bf16 v[160:175], v[60:63], a[248:251], v[160:175]
v_mul_f32 v150, v150, v41
v_mul_f32 v151, v151, v41
ds_read_b64_tr_b16 v[52:53], v12 offset:0
v_mfma_f32_32x32x16_bf16 v[176:191], v[60:63], a[252:255], v[176:191]
ds_read_b64_tr_b16 v[54:55], v12 offset:512
s_waitcnt vmcnt(28)
s_barrier
s_waitcnt lgkmcnt(2)
v_mfma_f32_32x32x16_bf16 v[160:175], v[48:51], v[64:67], v[160:175]
s_lshl_b32 s60, s68, 7
v_cvt_pk_bf16_f32 v147, v150, v151
ds_read_b64_tr_b16 v[56:57], v11 offset:4096
v_mfma_f32_16x16x32_bf16 v[44:47], v[20:23], v[48:51], v[44:47]
v_mul_f32 v152, v152, v41
v_mfma_f32_32x32x16_bf16 v[176:191], v[48:51], v[68:71], v[176:191]
s_add_u32 s60, s60, 0
v_mul_f32 v153, v153, v41
ds_read_b64_tr_b16 v[58:59], v11 offset:4608
s_waitcnt lgkmcnt(2)
v_mfma_f32_32x32x16_bf16 v[160:175], v[52:55], v[72:75], v[160:175]
s_add_u32 m0, s59, 98304
v_cvt_pk_bf16_f32 v148, v152, v153
ds_read_b64_tr_b16 v[60:61], v12 offset:4096
v_mfma_f32_32x32x16_bf16 v[176:191], v[52:55], v[76:79], v[176:191]
v_mul_f32 v154, v154, v41
ds_read_b64_tr_b16 v[62:63], v12 offset:4608
s_waitcnt lgkmcnt(2)
v_mfma_f32_32x32x16_bf16 v[160:175], v[56:59], v[80:83], v[160:175]
v_mul_f32 v155, v155, v41
v_cvt_pk_bf16_f32 v149, v154, v155
ds_read_b64_tr_b16 v[48:49], v11 offset:8192
v_mfma_f32_16x16x32_bf16 v[44:47], v[20:23], v[56:59], v[44:47]
buffer_load_dwordx4 v7, s[20:23], s60 offen offset:0  lds
v_mfma_f32_32x32x16_bf16 v[176:191], v[56:59], v[84:87], v[176:191]
v_mul_f32 v156, v156, v41
ds_read_b64_tr_b16 v[50:51], v11 offset:8704
s_waitcnt lgkmcnt(2)
v_mfma_f32_32x32x16_bf16 v[160:175], v[60:63], v[88:91], v[160:175]
v_mul_f32 v157, v157, v41
v_cvt_pk_bf16_f32 v150, v156, v157
ds_read_b64_tr_b16 v[52:53], v12 offset:8192
v_mfma_f32_32x32x16_bf16 v[176:191], v[60:63], v[92:95], v[176:191]
buffer_load_dwordx4 v8, s[20:23], s60 offen offset:1024  lds
ds_read_b64_tr_b16 v[54:55], v12 offset:8704
s_waitcnt lgkmcnt(2)
v_mfma_f32_32x32x16_bf16 v[160:175], v[48:51], v[96:99], v[160:175]
v_mul_f32 v158, v158, v41
v_mul_f32 v159, v159, v41
ds_read_b64_tr_b16 v[56:57], v11 offset:12288
v_mfma_f32_16x16x32_bf16 v[44:47], v[20:23], v[48:51], v[44:47]
v_cvt_pk_bf16_f32 v151, v158, v159
v_mfma_f32_32x32x16_bf16 v[176:191], v[48:51], v[100:103], v[176:191]
buffer_load_dwordx4 v9, s[20:23], s60 offen offset:2048  lds
ds_read_b64_tr_b16 v[58:59], v11 offset:12800
s_waitcnt lgkmcnt(2)
v_mfma_f32_32x32x16_bf16 v[160:175], v[52:55], v[104:107], v[160:175]
buffer_store_dwordx4 v[144:147], v16, s[24:27], s62 offen sc1
ds_read_b64_tr_b16 v[60:61], v12 offset:12288
v_mfma_f32_32x32x16_bf16 v[176:191], v[52:55], v[108:111], v[176:191]
buffer_store_dwordx4 v[148:151], v16, s[24:27], s62 offen offset:1024 sc1
ds_read_b64_tr_b16 v[62:63], v12 offset:12800
s_waitcnt lgkmcnt(2)
v_mfma_f32_32x32x16_bf16 v[160:175], v[56:59], v[112:115], v[160:175]
buffer_load_dwordx4 v10, s[20:23], s60 offen offset:3072  lds
v_add_u32 v11, 0xffff8000, v11
v_add_u32 v12, 0xffff8000, v12
ds_read_b64_tr_b16 v[48:49], v11 offset:0
v_mfma_f32_16x16x32_bf16 v[44:47], v[20:23], v[56:59], v[44:47]
v_mfma_f32_32x32x16_bf16 v[176:191], v[56:59], v[116:119], v[176:191]
ds_read_b64_tr_b16 v[50:51], v11 offset:512
s_waitcnt lgkmcnt(2)
v_mfma_f32_32x32x16_bf16 v[160:175], v[60:63], v[120:123], v[160:175]
ds_read_b64_tr_b16 v[52:53], v12 offset:0
s_nop 2
ds_write_b32 v18, v44 offset:0
ds_write_b32 v18, v45 offset:64
v_mfma_f32_32x32x16_bf16 v[176:191], v[60:63], v[124:127], v[176:191]
ds_read_b64_tr_b16 v[54:55], v12 offset:512
s_waitcnt vmcnt(28) lgkmcnt(1)
s_barrier
v_mfma_f32_32x32x16_bf16 v[128:143], v[48:51], a[0:3], 0
s_lshl_b32 s60, s68, 7
ds_read_b64_tr_b16 v[56:57], v11 offset:4096
v_mfma_f32_16x16x32_bf16 v[44:47], v[20:23], v[48:51], 0
v_mfma_f32_32x32x16_bf16 v[144:159], v[48:51], a[4:7], 0
s_add_u32 s60, s60, 442368
v_lshrrev_b32 v212, 4, v1
ds_read_b32 v38, v19 offset:0
ds_read_b64_tr_b16 v[58:59], v11 offset:4608
s_waitcnt lgkmcnt(3)
v_mfma_f32_32x32x16_bf16 v[128:143], v[52:55], a[8:11], v[128:143]
s_add_u32 m0, s59, 32768
v_bfe_u32 v213, v1, 2, 2
ds_read_b32 v39, v19 offset:128
ds_read_b64_tr_b16 v[60:61], v12 offset:4096
v_mfma_f32_32x32x16_bf16 v[144:159], v[52:55], a[12:15], v[144:159]
v_lshl_add_u32 v212, v212, 3, v213
s_waitcnt lgkmcnt(1)
ds_read_b64_tr_b16 v[62:63], v12 offset:4608
v_mfma_f32_32x32x16_bf16 v[128:143], v[56:59], a[16:19], v[128:143]
v_lshlrev_b32 v212, 8, v212
v_and_b32 v213, 3, v1
v_add_f32 v38, v38, v39
ds_read_b64_tr_b16 v[48:49], v11 offset:8192
v_mfma_f32_16x16x32_bf16 v[44:47], v[20:23], v[56:59], v[44:47]
buffer_load_dwordx4 v7, s[20:23], s60 offen offset:0  lds
v_mfma_f32_32x32x16_bf16 v[144:159], v[56:59], a[20:23], v[144:159]
v_mul_u32_u24 v213, 40, v213
v_cvt_pk_bf16_f32 v39, v38, v38
ds_read_b64_tr_b16 v[50:51], v11 offset:8704
s_waitcnt lgkmcnt(2)
v_mfma_f32_32x32x16_bf16 v[128:143], v[60:63], a[24:27], v[128:143]
v_add_u32 v212, v212, v213
s_add_u32 s88, s88, s87
v_lshlrev_b32 v39, 16, v39
ds_read_b64_tr_b16 v[52:53], v12 offset:8192
v_mfma_f32_32x32x16_bf16 v[144:159], v[60:63], a[28:31], v[144:159]
buffer_load_dwordx4 v8, s[20:23], s60 offen offset:1024  lds
v_sub_f32 v39, v38, v39
ds_read_b64_tr_b16 v[54:55], v12 offset:8704
s_waitcnt lgkmcnt(2)
v_mfma_f32_32x32x16_bf16 v[128:143], v[48:51], a[32:35], v[128:143]
v_add_u32 v212, s88, v212
s_mul_i32 s89, s85, 74
v_cvt_pk_bf16_f32 v24, v38, v39
ds_read_b64_tr_b16 v[56:57], v11 offset:12288
v_mfma_f32_16x16x32_bf16 v[44:47], v[20:23], v[48:51], v[44:47]
s_add_u32 s89, s89, s84
v_mfma_f32_32x32x16_bf16 v[144:159], v[48:51], a[36:39], v[144:159]
buffer_load_dwordx4 v9, s[20:23], s60 offen offset:2048  lds
ds_read_b64_tr_b16 v[58:59], v11 offset:12800
s_waitcnt lgkmcnt(2)
v_mfma_f32_32x32x16_bf16 v[128:143], v[52:55], a[40:43], v[128:143]
s_mul_i32 s89, s89, 5120
s_add_u32 s89, s89, 20971520
v_mfma_f32_32x32x8bf16_1k v[160:175], v[24:25], v[26:27], v[160:175]
ds_read_b64_tr_b16 v[60:61], v12 offset:12288
v_mfma_f32_32x32x16_bf16 v[144:159], v[52:55], a[44:47], v[144:159]
v_lshlrev_b32 v213, 4, v1
v_mfma_f32_32x32x8bf16_1k v[176:191], v[24:25], v[28:29], v[176:191]
ds_read_b64_tr_b16 v[62:63], v12 offset:12800
s_waitcnt lgkmcnt(2)
v_mfma_f32_32x32x16_bf16 v[128:143], v[56:59], a[48:51], v[128:143]
buffer_load_dwordx4 v10, s[20:23], s60 offen offset:3072  lds
v_add_u32 v11, 0xc000, v11
v_add_u32 v12, 0xc000, v12
ds_read_b64_tr_b16 v[48:49], v11 offset:0
v_mfma_f32_16x16x32_bf16 v[44:47], v[20:23], v[56:59], v[44:47]
v_add_u32 v213, s86, v213
v_mfma_f32_32x32x16_bf16 v[144:159], v[56:59], a[52:55], v[144:159]
s_waitcnt vmcnt(16)
s_cmp_lt_u32 s66, 10
s_cselect_b32 s63, 0x3ea52b5c, 1.0
ds_read_b64_tr_b16 v[50:51], v11 offset:512
s_waitcnt lgkmcnt(2)
v_mfma_f32_32x32x16_bf16 v[128:143], v[60:63], a[56:59], v[128:143]
ds_read_b64_tr_b16 v[192:193], v212 offset:0
ds_read_b64_tr_b16 v[194:195], v212 offset:1024
ds_read_b64_tr_b16 v[52:53], v12 offset:0
v_mfma_f32_32x32x16_bf16 v[144:159], v[60:63], a[60:63], v[144:159]
s_lshl_b32 s52, s66, 12
ds_read_b64_tr_b16 v[54:55], v12 offset:512
s_barrier
s_waitcnt lgkmcnt(4)
v_mfma_f32_32x32x16_bf16 v[128:143], v[48:51], a[64:67], v[128:143]
s_lshl_b32 s60, s68, 7
ds_read_b64_tr_b16 v[196:197], v212 offset:8
ds_read_b64_tr_b16 v[198:199], v212 offset:1032
ds_read_b64_tr_b16 v[56:57], v11 offset:4096
v_mfma_f32_16x16x32_bf16 v[44:47], v[20:23], v[48:51], v[44:47]
s_lshl_b32 s53, s44, 11
v_mfma_f32_32x32x16_bf16 v[144:159], v[48:51], a[68:71], v[144:159]
s_add_u32 s60, s60, 884736
ds_read_b64_tr_b16 v[200:201], v212 offset:16
s_add_u32 s52, s52, s53
ds_read_b64_tr_b16 v[58:59], v11 offset:4608
s_waitcnt lgkmcnt(5)
v_mfma_f32_32x32x16_bf16 v[128:143], v[52:55], a[72:75], v[128:143]
s_add_u32 m0, s59, 0
ds_read_b64_tr_b16 v[202:203], v212 offset:1040
s_mul_i32 s53, s55, 122880
ds_read_b64_tr_b16 v[60:61], v12 offset:4096
v_mfma_f32_32x32x16_bf16 v[144:159], v[52:55], a[76:79], v[144:159]
ds_read_b64_tr_b16 v[204:205], v212 offset:24
ds_read_b64_tr_b16 v[206:207], v212 offset:1048
s_add_u32 s61, s52, s53
ds_read_b64_tr_b16 v[62:63], v12 offset:4608
s_waitcnt lgkmcnt(5)
v_mfma_f32_32x32x16_bf16 v[128:143], v[56:59], a[80:83], v[128:143]
ds_read_b64_tr_b16 v[208:209], v212 offset:32
s_mul_i32 s53, s56, 122880
ds_read_b64_tr_b16 v[48:49], v11 offset:8192
v_mfma_f32_16x16x32_bf16 v[44:47], v[20:23], v[56:59], v[44:47]
buffer_load_dwordx4 v7, s[20:23], s60 offen offset:0  lds
v_mfma_f32_32x32x16_bf16 v[144:159], v[56:59], a[84:87], v[144:159]
ds_read_b64_tr_b16 v[210:211], v212 offset:1056
s_add_u32 s62, s52, s53
ds_read_b64_tr_b16 v[50:51], v11 offset:8704
s_waitcnt lgkmcnt(4)
v_mfma_f32_32x32x16_bf16 v[128:143], v[60:63], a[88:91], v[128:143]
s_waitcnt lgkmcnt(1)
buffer_store_dwordx4 v[192:195], v213, s[24:27], s89 offen offset:0 sc1
v_mul_f32 v40, s63, v30
ds_read_b64_tr_b16 v[52:53], v12 offset:8192
v_mfma_f32_32x32x16_bf16 v[144:159], v[60:63], a[92:95], v[144:159]
buffer_load_dwordx4 v8, s[20:23], s60 offen offset:1024  lds
ds_read_b64_tr_b16 v[54:55], v12 offset:8704
s_waitcnt lgkmcnt(2)
v_mfma_f32_32x32x16_bf16 v[128:143], v[48:51], a[96:99], v[128:143]
buffer_store_dwordx4 v[196:199], v213, s[24:27], s89 offen offset:1024 sc1
v_mul_f32 v41, s63, v31
v_mul_f32 v160, v160, v40
ds_read_b64_tr_b16 v[56:57], v11 offset:12288
v_mfma_f32_16x16x32_bf16 v[44:47], v[20:23], v[48:51], v[44:47]
v_mfma_f32_32x32x16_bf16 v[144:159], v[48:51], a[100:103], v[144:159]
buffer_load_dwordx4 v9, s[20:23], s60 offen offset:2048  lds
v_mul_f32 v161, v161, v40
ds_read_b64_tr_b16 v[58:59], v11 offset:12800
s_waitcnt lgkmcnt(2)
v_mfma_f32_32x32x16_bf16 v[128:143], v[52:55], a[104:107], v[128:143]
buffer_store_dwordx4 v[200:203], v213, s[24:27], s89 offen offset:2048 sc1
v_cvt_pk_bf16_f32 v160, v160, v161
ds_read_b64_tr_b16 v[60:61], v12 offset:12288
v_mfma_f32_32x32x16_bf16 v[144:159], v[52:55], a[108:111], v[144:159]
buffer_store_dwordx4 v[204:207], v213, s[24:27], s89 offen offset:3072 sc1
v_mul_f32 v162, v162, v40
ds_read_b64_tr_b16 v[62:63], v12 offset:12800
s_waitcnt lgkmcnt(2)
v_mfma_f32_32x32x16_bf16 v[128:143], v[56:59], a[112:115], v[128:143]
buffer_load_dwordx4 v10, s[20:23], s60 offen offset:3072  lds
v_add_u32 v11, 0x4000, v11
v_add_u32 v12, 0x4000, v12
ds_read_b64_tr_b16 v[48:49], v11 offset:0
v_mfma_f32_16x16x32_bf16 v[44:47], v[20:23], v[56:59], v[44:47]
v_mul_f32 v163, v163, v40
v_mfma_f32_32x32x16_bf16 v[144:159], v[56:59], a[116:119], v[144:159]
s_add_u32 s89, s89, 4096
v_cvt_pk_bf16_f32 v161, v162, v163
ds_read_b64_tr_b16 v[50:51], v11 offset:512
s_waitcnt lgkmcnt(2)
v_mfma_f32_32x32x16_bf16 v[128:143], v[60:63], a[120:123], v[128:143]
buffer_store_dwordx4 v[208:211], v213, s[24:27], s89 offen offset:0 sc1
v_mul_f32 v164, v164, v40
ds_read_b64_tr_b16 v[52:53], v12 offset:0
v_mfma_f32_32x32x16_bf16 v[144:159], v[60:63], a[124:127], v[144:159]
v_mul_f32 v165, v165, v40
ds_read_b64_tr_b16 v[54:55], v12 offset:512
s_barrier
s_waitcnt lgkmcnt(2)
v_mfma_f32_32x32x16_bf16 v[128:143], v[48:51], a[128:131], v[128:143]
s_lshl_b32 s60, s68, 7
s_add_u32 s60, s60, 1327104
s_add_u32 m0, s59, 49152
ds_read_b64_tr_b16 v[56:57], v11 offset:4096
v_mfma_f32_16x16x32_bf16 v[44:47], v[20:23], v[48:51], v[44:47]
buffer_load_dwordx4 v7, s[20:23], s60 offen offset:0  lds
v_mfma_f32_32x32x16_bf16 v[144:159], v[48:51], a[132:135], v[144:159]
buffer_load_dwordx4 v8, s[20:23], s60 offen offset:1024  lds
buffer_load_dwordx4 v9, s[20:23], s60 offen offset:2048  lds
ds_read_b64_tr_b16 v[58:59], v11 offset:4608
s_waitcnt lgkmcnt(2)
v_mfma_f32_32x32x16_bf16 v[128:143], v[52:55], a[136:139], v[128:143]
buffer_load_dwordx4 v10, s[20:23], s60 offen offset:3072  lds
s_sub_u32 s84, s2, 128
v_cvt_pk_bf16_f32 v162, v164, v165
ds_read_b64_tr_b16 v[60:61], v12 offset:4096
v_mfma_f32_32x32x16_bf16 v[144:159], v[52:55], a[140:143], v[144:159]
s_lshr_b32 s84, s84, 3
s_lshl_b32 s84, s84, 2
s_add_u32 s84, s84, s42
ds_read_b64_tr_b16 v[62:63], v12 offset:4608
s_waitcnt lgkmcnt(2)
v_mfma_f32_32x32x16_bf16 v[128:143], v[56:59], a[144:147], v[128:143]
s_add_u32 s84, s84, 64
s_and_b32 s85, s2, 7
s_cmp_lt_u32 s84, 74
s_cselect_b32 s86, 0, 0x40000000
v_mul_f32 v166, v166, v40
ds_read_b64_tr_b16 v[48:49], v11 offset:8192
v_mfma_f32_16x16x32_bf16 v[44:47], v[20:23], v[56:59], v[44:47]
s_min_u32 s84, s84, 73
v_mfma_f32_32x32x16_bf16 v[144:159], v[56:59], a[148:151], v[144:159]
s_mul_i32 s87, s85, 160
s_lshr_b32 s88, s87, 7
s_lshl_b32 s88, s88, 7
v_mul_f32 v167, v167, v40
ds_read_b64_tr_b16 v[50:51], v11 offset:8704
s_waitcnt lgkmcnt(2)
v_mfma_f32_32x32x16_bf16 v[128:143], v[60:63], a[152:155], v[128:143]
s_sub_u32 s87, s87, s88
s_cmp_lt_u32 s84, 54
s_cselect_b32 s89, 0, 54
s_cselect_b32 s28, s28, s32
s_cselect_b32 s29, s29, s33
s_cselect_b32 s30, s30, s34
ds_read_b64_tr_b16 v[52:53], v12 offset:8192
v_mfma_f32_32x32x16_bf16 v[144:159], v[60:63], a[156:159], v[144:159]
s_sub_u32 s89, s84, s89
v_cvt_pk_bf16_f32 v163, v166, v167
ds_read_b64_tr_b16 v[54:55], v12 offset:8704
s_waitcnt lgkmcnt(2)
v_mfma_f32_32x32x16_bf16 v[128:143], v[48:51], a[160:163], v[128:143]
s_mul_i32 s89, s89, 40960
s_add_u32 s89, s89, s88
v_lshrrev_b32 v212, 4, v1
ds_read_b64_tr_b16 v[56:57], v11 offset:12288
v_mfma_f32_16x16x32_bf16 v[44:47], v[20:23], v[48:51], v[44:47]
v_and_b32 v213, 15, v1
v_mul_u32_u24 v212, 1280, v212
v_mfma_f32_32x32x16_bf16 v[144:159], v[48:51], a[164:167], v[144:159]
v_lshl_add_u32 v212, v213, 4, v212
v_add_u32 v212, s86, v212
s_lshl_b32 s88, s42, 13
v_mul_f32 v168, v168, v40
ds_read_b64_tr_b16 v[58:59], v11 offset:12800
s_waitcnt lgkmcnt(2)
v_mfma_f32_32x32x16_bf16 v[128:143], v[52:55], a[168:171], v[128:143]
s_add_u32 s88, s88, 114688
s_add_u32 m0, s88, 0
s_add_u32 s90, s89, 0
ds_read_b64_tr_b16 v[60:61], v12 offset:12288
v_mfma_f32_32x32x16_bf16 v[144:159], v[52:55], a[172:175], v[144:159]
buffer_load_dwordx4 v212, s[28:31], s90 offen  lds
s_add_u32 m0, s88, 1024
v_mul_f32 v169, v169, v40
ds_read_b64_tr_b16 v[62:63], v12 offset:12800
s_waitcnt lgkmcnt(2)
v_mfma_f32_32x32x16_bf16 v[128:143], v[56:59], a[176:179], v[128:143]
s_add_u32 s90, s89, 5120
buffer_load_dwordx4 v212, s[28:31], s90 offen  lds
v_add_u32 v11, 0xffff4000, v11
v_add_u32 v12, 0xffff4000, v12
ds_read_b64_tr_b16 v[48:49], v11 offset:0
v_mfma_f32_16x16x32_bf16 v[44:47], v[20:23], v[56:59], v[44:47]
s_add_u32 m0, s88, 2048
v_mfma_f32_32x32x16_bf16 v[144:159], v[56:59], a[180:183], v[144:159]
s_add_u32 s90, s89, 10240
buffer_load_dwordx4 v212, s[28:31], s90 offen  lds
v_cvt_pk_bf16_f32 v164, v168, v169
ds_read_b64_tr_b16 v[50:51], v11 offset:512
s_waitcnt lgkmcnt(2)
v_mfma_f32_32x32x16_bf16 v[128:143], v[60:63], a[184:187], v[128:143]
v_mul_f32 v170, v170, v40
ds_read_b64_tr_b16 v[52:53], v12 offset:0
v_mfma_f32_32x32x16_bf16 v[144:159], v[60:63], a[188:191], v[144:159]
v_mul_f32 v171, v171, v40
ds_read_b64_tr_b16 v[54:55], v12 offset:512
s_waitcnt vmcnt(26)
s_barrier
s_waitcnt lgkmcnt(2)
v_mfma_f32_32x32x16_bf16 v[128:143], v[48:51], a[192:195], v[128:143]
s_lshl_b32 s60, s68, 7
s_add_u32 s60, s60, 1769472
v_cvt_pk_bf16_f32 v165, v170, v171
ds_read_b64_tr_b16 v[56:57], v11 offset:4096
v_mfma_f32_16x16x32_bf16 v[44:47], v[20:23], v[48:51], v[44:47]
v_mul_f32 v172, v172, v40
v_mfma_f32_32x32x16_bf16 v[144:159], v[48:51], a[196:199], v[144:159]
s_add_u32 m0, s59, 65536
v_mul_f32 v173, v173, v40
ds_read_b64_tr_b16 v[58:59], v11 offset:4608
s_waitcnt lgkmcnt(2)
v_mfma_f32_32x32x16_bf16 v[128:143], v[52:55], a[200:203], v[128:143]
buffer_load_dwordx4 v7, s[20:23], s60 offen offset:0  lds
v_cvt_pk_bf16_f32 v166, v172, v173
ds_read_b64_tr_b16 v[60:61], v12 offset:4096
v_mfma_f32_32x32x16_bf16 v[144:159], v[52:55], a[204:207], v[144:159]
buffer_load_dwordx4 v8, s[20:23], s60 offen offset:1024  lds
v_mul_f32 v174, v174, v40
ds_read_b64_tr_b16 v[62:63], v12 offset:4608
s_waitcnt lgkmcnt(2)
v_mfma_f32_32x32x16_bf16 v[128:143], v[56:59], a[208:211], v[128:143]
buffer_load_dwordx4 v9, s[20:23], s60 offen offset:2048  lds
v_mul_f32 v175, v175, v40
ds_read_b64_tr_b16 v[48:49], v11 offset:8192
v_mfma_f32_16x16x32_bf16 v[44:47], v[20:23], v[56:59], v[44:47]
v_mfma_f32_32x32x16_bf16 v[144:159], v[56:59], a[212:215], v[144:159]
buffer_load_dwordx4 v10, s[20:23], s60 offen offset:3072  lds
v_cvt_pk_bf16_f32 v167, v174, v175
ds_read_b64_tr_b16 v[50:51], v11 offset:8704
s_waitcnt lgkmcnt(2)
v_mfma_f32_32x32x16_bf16 v[128:143], v[60:63], a[216:219], v[128:143]
s_add_u32 m0, s88, 3072
buffer_store_dwordx4 v[160:163], v16, s[24:27], s61 offen sc1
ds_read_b64_tr_b16 v[52:53], v12 offset:8192
v_mfma_f32_32x32x16_bf16 v[144:159], v[60:63], a[220:223], v[144:159]
s_add_u32 s90, s89, 15360
ds_read_b64_tr_b16 v[54:55], v12 offset:8704
s_waitcnt lgkmcnt(2)
v_mfma_f32_32x32x16_bf16 v[128:143], v[48:51], a[224:227], v[128:143]
buffer_load_dwordx4 v212, s[28:31], s90 offen  lds
buffer_store_dwordx4 v[164:167], v16, s[24:27], s61 offen offset:1024 sc1
ds_read_b64_tr_b16 v[56:57], v11 offset:12288
v_mfma_f32_16x16x32_bf16 v[44:47], v[20:23], v[48:51], v[44:47]
s_add_u32 m0, s88, 4096
v_mfma_f32_32x32x16_bf16 v[144:159], v[48:51], a[228:231], v[144:159]
s_add_u32 s90, s89, 20480
v_mul_f32 v176, v176, v41
ds_read_b64_tr_b16 v[58:59], v11 offset:12800
s_waitcnt lgkmcnt(2)
v_mfma_f32_32x32x16_bf16 v[128:143], v[52:55], a[232:235], v[128:143]
buffer_load_dwordx4 v212, s[28:31], s90 offen  lds
v_mul_f32 v177, v177, v41
ds_read_b64_tr_b16 v[60:61], v12 offset:12288
v_mfma_f32_32x32x16_bf16 v[144:159], v[52:55], a[236:239], v[144:159]
s_add_u32 m0, s88, 5120
v_cvt_pk_bf16_f32 v176, v176, v177
ds_read_b64_tr_b16 v[62:63], v12 offset:12800
s_waitcnt lgkmcnt(2)
v_mfma_f32_32x32x16_bf16 v[128:143], v[56:59], a[240:243], v[128:143]
s_add_u32 s90, s89, 25600
v_mul_f32 v178, v178, v41
v_add_u32 v11, 0x10000, v11
v_add_u32 v12, 0x10000, v12
ds_read_b64_tr_b16 v[48:49], v11 offset:0
v_mfma_f32_16x16x32_bf16 v[44:47], v[20:23], v[56:59], v[44:47]
v_mul_f32 v179, v179, v41
v_mfma_f32_32x32x16_bf16 v[144:159], v[56:59], a[244:247], v[144:159]
buffer_load_dwordx4 v212, s[28:31], s90 offen  lds
ds_read_b64_tr_b16 v[50:51], v11 offset:512
s_waitcnt lgkmcnt(2)
v_mfma_f32_32x32x16_bf16 v[128:143], v[60:63], a[248:251], v[128:143]
v_cvt_pk_bf16_f32 v177, v178, v179
v_mul_f32 v180, v180, v41
ds_read_b64_tr_b16 v[52:53], v12 offset:0
v_mfma_f32_32x32x16_bf16 v[144:159], v[60:63], a[252:255], v[144:159]
v_mul_f32 v181, v181, v41
ds_read_b64_tr_b16 v[54:55], v12 offset:512
s_waitcnt vmcnt(29)
s_barrier
s_waitcnt lgkmcnt(2)
v_mfma_f32_32x32x16_bf16 v[128:143], v[48:51], v[64:67], v[128:143]
s_add_u32 m0, s88, 6144
v_cvt_pk_bf16_f32 v178, v180, v181
ds_read_b64_tr_b16 v[56:57], v11 offset:4096
v_mfma_f32_16x16x32_bf16 v[44:47], v[20:23], v[48:51], v[44:47]
v_mul_f32 v182, v182, v41
v_mfma_f32_32x32x16_bf16 v[144:159], v[48:51], v[68:71], v[144:159]
v_mul_f32 v183, v183, v41
ds_read_b64_tr_b16 v[58:59], v11 offset:4608
s_waitcnt lgkmcnt(2)
v_mfma_f32_32x32x16_bf16 v[128:143], v[52:55], v[72:75], v[128:143]
s_add_u32 s90, s89, 30720
v_cvt_pk_bf16_f32 v179, v182, v183
v_mul_f32 v184, v184, v41
ds_read_b64_tr_b16 v[60:61], v12 offset:4096
v_mfma_f32_32x32x16_bf16 v[144:159], v[52:55], v[76:79], v[144:159]
v_mul_f32 v185, v185, v41
ds_read_b64_tr_b16 v[62:63], v12 offset:4608
s_waitcnt lgkmcnt(2)
v_mfma_f32_32x32x16_bf16 v[128:143], v[56:59], v[80:83], v[128:143]
v_cvt_pk_bf16_f32 v180, v184, v185
v_mul_f32 v186, v186, v41
ds_read_b64_tr_b16 v[48:49], v11 offset:8192
v_mfma_f32_16x16x32_bf16 v[44:47], v[20:23], v[56:59], v[44:47]
buffer_load_dwordx4 v212, s[28:31], s90 offen  lds
v_mfma_f32_32x32x16_bf16 v[144:159], v[56:59], v[84:87], v[144:159]
v_mul_f32 v187, v187, v41
ds_read_b64_tr_b16 v[50:51], v11 offset:8704
s_waitcnt lgkmcnt(2)
v_mfma_f32_32x32x16_bf16 v[128:143], v[60:63], v[88:91], v[128:143]
v_cvt_pk_bf16_f32 v181, v186, v187
v_mul_f32 v188, v188, v41
ds_read_b64_tr_b16 v[52:53], v12 offset:8192
v_mfma_f32_32x32x16_bf16 v[144:159], v[60:63], v[92:95], v[144:159]
s_add_u32 m0, s88, 7168
v_mul_f32 v189, v189, v41
ds_read_b64_tr_b16 v[54:55], v12 offset:8704
s_waitcnt lgkmcnt(2)
v_mfma_f32_32x32x16_bf16 v[128:143], v[48:51], v[96:99], v[128:143]
v_cvt_pk_bf16_f32 v182, v188, v189
v_mul_f32 v190, v190, v41
ds_read_b64_tr_b16 v[56:57], v11 offset:12288
v_mfma_f32_16x16x32_bf16 v[44:47], v[20:23], v[48:51], v[44:47]
v_mul_f32 v191, v191, v41
v_mfma_f32_32x32x16_bf16 v[144:159], v[48:51], v[100:103], v[144:159]
s_add_u32 s90, s89, 35840
v_cvt_pk_bf16_f32 v183, v190, v191
ds_read_b64_tr_b16 v[58:59], v11 offset:12800
s_waitcnt lgkmcnt(2)
v_mfma_f32_32x32x16_bf16 v[128:143], v[52:55], v[104:107], v[128:143]
buffer_store_dwordx4 v[176:179], v16, s[24:27], s62 offen sc1
ds_read_b64_tr_b16 v[60:61], v12 offset:12288
v_mfma_f32_32x32x16_bf16 v[144:159], v[52:55], v[108:111], v[144:159]
ds_read_b64_tr_b16 v[62:63], v12 offset:12800
s_waitcnt lgkmcnt(2)
v_mfma_f32_32x32x16_bf16 v[128:143], v[56:59], v[112:115], v[128:143]
buffer_load_dwordx4 v212, s[28:31], s90 offen  lds
buffer_store_dwordx4 v[180:183], v16, s[24:27], s62 offen offset:1024 sc1
v_add_u32 v11, 0x4000, v11
v_add_u32 v12, 0x4000, v12
ds_read_b64_tr_b16 v[48:49], v11 offset:0
v_mfma_f32_16x16x32_bf16 v[44:47], v[20:23], v[56:59], v[44:47]
v_mfma_f32_32x32x16_bf16 v[144:159], v[56:59], v[116:119], v[144:159]
ds_read_b64_tr_b16 v[50:51], v11 offset:512
s_waitcnt lgkmcnt(2)
v_mfma_f32_32x32x16_bf16 v[128:143], v[60:63], v[120:123], v[128:143]
ds_read_b64_tr_b16 v[52:53], v12 offset:0
s_nop 2
ds_write_b32 v18, v44 offset:512
ds_write_b32 v18, v45 offset:576
v_mfma_f32_32x32x16_bf16 v[144:159], v[60:63], v[124:127], v[144:159]
ds_read_b64_tr_b16 v[54:55], v12 offset:512
s_waitcnt vmcnt(29) lgkmcnt(1)
s_barrier
v_mfma_f32_32x32x16_bf16 v[160:175], v[48:51], a[0:3], 0
ds_read_b64_tr_b16 v[56:57], v11 offset:4096
v_mfma_f32_16x16x32_bf16 v[44:47], v[20:23], v[48:51], 0
v_mfma_f32_32x32x16_bf16 v[176:191], v[48:51], a[4:7], 0
v_lshrrev_b32 v212, 4, v1
ds_read_b64_tr_b16 v[58:59], v11 offset:4608
s_waitcnt lgkmcnt(2)
v_mfma_f32_32x32x16_bf16 v[160:175], v[52:55], a[8:11], v[160:175]
v_bfe_u32 v213, v1, 2, 2
ds_read_b64_tr_b16 v[60:61], v12 offset:4096
v_mfma_f32_32x32x16_bf16 v[176:191], v[52:55], a[12:15], v[176:191]
v_lshl_add_u32 v212, v212, 3, v213
ds_read_b32 v38, v19 offset:512
ds_read_b64_tr_b16 v[62:63], v12 offset:4608
s_waitcnt lgkmcnt(3)
v_mfma_f32_32x32x16_bf16 v[160:175], v[56:59], a[16:19], v[160:175]
v_lshlrev_b32 v212, 8, v212
v_and_b32 v213, 3, v1
ds_read_b64_tr_b16 v[48:49], v11 offset:8192
v_mfma_f32_16x16x32_bf16 v[44:47], v[20:23], v[56:59], v[44:47]
v_mfma_f32_32x32x16_bf16 v[176:191], v[56:59], a[20:23], v[176:191]
v_mul_u32_u24 v213, 40, v213
ds_read_b64_tr_b16 v[50:51], v11 offset:8704
s_waitcnt lgkmcnt(2)
v_mfma_f32_32x32x16_bf16 v[160:175], v[60:63], a[24:27], v[160:175]
v_add_u32 v212, v212, v213
s_add_u32 s88, s88, s87
ds_read_b64_tr_b16 v[52:53], v12 offset:8192
v_mfma_f32_32x32x16_bf16 v[176:191], v[60:63], a[28:31], v[176:191]
v_add_u32 v212, s88, v212
ds_read_b64_tr_b16 v[54:55], v12 offset:8704
s_waitcnt lgkmcnt(2)
v_mfma_f32_32x32x16_bf16 v[160:175], v[48:51], a[32:35], v[160:175]
s_mul_i32 s89, s85, 74
ds_read_b32 v39, v19 offset:640
ds_read_b64_tr_b16 v[56:57], v11 offset:12288
v_mfma_f32_16x16x32_bf16 v[44:47], v[20:23], v[48:51], v[44:47]
s_add_u32 s89, s89, s84
v_mfma_f32_32x32x16_bf16 v[176:191], v[48:51], a[36:39], v[176:191]
s_mul_i32 s89, s89, 5120
ds_read_b64_tr_b16 v[58:59], v11 offset:12800
s_waitcnt lgkmcnt(3)
v_mfma_f32_32x32x16_bf16 v[160:175], v[52:55], a[40:43], v[160:175]
s_add_u32 s89, s89, 20971520
ds_read_b64_tr_b16 v[60:61], v12 offset:12288
v_mfma_f32_32x32x16_bf16 v[176:191], v[52:55], a[44:47], v[176:191]
v_lshlrev_b32 v213, 4, v1
ds_read_b64_tr_b16 v[62:63], v12 offset:12800
s_waitcnt lgkmcnt(2)
v_mfma_f32_32x32x16_bf16 v[160:175], v[56:59], a[48:51], v[160:175]
v_add_u32 v213, s86, v213
v_add_u32 v11, 0xffff0000, v11
v_add_u32 v12, 0xffff0000, v12
ds_read_b64_tr_b16 v[48:49], v11 offset:0
v_mfma_f32_16x16x32_bf16 v[44:47], v[20:23], v[56:59], v[44:47]
v_mfma_f32_32x32x16_bf16 v[176:191], v[56:59], a[52:55], v[176:191]
s_waitcnt vmcnt(1)
ds_read_b64_tr_b16 v[50:51], v11 offset:512
s_waitcnt lgkmcnt(2)
v_mfma_f32_32x32x16_bf16 v[160:175], v[60:63], a[56:59], v[160:175]
ds_read_b64_tr_b16 v[192:193], v212 offset:0
ds_read_b64_tr_b16 v[194:195], v212 offset:1024
ds_read_b64_tr_b16 v[52:53], v12 offset:0
v_mfma_f32_32x32x16_bf16 v[176:191], v[60:63], a[60:63], v[176:191]
ds_read_b64_tr_b16 v[54:55], v12 offset:512
s_barrier
s_waitcnt lgkmcnt(4)
v_mfma_f32_32x32x16_bf16 v[160:175], v[48:51], a[64:67], v[160:175]
ds_read_b64_tr_b16 v[196:197], v212 offset:8
ds_read_b64_tr_b16 v[198:199], v212 offset:1032
ds_read_b64_tr_b16 v[56:57], v11 offset:4096
v_mfma_f32_16x16x32_bf16 v[44:47], v[20:23], v[48:51], v[44:47]
v_mfma_f32_32x32x16_bf16 v[176:191], v[48:51], a[68:71], v[176:191]
ds_read_b64_tr_b16 v[200:201], v212 offset:16
ds_read_b64_tr_b16 v[58:59], v11 offset:4608
s_waitcnt lgkmcnt(5)
v_mfma_f32_32x32x16_bf16 v[160:175], v[52:55], a[72:75], v[160:175]
ds_read_b64_tr_b16 v[202:203], v212 offset:1040
ds_read_b64_tr_b16 v[204:205], v212 offset:24
v_add_f32 v38, v38, v39
ds_read_b64_tr_b16 v[60:61], v12 offset:4096
v_mfma_f32_32x32x16_bf16 v[176:191], v[52:55], a[76:79], v[176:191]
ds_read_b64_tr_b16 v[206:207], v212 offset:1048
ds_read_b64_tr_b16 v[62:63], v12 offset:4608
s_waitcnt lgkmcnt(5)
v_mfma_f32_32x32x16_bf16 v[160:175], v[56:59], a[80:83], v[160:175]
ds_read_b64_tr_b16 v[208:209], v212 offset:32
ds_read_b64_tr_b16 v[48:49], v11 offset:8192
v_mfma_f32_16x16x32_bf16 v[44:47], v[20:23], v[56:59], v[44:47]
ds_read_b64_tr_b16 v[210:211], v212 offset:1056
v_mfma_f32_32x32x16_bf16 v[176:191], v[56:59], a[84:87], v[176:191]
s_waitcnt lgkmcnt(0)
ds_read_b64_tr_b16 v[50:51], v11 offset:8704
v_mfma_f32_32x32x16_bf16 v[160:175], v[60:63], a[88:91], v[160:175]
ds_read_b64_tr_b16 v[52:53], v12 offset:8192
v_mfma_f32_32x32x16_bf16 v[176:191], v[60:63], a[92:95], v[176:191]
buffer_store_dwordx4 v[192:195], v213, s[24:27], s89 offen offset:0 sc1
v_cvt_pk_bf16_f32 v39, v38, v38
ds_read_b64_tr_b16 v[54:55], v12 offset:8704
s_waitcnt lgkmcnt(2)
v_mfma_f32_32x32x16_bf16 v[160:175], v[48:51], a[96:99], v[160:175]
buffer_store_dwordx4 v[196:199], v213, s[24:27], s89 offen offset:1024 sc1
ds_read_b64_tr_b16 v[56:57], v11 offset:12288
v_mfma_f32_16x16x32_bf16 v[44:47], v[20:23], v[48:51], v[44:47]
v_mfma_f32_32x32x16_bf16 v[176:191], v[48:51], a[100:103], v[176:191]
ds_read_b64_tr_b16 v[58:59], v11 offset:12800
s_waitcnt lgkmcnt(2)
v_mfma_f32_32x32x16_bf16 v[160:175], v[52:55], a[104:107], v[160:175]
buffer_store_dwordx4 v[200:203], v213, s[24:27], s89 offen offset:2048 sc1
ds_read_b64_tr_b16 v[60:61], v12 offset:12288
v_mfma_f32_32x32x16_bf16 v[176:191], v[52:55], a[108:111], v[176:191]
buffer_store_dwordx4 v[204:207], v213, s[24:27], s89 offen offset:3072 sc1
ds_read_b64_tr_b16 v[62:63], v12 offset:12800
s_waitcnt lgkmcnt(2)
v_mfma_f32_32x32x16_bf16 v[160:175], v[56:59], a[112:115], v[160:175]
v_lshlrev_b32 v39, 16, v39
v_add_u32 v11, 0xffff8000, v11
v_add_u32 v12, 0xffff8000, v12
ds_read_b64_tr_b16 v[48:49], v11 offset:0
v_mfma_f32_16x16x32_bf16 v[44:47], v[20:23], v[56:59], v[44:47]
s_add_u32 s89, s89, 4096
v_mfma_f32_32x32x16_bf16 v[176:191], v[56:59], a[116:119], v[176:191]
ds_read_b64_tr_b16 v[50:51], v11 offset:512
s_waitcnt lgkmcnt(2)
v_mfma_f32_32x32x16_bf16 v[160:175], v[60:63], a[120:123], v[160:175]
buffer_store_dwordx4 v[208:211], v213, s[24:27], s89 offen offset:0 sc1
ds_read_b64_tr_b16 v[52:53], v12 offset:0
v_mfma_f32_32x32x16_bf16 v[176:191], v[60:63], a[124:127], v[176:191]
ds_read_b64_tr_b16 v[54:55], v12 offset:512
s_waitcnt vmcnt(5)
s_barrier
s_cmp_lg_u32 s42, 0
s_cbranch_scc1 L_sig_21
s_add_u32 s46, s40, 0
s_lshl_b32 s46, s46, 5
s_add_u32 s46, s46, s41
s_lshl_b32 s46, s46, 2
s_add_u32 s46, s46, 25165824
s_mov_b64 exec, 1
v_mov_b32 v0, s46
v_mov_b32 v13, s79
buffer_store_dword v13, v0, s[24:27], 0 offen sc1
s_mov_b64 exec, -1
L_sig_21:
s_waitcnt lgkmcnt(2)
v_mfma_f32_32x32x16_bf16 v[160:175], v[48:51], a[128:131], v[160:175]
s_and_b32 s45, s2, 7
s_lshr_b32 s46, s2, 3
s_lshl_b32 s45, s45, 1
s_lshr_b32 s47, s46, 4
ds_read_b64_tr_b16 v[56:57], v11 offset:4096
v_mfma_f32_16x16x32_bf16 v[44:47], v[20:23], v[48:51], v[44:47]
s_add_u32 s81, s45, s47
s_and_b32 s80, s46, 15
v_mfma_f32_32x32x16_bf16 v[176:191], v[48:51], a[132:135], v[176:191]
s_lshl_b32 s45, s80, 2
s_add_u32 s82, s45, s42
s_sub_u32 s83, 8, s82
ds_read_b64_tr_b16 v[58:59], v11 offset:4608
s_waitcnt lgkmcnt(2)
v_mfma_f32_32x32x16_bf16 v[160:175], v[52:55], a[136:139], v[160:175]
s_max_i32 s83, s83, 0
v_min_u32 v0, 47, v1
v_lshrrev_b32 v13, 4, v0
s_sub_u32 s45, s80, 2
ds_read_b64_tr_b16 v[60:61], v12 offset:4096
v_mfma_f32_32x32x16_bf16 v[176:191], v[52:55], a[140:143], v[176:191]
v_add_u32 v13, s45, v13
v_max_i32 v13, 0, v13
v_and_b32 v0, 15, v0
v_lshlrev_b32 v0, 2, v0
ds_read_b64_tr_b16 v[62:63], v12 offset:4608
s_waitcnt lgkmcnt(2)
v_mfma_f32_32x32x16_bf16 v[160:175], v[56:59], a[144:147], v[160:175]
v_lshl_add_u32 v0, v13, 7, v0
v_add_u32 v0, 25165824, v0
s_lshl_b32 s45, s2, 2
s_add_u32 s45, s45, s42
ds_read_b64_tr_b16 v[48:49], v11 offset:8192
v_mfma_f32_16x16x32_bf16 v[44:47], v[20:23], v[56:59], v[44:47]
s_lshl_b32 s45, s45, 7
s_add_u32 s45, s45, 27262976
v_mfma_f32_32x32x16_bf16 v[176:191], v[56:59], a[148:151], v[176:191]
s_cmp_eq_u32 s42, 0
s_cselect_b64 s[48:49], -1, 0
v_mov_b32 v13, s45
ds_read_b64_tr_b16 v[50:51], v11 offset:8704
s_waitcnt lgkmcnt(2)
v_mfma_f32_32x32x16_bf16 v[160:175], v[60:63], a[152:155], v[160:175]
v_cndmask_b32_e64 v0, v13, v0, s[48:49]
buffer_load_dword v13, v0, s[24:27], 0 offen sc1
s_and_b32 s45, s2, 7
ds_read_b64_tr_b16 v[52:53], v12 offset:8192
v_mfma_f32_32x32x16_bf16 v[176:191], v[60:63], a[156:159], v[176:191]
s_lshr_b32 s46, s2, 3
s_and_b32 s47, s45, 3
s_lshl_b32 s47, s47, 3
ds_read_b64_tr_b16 v[54:55], v12 offset:8704
s_waitcnt lgkmcnt(2)
v_mfma_f32_32x32x16_bf16 v[160:175], v[48:51], a[160:163], v[160:175]
s_and_b32 s48, s46, 7
s_add_u32 s84, s47, s48
s_lshr_b32 s47, s45, 2
s_lshl_b32 s47, s47, 2
s_lshr_b32 s48, s46, 3
ds_read_b64_tr_b16 v[56:57], v11 offset:12288
v_mfma_f32_16x16x32_bf16 v[44:47], v[20:23], v[48:51], v[44:47]
s_add_u32 s85, s47, s48
v_sub_f32 v39, v38, v39
v_mfma_f32_32x32x16_bf16 v[176:191], v[48:51], a[164:167], v[176:191]
s_lshl_b32 s45, s84, 2
s_add_u32 s86, s45, s42
s_lshr_b32 s87, s84, 1
s_mul_i32 s88, s85, 378880
ds_read_b64_tr_b16 v[58:59], v11 offset:12800
s_waitcnt lgkmcnt(2)
v_mfma_f32_32x32x16_bf16 v[160:175], v[52:55], a[168:171], v[160:175]
s_mul_i32 s89, s42, 5120
s_add_u32 s88, s88, s89
s_add_u32 s88, s88, 20971520
s_and_b32 s45, s42, 1
ds_read_b64_tr_b16 v[60:61], v12 offset:12288
v_mfma_f32_32x32x16_bf16 v[176:191], v[52:55], a[172:175], v[176:191]
s_lshl_b32 s45, s45, 10
s_mul_i32 s91, s86, 55296
s_add_u32 s91, s91, s45
ds_read_b64_tr_b16 v[62:63], v12 offset:12800
s_waitcnt lgkmcnt(2)
v_mfma_f32_32x32x16_bf16 v[160:175], v[56:59], a[176:179], v[160:175]
s_add_u32 s91, s91, 8388608
s_mul_i32 s92, s86, 20480
s_add_u32 s92, s92, s45
v_add_u32 v11, 0xc000, v11
v_add_u32 v12, 0xc000, v12
ds_read_b64_tr_b16 v[48:49], v11 offset:0
v_mfma_f32_16x16x32_bf16 v[44:47], v[20:23], v[56:59], v[44:47]
s_add_u32 s92, s92, 16777216
v_mfma_f32_32x32x16_bf16 v[176:191], v[56:59], a[180:183], v[176:191]
s_sub_u32 s90, s92, s45
s_xor_b32 s46, s86, 1
s_mul_i32 s94, s46, 55296
s_add_u32 s94, s94, s45
ds_read_b64_tr_b16 v[50:51], v11 offset:512
s_waitcnt lgkmcnt(2)
v_mfma_f32_32x32x16_bf16 v[160:175], v[60:63], a[184:187], v[160:175]
s_add_u32 s94, s94, 8388608
s_mul_i32 s95, s46, 20480
s_add_u32 s95, s95, s45
s_add_u32 s95, s95, 16777216
ds_read_b64_tr_b16 v[52:53], v12 offset:0
v_mfma_f32_32x32x16_bf16 v[176:191], v[60:63], a[188:191], v[176:191]
ds_read_b64_tr_b16 v[54:55], v12 offset:512
s_barrier
s_waitcnt lgkmcnt(2)
v_mfma_f32_32x32x16_bf16 v[160:175], v[48:51], a[192:195], v[160:175]
s_mul_i32 s63, s82, 122880
s_mul_i32 s50, s81, 2560
s_add_u32 s63, s63, s50
v_lshlrev_b32 v5, 4, v1
ds_read_b64_tr_b16 v[56:57], v11 offset:4096
v_mfma_f32_16x16x32_bf16 v[44:47], v[20:23], v[48:51], v[44:47]
v_and_b32 v10, 31, v1
v_mfma_f32_32x32x16_bf16 v[176:191], v[48:51], a[196:199], v[176:191]
v_lshrrev_b32 v14, 5, v1
v_lshlrev_b32 v9, 4, v10
v_lshl_add_u32 v9, v14, 3, v9
ds_read_b64_tr_b16 v[58:59], v11 offset:4608
s_waitcnt lgkmcnt(2)
v_mfma_f32_32x32x16_bf16 v[160:175], v[52:55], a[200:203], v[160:175]
v_lshlrev_b32 v6, 2, v14
v_xor_b32 v6, v10, v6
v_lshlrev_b32 v6, 4, v6
ds_read_b64_tr_b16 v[60:61], v12 offset:4096
v_mfma_f32_32x32x16_bf16 v[176:191], v[52:55], a[204:207], v[176:191]
v_lshl_add_u32 v6, v14, 9, v6
v_sub_u32 v7, 1, v14
v_lshlrev_b32 v7, 3, v7
ds_read_b64_tr_b16 v[62:63], v12 offset:4608
s_waitcnt lgkmcnt(2)
v_mfma_f32_32x32x16_bf16 v[160:175], v[56:59], a[208:211], v[160:175]
v_xor_b32 v7, v10, v7
v_lshlrev_b32 v7, 4, v7
v_lshl_add_u32 v7, v14, 9, v7
v_xor_b32 v8, 4, v10
ds_read_b64_tr_b16 v[48:49], v11 offset:8192
v_mfma_f32_16x16x32_bf16 v[44:47], v[20:23], v[56:59], v[44:47]
v_lshlrev_b32 v8, 4, v8
v_mfma_f32_32x32x16_bf16 v[176:191], v[56:59], a[212:215], v[176:191]
v_lshl_add_u32 v8, v14, 9, v8
s_mul_i32 s72, s42, 3
s_add_u32 s72, s72, 0
ds_read_b64_tr_b16 v[50:51], v11 offset:8704
s_waitcnt lgkmcnt(2)
v_mfma_f32_32x32x16_bf16 v[160:175], v[60:63], a[216:219], v[160:175]
s_lshl_b32 s70, s80, 2
s_add_u32 s70, s70, s72
s_sub_u32 s70, s70, 8
s_max_i32 s70, s70, 0
ds_read_b64_tr_b16 v[52:53], v12 offset:8192
v_mfma_f32_32x32x16_bf16 v[176:191], v[60:63], a[220:223], v[176:191]
s_mul_i32 s70, s70, 122880
s_add_u32 s70, s70, s50
s_add_u32 s71, s70, 81920
v_cvt_pk_bf16_f32 v24, v38, v39
ds_read_b64_tr_b16 v[54:55], v12 offset:8704
s_waitcnt lgkmcnt(2)
v_mfma_f32_32x32x16_bf16 v[160:175], v[48:51], a[224:227], v[160:175]
s_add_u32 s70, s70, 40960
s_mul_i32 s72, s72, 3072
s_mul_i32 s75, s42, 3
ds_read_b64_tr_b16 v[56:57], v11 offset:12288
v_mfma_f32_16x16x32_bf16 v[44:47], v[20:23], v[48:51], v[44:47]
s_add_u32 s75, s75, 1
s_lshl_b32 s73, s80, 2
v_mfma_f32_32x32x16_bf16 v[176:191], v[48:51], a[228:231], v[176:191]
s_add_u32 s73, s73, s75
s_sub_u32 s73, s73, 8
s_max_i32 s73, s73, 0
ds_read_b64_tr_b16 v[58:59], v11 offset:12800
s_waitcnt lgkmcnt(2)
v_mfma_f32_32x32x16_bf16 v[160:175], v[52:55], a[232:235], v[160:175]
s_mul_i32 s73, s73, 122880
s_add_u32 s73, s73, s50
s_add_u32 s74, s73, 81920
ds_read_b64_tr_b16 v[60:61], v12 offset:12288
v_mfma_f32_32x32x16_bf16 v[176:191], v[52:55], a[236:239], v[176:191]
s_add_u32 s73, s73, 40960
s_mul_i32 s75, s75, 3072
s_mul_i32 s58, s42, 3
ds_read_b64_tr_b16 v[62:63], v12 offset:12800
s_waitcnt lgkmcnt(2)
v_mfma_f32_32x32x16_bf16 v[160:175], v[56:59], a[240:243], v[160:175]
s_add_u32 s58, s58, 2
s_lshl_b32 s76, s80, 2
v_add_u32 v11, 0x4000, v11
v_add_u32 v12, 0x4000, v12
ds_read_b64_tr_b16 v[48:49], v11 offset:0
v_mfma_f32_16x16x32_bf16 v[44:47], v[20:23], v[56:59], v[44:47]
s_add_u32 s76, s76, s58
s_sub_u32 s76, s76, 8
v_mfma_f32_32x32x16_bf16 v[176:191], v[56:59], a[244:247], v[176:191]
s_max_i32 s76, s76, 0
s_mul_i32 s76, s76, 122880
ds_read_b64_tr_b16 v[50:51], v11 offset:512
s_waitcnt lgkmcnt(2)
v_mfma_f32_32x32x16_bf16 v[160:175], v[60:63], a[248:251], v[160:175]
s_add_u32 s76, s76, s50
s_add_u32 s57, s76, 81920
s_add_u32 s76, s76, 40960
s_mul_i32 s58, s58, 3072
ds_read_b64_tr_b16 v[52:53], v12 offset:0
v_mfma_f32_32x32x16_bf16 v[176:191], v[60:63], a[252:255], v[176:191]
ds_read_b64_tr_b16 v[54:55], v12 offset:512
s_waitcnt vmcnt(1)
s_barrier
s_and_b32 s47, s2, 7
s_sub_u32 s48, s2, 128
s_lshr_b32 s48, s48, 3
s_cmp_lg_u32 s42, 0
s_cbranch_scc1 L_sig_22
s_add_u32 s46, s47, 48
s_lshl_b32 s46, s46, 5
s_add_u32 s46, s46, s48
s_lshl_b32 s46, s46, 2
s_add_u32 s46, s46, 25165824
s_mov_b64 exec, 1
v_mov_b32 v3, s46
v_mov_b32 v4, s79
buffer_store_dword v4, v3, s[24:27], 0 offen sc1
s_mov_b64 exec, -1
L_sig_22:
s_waitcnt lgkmcnt(2)
v_mfma_f32_32x32x16_bf16 v[160:175], v[48:51], v[64:67], v[160:175]
ds_read_b64_tr_b16 v[56:57], v11 offset:4096
v_mfma_f32_16x16x32_bf16 v[44:47], v[20:23], v[48:51], v[44:47]
v_mfma_f32_32x32x16_bf16 v[176:191], v[48:51], v[68:71], v[176:191]
ds_read_b64_tr_b16 v[58:59], v11 offset:4608
s_waitcnt lgkmcnt(2)
v_mfma_f32_32x32x16_bf16 v[160:175], v[52:55], v[72:75], v[160:175]
v_mfma_f32_32x32x8bf16_1k v[128:143], v[24:25], v[26:27], v[128:143]
ds_read_b64_tr_b16 v[60:61], v12 offset:4096
v_mfma_f32_32x32x16_bf16 v[176:191], v[52:55], v[76:79], v[176:191]
ds_read_b64_tr_b16 v[62:63], v12 offset:4608
s_waitcnt lgkmcnt(2)
v_mfma_f32_32x32x16_bf16 v[160:175], v[56:59], v[80:83], v[160:175]
ds_read_b64_tr_b16 v[48:49], v11 offset:8192
v_mfma_f32_16x16x32_bf16 v[44:47], v[20:23], v[56:59], v[44:47]
v_mfma_f32_32x32x16_bf16 v[176:191], v[56:59], v[84:87], v[176:191]
ds_read_b64_tr_b16 v[50:51], v11 offset:8704
s_waitcnt lgkmcnt(2)
v_mfma_f32_32x32x16_bf16 v[160:175], v[60:63], v[88:91], v[160:175]
ds_read_b64_tr_b16 v[52:53], v12 offset:8192
v_mfma_f32_32x32x16_bf16 v[176:191], v[60:63], v[92:95], v[176:191]
ds_read_b64_tr_b16 v[54:55], v12 offset:8704
s_waitcnt lgkmcnt(2)
v_mfma_f32_32x32x16_bf16 v[160:175], v[48:51], v[96:99], v[160:175]
ds_read_b64_tr_b16 v[56:57], v11 offset:12288
v_mfma_f32_16x16x32_bf16 v[44:47], v[20:23], v[48:51], v[44:47]
v_mfma_f32_32x32x16_bf16 v[176:191], v[48:51], v[100:103], v[176:191]
v_mfma_f32_32x32x8bf16_1k v[144:159], v[24:25], v[28:29], v[144:159]
ds_read_b64_tr_b16 v[58:59], v11 offset:12800
s_waitcnt lgkmcnt(2)
v_mfma_f32_32x32x16_bf16 v[160:175], v[52:55], v[104:107], v[160:175]
ds_read_b64_tr_b16 v[60:61], v12 offset:12288
v_mfma_f32_32x32x16_bf16 v[176:191], v[52:55], v[108:111], v[176:191]
ds_read_b64_tr_b16 v[62:63], v12 offset:12800
s_waitcnt lgkmcnt(2)
v_mfma_f32_32x32x16_bf16 v[160:175], v[56:59], v[112:115], v[160:175]
v_mfma_f32_16x16x32_bf16 v[44:47], v[20:23], v[56:59], v[44:47]
v_mfma_f32_32x32x16_bf16 v[176:191], v[56:59], v[116:119], v[176:191]
s_waitcnt lgkmcnt(0)
v_mfma_f32_32x32x16_bf16 v[160:175], v[60:63], v[120:123], v[160:175]
s_nop 4
ds_write_b32 v18, v44 offset:0
ds_write_b32 v18, v45 offset:64
v_mfma_f32_32x32x16_bf16 v[176:191], v[60:63], v[124:127], v[176:191]
s_waitcnt lgkmcnt(0)
s_waitcnt vmcnt(0)
s_cmp_lg_u32 s42, 0
s_cbranch_scc1 L_pc_23
v_cmp_ne_u32 s[48:49], s79, v13
s_nop 1
s_cmp_eq_u64 s[48:49], 0
s_cbranch_scc1 L_pc_23
s_cmp_lg_u32 s42, 0
s_cbranch_scc1 L_poll_24_ok
s_mov_b32 s46, 0x40000
L_poll_24:
buffer_load_dword v13, v0, s[24:27], 0 offen sc1
s_waitcnt vmcnt(0)
v_cmp_ne_u32 s[48:49], s79, v13
s_nop 1
s_cmp_eq_u64 s[48:49], 0
s_cbranch_scc1 L_poll_24_ok
s_sleep 1
s_sub_u32 s46, s46, 1
s_cmp_lg_u32 s46, 0
s_cbranch_scc1 L_poll_24
L_poll_24_ok:
L_pc_23:
s_barrier
ds_read_b32 v38, v19 offset:0
ds_read_b32 v39, v19 offset:128
s_waitcnt lgkmcnt(0)
v_add_f32 v38, v38, v39
v_cvt_pk_bf16_f32 v39, v38, v38
v_lshlrev_b32 v39, 16, v39
v_sub_f32 v39, v38, v39
s_add_u32 m0, s72, 0
s_nop 0
buffer_load_dwordx4 v5, s[24:27], s70 offen sc1 lds
v_cvt_pk_bf16_f32 v24, v38, v39
s_nop 1
v_mfma_f32_32x32x8bf16_1k v[160:175], v[24:25], v[26:27], v[160:175]
v_mfma_f32_32x32x8bf16_1k v[176:191], v[24:25], v[28:29], v[176:191]
s_lshl_b32 s52, s68, 1
s_add_u32 s52, s52, s44
s_lshl_b32 s52, s52, 10
s_add_u32 s52, s52, 8388608
buffer_load_dwordx4 v5, s[24:27], s70 offen offset:1024 sc1 lds
s_mul_i32 s53, s55, 110592
s_add_u32 s61, s52, s53
s_mul_i32 s53, s56, 110592
s_add_u32 s62, s52, s53
v_pk_mul_f32 v[44:45], v[128:129], v[128:129]
v_pk_mul_f32 v[46:47], v[130:131], v[130:131]
v_pk_mul_f32 v[48:49], v[132:133], v[132:133]
s_mov_b32 exec_hi, 0
buffer_load_dwordx4 v5, s[24:27], s70 offen offset:2048 sc1 lds
s_mov_b32 exec_hi, -1
v_pk_mul_f32 v[50:51], v[134:135], v[134:135]
v_pk_fma_f32 v[44:45], v[44:45], v[32:33], v[32:33] op_sel:[0,1,0] op_sel_hi:[1,1,0]
v_pk_fma_f32 v[46:47], v[46:47], v[32:33], v[32:33] op_sel:[0,1,0] op_sel_hi:[1,1,0]
v_pk_fma_f32 v[48:49], v[48:49], v[32:33], v[32:33] op_sel:[0,1,0] op_sel_hi:[1,1,0]
v_pk_fma_f32 v[50:51], v[50:51], v[32:33], v[32:33] op_sel:[0,1,0] op_sel_hi:[1,1,0]
v_pk_mul_f32 v[44:45], v[128:129], v[44:45]
s_add_u32 m0, s72, 36864
s_nop 0
buffer_load_dwordx4 v6, s[24:27], s71 offen sc1 lds
v_pk_mul_f32 v[46:47], v[130:131], v[46:47]
v_pk_mul_f32 v[48:49], v[132:133], v[48:49]
v_pk_mul_f32 v[50:51], v[134:135], v[50:51]
v_exp_f32 v44, v44
v_exp_f32 v45, v45
v_exp_f32 v46, v46
v_exp_f32 v47, v47
buffer_load_dwordx4 v7, s[24:27], s71 offen offset:1024 sc1 lds
v_exp_f32 v48, v48
v_exp_f32 v49, v49
v_exp_f32 v50, v50
v_exp_f32 v51, v51
v_pk_mul_f32 v[128:129], v[128:129], v[160:161]
v_pk_mul_f32 v[130:131], v[130:131], v[162:163]
v_pk_mul_f32 v[132:133], v[132:133], v[164:165]
s_mov_b32 exec_hi, 0
buffer_load_dwordx4 v8, s[24:27], s71 offen offset:2048 sc1 lds
s_mov_b32 exec_hi, -1
v_pk_mul_f32 v[134:135], v[134:135], v[166:167]
v_pk_fma_f32 v[44:45], v[44:45], v[34:35], v[34:35] op_sel:[0,0,0] op_sel_hi:[1,0,0]
v_pk_fma_f32 v[46:47], v[46:47], v[34:35], v[34:35] op_sel:[0,0,0] op_sel_hi:[1,0,0]
v_pk_fma_f32 v[48:49], v[48:49], v[34:35], v[34:35] op_sel:[0,0,0] op_sel_hi:[1,0,0]
v_pk_fma_f32 v[50:51], v[50:51], v[34:35], v[34:35] op_sel:[0,0,0] op_sel_hi:[1,0,0]
v_rcp_f32 v44, v44
v_rcp_f32 v45, v45
s_add_u32 m0, s75, 0
s_nop 0
buffer_load_dwordx4 v5, s[24:27], s73 offen sc1 lds
v_rcp_f32 v46, v46
v_rcp_f32 v47, v47
v_rcp_f32 v48, v48
v_rcp_f32 v49, v49
v_rcp_f32 v50, v50
v_rcp_f32 v51, v51
buffer_load_dwordx4 v5, s[24:27], s73 offen offset:1024 sc1 lds
v_pk_mul_f32 v[128:129], v[128:129], v[44:45]
v_pk_mul_f32 v[130:131], v[130:131], v[46:47]
v_pk_mul_f32 v[132:133], v[132:133], v[48:49]
v_pk_mul_f32 v[134:135], v[134:135], v[50:51]
v_cvt_pk_bf16_f32 v160, v128, v129
v_cvt_pk_bf16_f32 v161, v130, v131
v_cvt_pk_bf16_f32 v162, v132, v133
s_mov_b32 exec_hi, 0
buffer_load_dwordx4 v5, s[24:27], s73 offen offset:2048 sc1 lds
s_mov_b32 exec_hi, -1
v_cvt_pk_bf16_f32 v163, v134, v135
v_pk_mul_f32 v[44:45], v[136:137], v[136:137]
v_pk_mul_f32 v[46:47], v[138:139], v[138:139]
v_pk_mul_f32 v[48:49], v[140:141], v[140:141]
v_pk_mul_f32 v[50:51], v[142:143], v[142:143]
v_pk_fma_f32 v[44:45], v[44:45], v[32:33], v[32:33] op_sel:[0,1,0] op_sel_hi:[1,1,0]
v_pk_fma_f32 v[46:47], v[46:47], v[32:33], v[32:33] op_sel:[0,1,0] op_sel_hi:[1,1,0]
s_add_u32 m0, s75, 36864
s_nop 0
buffer_load_dwordx4 v6, s[24:27], s74 offen sc1 lds
v_pk_fma_f32 v[48:49], v[48:49], v[32:33], v[32:33] op_sel:[0,1,0] op_sel_hi:[1,1,0]
v_pk_fma_f32 v[50:51], v[50:51], v[32:33], v[32:33] op_sel:[0,1,0] op_sel_hi:[1,1,0]
v_pk_mul_f32 v[44:45], v[136:137], v[44:45]
v_pk_mul_f32 v[46:47], v[138:139], v[46:47]
v_pk_mul_f32 v[48:49], v[140:141], v[48:49]
v_pk_mul_f32 v[50:51], v[142:143], v[50:51]
buffer_load_dwordx4 v7, s[24:27], s74 offen offset:1024 sc1 lds
v_exp_f32 v44, v44
v_exp_f32 v45, v45
v_exp_f32 v46, v46
v_exp_f32 v47, v47
v_exp_f32 v48, v48
v_exp_f32 v49, v49
v_exp_f32 v50, v50
s_mov_b32 exec_hi, 0
buffer_load_dwordx4 v8, s[24:27], s74 offen offset:2048 sc1 lds
s_mov_b32 exec_hi, -1
v_exp_f32 v51, v51
v_pk_mul_f32 v[136:137], v[136:137], v[168:169]
v_pk_mul_f32 v[138:139], v[138:139], v[170:171]
v_pk_mul_f32 v[140:141], v[140:141], v[172:173]
v_pk_mul_f32 v[142:143], v[142:143], v[174:175]
v_pk_fma_f32 v[44:45], v[44:45], v[34:35], v[34:35] op_sel:[0,0,0] op_sel_hi:[1,0,0]
v_pk_fma_f32 v[46:47], v[46:47], v[34:35], v[34:35] op_sel:[0,0,0] op_sel_hi:[1,0,0]
s_add_u32 m0, s58, 0
s_nop 0
buffer_load_dwordx4 v5, s[24:27], s76 offen sc1 lds
v_pk_fma_f32 v[48:49], v[48:49], v[34:35], v[34:35] op_sel:[0,0,0] op_sel_hi:[1,0,0]
v_pk_fma_f32 v[50:51], v[50:51], v[34:35], v[34:35] op_sel:[0,0,0] op_sel_hi:[1,0,0]
v_rcp_f32 v44, v44
v_rcp_f32 v45, v45
v_rcp_f32 v46, v46
v_rcp_f32 v47, v47
v_rcp_f32 v48, v48
buffer_load_dwordx4 v5, s[24:27], s76 offen offset:1024 sc1 lds
v_rcp_f32 v49, v49
v_rcp_f32 v50, v50
v_rcp_f32 v51, v51
v_pk_mul_f32 v[136:137], v[136:137], v[44:45]
v_pk_mul_f32 v[138:139], v[138:139], v[46:47]
v_pk_mul_f32 v[140:141], v[140:141], v[48:49]
s_mov_b32 exec_hi, 0
buffer_load_dwordx4 v5, s[24:27], s76 offen offset:2048 sc1 lds
s_mov_b32 exec_hi, -1
v_pk_mul_f32 v[142:143], v[142:143], v[50:51]
v_cvt_pk_bf16_f32 v164, v136, v137
v_cvt_pk_bf16_f32 v165, v138, v139
v_cvt_pk_bf16_f32 v166, v140, v141
v_cvt_pk_bf16_f32 v167, v142, v143
buffer_store_dwordx4 v[160:163], v17, s[24:27], s61 offen sc1
buffer_store_dwordx4 v[164:167], v17, s[24:27], s61 offen offset:512 sc1
s_add_u32 m0, s58, 36864
s_nop 0
buffer_load_dwordx4 v6, s[24:27], s57 offen sc1 lds
v_pk_mul_f32 v[44:45], v[144:145], v[144:145]
v_pk_mul_f32 v[46:47], v[146:147], v[146:147]
v_pk_mul_f32 v[48:49], v[148:149], v[148:149]
v_pk_mul_f32 v[50:51], v[150:151], v[150:151]
v_pk_fma_f32 v[44:45], v[44:45], v[36:37], v[34:35] op_sel:[0,0,1] op_sel_hi:[1,0,1]
v_pk_fma_f32 v[46:47], v[46:47], v[36:37], v[34:35] op_sel:[0,0,1] op_sel_hi:[1,0,1]
v_pk_fma_f32 v[48:49], v[48:49], v[36:37], v[34:35] op_sel:[0,0,1] op_sel_hi:[1,0,1]
buffer_load_dwordx4 v7, s[24:27], s57 offen offset:1024 sc1 lds
v_pk_fma_f32 v[50:51], v[50:51], v[36:37], v[34:35] op_sel:[0,0,1] op_sel_hi:[1,0,1]
v_pk_mul_f32 v[44:45], v[144:145], v[44:45]
v_pk_mul_f32 v[46:47], v[146:147], v[46:47]
v_pk_mul_f32 v[48:49], v[148:149], v[48:49]
v_pk_mul_f32 v[50:51], v[150:151], v[50:51]
v_exp_f32 v44, v44
v_exp_f32 v45, v45
s_mov_b32 exec_hi, 0
buffer_load_dwordx4 v8, s[24:27], s57 offen offset:2048 sc1 lds
s_mov_b32 exec_hi, -1
v_exp_f32 v46, v46
v_exp_f32 v47, v47
v_exp_f32 v48, v48
v_exp_f32 v49, v49
v_exp_f32 v50, v50
v_exp_f32 v51, v51
buffer_load_dwordx4 v[64:67], v5, s[24:27], s63 offen sc1
v_pk_mul_f32 v[144:145], v[144:145], v[176:177]
v_pk_mul_f32 v[146:147], v[146:147], v[178:179]
v_pk_mul_f32 v[148:149], v[148:149], v[180:181]
v_pk_mul_f32 v[150:151], v[150:151], v[182:183]
v_pk_fma_f32 v[44:45], v[44:45], v[36:37], v[36:37] op_sel:[0,1,1] op_sel_hi:[1,1,1]
v_pk_fma_f32 v[46:47], v[46:47], v[36:37], v[36:37] op_sel:[0,1,1] op_sel_hi:[1,1,1]
v_pk_fma_f32 v[48:49], v[48:49], v[36:37], v[36:37] op_sel:[0,1,1] op_sel_hi:[1,1,1]
buffer_load_dwordx4 v[68:71], v5, s[24:27], s63 offen offset:1536 sc1
v_pk_fma_f32 v[50:51], v[50:51], v[36:37], v[36:37] op_sel:[0,1,1] op_sel_hi:[1,1,1]
v_rcp_f32 v44, v44
v_rcp_f32 v45, v45
v_rcp_f32 v46, v46
v_rcp_f32 v47, v47
v_rcp_f32 v48, v48
v_rcp_f32 v49, v49
buffer_load_dwordx2 v[72:73], v9, s[24:27], s63 offen offset:1024 sc1
v_rcp_f32 v50, v50
v_rcp_f32 v51, v51
v_pk_mul_f32 v[144:145], v[144:145], v[44:45]
v_pk_mul_f32 v[146:147], v[146:147], v[46:47]
v_pk_mul_f32 v[148:149], v[148:149], v[48:49]
v_pk_mul_f32 v[150:151], v[150:151], v[50:51]
s_add_u32 s45, s85, 48
s_lshl_b32 s45, s45, 7
s_add_u32 s45, s45, 25165824
v_min_u32 v78, 15, v1
v_lshl_add_u32 v78, v78, 2, s45
s_lshl_b32 s45, s2, 2
s_add_u32 s45, s45, s42
s_lshl_b32 s45, s45, 7
s_add_u32 s45, s45, 27262976
s_cmp_eq_u32 s42, 0
s_cselect_b64 s[48:49], -1, 0
v_mov_b32 v79, s45
v_cndmask_b32_e64 v78, v79, v78, s[48:49]
buffer_load_dword v79, v78, s[24:27], 0 offen sc1
v_cvt_pk_bf16_f32 v176, v144, v145
v_cvt_pk_bf16_f32 v177, v146, v147
v_cvt_pk_bf16_f32 v178, v148, v149
v_cvt_pk_bf16_f32 v179, v150, v151
v_pk_mul_f32 v[44:45], v[152:153], v[152:153]
v_pk_mul_f32 v[46:47], v[154:155], v[154:155]
v_pk_mul_f32 v[48:49], v[156:157], v[156:157]
v_pk_mul_f32 v[50:51], v[158:159], v[158:159]
v_pk_fma_f32 v[44:45], v[44:45], v[36:37], v[34:35] op_sel:[0,0,1] op_sel_hi:[1,0,1]
v_pk_fma_f32 v[46:47], v[46:47], v[36:37], v[34:35] op_sel:[0,0,1] op_sel_hi:[1,0,1]
v_pk_fma_f32 v[48:49], v[48:49], v[36:37], v[34:35] op_sel:[0,0,1] op_sel_hi:[1,0,1]
v_pk_fma_f32 v[50:51], v[50:51], v[36:37], v[34:35] op_sel:[0,0,1] op_sel_hi:[1,0,1]
v_pk_mul_f32 v[44:45], v[152:153], v[44:45]
v_pk_mul_f32 v[46:47], v[154:155], v[46:47]
v_pk_mul_f32 v[48:49], v[156:157], v[48:49]
v_pk_mul_f32 v[50:51], v[158:159], v[50:51]
v_exp_f32 v44, v44
v_exp_f32 v45, v45
v_exp_f32 v46, v46
v_exp_f32 v47, v47
v_exp_f32 v48, v48
v_exp_f32 v49, v49
v_exp_f32 v50, v50
v_exp_f32 v51, v51
v_pk_mul_f32 v[152:153], v[152:153], v[184:185]
v_pk_mul_f32 v[154:155], v[154:155], v[186:187]
v_pk_mul_f32 v[156:157], v[156:157], v[188:189]
v_pk_mul_f32 v[158:159], v[158:159], v[190:191]
v_pk_fma_f32 v[44:45], v[44:45], v[36:37], v[36:37] op_sel:[0,1,1] op_sel_hi:[1,1,1]
v_pk_fma_f32 v[46:47], v[46:47], v[36:37], v[36:37] op_sel:[0,1,1] op_sel_hi:[1,1,1]
v_pk_fma_f32 v[48:49], v[48:49], v[36:37], v[36:37] op_sel:[0,1,1] op_sel_hi:[1,1,1]
v_pk_fma_f32 v[50:51], v[50:51], v[36:37], v[36:37] op_sel:[0,1,1] op_sel_hi:[1,1,1]
v_rcp_f32 v44, v44
v_rcp_f32 v45, v45
v_rcp_f32 v46, v46
v_rcp_f32 v47, v47
v_rcp_f32 v48, v48
v_rcp_f32 v49, v49
v_rcp_f32 v50, v50
v_rcp_f32 v51, v51
v_pk_mul_f32 v[152:153], v[152:153], v[44:45]
v_pk_mul_f32 v[154:155], v[154:155], v[46:47]
v_pk_mul_f32 v[156:157], v[156:157], v[48:49]
v_pk_mul_f32 v[158:159], v[158:159], v[50:51]
v_cvt_pk_bf16_f32 v180, v152, v153
v_cvt_pk_bf16_f32 v181, v154, v155
v_cvt_pk_bf16_f32 v182, v156, v157
v_cvt_pk_bf16_f32 v183, v158, v159
buffer_store_dwordx4 v[176:179], v17, s[24:27], s62 offen sc1
buffer_store_dwordx4 v[180:183], v17, s[24:27], s62 offen offset:512 sc1
s_branch L_common
L_common:
v_mov_b32 v74, v5
v_and_b32 v18, 31, v1
v_lshrrev_b32 v19, 5, v1
v_mov_b32 v22, 0x3f803f80
v_mov_b32 v23, 0x3f803f80
v_mov_b32 v24, 0x3f803f80
v_mov_b32 v25, 0x3f803f80
s_mul_i32 s47, s42, 9216
s_add_u32 s47, s47, 39424
v_lshl_add_u32 v20, v18, 4, s47
s_mov_b32 exec_hi, 0
ds_write_b128 v20, v[22:25] offset:0
ds_write_b128 v20, v[22:25] offset:3072
ds_write_b128 v20, v[22:25] offset:6144
s_mov_b32 exec_hi, -1
v_lshlrev_b32 v20, 2, v19
v_sub_u32 v20, v18, v20
v_mov_b32 v21, 0xf149f2ca
v_cmp_gt_i32 s[50:51], 0, v20
v_cmp_gt_i32 s[52:53], 1, v20
s_nop 0
v_cndmask_b32_e64 v116, v21, 0, s[50:51]
v_cndmask_b32_e64 v132, 0, v21, s[50:51]
v_cmp_gt_i32 s[50:51], 2, v20
v_cndmask_b32_e64 v117, v21, 0, s[52:53]
v_cndmask_b32_e64 v133, 0, v21, s[52:53]
v_cmp_gt_i32 s[52:53], 3, v20
v_cndmask_b32_e64 v118, v21, 0, s[50:51]
v_cndmask_b32_e64 v134, 0, v21, s[50:51]
v_cmp_gt_i32 s[50:51], 8, v20
v_cndmask_b32_e64 v119, v21, 0, s[52:53]
v_cndmask_b32_e64 v135, 0, v21, s[52:53]
v_cmp_gt_i32 s[52:53], 9, v20
v_cndmask_b32_e64 v120, v21, 0, s[50:51]
v_cndmask_b32_e64 v136, 0, v21, s[50:51]
v_cmp_gt_i32 s[50:51], 10, v20
v_cndmask_b32_e64 v121, v21, 0, s[52:53]
v_cndmask_b32_e64 v137, 0, v21, s[52:53]
v_cmp_gt_i32 s[52:53], 11, v20
v_cndmask_b32_e64 v122, v21, 0, s[50:51]
v_cndmask_b32_e64 v138, 0, v21, s[50:51]
v_cmp_gt_i32 s[50:51], 16, v20
v_cndmask_b32_e64 v123, v21, 0, s[52:53]
v_cndmask_b32_e64 v139, 0, v21, s[52:53]
v_cmp_gt_i32 s[52:53], 17, v20
v_cndmask_b32_e64 v124, v21, 0, s[50:51]
v_cndmask_b32_e64 v140, 0, v21, s[50:51]
v_cmp_gt_i32 s[50:51], 18, v20
v_cndmask_b32_e64 v125, v21, 0, s[52:53]
v_cndmask_b32_e64 v141, 0, v21, s[52:53]
v_cmp_gt_i32 s[52:53], 19, v20
v_cndmask_b32_e64 v126, v21, 0, s[50:51]
v_cndmask_b32_e64 v142, 0, v21, s[50:51]
v_cmp_gt_i32 s[50:51], 24, v20
v_cndmask_b32_e64 v127, v21, 0, s[52:53]
v_cndmask_b32_e64 v143, 0, v21, s[52:53]
v_cmp_gt_i32 s[52:53], 25, v20
v_cndmask_b32_e64 v128, v21, 0, s[50:51]
v_cndmask_b32_e64 v144, 0, v21, s[50:51]
v_cmp_gt_i32 s[50:51], 26, v20
v_cndmask_b32_e64 v129, v21, 0, s[52:53]
v_cndmask_b32_e64 v145, 0, v21, s[52:53]
v_cmp_gt_i32 s[52:53], 27, v20
v_cndmask_b32_e64 v130, v21, 0, s[50:51]
v_cndmask_b32_e64 v146, 0, v21, s[50:51]
v_cndmask_b32_e64 v131, v21, 0, s[52:53]
v_cndmask_b32_e64 v147, 0, v21, s[52:53]
s_mul_i32 s47, s42, 3072
v_add_u32 v7, s47, v74
v_lshlrev_b32 v20, 4, v18
v_lshl_add_u32 v20, v19, 3, v20
v_add_u32 v8, s47, v20
v_lshrrev_b32 v20, 4, v18
v_mul_u32_u24 v20, 20480, v20
v_and_b32 v21, 15, v18
v_lshl_add_u32 v20, v21, 4, v20
v_lshl_add_u32 v9, v19, 8, v20
v_cmp_gt_u32 s[50:51], 32, v1
s_nop 1
v_cndmask_b32_e64 v180, 0, -1, s[50:51]
v_not_b32 v181, v180
v_mov_b32 v182, 16256
v_bfe_u32 v20, v1, 4, 1
v_bfe_u32 v21, v1, 2, 2
v_and_b32 v22, 3, v1
v_cmp_eq_u32 s[50:51], 1, v20
v_cmp_eq_u32 s[52:53], 0, v22
s_nop 0
s_and_b64 s[52:53], s[52:53], s[50:51]
v_and_b32 v23, 1, v22
v_mov_b32 v24, v23
v_add_u32 v23, 0, v23
v_lshrrev_b32 v25, 1, v22
v_and_b32 v26, 1, v22
v_cndmask_b32_e64 v23, v23, 5, s[50:51]
v_cndmask_b32_e64 v24, v24, 3, s[50:51]
v_cndmask_b32_e64 v25, v25, v26, s[50:51]
v_cndmask_b32_e64 v23, v23, 2, s[52:53]
v_cndmask_b32_e64 v24, v24, 2, s[52:53]
v_cndmask_b32_e64 v25, v25, 0, s[52:53]
v_lshl_add_u32 v26, v19, 2, v21
v_lshlrev_b32 v24, 2, v24
v_xor_b32 v26, v26, v24
v_lshlrev_b32 v26, 4, v26
v_lshl_add_u32 v26, v23, 9, v26
v_lshl_add_u32 v26, v25, 3, v26
s_mul_i32 s47, s42, 3072
s_add_u32 s47, s47, 36864
v_add_u32 v3, s47, v26
v_xor_b32 v4, 128, v3
v_and_b32 v23, 1, v22
v_mov_b32 v24, v23
v_add_u32 v23, 3, v23
v_lshrrev_b32 v25, 1, v22
v_and_b32 v26, 1, v22
v_cndmask_b32_e64 v23, v23, 5, s[50:51]
v_cndmask_b32_e64 v24, v24, 3, s[50:51]
v_cndmask_b32_e64 v25, v25, v26, s[50:51]
v_cndmask_b32_e64 v23, v23, 2, s[52:53]
v_cndmask_b32_e64 v24, v24, 2, s[52:53]
v_cndmask_b32_e64 v25, v25, 1, s[52:53]
v_lshl_add_u32 v26, v19, 2, v21
v_lshlrev_b32 v24, 2, v24
v_xor_b32 v26, v26, v24
v_lshlrev_b32 v26, 4, v26
v_lshl_add_u32 v26, v23, 9, v26
v_lshl_add_u32 v26, v25, 3, v26
s_mul_i32 s47, s42, 3072
s_add_u32 s47, s47, 36864
v_add_u32 v5, s47, v26
v_xor_b32 v6, 128, v5
s_waitcnt vmcnt(3)
v_bfi_b32 v12, v180, v72, v182
v_and_b32 v13, v180, v73
v_bfi_b32 v14, v181, v72, v182
v_and_b32 v15, v181, v73
s_waitcnt vmcnt(2)
s_cmp_lg_u32 s42, 0
s_cbranch_scc1 L_pc_25
v_cmp_ne_u32 s[48:49], s79, v79
s_nop 1
s_cmp_eq_u64 s[48:49], 0
s_cbranch_scc1 L_pc_25
s_cmp_lg_u32 s42, 0
s_cbranch_scc1 L_poll_26_ok
s_mov_b32 s46, 0x40000
L_poll_26:
buffer_load_dword v79, v78, s[24:27], 0 offen sc1
s_waitcnt vmcnt(0)
v_cmp_ne_u32 s[48:49], s79, v79
s_nop 1
s_cmp_eq_u64 s[48:49], 0
s_cbranch_scc1 L_poll_26_ok
s_sleep 1
s_sub_u32 s46, s46, 1
s_cmp_lg_u32 s46, 0
s_cbranch_scc1 L_poll_26
L_poll_26_ok:
L_pc_25:
s_waitcnt lgkmcnt(0)
s_barrier
ds_read_b128 a[0:3], v7 offset:0
ds_read_b64 v[98:99], v8 offset:1024
ds_read_b128 a[4:7], v7 offset:3072
ds_read_b64 v[100:101], v8 offset:4096
ds_read_b128 a[8:11], v7 offset:6144
ds_read_b64 v[102:103], v8 offset:7168
ds_read_b128 a[12:15], v7 offset:9216
ds_read_b64 v[104:105], v8 offset:10240
ds_read_b128 a[16:19], v7 offset:12288
ds_read_b64 v[106:107], v8 offset:13312
ds_read_b128 a[20:23], v7 offset:15360
ds_read_b64 v[108:109], v8 offset:16384
ds_read_b128 a[24:27], v7 offset:18432
ds_read_b64 v[110:111], v8 offset:19456
ds_read_b128 a[28:31], v7 offset:21504
ds_read_b64 v[112:113], v8 offset:22528
ds_read_b128 a[32:35], v7 offset:24576
ds_read_b64 v[114:115], v8 offset:25600
v_mov_b32 v183, 0x3f800000
s_waitcnt lgkmcnt(15)
v_bfi_b32 v80, v180, v98, v183
v_bfi_b32 v81, v180, v99, v182
v_bfi_b32 v98, v181, v98, v183
v_bfi_b32 v99, v181, v99, v182
s_waitcnt lgkmcnt(14)
v_bfi_b32 v82, v180, v100, v183
v_bfi_b32 v83, v180, v101, v182
v_bfi_b32 v100, v181, v100, v183
v_bfi_b32 v101, v181, v101, v182
s_waitcnt lgkmcnt(12)
v_bfi_b32 v84, v180, v102, v183
v_bfi_b32 v85, v180, v103, v182
v_bfi_b32 v102, v181, v102, v183
v_bfi_b32 v103, v181, v103, v182
s_waitcnt lgkmcnt(10)
v_bfi_b32 v86, v180, v104, v183
v_bfi_b32 v87, v180, v105, v182
v_bfi_b32 v104, v181, v104, v183
v_bfi_b32 v105, v181, v105, v182
s_waitcnt lgkmcnt(8)
v_bfi_b32 v88, v180, v106, v183
v_bfi_b32 v89, v180, v107, v182
v_bfi_b32 v106, v181, v106, v183
v_bfi_b32 v107, v181, v107, v182
s_waitcnt lgkmcnt(6)
v_bfi_b32 v90, v180, v108, v183
v_bfi_b32 v91, v180, v109, v182
v_bfi_b32 v108, v181, v108, v183
v_bfi_b32 v109, v181, v109, v182
s_waitcnt lgkmcnt(4)
v_bfi_b32 v92, v180, v110, v183
v_bfi_b32 v93, v180, v111, v182
v_bfi_b32 v110, v181, v110, v183
v_bfi_b32 v111, v181, v111, v182
s_waitcnt lgkmcnt(2)
v_bfi_b32 v94, v180, v112, v183
v_bfi_b32 v95, v180, v113, v182
v_bfi_b32 v112, v181, v112, v183
v_bfi_b32 v113, v181, v113, v182
s_waitcnt lgkmcnt(0)
v_bfi_b32 v96, v180, v114, v183
v_bfi_b32 v97, v180, v115, v182
v_bfi_b32 v114, v181, v114, v183
v_bfi_b32 v115, v181, v115, v182
s_cmp_eq_u32 s83, 0
s_cbranch_scc1 L_kp_30
v_mov_b32 v18, 0x3f80f149
s_cmp_le_u32 s83, 0
s_cbranch_scc1 L_kp_30
v_bfi_b32 v80, v180, v80, v18
v_bfi_b32 v98, v181, v98, v18
s_cmp_le_u32 s83, 1
s_cbranch_scc1 L_kp_30
v_bfi_b32 v82, v180, v82, v18
v_bfi_b32 v100, v181, v100, v18
s_cmp_le_u32 s83, 2
s_cbranch_scc1 L_kp_30
v_bfi_b32 v84, v180, v84, v18
v_bfi_b32 v102, v181, v102, v18
s_cmp_le_u32 s83, 3
s_cbranch_scc1 L_kp_30
v_bfi_b32 v86, v180, v86, v18
v_bfi_b32 v104, v181, v104, v18
s_cmp_le_u32 s83, 4
s_cbranch_scc1 L_kp_30
v_bfi_b32 v88, v180, v88, v18
v_bfi_b32 v106, v181, v106, v18
s_cmp_le_u32 s83, 5
s_cbranch_scc1 L_kp_30
v_bfi_b32 v90, v180, v90, v18
v_bfi_b32 v108, v181, v108, v18
s_cmp_le_u32 s83, 6
s_cbranch_scc1 L_kp_30
v_bfi_b32 v92, v180, v92, v18
v_bfi_b32 v110, v181, v110, v18
s_cmp_le_u32 s83, 7
s_cbranch_scc1 L_kp_30
v_bfi_b32 v94, v180, v94, v18
v_bfi_b32 v112, v181, v112, v18
L_kp_30:
v_mov_b32 v10, 0xf149f2ca
v_mfma_f32_32x32x16_bf16 v[148:163], a[0:3], v[64:67], v[116:131]
v_mfma_f32_32x32x8bf16_1k v[148:163], v[80:81], v[12:13], v[148:163]
ds_read_b128 a[36:39], v7 offset:1536
v_mfma_f32_32x32x16_bf16 v[164:179], a[4:7], v[64:67], 0
ds_read_b64_tr_b16 a[72:73], v3 offset:0
ds_read_b64_tr_b16 a[74:75], v4 offset:0
s_nop 7
v_max3_f32 v10, v148, v149, v10
v_max3_f32 v10, v150, v151, v10
v_max3_f32 v10, v152, v153, v10
v_max3_f32 v10, v154, v155, v10
v_mfma_f32_32x32x8bf16_1k v[164:179], v[82:83], v[12:13], v[164:179]
ds_read_b64_tr_b16 a[76:77], v3 offset:256
ds_read_b64_tr_b16 a[78:79], v4 offset:256
s_add_u32 m0, s89, 81920
s_add_u32 s60, s88, 0
buffer_load_dwordx4 v74, s[24:27], s60 offen offset:0 sc1 lds
v_max3_f32 v10, v156, v157, v10
v_max3_f32 v10, v158, v159, v10
v_max3_f32 v10, v160, v161, v10
v_max3_f32 v10, v162, v163, v10
ds_read_b128 a[40:43], v7 offset:4608
v_mfma_f32_32x32x16_bf16 v[148:163], a[8:11], v[64:67], 0
ds_read_b64_tr_b16 a[80:81], v3 offset:3072
ds_read_b64_tr_b16 a[82:83], v4 offset:3072
v_max3_f32 v10, v164, v165, v10
v_max3_f32 v10, v166, v167, v10
v_max3_f32 v10, v168, v169, v10
v_max3_f32 v10, v170, v171, v10
v_mfma_f32_32x32x8bf16_1k v[148:163], v[84:85], v[12:13], v[148:163]
ds_read_b64_tr_b16 a[84:85], v3 offset:3328
buffer_load_dwordx4 v74, s[24:27], s60 offen offset:1024 sc1 lds
ds_read_b64_tr_b16 a[86:87], v4 offset:3328
v_max3_f32 v10, v172, v173, v10
v_max3_f32 v10, v174, v175, v10
v_max3_f32 v10, v176, v177, v10
v_max3_f32 v10, v178, v179, v10
ds_read_b128 a[44:47], v7 offset:7680
v_mfma_f32_32x32x16_bf16 v[164:179], a[12:15], v[64:67], 0
ds_read_b64_tr_b16 a[88:89], v3 offset:6144
ds_read_b64_tr_b16 a[90:91], v4 offset:6144
s_nop 0
v_max3_f32 v10, v148, v149, v10
v_max3_f32 v10, v150, v151, v10
v_max3_f32 v10, v152, v153, v10
v_max3_f32 v10, v154, v155, v10
buffer_load_dwordx4 v74, s[24:27], s60 offen offset:2048 sc1 lds
v_mfma_f32_32x32x8bf16_1k v[164:179], v[86:87], v[12:13], v[164:179]
ds_read_b64_tr_b16 a[92:93], v3 offset:6400
ds_read_b64_tr_b16 a[94:95], v4 offset:6400
v_max3_f32 v10, v156, v157, v10
v_max3_f32 v10, v158, v159, v10
v_max3_f32 v10, v160, v161, v10
v_max3_f32 v10, v162, v163, v10
ds_read_b128 a[48:51], v7 offset:10752
v_mfma_f32_32x32x16_bf16 v[148:163], a[16:19], v[64:67], 0
ds_read_b64_tr_b16 a[96:97], v3 offset:9216
ds_read_b64_tr_b16 a[98:99], v4 offset:9216
s_nop 1
v_max3_f32 v10, v164, v165, v10
v_max3_f32 v10, v166, v167, v10
v_max3_f32 v10, v168, v169, v10
buffer_load_dwordx4 v74, s[24:27], s60 offen offset:3072 sc1 lds
v_max3_f32 v10, v170, v171, v10
v_mfma_f32_32x32x8bf16_1k v[148:163], v[88:89], v[12:13], v[148:163]
ds_read_b64_tr_b16 a[100:101], v3 offset:9472
ds_read_b64_tr_b16 a[102:103], v4 offset:9472
v_max3_f32 v10, v172, v173, v10
v_max3_f32 v10, v174, v175, v10
v_max3_f32 v10, v176, v177, v10
v_max3_f32 v10, v178, v179, v10
ds_read_b128 a[52:55], v7 offset:13824
v_mfma_f32_32x32x16_bf16 v[164:179], a[20:23], v[64:67], 0
ds_read_b64_tr_b16 a[104:105], v3 offset:12288
ds_read_b64_tr_b16 a[106:107], v4 offset:12288
s_nop 1
v_max3_f32 v10, v148, v149, v10
s_add_u32 m0, s89, 86016
s_add_u32 s60, s60, 4096
buffer_load_dwordx4 v74, s[24:27], s60 offen sc1 lds
v_max3_f32 v10, v150, v151, v10
v_max3_f32 v10, v152, v153, v10
v_max3_f32 v10, v154, v155, v10
v_mfma_f32_32x32x8bf16_1k v[164:179], v[90:91], v[12:13], v[164:179]
ds_read_b64_tr_b16 a[108:109], v3 offset:12544
ds_read_b64_tr_b16 a[110:111], v4 offset:12544
v_max3_f32 v10, v156, v157, v10
v_max3_f32 v10, v158, v159, v10
v_max3_f32 v10, v160, v161, v10
v_max3_f32 v10, v162, v163, v10
ds_read_b128 a[56:59], v7 offset:16896
v_mfma_f32_32x32x16_bf16 v[148:163], a[24:27], v[64:67], 0
ds_read_b64_tr_b16 a[112:113], v3 offset:15360
ds_read_b64_tr_b16 a[114:115], v4 offset:15360
s_add_u32 m0, s89, 102400
s_add_u32 s60, s88, 20480
buffer_load_dwordx4 v74, s[24:27], s60 offen offset:0 sc1 lds
v_max3_f32 v10, v164, v165, v10
v_max3_f32 v10, v166, v167, v10
v_max3_f32 v10, v168, v169, v10
v_max3_f32 v10, v170, v171, v10
v_mfma_f32_32x32x8bf16_1k v[148:163], v[92:93], v[12:13], v[148:163]
ds_read_b64_tr_b16 a[116:117], v3 offset:15616
ds_read_b64_tr_b16 a[118:119], v4 offset:15616
v_max3_f32 v10, v172, v173, v10
v_max3_f32 v10, v174, v175, v10
v_max3_f32 v10, v176, v177, v10
v_max3_f32 v10, v178, v179, v10
ds_read_b128 a[60:63], v7 offset:19968
v_mfma_f32_32x32x16_bf16 v[164:179], a[28:31], v[64:67], 0
ds_read_b64_tr_b16 a[120:121], v3 offset:18432
buffer_load_dwordx4 v74, s[24:27], s60 offen offset:1024 sc1 lds
ds_read_b64_tr_b16 a[122:123], v4 offset:18432
s_nop 0
v_max3_f32 v10, v148, v149, v10
v_max3_f32 v10, v150, v151, v10
v_max3_f32 v10, v152, v153, v10
v_max3_f32 v10, v154, v155, v10
v_mfma_f32_32x32x8bf16_1k v[164:179], v[94:95], v[12:13], v[164:179]
ds_read_b64_tr_b16 a[124:125], v3 offset:18688
ds_read_b64_tr_b16 a[126:127], v4 offset:18688
v_max3_f32 v10, v156, v157, v10
v_max3_f32 v10, v158, v159, v10
v_max3_f32 v10, v160, v161, v10
v_max3_f32 v10, v162, v163, v10
ds_read_b128 a[64:67], v7 offset:23040
buffer_load_dwordx4 v74, s[24:27], s60 offen offset:2048 sc1 lds
v_mfma_f32_32x32x16_bf16 v[148:163], a[32:35], v[64:67], v[132:147]
ds_read_b64_tr_b16 a[128:129], v3 offset:21504
ds_read_b64_tr_b16 a[130:131], v4 offset:21504
s_nop 0
v_max3_f32 v10, v164, v165, v10
v_max3_f32 v10, v166, v167, v10
v_max3_f32 v10, v168, v169, v10
v_max3_f32 v10, v170, v171, v10
v_mfma_f32_32x32x8bf16_1k v[148:163], v[96:97], v[12:13], v[148:163]
ds_read_b64_tr_b16 a[132:133], v3 offset:21760
ds_read_b64_tr_b16 a[134:135], v4 offset:21760
v_max3_f32 v10, v172, v173, v10
v_max3_f32 v10, v174, v175, v10
v_max3_f32 v10, v176, v177, v10
v_max3_f32 v10, v178, v179, v10
buffer_load_dwordx4 v74, s[24:27], s60 offen offset:3072 sc1 lds
ds_read_b128 a[68:71], v7 offset:26112
ds_read_b64_tr_b16 a[136:137], v3 offset:24576
ds_read_b64_tr_b16 a[138:139], v4 offset:24576
s_nop 1
v_max3_f32 v10, v148, v149, v10
v_max3_f32 v10, v150, v151, v10
v_max3_f32 v10, v152, v153, v10
v_max3_f32 v10, v154, v155, v10
ds_read_b64_tr_b16 a[140:141], v3 offset:24832
ds_read_b64_tr_b16 a[142:143], v4 offset:24832
v_max3_f32 v10, v156, v157, v10
v_max3_f32 v10, v158, v159, v10
v_max3_f32 v10, v160, v161, v10
v_max3_f32 v10, v162, v163, v10
s_add_u32 m0, s89, 106496
s_add_u32 s60, s60, 4096
buffer_load_dwordx4 v74, s[24:27], s60 offen sc1 lds
v_mov_b32 v18, v10
s_nop 1
v_permlane32_swap_b32 v10, v18
v_max_f32 v10, v10, v18
v_sub_f32 v10, 0, v10
v_cvt_pk_bf16_f32 v18, v10, v10
v_and_b32 v19, 0xffff0000, v18
v_sub_f32 v20, v10, v19
v_cvt_pk_bf16_f32 v20, v20, 0
v_or_b32 v19, v182, v19
v_bfi_b32 v16, v180, v72, v19
v_bfi_b32 v17, v180, v73, v20
s_waitcnt lgkmcnt(0)
s_waitcnt vmcnt(10)
s_barrier
s_cmp_lg_u32 s42, 0
s_cbranch_scc1 L_sig_27
s_add_u32 s46, s77, 16
s_lshl_b32 s46, s46, 5
s_add_u32 s46, s46, s96
s_lshl_b32 s46, s46, 2
s_add_u32 s46, s46, 25165824
s_mov_b64 exec, 1
v_mov_b32 v22, s46
v_mov_b32 v23, s79
buffer_store_dword v23, v22, s[24:27], 0 offen sc1
s_mov_b64 exec, -1
L_sig_27:
v_mfma_f32_32x32x16_bf16 v[148:163], a[0:3], v[64:67], v[116:131]
v_mfma_f32_32x32x8bf16_1k v[148:163], v[80:81], v[16:17], v[148:163]
v_mfma_f32_32x32x16_bf16 v[164:179], a[4:7], v[64:67], 0
s_nop 10
v_exp_f32 v148, v148
v_exp_f32 v149, v149
v_exp_f32 v150, v150
v_exp_f32 v151, v151
v_cvt_pk_bf16_f32 v32, v148, v149
v_exp_f32 v152, v152
v_exp_f32 v153, v153
v_cvt_pk_bf16_f32 v33, v150, v151
v_exp_f32 v154, v154
v_exp_f32 v155, v155
v_cvt_pk_bf16_f32 v34, v152, v153
v_exp_f32 v156, v156
v_mfma_f32_32x32x8bf16_1k v[164:179], v[82:83], v[16:17], v[164:179]
v_exp_f32 v157, v157
v_cvt_pk_bf16_f32 v35, v154, v155
s_add_u32 m0, s89, 122880
s_add_u32 s60, s88, 40960
buffer_load_dwordx4 v74, s[24:27], s60 offen offset:0 sc1 lds
v_exp_f32 v158, v158
v_exp_f32 v159, v159
v_cvt_pk_bf16_f32 v36, v156, v157
v_exp_f32 v160, v160
v_exp_f32 v161, v161
v_cvt_pk_bf16_f32 v37, v158, v159
v_exp_f32 v162, v162
v_exp_f32 v163, v163
v_cvt_pk_bf16_f32 v38, v160, v161
v_cvt_pk_bf16_f32 v39, v162, v163
v_mfma_f32_32x32x16_bf16 v[148:163], a[8:11], v[64:67], 0
v_exp_f32 v164, v164
v_exp_f32 v165, v165
v_exp_f32 v166, v166
v_exp_f32 v167, v167
v_cvt_pk_bf16_f32 v40, v164, v165
v_exp_f32 v168, v168
v_mfma_f32_32x32x8bf16_1k v[148:163], v[84:85], v[16:17], v[148:163]
buffer_load_dwordx4 v74, s[24:27], s60 offen offset:1024 sc1 lds
v_exp_f32 v169, v169
v_cvt_pk_bf16_f32 v41, v166, v167
v_exp_f32 v170, v170
v_exp_f32 v171, v171
v_cvt_pk_bf16_f32 v42, v168, v169
v_exp_f32 v172, v172
v_mfma_f32_32x32x16_bf16 v[48:63], a[72:75], v[32:35], 0
v_exp_f32 v173, v173
v_cvt_pk_bf16_f32 v43, v170, v171
v_exp_f32 v174, v174
v_exp_f32 v175, v175
v_cvt_pk_bf16_f32 v44, v172, v173
v_exp_f32 v176, v176
v_mfma_f32_32x32x16_bf16 v[48:63], a[76:79], v[36:39], v[48:63]
v_exp_f32 v177, v177
v_cvt_pk_bf16_f32 v45, v174, v175
v_exp_f32 v178, v178
v_exp_f32 v179, v179
buffer_load_dwordx4 v74, s[24:27], s60 offen offset:2048 sc1 lds
v_cvt_pk_bf16_f32 v46, v176, v177
v_cvt_pk_bf16_f32 v47, v178, v179
v_mfma_f32_32x32x16_bf16 v[164:179], a[12:15], v[64:67], 0
v_exp_f32 v148, v148
v_exp_f32 v149, v149
v_exp_f32 v150, v150
v_exp_f32 v151, v151
v_cvt_pk_bf16_f32 v32, v148, v149
v_exp_f32 v152, v152
v_mfma_f32_32x32x8bf16_1k v[164:179], v[86:87], v[16:17], v[164:179]
v_exp_f32 v153, v153
v_cvt_pk_bf16_f32 v33, v150, v151
v_exp_f32 v154, v154
v_exp_f32 v155, v155
v_cvt_pk_bf16_f32 v34, v152, v153
v_exp_f32 v156, v156
v_mfma_f32_32x32x16_bf16 v[48:63], a[80:83], v[40:43], v[48:63]
buffer_load_dwordx4 v74, s[24:27], s60 offen offset:3072 sc1 lds
v_exp_f32 v157, v157
v_cvt_pk_bf16_f32 v35, v154, v155
v_exp_f32 v158, v158
v_exp_f32 v159, v159
v_cvt_pk_bf16_f32 v36, v156, v157
v_exp_f32 v160, v160
v_mfma_f32_32x32x16_bf16 v[48:63], a[84:87], v[44:47], v[48:63]
v_exp_f32 v161, v161
v_cvt_pk_bf16_f32 v37, v158, v159
v_exp_f32 v162, v162
v_exp_f32 v163, v163
v_cvt_pk_bf16_f32 v38, v160, v161
v_cvt_pk_bf16_f32 v39, v162, v163
v_mfma_f32_32x32x16_bf16 v[148:163], a[16:19], v[64:67], 0
v_exp_f32 v164, v164
v_exp_f32 v165, v165
v_exp_f32 v166, v166
v_exp_f32 v167, v167
s_add_u32 m0, s89, 126976
s_add_u32 s60, s60, 4096
buffer_load_dwordx4 v74, s[24:27], s60 offen sc1 lds
v_cvt_pk_bf16_f32 v40, v164, v165
v_exp_f32 v168, v168
v_mfma_f32_32x32x8bf16_1k v[148:163], v[88:89], v[16:17], v[148:163]
v_exp_f32 v169, v169
v_cvt_pk_bf16_f32 v41, v166, v167
v_exp_f32 v170, v170
v_exp_f32 v171, v171
v_cvt_pk_bf16_f32 v42, v168, v169
v_exp_f32 v172, v172
v_mfma_f32_32x32x16_bf16 v[48:63], a[88:91], v[32:35], v[48:63]
v_exp_f32 v173, v173
v_cvt_pk_bf16_f32 v43, v170, v171
v_exp_f32 v174, v174
v_exp_f32 v175, v175
v_cvt_pk_bf16_f32 v44, v172, v173
v_exp_f32 v176, v176
v_mfma_f32_32x32x16_bf16 v[48:63], a[92:95], v[36:39], v[48:63]
v_exp_f32 v177, v177
s_add_u32 m0, s89, 143360
s_add_u32 s60, s88, 61440
buffer_load_dwordx4 v74, s[24:27], s60 offen offset:0 sc1 lds
v_cvt_pk_bf16_f32 v45, v174, v175
v_exp_f32 v178, v178
v_exp_f32 v179, v179
v_cvt_pk_bf16_f32 v46, v176, v177
v_cvt_pk_bf16_f32 v47, v178, v179
v_mfma_f32_32x32x16_bf16 v[164:179], a[20:23], v[64:67], 0
v_exp_f32 v148, v148
v_exp_f32 v149, v149
v_exp_f32 v150, v150
v_exp_f32 v151, v151
v_cvt_pk_bf16_f32 v32, v148, v149
v_exp_f32 v152, v152
v_mfma_f32_32x32x8bf16_1k v[164:179], v[90:91], v[16:17], v[164:179]
v_exp_f32 v153, v153
v_cvt_pk_bf16_f32 v33, v150, v151
v_exp_f32 v154, v154
v_exp_f32 v155, v155
v_cvt_pk_bf16_f32 v34, v152, v153
buffer_load_dwordx4 v74, s[24:27], s60 offen offset:1024 sc1 lds
v_exp_f32 v156, v156
v_mfma_f32_32x32x16_bf16 v[48:63], a[96:99], v[40:43], v[48:63]
v_exp_f32 v157, v157
v_cvt_pk_bf16_f32 v35, v154, v155
v_exp_f32 v158, v158
v_exp_f32 v159, v159
v_cvt_pk_bf16_f32 v36, v156, v157
v_exp_f32 v160, v160
v_mfma_f32_32x32x16_bf16 v[48:63], a[100:103], v[44:47], v[48:63]
v_exp_f32 v161, v161
v_cvt_pk_bf16_f32 v37, v158, v159
v_exp_f32 v162, v162
v_exp_f32 v163, v163
v_cvt_pk_bf16_f32 v38, v160, v161
v_cvt_pk_bf16_f32 v39, v162, v163
s_add_u32 s45, s87, 16
s_lshl_b32 s45, s45, 7
buffer_load_dwordx4 v74, s[24:27], s60 offen offset:2048 sc1 lds
s_add_u32 s45, s45, 25165824
v_min_u32 v184, 15, v1
v_lshl_add_u32 v184, v184, 2, s45
s_lshl_b32 s45, s2, 2
s_add_u32 s45, s45, s42
s_lshl_b32 s45, s45, 7
s_add_u32 s45, s45, 27262976
s_cmp_eq_u32 s42, 0
s_cselect_b64 s[48:49], -1, 0
v_mov_b32 v185, s45
v_cndmask_b32_e64 v184, v185, v184, s[48:49]
buffer_load_dword v185, v184, s[24:27], 0 offen sc1
v_mfma_f32_32x32x16_bf16 v[148:163], a[24:27], v[64:67], 0
v_exp_f32 v164, v164
v_exp_f32 v165, v165
v_exp_f32 v166, v166
v_exp_f32 v167, v167
v_cvt_pk_bf16_f32 v40, v164, v165
buffer_load_dwordx4 v74, s[24:27], s60 offen offset:3072 sc1 lds
v_exp_f32 v168, v168
v_mfma_f32_32x32x8bf16_1k v[148:163], v[92:93], v[16:17], v[148:163]
v_exp_f32 v169, v169
v_cvt_pk_bf16_f32 v41, v166, v167
v_exp_f32 v170, v170
v_exp_f32 v171, v171
v_cvt_pk_bf16_f32 v42, v168, v169
v_exp_f32 v172, v172
v_mfma_f32_32x32x16_bf16 v[48:63], a[104:107], v[32:35], v[48:63]
v_exp_f32 v173, v173
v_cvt_pk_bf16_f32 v43, v170, v171
v_exp_f32 v174, v174
v_exp_f32 v175, v175
v_cvt_pk_bf16_f32 v44, v172, v173
v_exp_f32 v176, v176
v_mfma_f32_32x32x16_bf16 v[48:63], a[108:111], v[36:39], v[48:63]
v_exp_f32 v177, v177
v_cvt_pk_bf16_f32 v45, v174, v175
s_add_u32 m0, s89, 147456
s_add_u32 s60, s60, 4096
buffer_load_dwordx4 v74, s[24:27], s60 offen sc1 lds
v_exp_f32 v178, v178
v_exp_f32 v179, v179
v_cvt_pk_bf16_f32 v46, v176, v177
v_cvt_pk_bf16_f32 v47, v178, v179
v_mfma_f32_32x32x16_bf16 v[164:179], a[28:31], v[64:67], 0
v_exp_f32 v148, v148
v_exp_f32 v149, v149
v_exp_f32 v150, v150
v_exp_f32 v151, v151
v_cvt_pk_bf16_f32 v32, v148, v149
v_exp_f32 v152, v152
v_mfma_f32_32x32x8bf16_1k v[164:179], v[94:95], v[16:17], v[164:179]
v_exp_f32 v153, v153
v_cvt_pk_bf16_f32 v33, v150, v151
v_exp_f32 v154, v154
v_exp_f32 v155, v155
v_cvt_pk_bf16_f32 v34, v152, v153
v_exp_f32 v156, v156
s_add_u32 m0, s89, 0
s_add_u32 s60, s88, 81920
buffer_load_dwordx4 v74, s[24:27], s60 offen offset:0 sc1 lds
v_mfma_f32_32x32x16_bf16 v[48:63], a[112:115], v[40:43], v[48:63]
v_exp_f32 v157, v157
v_cvt_pk_bf16_f32 v35, v154, v155
v_exp_f32 v158, v158
v_exp_f32 v159, v159
v_cvt_pk_bf16_f32 v36, v156, v157
v_exp_f32 v160, v160
v_mfma_f32_32x32x16_bf16 v[48:63], a[116:119], v[44:47], v[48:63]
v_exp_f32 v161, v161
v_cvt_pk_bf16_f32 v37, v158, v159
v_exp_f32 v162, v162
v_exp_f32 v163, v163
v_cvt_pk_bf16_f32 v38, v160, v161
v_cvt_pk_bf16_f32 v39, v162, v163
v_mfma_f32_32x32x16_bf16 v[148:163], a[32:35], v[64:67], v[132:147]
v_exp_f32 v164, v164
v_exp_f32 v165, v165
buffer_load_dwordx4 v74, s[24:27], s60 offen offset:1024 sc1 lds
v_exp_f32 v166, v166
v_exp_f32 v167, v167
v_cvt_pk_bf16_f32 v40, v164, v165
v_exp_f32 v168, v168
v_mfma_f32_32x32x8bf16_1k v[148:163], v[96:97], v[16:17], v[148:163]
v_exp_f32 v169, v169
v_cvt_pk_bf16_f32 v41, v166, v167
v_exp_f32 v170, v170
v_exp_f32 v171, v171
v_cvt_pk_bf16_f32 v42, v168, v169
v_exp_f32 v172, v172
v_mfma_f32_32x32x16_bf16 v[48:63], a[120:123], v[32:35], v[48:63]
v_exp_f32 v173, v173
v_cvt_pk_bf16_f32 v43, v170, v171
v_exp_f32 v174, v174
v_exp_f32 v175, v175
v_cvt_pk_bf16_f32 v44, v172, v173
v_exp_f32 v176, v176
buffer_load_dwordx4 v74, s[24:27], s60 offen offset:2048 sc1 lds
v_mfma_f32_32x32x16_bf16 v[48:63], a[124:127], v[36:39], v[48:63]
v_exp_f32 v177, v177
v_cvt_pk_bf16_f32 v45, v174, v175
v_exp_f32 v178, v178
v_exp_f32 v179, v179
v_cvt_pk_bf16_f32 v46, v176, v177
v_cvt_pk_bf16_f32 v47, v178, v179
v_mfma_f32_32x32x16_bf16 v[48:63], a[128:131], v[40:43], v[48:63]
v_exp_f32 v148, v148
v_exp_f32 v149, v149
v_exp_f32 v150, v150
v_exp_f32 v151, v151
v_cvt_pk_bf16_f32 v32, v148, v149
v_exp_f32 v152, v152
v_exp_f32 v153, v153
v_cvt_pk_bf16_f32 v33, v150, v151
v_exp_f32 v154, v154
v_exp_f32 v155, v155
buffer_load_dwordx4 v74, s[24:27], s60 offen offset:3072 sc1 lds
v_cvt_pk_bf16_f32 v34, v152, v153
v_exp_f32 v156, v156
v_mfma_f32_32x32x16_bf16 v[48:63], a[132:135], v[44:47], v[48:63]
v_exp_f32 v157, v157
v_cvt_pk_bf16_f32 v35, v154, v155
v_exp_f32 v158, v158
v_exp_f32 v159, v159
v_cvt_pk_bf16_f32 v36, v156, v157
v_exp_f32 v160, v160
v_exp_f32 v161, v161
v_cvt_pk_bf16_f32 v37, v158, v159
v_exp_f32 v162, v162
v_exp_f32 v163, v163
v_cvt_pk_bf16_f32 v38, v160, v161
v_cvt_pk_bf16_f32 v39, v162, v163
v_mfma_f32_32x32x16_bf16 v[48:63], a[136:139], v[32:35], v[48:63]
s_nop 0
v_mfma_f32_32x32x16_bf16 v[48:63], a[140:143], v[36:39], v[48:63]
s_add_u32 m0, s89, 4096
s_add_u32 s60, s60, 4096
buffer_load_dwordx4 v74, s[24:27], s60 offen sc1 lds
s_nop 8
v_mov_b32 v18, v56
v_mov_b32 v19, v56
s_nop 1
v_permlane32_swap_b32 v18, v19
v_rcp_f32 v19, v19
s_nop 0
v_mul_f32 v48, v48, v19
v_mul_f32 v49, v49, v19
v_mul_f32 v50, v50, v19
v_mul_f32 v51, v51, v19
v_mul_f32 v52, v52, v19
v_mul_f32 v53, v53, v19
v_mul_f32 v54, v54, v19
v_mul_f32 v55, v55, v19
v_mul_f32 v56, v56, v19
v_mul_f32 v57, v57, v19
v_mul_f32 v58, v58, v19
v_mul_f32 v59, v59, v19
v_cvt_pk_bf16_f32 v20, v48, v49
v_cvt_pk_bf16_f32 v21, v50, v51
v_cvt_pk_bf16_f32 v22, v52, v53
v_cvt_pk_bf16_f32 v23, v54, v55
v_cvt_pk_bf16_f32 v28, v56, v57
v_cvt_pk_bf16_f32 v29, v58, v59
s_mul_i32 s47, s82, 40960
s_mul_i32 s48, s81, 1280
s_add_u32 s47, s47, s48
s_add_u32 s47, s47, 16777216
buffer_store_dwordx4 v[20:23], v9, s[24:27], s47 offen offset:0 sc1
s_waitcnt vmcnt(8)
s_cmp_lg_u32 s42, 0
s_cbranch_scc1 L_pc_28
v_cmp_ne_u32 s[48:49], s79, v185
s_nop 1
s_cmp_eq_u64 s[48:49], 0
s_cbranch_scc1 L_pc_28
s_cmp_lg_u32 s42, 0
s_cbranch_scc1 L_poll_29_ok
s_mov_b32 s46, 0x40000
L_poll_29:
buffer_load_dword v185, v184, s[24:27], 0 offen sc1
s_waitcnt vmcnt(0)
v_cmp_ne_u32 s[48:49], s79, v185
s_nop 1
s_cmp_eq_u64 s[48:49], 0
s_cbranch_scc1 L_poll_29_ok
s_sleep 1
s_sub_u32 s46, s46, 1
s_cmp_lg_u32 s46, 0
s_cbranch_scc1 L_poll_29
L_poll_29_ok:
L_pc_28:
s_barrier
v_mov_b32 v10, 0xf149f2ca
v_mfma_f32_32x32x16_bf16 v[148:163], a[36:39], v[68:71], v[116:131]
v_mfma_f32_32x32x8bf16_1k v[148:163], v[98:99], v[14:15], v[148:163]
v_mfma_f32_32x32x16_bf16 v[164:179], a[40:43], v[68:71], 0
ds_read_b64_tr_b16 a[144:145], v5 offset:0
ds_read_b64_tr_b16 a[146:147], v6 offset:0
s_nop 8
v_max3_f32 v10, v148, v149, v10
v_max3_f32 v10, v150, v151, v10
s_add_u32 s61, s91, 0
buffer_load_dwordx4 v[192:195], v74, s[24:27], s61 offen offset:0 sc1
v_max3_f32 v10, v152, v153, v10
v_max3_f32 v10, v154, v155, v10
v_mfma_f32_32x32x8bf16_1k v[164:179], v[100:101], v[14:15], v[164:179]
ds_read_b64_tr_b16 a[148:149], v5 offset:256
ds_read_b64_tr_b16 a[150:151], v6 offset:256
v_max3_f32 v10, v156, v157, v10
v_max3_f32 v10, v158, v159, v10
v_max3_f32 v10, v160, v161, v10
s_add_u32 s61, s94, 0
buffer_load_dwordx4 v[196:199], v74, s[24:27], s61 offen offset:0 sc1
v_max3_f32 v10, v162, v163, v10
v_mfma_f32_32x32x16_bf16 v[148:163], a[44:47], v[68:71], 0
ds_read_b64_tr_b16 a[152:153], v5 offset:3072
ds_read_b64_tr_b16 a[154:155], v6 offset:3072
s_nop 0
v_max3_f32 v10, v164, v165, v10
v_max3_f32 v10, v166, v167, v10
v_max3_f32 v10, v168, v169, v10
v_max3_f32 v10, v170, v171, v10
s_add_u32 s61, s91, 0
buffer_load_dwordx4 v[200:203], v74, s[24:27], s61 offen offset:2048 sc1
v_mfma_f32_32x32x8bf16_1k v[148:163], v[102:103], v[14:15], v[148:163]
ds_read_b64_tr_b16 a[156:157], v5 offset:3328
ds_read_b64_tr_b16 a[158:159], v6 offset:3328
v_max3_f32 v10, v172, v173, v10
v_max3_f32 v10, v174, v175, v10
v_max3_f32 v10, v176, v177, v10
v_max3_f32 v10, v178, v179, v10
v_mfma_f32_32x32x16_bf16 v[164:179], a[48:51], v[68:71], 0
s_add_u32 s61, s94, 0
buffer_load_dwordx4 v[204:207], v74, s[24:27], s61 offen offset:2048 sc1
ds_read_b64_tr_b16 a[160:161], v5 offset:6144
ds_read_b64_tr_b16 a[162:163], v6 offset:6144
s_nop 0
v_max3_f32 v10, v148, v149, v10
v_max3_f32 v10, v150, v151, v10
v_max3_f32 v10, v152, v153, v10
v_max3_f32 v10, v154, v155, v10
v_mfma_f32_32x32x8bf16_1k v[164:179], v[104:105], v[14:15], v[164:179]
ds_read_b64_tr_b16 a[164:165], v5 offset:6400
s_add_u32 s61, s91, 4096
buffer_load_dwordx4 v[208:211], v74, s[24:27], s61 offen offset:0 sc1
ds_read_b64_tr_b16 a[166:167], v6 offset:6400
v_max3_f32 v10, v156, v157, v10
v_max3_f32 v10, v158, v159, v10
v_max3_f32 v10, v160, v161, v10
v_max3_f32 v10, v162, v163, v10
v_mfma_f32_32x32x16_bf16 v[148:163], a[52:55], v[68:71], 0
ds_read_b64_tr_b16 a[168:169], v5 offset:9216
ds_read_b64_tr_b16 a[170:171], v6 offset:9216
s_add_u32 s61, s94, 4096
buffer_load_dwordx4 v[212:215], v74, s[24:27], s61 offen offset:0 sc1
v_max3_f32 v10, v164, v165, v10
v_max3_f32 v10, v166, v167, v10
v_max3_f32 v10, v168, v169, v10
v_max3_f32 v10, v170, v171, v10
v_mfma_f32_32x32x8bf16_1k v[148:163], v[106:107], v[14:15], v[148:163]
ds_read_b64_tr_b16 a[172:173], v5 offset:9472
ds_read_b64_tr_b16 a[174:175], v6 offset:9472
v_max3_f32 v10, v172, v173, v10
s_add_u32 s61, s91, 4096
buffer_load_dwordx4 v[216:219], v74, s[24:27], s61 offen offset:2048 sc1
v_max3_f32 v10, v174, v175, v10
v_max3_f32 v10, v176, v177, v10
v_max3_f32 v10, v178, v179, v10
v_mfma_f32_32x32x16_bf16 v[164:179], a[56:59], v[68:71], 0
ds_read_b64_tr_b16 a[176:177], v5 offset:12288
ds_read_b64_tr_b16 a[178:179], v6 offset:12288
s_nop 0
v_max3_f32 v10, v148, v149, v10
v_max3_f32 v10, v150, v151, v10
s_add_u32 s61, s94, 4096
buffer_load_dwordx4 v[220:223], v74, s[24:27], s61 offen offset:2048 sc1
v_max3_f32 v10, v152, v153, v10
v_max3_f32 v10, v154, v155, v10
v_mfma_f32_32x32x8bf16_1k v[164:179], v[108:109], v[14:15], v[164:179]
ds_read_b64_tr_b16 a[180:181], v5 offset:12544
ds_read_b64_tr_b16 a[182:183], v6 offset:12544
v_max3_f32 v10, v156, v157, v10
v_max3_f32 v10, v158, v159, v10
v_max3_f32 v10, v160, v161, v10
s_add_u32 s61, s91, 8192
buffer_load_dwordx4 v[224:227], v74, s[24:27], s61 offen offset:0 sc1
v_max3_f32 v10, v162, v163, v10
v_mfma_f32_32x32x16_bf16 v[148:163], a[60:63], v[68:71], 0
ds_read_b64_tr_b16 a[184:185], v5 offset:15360
ds_read_b64_tr_b16 a[186:187], v6 offset:15360
s_nop 0
v_max3_f32 v10, v164, v165, v10
v_max3_f32 v10, v166, v167, v10
v_max3_f32 v10, v168, v169, v10
v_max3_f32 v10, v170, v171, v10
s_add_u32 s61, s94, 8192
buffer_load_dwordx4 v[228:231], v74, s[24:27], s61 offen offset:0 sc1
v_mfma_f32_32x32x8bf16_1k v[148:163], v[110:111], v[14:15], v[148:163]
ds_read_b64_tr_b16 a[188:189], v5 offset:15616
ds_read_b64_tr_b16 a[190:191], v6 offset:15616
v_max3_f32 v10, v172, v173, v10
v_max3_f32 v10, v174, v175, v10
v_max3_f32 v10, v176, v177, v10
v_max3_f32 v10, v178, v179, v10
v_mfma_f32_32x32x16_bf16 v[164:179], a[64:67], v[68:71], 0
s_add_u32 s61, s91, 8192
buffer_load_dwordx4 v[232:235], v74, s[24:27], s61 offen offset:2048 sc1
ds_read_b64_tr_b16 a[192:193], v5 offset:18432
ds_read_b64_tr_b16 a[194:195], v6 offset:18432
s_nop 0
v_max3_f32 v10, v148, v149, v10
v_max3_f32 v10, v150, v151, v10
v_max3_f32 v10, v152, v153, v10
v_max3_f32 v10, v154, v155, v10
v_mfma_f32_32x32x8bf16_1k v[164:179], v[112:113], v[14:15], v[164:179]
ds_read_b64_tr_b16 a[196:197], v5 offset:18688
s_add_u32 s61, s94, 8192
buffer_load_dwordx4 v[236:239], v74, s[24:27], s61 offen offset:2048 sc1
ds_read_b64_tr_b16 a[198:199], v6 offset:18688
v_max3_f32 v10, v156, v157, v10
v_max3_f32 v10, v158, v159, v10
v_max3_f32 v10, v160, v161, v10
v_max3_f32 v10, v162, v163, v10
v_mfma_f32_32x32x16_bf16 v[148:163], a[68:71], v[68:71], v[132:147]
ds_read_b64_tr_b16 a[200:201], v5 offset:21504
ds_read_b64_tr_b16 a[202:203], v6 offset:21504
s_add_u32 s61, s91, 12288
buffer_load_dwordx4 v[240:243], v74, s[24:27], s61 offen offset:0 sc1
v_max3_f32 v10, v164, v165, v10
v_max3_f32 v10, v166, v167, v10
v_max3_f32 v10, v168, v169, v10
v_max3_f32 v10, v170, v171, v10
v_mfma_f32_32x32x8bf16_1k v[148:163], v[114:115], v[14:15], v[148:163]
ds_read_b64_tr_b16 a[204:205], v5 offset:21760
ds_read_b64_tr_b16 a[206:207], v6 offset:21760
v_max3_f32 v10, v172, v173, v10
s_add_u32 s61, s94, 12288
buffer_load_dwordx4 v[244:247], v74, s[24:27], s61 offen offset:0 sc1
v_max3_f32 v10, v174, v175, v10
v_max3_f32 v10, v176, v177, v10
v_max3_f32 v10, v178, v179, v10
ds_read_b64_tr_b16 a[208:209], v5 offset:24576
ds_read_b64_tr_b16 a[210:211], v6 offset:24576
s_nop 1
v_max3_f32 v10, v148, v149, v10
v_max3_f32 v10, v150, v151, v10
v_max3_f32 v10, v152, v153, v10
s_add_u32 s61, s91, 12288
buffer_load_dwordx4 v[248:251], v74, s[24:27], s61 offen offset:2048 sc1
v_max3_f32 v10, v154, v155, v10
ds_read_b64_tr_b16 a[212:213], v5 offset:24832
ds_read_b64_tr_b16 a[214:215], v6 offset:24832
v_max3_f32 v10, v156, v157, v10
v_max3_f32 v10, v158, v159, v10
v_max3_f32 v10, v160, v161, v10
v_max3_f32 v10, v162, v163, v10
s_add_u32 s61, s94, 12288
buffer_load_dwordx4 v[252:255], v74, s[24:27], s61 offen offset:2048 sc1
v_mov_b32 v18, v10
s_nop 1
v_permlane32_swap_b32 v10, v18
v_max_f32 v10, v10, v18
v_sub_f32 v10, 0, v10
v_cvt_pk_bf16_f32 v18, v10, v10
v_and_b32 v19, 0xffff0000, v18
v_sub_f32 v20, v10, v19
v_cvt_pk_bf16_f32 v20, v20, 0
v_or_b32 v19, v182, v19
v_bfi_b32 v16, v181, v72, v19
v_bfi_b32 v17, v181, v73, v20
s_waitcnt lgkmcnt(0)
v_mfma_f32_32x32x16_bf16 v[148:163], a[36:39], v[68:71], v[116:131]
v_mfma_f32_32x32x8bf16_1k v[148:163], v[98:99], v[16:17], v[148:163]
v_mfma_f32_32x32x16_bf16 v[164:179], a[40:43], v[68:71], 0
s_nop 10
v_exp_f32 v148, v148
v_exp_f32 v149, v149
v_exp_f32 v150, v150
v_exp_f32 v151, v151
s_add_u32 s61, s91, 16384
buffer_load_dwordx4 a[216:219], v74, s[24:27], s61 offen offset:0 sc1
v_cvt_pk_bf16_f32 v32, v148, v149
v_exp_f32 v152, v152
v_exp_f32 v153, v153
v_cvt_pk_bf16_f32 v33, v150, v151
v_exp_f32 v154, v154
v_exp_f32 v155, v155
v_cvt_pk_bf16_f32 v34, v152, v153
s_add_u32 s61, s94, 16384
buffer_load_dwordx4 a[220:223], v74, s[24:27], s61 offen offset:0 sc1
v_exp_f32 v156, v156
v_mfma_f32_32x32x8bf16_1k v[164:179], v[100:101], v[16:17], v[164:179]
v_exp_f32 v157, v157
v_cvt_pk_bf16_f32 v35, v154, v155
v_exp_f32 v158, v158
v_exp_f32 v159, v159
v_cvt_pk_bf16_f32 v36, v156, v157
s_add_u32 s61, s91, 16384
buffer_load_dwordx4 a[224:227], v74, s[24:27], s61 offen offset:2048 sc1
v_exp_f32 v160, v160
v_exp_f32 v161, v161
v_cvt_pk_bf16_f32 v37, v158, v159
v_exp_f32 v162, v162
v_exp_f32 v163, v163
v_cvt_pk_bf16_f32 v38, v160, v161
v_cvt_pk_bf16_f32 v39, v162, v163
s_add_u32 s61, s94, 16384
buffer_load_dwordx4 a[228:231], v74, s[24:27], s61 offen offset:2048 sc1
v_mfma_f32_32x32x16_bf16 v[148:163], a[44:47], v[68:71], 0
v_exp_f32 v164, v164
v_exp_f32 v165, v165
v_exp_f32 v166, v166
v_exp_f32 v167, v167
v_cvt_pk_bf16_f32 v40, v164, v165
v_exp_f32 v168, v168
s_add_u32 s61, s91, 20480
buffer_load_dwordx4 a[232:235], v74, s[24:27], s61 offen offset:0 sc1
v_mfma_f32_32x32x8bf16_1k v[148:163], v[102:103], v[16:17], v[148:163]
v_exp_f32 v169, v169
v_cvt_pk_bf16_f32 v41, v166, v167
v_exp_f32 v170, v170
v_exp_f32 v171, v171
v_cvt_pk_bf16_f32 v42, v168, v169
s_add_u32 s61, s94, 20480
buffer_load_dwordx4 a[236:239], v74, s[24:27], s61 offen offset:0 sc1
v_exp_f32 v172, v172
v_mfma_f32_32x32x16_bf16 v[48:63], a[144:147], v[32:35], 0
v_exp_f32 v173, v173
v_cvt_pk_bf16_f32 v43, v170, v171
v_exp_f32 v174, v174
v_exp_f32 v175, v175
v_cvt_pk_bf16_f32 v44, v172, v173
s_add_u32 s61, s91, 20480
buffer_load_dwordx4 a[240:243], v74, s[24:27], s61 offen offset:2048 sc1
v_exp_f32 v176, v176
v_mfma_f32_32x32x16_bf16 v[48:63], a[148:151], v[36:39], v[48:63]
v_exp_f32 v177, v177
v_cvt_pk_bf16_f32 v45, v174, v175
v_exp_f32 v178, v178
v_exp_f32 v179, v179
v_cvt_pk_bf16_f32 v46, v176, v177
s_add_u32 s61, s94, 20480
buffer_load_dwordx4 a[244:247], v74, s[24:27], s61 offen offset:2048 sc1
v_cvt_pk_bf16_f32 v47, v178, v179
v_mfma_f32_32x32x16_bf16 v[164:179], a[48:51], v[68:71], 0
v_exp_f32 v148, v148
v_exp_f32 v149, v149
v_exp_f32 v150, v150
v_exp_f32 v151, v151
v_cvt_pk_bf16_f32 v32, v148, v149
s_add_u32 s61, s91, 24576
buffer_load_dwordx4 a[248:251], v74, s[24:27], s61 offen offset:0 sc1
v_exp_f32 v152, v152
v_mfma_f32_32x32x8bf16_1k v[164:179], v[104:105], v[16:17], v[164:179]
v_exp_f32 v153, v153
v_cvt_pk_bf16_f32 v33, v150, v151
v_exp_f32 v154, v154
v_exp_f32 v155, v155
v_cvt_pk_bf16_f32 v34, v152, v153
s_add_u32 s61, s94, 24576
buffer_load_dwordx4 a[252:255], v74, s[24:27], s61 offen offset:0 sc1
v_exp_f32 v156, v156
v_mfma_f32_32x32x16_bf16 v[48:63], a[152:155], v[40:43], v[48:63]
v_exp_f32 v157, v157
v_cvt_pk_bf16_f32 v35, v154, v155
v_exp_f32 v158, v158
v_exp_f32 v159, v159
s_add_u32 s61, s91, 24576
buffer_load_dwordx4 a[0:3], v74, s[24:27], s61 offen offset:2048 sc1
v_cvt_pk_bf16_f32 v36, v156, v157
v_exp_f32 v160, v160
v_mfma_f32_32x32x16_bf16 v[48:63], a[156:159], v[44:47], v[48:63]
v_exp_f32 v161, v161
v_cvt_pk_bf16_f32 v37, v158, v159
v_exp_f32 v162, v162
v_exp_f32 v163, v163
s_add_u32 s61, s94, 24576
buffer_load_dwordx4 a[4:7], v74, s[24:27], s61 offen offset:2048 sc1
v_cvt_pk_bf16_f32 v38, v160, v161
v_cvt_pk_bf16_f32 v39, v162, v163
v_mfma_f32_32x32x16_bf16 v[148:163], a[52:55], v[68:71], 0
v_exp_f32 v164, v164
v_exp_f32 v165, v165
v_exp_f32 v166, v166
v_exp_f32 v167, v167
s_add_u32 s61, s91, 28672
buffer_load_dwordx4 a[8:11], v74, s[24:27], s61 offen offset:0 sc1
v_cvt_pk_bf16_f32 v40, v164, v165
v_exp_f32 v168, v168
v_mfma_f32_32x32x8bf16_1k v[148:163], v[106:107], v[16:17], v[148:163]
v_exp_f32 v169, v169
v_cvt_pk_bf16_f32 v41, v166, v167
v_exp_f32 v170, v170
v_exp_f32 v171, v171
s_add_u32 s61, s94, 28672
buffer_load_dwordx4 a[12:15], v74, s[24:27], s61 offen offset:0 sc1
v_cvt_pk_bf16_f32 v42, v168, v169
v_exp_f32 v172, v172
v_mfma_f32_32x32x16_bf16 v[48:63], a[160:163], v[32:35], v[48:63]
v_exp_f32 v173, v173
v_cvt_pk_bf16_f32 v43, v170, v171
v_exp_f32 v174, v174
v_exp_f32 v175, v175
s_add_u32 s61, s91, 28672
buffer_load_dwordx4 a[16:19], v74, s[24:27], s61 offen offset:2048 sc1
v_cvt_pk_bf16_f32 v44, v172, v173
v_exp_f32 v176, v176
v_mfma_f32_32x32x16_bf16 v[48:63], a[164:167], v[36:39], v[48:63]
v_exp_f32 v177, v177
v_cvt_pk_bf16_f32 v45, v174, v175
v_exp_f32 v178, v178
s_add_u32 s61, s94, 28672
buffer_load_dwordx4 a[20:23], v74, s[24:27], s61 offen offset:2048 sc1
v_exp_f32 v179, v179
v_cvt_pk_bf16_f32 v46, v176, v177
v_cvt_pk_bf16_f32 v47, v178, v179
v_mfma_f32_32x32x16_bf16 v[164:179], a[56:59], v[68:71], 0
v_exp_f32 v148, v148
v_exp_f32 v149, v149
v_exp_f32 v150, v150
s_add_u32 s61, s91, 32768
buffer_load_dwordx4 a[24:27], v74, s[24:27], s61 offen offset:0 sc1
v_exp_f32 v151, v151
v_cvt_pk_bf16_f32 v32, v148, v149
v_exp_f32 v152, v152
v_mfma_f32_32x32x8bf16_1k v[164:179], v[108:109], v[16:17], v[164:179]
v_exp_f32 v153, v153
v_cvt_pk_bf16_f32 v33, v150, v151
v_exp_f32 v154, v154
s_add_u32 s61, s94, 32768
buffer_load_dwordx4 a[28:31], v74, s[24:27], s61 offen offset:0 sc1
v_exp_f32 v155, v155
v_cvt_pk_bf16_f32 v34, v152, v153
v_exp_f32 v156, v156
v_mfma_f32_32x32x16_bf16 v[48:63], a[168:171], v[40:43], v[48:63]
v_exp_f32 v157, v157
v_cvt_pk_bf16_f32 v35, v154, v155
v_exp_f32 v158, v158
s_add_u32 s61, s91, 32768
buffer_load_dwordx4 a[32:35], v74, s[24:27], s61 offen offset:2048 sc1
v_exp_f32 v159, v159
v_cvt_pk_bf16_f32 v36, v156, v157
v_exp_f32 v160, v160
v_mfma_f32_32x32x16_bf16 v[48:63], a[172:175], v[44:47], v[48:63]
v_exp_f32 v161, v161
v_cvt_pk_bf16_f32 v37, v158, v159
v_exp_f32 v162, v162
s_add_u32 s61, s94, 32768
buffer_load_dwordx4 a[72:75], v74, s[24:27], s61 offen offset:2048 sc1
v_exp_f32 v163, v163
v_cvt_pk_bf16_f32 v38, v160, v161
v_cvt_pk_bf16_f32 v39, v162, v163
v_mfma_f32_32x32x16_bf16 v[148:163], a[60:63], v[68:71], 0
v_exp_f32 v164, v164
v_exp_f32 v165, v165
v_exp_f32 v166, v166
s_add_u32 s61, s91, 36864
buffer_load_dwordx4 a[76:79], v74, s[24:27], s61 offen offset:0 sc1
v_exp_f32 v167, v167
v_cvt_pk_bf16_f32 v40, v164, v165
v_exp_f32 v168, v168
v_mfma_f32_32x32x8bf16_1k v[148:163], v[110:111], v[16:17], v[148:163]
v_exp_f32 v169, v169
v_cvt_pk_bf16_f32 v41, v166, v167
s_add_u32 s61, s94, 36864
buffer_load_dwordx4 a[80:83], v74, s[24:27], s61 offen offset:0 sc1
v_exp_f32 v170, v170
v_exp_f32 v171, v171
v_cvt_pk_bf16_f32 v42, v168, v169
v_exp_f32 v172, v172
v_mfma_f32_32x32x16_bf16 v[48:63], a[176:179], v[32:35], v[48:63]
v_exp_f32 v173, v173
v_cvt_pk_bf16_f32 v43, v170, v171
s_add_u32 s61, s91, 36864
buffer_load_dwordx4 a[84:87], v74, s[24:27], s61 offen offset:2048 sc1
v_exp_f32 v174, v174
v_exp_f32 v175, v175
v_cvt_pk_bf16_f32 v44, v172, v173
v_exp_f32 v176, v176
v_mfma_f32_32x32x16_bf16 v[48:63], a[180:183], v[36:39], v[48:63]
v_exp_f32 v177, v177
v_cvt_pk_bf16_f32 v45, v174, v175
s_add_u32 s61, s94, 36864
buffer_load_dwordx4 a[88:91], v74, s[24:27], s61 offen offset:2048 sc1
v_exp_f32 v178, v178
v_exp_f32 v179, v179
v_cvt_pk_bf16_f32 v46, v176, v177
v_cvt_pk_bf16_f32 v47, v178, v179
v_mfma_f32_32x32x16_bf16 v[164:179], a[64:67], v[68:71], 0
v_exp_f32 v148, v148
v_exp_f32 v149, v149
s_add_u32 s61, s91, 40960
buffer_load_dwordx4 a[92:95], v74, s[24:27], s61 offen offset:0 sc1
v_exp_f32 v150, v150
v_exp_f32 v151, v151
v_cvt_pk_bf16_f32 v32, v148, v149
v_exp_f32 v152, v152
v_mfma_f32_32x32x8bf16_1k v[164:179], v[112:113], v[16:17], v[164:179]
v_exp_f32 v153, v153
v_cvt_pk_bf16_f32 v33, v150, v151
s_add_u32 s61, s94, 40960
buffer_load_dwordx4 a[96:99], v74, s[24:27], s61 offen offset:0 sc1
v_exp_f32 v154, v154
v_exp_f32 v155, v155
v_cvt_pk_bf16_f32 v34, v152, v153
v_exp_f32 v156, v156
v_mfma_f32_32x32x16_bf16 v[48:63], a[184:187], v[40:43], v[48:63]
v_exp_f32 v157, v157
s_add_u32 s61, s91, 40960
buffer_load_dwordx4 a[100:103], v74, s[24:27], s61 offen offset:2048 sc1
v_cvt_pk_bf16_f32 v35, v154, v155
v_exp_f32 v158, v158
v_exp_f32 v159, v159
v_cvt_pk_bf16_f32 v36, v156, v157
v_exp_f32 v160, v160
v_mfma_f32_32x32x16_bf16 v[48:63], a[188:191], v[44:47], v[48:63]
v_exp_f32 v161, v161
s_add_u32 s61, s94, 40960
buffer_load_dwordx4 a[104:107], v74, s[24:27], s61 offen offset:2048 sc1
v_cvt_pk_bf16_f32 v37, v158, v159
v_exp_f32 v162, v162
v_exp_f32 v163, v163
v_cvt_pk_bf16_f32 v38, v160, v161
v_cvt_pk_bf16_f32 v39, v162, v163
v_mfma_f32_32x32x16_bf16 v[148:163], a[68:71], v[68:71], v[132:147]
v_exp_f32 v164, v164
s_add_u32 s61, s91, 45056
s_waitcnt vmcnt(43)
buffer_load_dwordx4 a[108:111], v74, s[24:27], s61 offen offset:0 sc1
v_exp_f32 v165, v165
v_exp_f32 v166, v166
v_exp_f32 v167, v167
v_cvt_pk_bf16_f32 v40, v164, v165
v_exp_f32 v168, v168
v_mfma_f32_32x32x8bf16_1k v[148:163], v[114:115], v[16:17], v[148:163]
v_exp_f32 v169, v169
s_add_u32 s61, s94, 45056
s_waitcnt vmcnt(43)
buffer_load_dwordx4 a[112:115], v74, s[24:27], s61 offen offset:0 sc1
v_cvt_pk_bf16_f32 v41, v166, v167
v_exp_f32 v170, v170
v_exp_f32 v171, v171
v_cvt_pk_bf16_f32 v42, v168, v169
v_exp_f32 v172, v172
v_mfma_f32_32x32x16_bf16 v[48:63], a[192:195], v[32:35], v[48:63]
v_exp_f32 v173, v173
s_add_u32 s61, s91, 45056
s_waitcnt vmcnt(43)
buffer_load_dwordx4 a[116:119], v74, s[24:27], s61 offen offset:2048 sc1
v_cvt_pk_bf16_f32 v43, v170, v171
v_exp_f32 v174, v174
v_exp_f32 v175, v175
v_cvt_pk_bf16_f32 v44, v172, v173
v_exp_f32 v176, v176
v_mfma_f32_32x32x16_bf16 v[48:63], a[196:199], v[36:39], v[48:63]
s_add_u32 s61, s94, 45056
s_waitcnt vmcnt(43)
buffer_load_dwordx4 a[120:123], v74, s[24:27], s61 offen offset:2048 sc1
v_exp_f32 v177, v177
v_cvt_pk_bf16_f32 v45, v174, v175
v_exp_f32 v178, v178
v_exp_f32 v179, v179
v_cvt_pk_bf16_f32 v46, v176, v177
v_cvt_pk_bf16_f32 v47, v178, v179
v_mfma_f32_32x32x16_bf16 v[48:63], a[200:203], v[40:43], v[48:63]
s_add_u32 s61, s91, 49152
s_waitcnt vmcnt(43)
buffer_load_dwordx4 a[124:127], v74, s[24:27], s61 offen offset:0 sc1
v_exp_f32 v148, v148
v_exp_f32 v149, v149
v_exp_f32 v150, v150
v_exp_f32 v151, v151
v_cvt_pk_bf16_f32 v32, v148, v149
v_exp_f32 v152, v152
v_exp_f32 v153, v153
s_add_u32 s61, s94, 49152
s_waitcnt vmcnt(43)
buffer_load_dwordx4 a[128:131], v74, s[24:27], s61 offen offset:0 sc1
v_cvt_pk_bf16_f32 v33, v150, v151
v_exp_f32 v154, v154
v_exp_f32 v155, v155
v_cvt_pk_bf16_f32 v34, v152, v153
v_exp_f32 v156, v156
v_mfma_f32_32x32x16_bf16 v[48:63], a[204:207], v[44:47], v[48:63]
v_exp_f32 v157, v157
s_add_u32 s61, s91, 49152
s_waitcnt vmcnt(43)
buffer_load_dwordx4 a[132:135], v74, s[24:27], s61 offen offset:2048 sc1
v_cvt_pk_bf16_f32 v35, v154, v155
v_exp_f32 v158, v158
v_exp_f32 v159, v159
v_cvt_pk_bf16_f32 v36, v156, v157
v_exp_f32 v160, v160
v_exp_f32 v161, v161
v_cvt_pk_bf16_f32 v37, v158, v159
s_add_u32 s61, s94, 49152
s_waitcnt vmcnt(43)
buffer_load_dwordx4 a[136:139], v74, s[24:27], s61 offen offset:2048 sc1
v_exp_f32 v162, v162
v_exp_f32 v163, v163
v_cvt_pk_bf16_f32 v38, v160, v161
v_cvt_pk_bf16_f32 v39, v162, v163
v_mfma_f32_32x32x16_bf16 v[48:63], a[208:211], v[32:35], v[48:63]
s_nop 0
v_mfma_f32_32x32x16_bf16 v[48:63], a[212:215], v[36:39], v[48:63]
s_add_u32 s61, s91, 53248
s_waitcnt vmcnt(43)
buffer_load_dwordx4 a[140:143], v74, s[24:27], s61 offen offset:0 sc1
s_nop 8
v_mov_b32 v18, v56
v_mov_b32 v19, v56
s_nop 1
v_permlane32_swap_b32 v18, v19
v_rcp_f32 v19, v19
s_nop 0
v_mul_f32 v48, v48, v19
v_mul_f32 v49, v49, v19
v_mul_f32 v50, v50, v19
v_mul_f32 v51, v51, v19
v_mul_f32 v52, v52, v19
v_mul_f32 v53, v53, v19
v_mul_f32 v54, v54, v19
v_mul_f32 v55, v55, v19
v_mul_f32 v56, v56, v19
v_mul_f32 v57, v57, v19
v_mul_f32 v58, v58, v19
v_mul_f32 v59, v59, v19
v_cvt_pk_bf16_f32 v20, v48, v49
v_cvt_pk_bf16_f32 v21, v50, v51
v_cvt_pk_bf16_f32 v22, v52, v53
v_cvt_pk_bf16_f32 v23, v54, v55
v_cvt_pk_bf16_f32 v30, v56, v57
v_cvt_pk_bf16_f32 v31, v58, v59
s_mul_i32 s47, s82, 40960
s_mul_i32 s48, s81, 1280
s_add_u32 s47, s47, s48
s_add_u32 s47, s47, 16777216
buffer_store_dwordx4 v[20:23], v9, s[24:27], s47 offen offset:768 sc1
s_mov_b32 exec_hi, 0
buffer_store_dwordx4 v[28:31], v9, s[24:27], s47 offen offset:512 sc1
s_mov_b32 exec_hi, -1
v_and_b32 v3, 15, v1
v_lshrrev_b32 v4, 4, v1
v_mul_u32_u24 v78, 1280, v3
v_mul_u32_u24 v4, 40, v4
v_add_u32 v78, v78, v4
s_lshl_b32 s45, s86, 4
s_mul_i32 s45, s45, 1280
s_mul_i32 s46, s85, 160
s_add_u32 s93, s45, s46
s_and_b32 s45, s42, 1
s_mul_i32 s45, s45, 5120
s_add_u32 s45, s45, 81920
v_add_u32 v75, s45, v74
s_mul_i32 s45, s42, 5120
s_add_u32 s45, s45, 61440
v_add_u32 v76, s45, v74
s_xor_b32 s45, s42, 1
s_mul_i32 s45, s45, 5120
s_add_u32 s45, s45, 61440
v_add_u32 v77, s45, v74
s_lshl_b32 s45, s42, 12
s_add_u32 s45, s45, 81920
v_and_b32 v3, 15, v1
v_mul_u32_u24 v3, 160, v3
v_lshrrev_b32 v4, 4, v1
v_mul_u32_u24 v4, 40, v4
v_add3_u32 v68, v3, v4, s45
v_add_u32 v69, s45, v74
v_add_u32 v3, 0, v1
v_mul_u32_u24 v4, 6554, v3
v_lshrrev_b32 v4, 16, v4
v_mul_u32_u24 v5, 10, v4
v_sub_u32 v5, v3, v5
v_mul_u32_u24 v4, 1280, v4
v_lshl_add_u32 v70, v5, 4, v4
v_add_u32 v3, 64, v1
v_mul_u32_u24 v4, 6554, v3
v_lshrrev_b32 v4, 16, v4
v_mul_u32_u24 v5, 10, v4
v_sub_u32 v5, v3, v5
v_mul_u32_u24 v4, 1280, v4
v_lshl_add_u32 v71, v5, 4, v4
v_add_u32 v3, 128, v1
v_mul_u32_u24 v4, 6554, v3
v_lshrrev_b32 v4, 16, v4
v_mul_u32_u24 v5, 10, v4
v_sub_u32 v5, v3, v5
v_mul_u32_u24 v4, 1280, v4
v_lshl_add_u32 v72, v5, 4, v4
v_cmp_gt_u32 s[46:47], 32, v1
v_mov_b32 v3, 0x40000000
s_nop 0
v_cndmask_b32_e64 v72, v3, v72, s[46:47]
s_barrier
ds_read_b128 v[118:121], v75 offset:0
ds_read_b128 v[122:125], v75 offset:1024
ds_read_b128 v[126:129], v75 offset:2048
ds_read_b128 v[130:133], v75 offset:3072
ds_read_b128 v[134:137], v75 offset:4096
ds_read_b128 v[138:141], v75 offset:10240
ds_read_b128 v[142:145], v75 offset:11264
ds_read_b128 v[146:149], v75 offset:12288
ds_read_b128 v[150:153], v75 offset:13312
ds_read_b128 v[154:157], v75 offset:14336
s_waitcnt lgkmcnt(5)
v_mfma_f32_16x16x32_bf16 v[8:11], v[118:121], v[192:195], 0
v_add_u32 v75, 0x5000, v75
s_add_u32 m0, s89, 20480
s_add_u32 s60, s88, 102400
buffer_load_dwordx4 v74, s[24:27], s60 offen offset:0 sc1 lds
v_mfma_f32_16x16x32_bf16 v[28:31], v[118:121], v[196:199], 0
v_mfma_f32_16x16x32_bf16 v[12:15], v[122:125], v[192:195], 0
ds_read_b128 v[158:161], v75 offset:0
buffer_load_dwordx4 v74, s[24:27], s60 offen offset:1024 sc1 lds
v_mfma_f32_16x16x32_bf16 v[32:35], v[122:125], v[196:199], 0
v_mfma_f32_16x16x32_bf16 v[16:19], v[126:129], v[192:195], 0
ds_read_b128 v[162:165], v75 offset:1024
buffer_load_dwordx4 v74, s[24:27], s60 offen offset:2048 sc1 lds
v_mfma_f32_16x16x32_bf16 v[36:39], v[126:129], v[196:199], 0
v_mfma_f32_16x16x32_bf16 v[20:23], v[130:133], v[192:195], 0
ds_read_b128 v[166:169], v75 offset:2048
buffer_load_dwordx4 v74, s[24:27], s60 offen offset:3072 sc1 lds
v_mfma_f32_16x16x32_bf16 v[40:43], v[130:133], v[196:199], 0
v_mfma_f32_16x16x32_bf16 v[24:27], v[134:137], v[192:195], 0
ds_read_b128 v[170:173], v75 offset:3072
s_add_u32 m0, s89, 24576
s_add_u32 s60, s60, 4096
buffer_load_dwordx4 v74, s[24:27], s60 offen sc1 lds
v_mfma_f32_16x16x32_bf16 v[44:47], v[134:137], v[196:199], 0
ds_read_b128 v[174:177], v75 offset:4096
s_waitcnt lgkmcnt(5)
v_mfma_f32_16x16x32_bf16 v[8:11], v[138:141], v[200:203], v[8:11]
ds_read_b128 v[118:121], v75 offset:10240
s_add_u32 m0, s89, 40960
s_add_u32 s60, s88, 122880
buffer_load_dwordx4 v74, s[24:27], s60 offen offset:0 sc1 lds
v_mfma_f32_16x16x32_bf16 v[28:31], v[138:141], v[204:207], v[28:31]
v_mfma_f32_16x16x32_bf16 v[12:15], v[142:145], v[200:203], v[12:15]
ds_read_b128 v[122:125], v75 offset:11264
buffer_load_dwordx4 v74, s[24:27], s60 offen offset:1024 sc1 lds
v_mfma_f32_16x16x32_bf16 v[32:35], v[142:145], v[204:207], v[32:35]
v_mfma_f32_16x16x32_bf16 v[16:19], v[146:149], v[200:203], v[16:19]
ds_read_b128 v[126:129], v75 offset:12288
buffer_load_dwordx4 v74, s[24:27], s60 offen offset:2048 sc1 lds
v_mfma_f32_16x16x32_bf16 v[36:39], v[146:149], v[204:207], v[36:39]
v_mfma_f32_16x16x32_bf16 v[20:23], v[150:153], v[200:203], v[20:23]
ds_read_b128 v[130:133], v75 offset:13312
buffer_load_dwordx4 v74, s[24:27], s60 offen offset:3072 sc1 lds
v_mfma_f32_16x16x32_bf16 v[40:43], v[150:153], v[204:207], v[40:43]
v_mfma_f32_16x16x32_bf16 v[24:27], v[154:157], v[200:203], v[24:27]
ds_read_b128 v[134:137], v75 offset:14336
s_add_u32 m0, s89, 45056
s_add_u32 s60, s60, 4096
buffer_load_dwordx4 v74, s[24:27], s60 offen sc1 lds
v_mfma_f32_16x16x32_bf16 v[44:47], v[154:157], v[204:207], v[44:47]
s_barrier
s_waitcnt lgkmcnt(5)
v_mfma_f32_16x16x32_bf16 v[8:11], v[158:161], v[208:211], v[8:11]
v_add_u32 v75, 0x5000, v75
s_add_u32 m0, s89, 81920
s_add_u32 s60, s88, 143360
buffer_load_dwordx4 v74, s[24:27], s60 offen offset:0 sc1 lds
v_mfma_f32_16x16x32_bf16 v[28:31], v[158:161], v[212:215], v[28:31]
v_mfma_f32_16x16x32_bf16 v[12:15], v[162:165], v[208:211], v[12:15]
ds_read_b128 v[138:141], v75 offset:0
v_mfma_f32_16x16x32_bf16 v[32:35], v[162:165], v[212:215], v[32:35]
v_mfma_f32_16x16x32_bf16 v[16:19], v[166:169], v[208:211], v[16:19]
ds_read_b128 v[142:145], v75 offset:1024
buffer_load_dwordx4 v74, s[24:27], s60 offen offset:1024 sc1 lds
v_mfma_f32_16x16x32_bf16 v[36:39], v[166:169], v[212:215], v[36:39]
v_mfma_f32_16x16x32_bf16 v[20:23], v[170:173], v[208:211], v[20:23]
ds_read_b128 v[146:149], v75 offset:2048
v_mfma_f32_16x16x32_bf16 v[40:43], v[170:173], v[212:215], v[40:43]
v_mfma_f32_16x16x32_bf16 v[24:27], v[174:177], v[208:211], v[24:27]
ds_read_b128 v[150:153], v75 offset:3072
buffer_load_dwordx4 v74, s[24:27], s60 offen offset:2048 sc1 lds
v_mfma_f32_16x16x32_bf16 v[44:47], v[174:177], v[212:215], v[44:47]
ds_read_b128 v[154:157], v75 offset:4096
s_waitcnt lgkmcnt(5)
v_mfma_f32_16x16x32_bf16 v[8:11], v[118:121], v[216:219], v[8:11]
ds_read_b128 v[158:161], v75 offset:10240
v_mfma_f32_16x16x32_bf16 v[28:31], v[118:121], v[220:223], v[28:31]
v_mfma_f32_16x16x32_bf16 v[12:15], v[122:125], v[216:219], v[12:15]
ds_read_b128 v[162:165], v75 offset:11264
buffer_load_dwordx4 v74, s[24:27], s60 offen offset:3072 sc1 lds
v_mfma_f32_16x16x32_bf16 v[32:35], v[122:125], v[220:223], v[32:35]
v_mfma_f32_16x16x32_bf16 v[16:19], v[126:129], v[216:219], v[16:19]
ds_read_b128 v[166:169], v75 offset:12288
v_mfma_f32_16x16x32_bf16 v[36:39], v[126:129], v[220:223], v[36:39]
v_mfma_f32_16x16x32_bf16 v[20:23], v[130:133], v[216:219], v[20:23]
ds_read_b128 v[170:173], v75 offset:13312
s_add_u32 m0, s89, 86016
s_add_u32 s60, s60, 4096
buffer_load_dwordx4 v74, s[24:27], s60 offen sc1 lds
v_mfma_f32_16x16x32_bf16 v[40:43], v[130:133], v[220:223], v[40:43]
v_mfma_f32_16x16x32_bf16 v[24:27], v[134:137], v[216:219], v[24:27]
ds_read_b128 v[174:177], v75 offset:14336
v_mfma_f32_16x16x32_bf16 v[44:47], v[134:137], v[220:223], v[44:47]
s_waitcnt vmcnt(15)
s_barrier
s_cmp_lg_u32 s42, 0
s_cbranch_scc1 L_sig_31
s_add_u32 s46, s80, 32
s_lshl_b32 s46, s46, 5
s_add_u32 s46, s46, s81
s_lshl_b32 s46, s46, 2
s_add_u32 s46, s46, 25165824
s_mov_b64 exec, 1
v_mov_b32 v186, s46
v_mov_b32 v187, s79
buffer_store_dword v187, v186, s[24:27], 0 offen sc1
s_mov_b64 exec, -1
L_sig_31:
s_waitcnt lgkmcnt(5)
v_mfma_f32_16x16x32_bf16 v[8:11], v[138:141], v[224:227], v[8:11]
v_add_u32 v75, 0x5000, v75
s_add_u32 m0, s89, 102400
s_add_u32 s60, s88, 163840
buffer_load_dwordx4 v74, s[24:27], s60 offen offset:0 sc1 lds
v_mfma_f32_16x16x32_bf16 v[28:31], v[138:141], v[228:231], v[28:31]
v_mfma_f32_16x16x32_bf16 v[12:15], v[142:145], v[224:227], v[12:15]
ds_read_b128 v[118:121], v75 offset:0
v_mfma_f32_16x16x32_bf16 v[32:35], v[142:145], v[228:231], v[32:35]
v_mfma_f32_16x16x32_bf16 v[16:19], v[146:149], v[224:227], v[16:19]
ds_read_b128 v[122:125], v75 offset:1024
buffer_load_dwordx4 v74, s[24:27], s60 offen offset:1024 sc1 lds
v_mfma_f32_16x16x32_bf16 v[36:39], v[146:149], v[228:231], v[36:39]
v_mfma_f32_16x16x32_bf16 v[20:23], v[150:153], v[224:227], v[20:23]
ds_read_b128 v[126:129], v75 offset:2048
v_mfma_f32_16x16x32_bf16 v[40:43], v[150:153], v[228:231], v[40:43]
v_mfma_f32_16x16x32_bf16 v[24:27], v[154:157], v[224:227], v[24:27]
ds_read_b128 v[130:133], v75 offset:3072
buffer_load_dwordx4 v74, s[24:27], s60 offen offset:2048 sc1 lds
v_mfma_f32_16x16x32_bf16 v[44:47], v[154:157], v[228:231], v[44:47]
ds_read_b128 v[134:137], v75 offset:4096
s_waitcnt lgkmcnt(5)
v_mfma_f32_16x16x32_bf16 v[8:11], v[158:161], v[232:235], v[8:11]
ds_read_b128 v[138:141], v75 offset:10240
v_mfma_f32_16x16x32_bf16 v[28:31], v[158:161], v[236:239], v[28:31]
v_mfma_f32_16x16x32_bf16 v[12:15], v[162:165], v[232:235], v[12:15]
ds_read_b128 v[142:145], v75 offset:11264
buffer_load_dwordx4 v74, s[24:27], s60 offen offset:3072 sc1 lds
v_mfma_f32_16x16x32_bf16 v[32:35], v[162:165], v[236:239], v[32:35]
v_mfma_f32_16x16x32_bf16 v[16:19], v[166:169], v[232:235], v[16:19]
ds_read_b128 v[146:149], v75 offset:12288
v_mfma_f32_16x16x32_bf16 v[36:39], v[166:169], v[236:239], v[36:39]
v_mfma_f32_16x16x32_bf16 v[20:23], v[170:173], v[232:235], v[20:23]
ds_read_b128 v[150:153], v75 offset:13312
s_add_u32 m0, s89, 106496
s_add_u32 s60, s60, 4096
buffer_load_dwordx4 v74, s[24:27], s60 offen sc1 lds
v_mfma_f32_16x16x32_bf16 v[40:43], v[170:173], v[236:239], v[40:43]
v_mfma_f32_16x16x32_bf16 v[24:27], v[174:177], v[232:235], v[24:27]
ds_read_b128 v[154:157], v75 offset:14336
v_mfma_f32_16x16x32_bf16 v[44:47], v[174:177], v[236:239], v[44:47]
s_barrier
s_waitcnt lgkmcnt(5)
v_mfma_f32_16x16x32_bf16 v[8:11], v[118:121], v[240:243], v[8:11]
v_add_u32 v75, 0xfffdd000, v75
s_add_u32 m0, s89, 122880
s_add_u32 s60, s88, 184320
buffer_load_dwordx4 v74, s[24:27], s60 offen offset:0 sc1 lds
v_mfma_f32_16x16x32_bf16 v[28:31], v[118:121], v[244:247], v[28:31]
v_mfma_f32_16x16x32_bf16 v[12:15], v[122:125], v[240:243], v[12:15]
ds_read_b128 v[158:161], v75 offset:0
v_mfma_f32_16x16x32_bf16 v[32:35], v[122:125], v[244:247], v[32:35]
v_mfma_f32_16x16x32_bf16 v[16:19], v[126:129], v[240:243], v[16:19]
ds_read_b128 v[162:165], v75 offset:1024
buffer_load_dwordx4 v74, s[24:27], s60 offen offset:1024 sc1 lds
v_mfma_f32_16x16x32_bf16 v[36:39], v[126:129], v[244:247], v[36:39]
v_mfma_f32_16x16x32_bf16 v[20:23], v[130:133], v[240:243], v[20:23]
ds_read_b128 v[166:169], v75 offset:2048
v_mfma_f32_16x16x32_bf16 v[40:43], v[130:133], v[244:247], v[40:43]
v_mfma_f32_16x16x32_bf16 v[24:27], v[134:137], v[240:243], v[24:27]
ds_read_b128 v[170:173], v75 offset:3072
buffer_load_dwordx4 v74, s[24:27], s60 offen offset:2048 sc1 lds
v_mfma_f32_16x16x32_bf16 v[44:47], v[134:137], v[244:247], v[44:47]
ds_read_b128 v[174:177], v75 offset:4096
s_waitcnt lgkmcnt(5)
v_mfma_f32_16x16x32_bf16 v[8:11], v[138:141], v[248:251], v[8:11]
ds_read_b128 v[118:121], v75 offset:10240
v_mfma_f32_16x16x32_bf16 v[28:31], v[138:141], v[252:255], v[28:31]
v_mfma_f32_16x16x32_bf16 v[12:15], v[142:145], v[248:251], v[12:15]
ds_read_b128 v[122:125], v75 offset:11264
buffer_load_dwordx4 v74, s[24:27], s60 offen offset:3072 sc1 lds
v_mfma_f32_16x16x32_bf16 v[32:35], v[142:145], v[252:255], v[32:35]
v_mfma_f32_16x16x32_bf16 v[16:19], v[146:149], v[248:251], v[16:19]
ds_read_b128 v[126:129], v75 offset:12288
v_mfma_f32_16x16x32_bf16 v[36:39], v[146:149], v[252:255], v[36:39]
v_mfma_f32_16x16x32_bf16 v[20:23], v[150:153], v[248:251], v[20:23]
ds_read_b128 v[130:133], v75 offset:13312
s_add_u32 m0, s89, 126976
s_add_u32 s60, s60, 4096
buffer_load_dwordx4 v74, s[24:27], s60 offen sc1 lds
v_mfma_f32_16x16x32_bf16 v[40:43], v[150:153], v[252:255], v[40:43]
v_mfma_f32_16x16x32_bf16 v[24:27], v[154:157], v[248:251], v[24:27]
ds_read_b128 v[134:137], v75 offset:14336
v_mfma_f32_16x16x32_bf16 v[44:47], v[154:157], v[252:255], v[44:47]
s_waitcnt vmcnt(20)
s_barrier
s_waitcnt lgkmcnt(5)
v_mfma_f32_16x16x32_bf16 v[8:11], v[158:161], a[216:219], v[8:11]
v_add_u32 v75, 0x5000, v75
s_add_u32 m0, s89, 143360
s_add_u32 s60, s88, 204800
buffer_load_dwordx4 v74, s[24:27], s60 offen offset:0 sc1 lds
v_mfma_f32_16x16x32_bf16 v[28:31], v[158:161], a[220:223], v[28:31]
v_mfma_f32_16x16x32_bf16 v[12:15], v[162:165], a[216:219], v[12:15]
ds_read_b128 v[138:141], v75 offset:0
v_mfma_f32_16x16x32_bf16 v[32:35], v[162:165], a[220:223], v[32:35]
v_mfma_f32_16x16x32_bf16 v[16:19], v[166:169], a[216:219], v[16:19]
ds_read_b128 v[142:145], v75 offset:1024
buffer_load_dwordx4 v74, s[24:27], s60 offen offset:1024 sc1 lds
v_mfma_f32_16x16x32_bf16 v[36:39], v[166:169], a[220:223], v[36:39]
v_mfma_f32_16x16x32_bf16 v[20:23], v[170:173], a[216:219], v[20:23]
ds_read_b128 v[146:149], v75 offset:2048
v_mfma_f32_16x16x32_bf16 v[40:43], v[170:173], a[220:223], v[40:43]
v_mfma_f32_16x16x32_bf16 v[24:27], v[174:177], a[216:219], v[24:27]
ds_read_b128 v[150:153], v75 offset:3072
buffer_load_dwordx4 v74, s[24:27], s60 offen offset:2048 sc1 lds
v_mfma_f32_16x16x32_bf16 v[44:47], v[174:177], a[220:223], v[44:47]
ds_read_b128 v[154:157], v75 offset:4096
s_waitcnt lgkmcnt(5)
v_mfma_f32_16x16x32_bf16 v[8:11], v[118:121], a[224:227], v[8:11]
ds_read_b128 v[158:161], v75 offset:10240
v_mfma_f32_16x16x32_bf16 v[28:31], v[118:121], a[228:231], v[28:31]
v_mfma_f32_16x16x32_bf16 v[12:15], v[122:125], a[224:227], v[12:15]
ds_read_b128 v[162:165], v75 offset:11264
buffer_load_dwordx4 v74, s[24:27], s60 offen offset:3072 sc1 lds
v_mfma_f32_16x16x32_bf16 v[32:35], v[122:125], a[228:231], v[32:35]
v_mfma_f32_16x16x32_bf16 v[16:19], v[126:129], a[224:227], v[16:19]
ds_read_b128 v[166:169], v75 offset:12288
v_mfma_f32_16x16x32_bf16 v[36:39], v[126:129], a[228:231], v[36:39]
v_mfma_f32_16x16x32_bf16 v[20:23], v[130:133], a[224:227], v[20:23]
ds_read_b128 v[170:173], v75 offset:13312
s_add_u32 m0, s89, 147456
s_add_u32 s60, s60, 4096
buffer_load_dwordx4 v74, s[24:27], s60 offen sc1 lds
v_mfma_f32_16x16x32_bf16 v[40:43], v[130:133], a[228:231], v[40:43]
v_mfma_f32_16x16x32_bf16 v[24:27], v[134:137], a[224:227], v[24:27]
ds_read_b128 v[174:177], v75 offset:14336
v_mfma_f32_16x16x32_bf16 v[44:47], v[134:137], a[228:231], v[44:47]
s_waitcnt vmcnt(20)
s_barrier
s_waitcnt lgkmcnt(5)
v_mfma_f32_16x16x32_bf16 v[8:11], v[138:141], a[232:235], v[8:11]
v_add_u32 v75, 0x5000, v75
s_add_u32 m0, s89, 0
s_add_u32 s60, s88, 225280
buffer_load_dwordx4 v74, s[24:27], s60 offen offset:0 sc1 lds
v_mfma_f32_16x16x32_bf16 v[28:31], v[138:141], a[236:239], v[28:31]
v_mfma_f32_16x16x32_bf16 v[12:15], v[142:145], a[232:235], v[12:15]
ds_read_b128 v[118:121], v75 offset:0
v_mfma_f32_16x16x32_bf16 v[32:35], v[142:145], a[236:239], v[32:35]
v_mfma_f32_16x16x32_bf16 v[16:19], v[146:149], a[232:235], v[16:19]
ds_read_b128 v[122:125], v75 offset:1024
buffer_load_dwordx4 v74, s[24:27], s60 offen offset:1024 sc1 lds
v_mfma_f32_16x16x32_bf16 v[36:39], v[146:149], a[236:239], v[36:39]
v_mfma_f32_16x16x32_bf16 v[20:23], v[150:153], a[232:235], v[20:23]
ds_read_b128 v[126:129], v75 offset:2048
v_mfma_f32_16x16x32_bf16 v[40:43], v[150:153], a[236:239], v[40:43]
v_mfma_f32_16x16x32_bf16 v[24:27], v[154:157], a[232:235], v[24:27]
ds_read_b128 v[130:133], v75 offset:3072
buffer_load_dwordx4 v74, s[24:27], s60 offen offset:2048 sc1 lds
v_mfma_f32_16x16x32_bf16 v[44:47], v[154:157], a[236:239], v[44:47]
ds_read_b128 v[134:137], v75 offset:4096
s_waitcnt lgkmcnt(5)
v_mfma_f32_16x16x32_bf16 v[8:11], v[158:161], a[240:243], v[8:11]
ds_read_b128 v[138:141], v75 offset:10240
v_mfma_f32_16x16x32_bf16 v[28:31], v[158:161], a[244:247], v[28:31]
v_mfma_f32_16x16x32_bf16 v[12:15], v[162:165], a[240:243], v[12:15]
ds_read_b128 v[142:145], v75 offset:11264
buffer_load_dwordx4 v74, s[24:27], s60 offen offset:3072 sc1 lds
v_mfma_f32_16x16x32_bf16 v[32:35], v[162:165], a[244:247], v[32:35]
v_mfma_f32_16x16x32_bf16 v[16:19], v[166:169], a[240:243], v[16:19]
ds_read_b128 v[146:149], v75 offset:12288
v_mfma_f32_16x16x32_bf16 v[36:39], v[166:169], a[244:247], v[36:39]
v_mfma_f32_16x16x32_bf16 v[20:23], v[170:173], a[240:243], v[20:23]
ds_read_b128 v[150:153], v75 offset:13312
s_add_u32 m0, s89, 4096
s_add_u32 s60, s60, 4096
buffer_load_dwordx4 v74, s[24:27], s60 offen sc1 lds
v_mfma_f32_16x16x32_bf16 v[40:43], v[170:173], a[244:247], v[40:43]
v_mfma_f32_16x16x32_bf16 v[24:27], v[174:177], a[240:243], v[24:27]
ds_read_b128 v[154:157], v75 offset:14336
v_mfma_f32_16x16x32_bf16 v[44:47], v[174:177], a[244:247], v[44:47]
s_waitcnt vmcnt(20)
s_barrier
s_add_u32 s45, s87, 32
s_lshl_b32 s45, s45, 7
s_add_u32 s45, s45, 25165824
v_min_u32 v184, 15, v1
v_lshl_add_u32 v184, v184, 2, s45
s_lshl_b32 s45, s2, 2
s_add_u32 s45, s45, s42
s_lshl_b32 s45, s45, 7
s_add_u32 s45, s45, 27262976
s_cmp_eq_u32 s42, 0
s_cselect_b64 s[48:49], -1, 0
v_mov_b32 v185, s45
v_cndmask_b32_e64 v184, v185, v184, s[48:49]
buffer_load_dword v185, v184, s[24:27], 0 offen sc1
s_waitcnt lgkmcnt(5)
v_mfma_f32_16x16x32_bf16 v[8:11], v[118:121], a[248:251], v[8:11]
v_add_u32 v75, 0xa000, v75
s_add_u32 m0, s89, 20480
s_add_u32 s60, s88, 245760
buffer_load_dwordx4 v74, s[24:27], s60 offen offset:0 sc1 lds
v_mfma_f32_16x16x32_bf16 v[28:31], v[118:121], a[252:255], v[28:31]
v_mfma_f32_16x16x32_bf16 v[12:15], v[122:125], a[248:251], v[12:15]
ds_read_b128 v[158:161], v75 offset:0
v_mfma_f32_16x16x32_bf16 v[32:35], v[122:125], a[252:255], v[32:35]
v_mfma_f32_16x16x32_bf16 v[16:19], v[126:129], a[248:251], v[16:19]
ds_read_b128 v[162:165], v75 offset:1024
buffer_load_dwordx4 v74, s[24:27], s60 offen offset:1024 sc1 lds
v_mfma_f32_16x16x32_bf16 v[36:39], v[126:129], a[252:255], v[36:39]
v_mfma_f32_16x16x32_bf16 v[20:23], v[130:133], a[248:251], v[20:23]
ds_read_b128 v[166:169], v75 offset:2048
v_mfma_f32_16x16x32_bf16 v[40:43], v[130:133], a[252:255], v[40:43]
v_mfma_f32_16x16x32_bf16 v[24:27], v[134:137], a[248:251], v[24:27]
ds_read_b128 v[170:173], v75 offset:3072
buffer_load_dwordx4 v74, s[24:27], s60 offen offset:2048 sc1 lds
v_mfma_f32_16x16x32_bf16 v[44:47], v[134:137], a[252:255], v[44:47]
ds_read_b128 v[174:177], v75 offset:4096
s_waitcnt lgkmcnt(5)
v_mfma_f32_16x16x32_bf16 v[8:11], v[138:141], a[0:3], v[8:11]
ds_read_b128 v[118:121], v75 offset:10240
v_mfma_f32_16x16x32_bf16 v[28:31], v[138:141], a[4:7], v[28:31]
v_mfma_f32_16x16x32_bf16 v[12:15], v[142:145], a[0:3], v[12:15]
ds_read_b128 v[122:125], v75 offset:11264
buffer_load_dwordx4 v74, s[24:27], s60 offen offset:3072 sc1 lds
v_mfma_f32_16x16x32_bf16 v[32:35], v[142:145], a[4:7], v[32:35]
v_mfma_f32_16x16x32_bf16 v[16:19], v[146:149], a[0:3], v[16:19]
ds_read_b128 v[126:129], v75 offset:12288
v_mfma_f32_16x16x32_bf16 v[36:39], v[146:149], a[4:7], v[36:39]
v_mfma_f32_16x16x32_bf16 v[20:23], v[150:153], a[0:3], v[20:23]
ds_read_b128 v[130:133], v75 offset:13312
s_add_u32 m0, s89, 24576
s_add_u32 s60, s60, 4096
buffer_load_dwordx4 v74, s[24:27], s60 offen sc1 lds
v_mfma_f32_16x16x32_bf16 v[40:43], v[150:153], a[4:7], v[40:43]
v_mfma_f32_16x16x32_bf16 v[24:27], v[154:157], a[0:3], v[24:27]
ds_read_b128 v[134:137], v75 offset:14336
v_mfma_f32_16x16x32_bf16 v[44:47], v[154:157], a[4:7], v[44:47]
s_waitcnt vmcnt(21)
s_barrier
s_waitcnt lgkmcnt(5)
v_mfma_f32_16x16x32_bf16 v[8:11], v[158:161], a[8:11], v[8:11]
v_add_u32 v75, 0x5000, v75
s_add_u32 m0, s89, 40960
s_add_u32 s60, s88, 266240
buffer_load_dwordx4 v74, s[24:27], s60 offen offset:0 sc1 lds
v_mfma_f32_16x16x32_bf16 v[28:31], v[158:161], a[12:15], v[28:31]
v_mfma_f32_16x16x32_bf16 v[12:15], v[162:165], a[8:11], v[12:15]
ds_read_b128 v[138:141], v75 offset:0
v_mfma_f32_16x16x32_bf16 v[32:35], v[162:165], a[12:15], v[32:35]
v_mfma_f32_16x16x32_bf16 v[16:19], v[166:169], a[8:11], v[16:19]
ds_read_b128 v[142:145], v75 offset:1024
buffer_load_dwordx4 v74, s[24:27], s60 offen offset:1024 sc1 lds
v_mfma_f32_16x16x32_bf16 v[36:39], v[166:169], a[12:15], v[36:39]
v_mfma_f32_16x16x32_bf16 v[20:23], v[170:173], a[8:11], v[20:23]
ds_read_b128 v[146:149], v75 offset:2048
v_mfma_f32_16x16x32_bf16 v[40:43], v[170:173], a[12:15], v[40:43]
v_mfma_f32_16x16x32_bf16 v[24:27], v[174:177], a[8:11], v[24:27]
ds_read_b128 v[150:153], v75 offset:3072
buffer_load_dwordx4 v74, s[24:27], s60 offen offset:2048 sc1 lds
v_mfma_f32_16x16x32_bf16 v[44:47], v[174:177], a[12:15], v[44:47]
ds_read_b128 v[154:157], v75 offset:4096
s_waitcnt lgkmcnt(5)
v_mfma_f32_16x16x32_bf16 v[8:11], v[118:121], a[16:19], v[8:11]
ds_read_b128 v[158:161], v75 offset:10240
v_mfma_f32_16x16x32_bf16 v[28:31], v[118:121], a[20:23], v[28:31]
v_mfma_f32_16x16x32_bf16 v[12:15], v[122:125], a[16:19], v[12:15]
ds_read_b128 v[162:165], v75 offset:11264
buffer_load_dwordx4 v74, s[24:27], s60 offen offset:3072 sc1 lds
v_mfma_f32_16x16x32_bf16 v[32:35], v[122:125], a[20:23], v[32:35]
v_mfma_f32_16x16x32_bf16 v[16:19], v[126:129], a[16:19], v[16:19]
ds_read_b128 v[166:169], v75 offset:12288
v_mfma_f32_16x16x32_bf16 v[36:39], v[126:129], a[20:23], v[36:39]
v_mfma_f32_16x16x32_bf16 v[20:23], v[130:133], a[16:19], v[20:23]
ds_read_b128 v[170:173], v75 offset:13312
s_add_u32 m0, s89, 45056
s_add_u32 s60, s60, 4096
buffer_load_dwordx4 v74, s[24:27], s60 offen sc1 lds
v_mfma_f32_16x16x32_bf16 v[40:43], v[130:133], a[20:23], v[40:43]
v_mfma_f32_16x16x32_bf16 v[24:27], v[134:137], a[16:19], v[24:27]
ds_read_b128 v[174:177], v75 offset:14336
v_mfma_f32_16x16x32_bf16 v[44:47], v[134:137], a[20:23], v[44:47]
s_waitcnt vmcnt(21)
s_barrier
s_waitcnt lgkmcnt(5)
v_mfma_f32_16x16x32_bf16 v[8:11], v[138:141], a[24:27], v[8:11]
v_add_u32 v75, 0x5000, v75
s_add_u32 m0, s89, 81920
s_add_u32 s60, s88, 286720
buffer_load_dwordx4 v74, s[24:27], s60 offen offset:0 sc1 lds
v_mfma_f32_16x16x32_bf16 v[28:31], v[138:141], a[28:31], v[28:31]
v_mfma_f32_16x16x32_bf16 v[12:15], v[142:145], a[24:27], v[12:15]
ds_read_b128 v[118:121], v75 offset:0
v_mfma_f32_16x16x32_bf16 v[32:35], v[142:145], a[28:31], v[32:35]
buffer_load_dwordx4 v74, s[24:27], s60 offen offset:1024 sc1 lds
v_mfma_f32_16x16x32_bf16 v[16:19], v[146:149], a[24:27], v[16:19]
ds_read_b128 v[122:125], v75 offset:1024
v_mfma_f32_16x16x32_bf16 v[36:39], v[146:149], a[28:31], v[36:39]
v_mfma_f32_16x16x32_bf16 v[20:23], v[150:153], a[24:27], v[20:23]
ds_read_b128 v[126:129], v75 offset:2048
buffer_load_dwordx4 v74, s[24:27], s60 offen offset:2048 sc1 lds
v_mfma_f32_16x16x32_bf16 v[40:43], v[150:153], a[28:31], v[40:43]
v_mfma_f32_16x16x32_bf16 v[24:27], v[154:157], a[24:27], v[24:27]
ds_read_b128 v[130:133], v75 offset:3072
v_mfma_f32_16x16x32_bf16 v[44:47], v[154:157], a[28:31], v[44:47]
ds_read_b128 v[134:137], v75 offset:4096
s_waitcnt lgkmcnt(5)
v_mfma_f32_16x16x32_bf16 v[8:11], v[158:161], a[32:35], v[8:11]
ds_read_b128 v[138:141], v75 offset:10240
buffer_load_dwordx4 v74, s[24:27], s60 offen offset:3072 sc1 lds
v_mfma_f32_16x16x32_bf16 v[28:31], v[158:161], a[72:75], v[28:31]
v_mfma_f32_16x16x32_bf16 v[12:15], v[162:165], a[32:35], v[12:15]
ds_read_b128 v[142:145], v75 offset:11264
v_mfma_f32_16x16x32_bf16 v[32:35], v[162:165], a[72:75], v[32:35]
s_add_u32 m0, s89, 86016
s_add_u32 s60, s60, 4096
buffer_load_dwordx4 v74, s[24:27], s60 offen sc1 lds
v_mfma_f32_16x16x32_bf16 v[16:19], v[166:169], a[32:35], v[16:19]
ds_read_b128 v[146:149], v75 offset:12288
v_mfma_f32_16x16x32_bf16 v[36:39], v[166:169], a[72:75], v[36:39]
v_mfma_f32_16x16x32_bf16 v[20:23], v[170:173], a[32:35], v[20:23]
ds_read_b128 v[150:153], v75 offset:13312
s_add_u32 s61, s94, 53248
buffer_load_dwordx4 a[36:39], v74, s[24:27], s61 offen offset:0 sc1
v_mfma_f32_16x16x32_bf16 v[40:43], v[170:173], a[72:75], v[40:43]
v_mfma_f32_16x16x32_bf16 v[24:27], v[174:177], a[32:35], v[24:27]
ds_read_b128 v[154:157], v75 offset:14336
v_mfma_f32_16x16x32_bf16 v[44:47], v[174:177], a[72:75], v[44:47]
s_waitcnt vmcnt(22)
s_waitcnt vmcnt(16)
s_cmp_lg_u32 s42, 0
s_cbranch_scc1 L_pc_32
v_cmp_ne_u32 s[48:49], s79, v185
s_nop 1
s_cmp_eq_u64 s[48:49], 0
s_cbranch_scc1 L_pc_32
s_cmp_lg_u32 s42, 0
s_cbranch_scc1 L_poll_33_ok
s_mov_b32 s46, 0x40000
L_poll_33:
buffer_load_dword v185, v184, s[24:27], 0 offen sc1
s_waitcnt vmcnt(0)
v_cmp_ne_u32 s[48:49], s79, v185
s_nop 1
s_cmp_eq_u64 s[48:49], 0
s_cbranch_scc1 L_poll_33_ok
s_sleep 1
s_sub_u32 s46, s46, 1
s_cmp_lg_u32 s46, 0
s_cbranch_scc1 L_poll_33
L_poll_33_ok:
L_pc_32:
s_barrier
s_waitcnt lgkmcnt(5)
v_mfma_f32_16x16x32_bf16 v[8:11], v[118:121], a[76:79], v[8:11]
v_add_u32 v75, 0x5000, v75
s_add_u32 m0, s89, 102400
s_add_u32 s60, s88, 307200
buffer_load_dwordx4 v74, s[24:27], s60 offen offset:0 sc1 lds
v_mfma_f32_16x16x32_bf16 v[28:31], v[118:121], a[80:83], v[28:31]
buffer_load_dwordx4 v74, s[24:27], s60 offen offset:1024 sc1 lds
v_mfma_f32_16x16x32_bf16 v[12:15], v[122:125], a[76:79], v[12:15]
ds_read_b128 v[158:161], v75 offset:0
v_mfma_f32_16x16x32_bf16 v[32:35], v[122:125], a[80:83], v[32:35]
buffer_load_dwordx4 v74, s[24:27], s60 offen offset:2048 sc1 lds
v_mfma_f32_16x16x32_bf16 v[16:19], v[126:129], a[76:79], v[16:19]
ds_read_b128 v[162:165], v75 offset:1024
v_mfma_f32_16x16x32_bf16 v[36:39], v[126:129], a[80:83], v[36:39]
buffer_load_dwordx4 v74, s[24:27], s60 offen offset:3072 sc1 lds
v_mfma_f32_16x16x32_bf16 v[20:23], v[130:133], a[76:79], v[20:23]
ds_read_b128 v[166:169], v75 offset:2048
v_mfma_f32_16x16x32_bf16 v[40:43], v[130:133], a[80:83], v[40:43]
s_add_u32 m0, s89, 106496
s_add_u32 s60, s60, 4096
buffer_load_dwordx4 v74, s[24:27], s60 offen sc1 lds
v_mfma_f32_16x16x32_bf16 v[24:27], v[134:137], a[76:79], v[24:27]
ds_read_b128 v[170:173], v75 offset:3072
v_mfma_f32_16x16x32_bf16 v[44:47], v[134:137], a[80:83], v[44:47]
s_add_u32 s61, s92, 0
buffer_load_dwordx4 a[40:43], v74, s[24:27], s61 offen offset:0 sc1
ds_read_b128 v[174:177], v75 offset:4096
s_waitcnt lgkmcnt(5)
v_mfma_f32_16x16x32_bf16 v[8:11], v[138:141], a[84:87], v[8:11]
ds_read_b128 v[118:121], v75 offset:10240
s_add_u32 s61, s95, 0
buffer_load_dwordx4 a[44:47], v74, s[24:27], s61 offen offset:0 sc1
v_mfma_f32_16x16x32_bf16 v[28:31], v[138:141], a[88:91], v[28:31]
v_mfma_f32_16x16x32_bf16 v[12:15], v[142:145], a[84:87], v[12:15]
ds_read_b128 v[122:125], v75 offset:11264
s_add_u32 s61, s92, 0
buffer_load_dwordx4 a[48:51], v74, s[24:27], s61 offen offset:2048 sc1
v_mfma_f32_16x16x32_bf16 v[32:35], v[142:145], a[88:91], v[32:35]
v_mfma_f32_16x16x32_bf16 v[16:19], v[146:149], a[84:87], v[16:19]
ds_read_b128 v[126:129], v75 offset:12288
s_add_u32 s61, s95, 0
buffer_load_dwordx4 a[52:55], v74, s[24:27], s61 offen offset:2048 sc1
v_mfma_f32_16x16x32_bf16 v[36:39], v[146:149], a[88:91], v[36:39]
v_mfma_f32_16x16x32_bf16 v[20:23], v[150:153], a[84:87], v[20:23]
ds_read_b128 v[130:133], v75 offset:13312
s_add_u32 s61, s92, 4096
buffer_load_dwordx4 a[56:59], v74, s[24:27], s61 offen offset:0 sc1
v_mfma_f32_16x16x32_bf16 v[40:43], v[150:153], a[88:91], v[40:43]
v_mfma_f32_16x16x32_bf16 v[24:27], v[154:157], a[84:87], v[24:27]
ds_read_b128 v[134:137], v75 offset:14336
s_add_u32 s61, s95, 4096
buffer_load_dwordx4 a[60:63], v74, s[24:27], s61 offen offset:0 sc1
v_mfma_f32_16x16x32_bf16 v[44:47], v[154:157], a[88:91], v[44:47]
s_barrier
s_waitcnt lgkmcnt(5)
v_mfma_f32_16x16x32_bf16 v[8:11], v[158:161], a[92:95], v[8:11]
v_add_u32 v75, 0xfffdd000, v75
s_add_u32 m0, s89, 122880
s_add_u32 s60, s88, 327680
buffer_load_dwordx4 v74, s[24:27], s60 offen offset:0 sc1 lds
v_mfma_f32_16x16x32_bf16 v[28:31], v[158:161], a[96:99], v[28:31]
v_mfma_f32_16x16x32_bf16 v[12:15], v[162:165], a[92:95], v[12:15]
ds_read_b128 v[138:141], v75 offset:0
buffer_load_dwordx4 v74, s[24:27], s60 offen offset:1024 sc1 lds
v_mfma_f32_16x16x32_bf16 v[32:35], v[162:165], a[96:99], v[32:35]
v_mfma_f32_16x16x32_bf16 v[16:19], v[166:169], a[92:95], v[16:19]
ds_read_b128 v[142:145], v75 offset:1024
buffer_load_dwordx4 v74, s[24:27], s60 offen offset:2048 sc1 lds
v_mfma_f32_16x16x32_bf16 v[36:39], v[166:169], a[96:99], v[36:39]
v_mfma_f32_16x16x32_bf16 v[20:23], v[170:173], a[92:95], v[20:23]
ds_read_b128 v[146:149], v75 offset:2048
buffer_load_dwordx4 v74, s[24:27], s60 offen offset:3072 sc1 lds
v_mfma_f32_16x16x32_bf16 v[40:43], v[170:173], a[96:99], v[40:43]
v_mfma_f32_16x16x32_bf16 v[24:27], v[174:177], a[92:95], v[24:27]
ds_read_b128 v[150:153], v75 offset:3072
s_add_u32 m0, s89, 126976
s_add_u32 s60, s60, 4096
buffer_load_dwordx4 v74, s[24:27], s60 offen sc1 lds
v_mfma_f32_16x16x32_bf16 v[44:47], v[174:177], a[96:99], v[44:47]
ds_read_b128 v[154:157], v75 offset:4096
s_waitcnt lgkmcnt(5)
v_mfma_f32_16x16x32_bf16 v[8:11], v[118:121], a[100:103], v[8:11]
ds_read_b128 v[158:161], v75 offset:10240
v_mfma_f32_16x16x32_bf16 v[28:31], v[118:121], a[104:107], v[28:31]
s_add_u32 s61, s92, 4096
buffer_load_dwordx4 a[64:67], v74, s[24:27], s61 offen offset:2048 sc1
v_mfma_f32_16x16x32_bf16 v[12:15], v[122:125], a[100:103], v[12:15]
ds_read_b128 v[162:165], v75 offset:11264
v_mfma_f32_16x16x32_bf16 v[32:35], v[122:125], a[104:107], v[32:35]
s_add_u32 s61, s95, 4096
buffer_load_dwordx4 a[68:71], v74, s[24:27], s61 offen offset:2048 sc1
v_mfma_f32_16x16x32_bf16 v[16:19], v[126:129], a[100:103], v[16:19]
ds_read_b128 v[166:169], v75 offset:12288
v_mfma_f32_16x16x32_bf16 v[36:39], v[126:129], a[104:107], v[36:39]
s_add_u32 s61, s92, 8192
buffer_load_dwordx4 a[144:147], v74, s[24:27], s61 offen offset:0 sc1
v_mfma_f32_16x16x32_bf16 v[20:23], v[130:133], a[100:103], v[20:23]
ds_read_b128 v[170:173], v75 offset:13312
v_mfma_f32_16x16x32_bf16 v[40:43], v[130:133], a[104:107], v[40:43]
s_add_u32 s61, s95, 8192
buffer_load_dwordx4 a[148:151], v74, s[24:27], s61 offen offset:0 sc1
v_mfma_f32_16x16x32_bf16 v[24:27], v[134:137], a[100:103], v[24:27]
ds_read_b128 v[174:177], v75 offset:14336
v_mfma_f32_16x16x32_bf16 v[44:47], v[134:137], a[104:107], v[44:47]
s_waitcnt vmcnt(31)
s_barrier
s_waitcnt lgkmcnt(5)
v_mfma_f32_16x16x32_bf16 v[8:11], v[138:141], a[108:111], v[8:11]
v_add_u32 v75, 0x5000, v75
s_add_u32 m0, s89, 143360
s_add_u32 s60, s88, 348160
buffer_load_dwordx4 v74, s[24:27], s60 offen offset:0 sc1 lds
v_mfma_f32_16x16x32_bf16 v[28:31], v[138:141], a[112:115], v[28:31]
v_mfma_f32_16x16x32_bf16 v[12:15], v[142:145], a[108:111], v[12:15]
ds_read_b128 v[118:121], v75 offset:0
buffer_load_dwordx4 v74, s[24:27], s60 offen offset:1024 sc1 lds
v_mfma_f32_16x16x32_bf16 v[32:35], v[142:145], a[112:115], v[32:35]
v_mfma_f32_16x16x32_bf16 v[16:19], v[146:149], a[108:111], v[16:19]
ds_read_b128 v[122:125], v75 offset:1024
buffer_load_dwordx4 v74, s[24:27], s60 offen offset:2048 sc1 lds
v_mfma_f32_16x16x32_bf16 v[36:39], v[146:149], a[112:115], v[36:39]
v_mfma_f32_16x16x32_bf16 v[20:23], v[150:153], a[108:111], v[20:23]
ds_read_b128 v[126:129], v75 offset:2048
buffer_load_dwordx4 v74, s[24:27], s60 offen offset:3072 sc1 lds
v_mfma_f32_16x16x32_bf16 v[40:43], v[150:153], a[112:115], v[40:43]
v_mfma_f32_16x16x32_bf16 v[24:27], v[154:157], a[108:111], v[24:27]
ds_read_b128 v[130:133], v75 offset:3072
s_add_u32 m0, s89, 147456
s_add_u32 s60, s60, 4096
buffer_load_dwordx4 v74, s[24:27], s60 offen sc1 lds
v_mfma_f32_16x16x32_bf16 v[44:47], v[154:157], a[112:115], v[44:47]
ds_read_b128 v[134:137], v75 offset:4096
s_waitcnt lgkmcnt(5)
v_mfma_f32_16x16x32_bf16 v[8:11], v[158:161], a[116:119], v[8:11]
ds_read_b128 v[138:141], v75 offset:10240
v_mfma_f32_16x16x32_bf16 v[28:31], v[158:161], a[120:123], v[28:31]
s_add_u32 s61, s92, 8192
buffer_load_dwordx4 a[152:155], v74, s[24:27], s61 offen offset:2048 sc1
v_mfma_f32_16x16x32_bf16 v[12:15], v[162:165], a[116:119], v[12:15]
ds_read_b128 v[142:145], v75 offset:11264
v_mfma_f32_16x16x32_bf16 v[32:35], v[162:165], a[120:123], v[32:35]
s_add_u32 s61, s95, 8192
buffer_load_dwordx4 a[156:159], v74, s[24:27], s61 offen offset:2048 sc1
v_mfma_f32_16x16x32_bf16 v[16:19], v[166:169], a[116:119], v[16:19]
ds_read_b128 v[146:149], v75 offset:12288
v_mfma_f32_16x16x32_bf16 v[36:39], v[166:169], a[120:123], v[36:39]
s_add_u32 s61, s92, 12288
buffer_load_dwordx4 a[160:163], v74, s[24:27], s61 offen offset:0 sc1
v_mfma_f32_16x16x32_bf16 v[20:23], v[170:173], a[116:119], v[20:23]
ds_read_b128 v[150:153], v75 offset:13312
v_mfma_f32_16x16x32_bf16 v[40:43], v[170:173], a[120:123], v[40:43]
s_add_u32 s61, s95, 12288
buffer_load_dwordx4 a[164:167], v74, s[24:27], s61 offen offset:0 sc1
v_mfma_f32_16x16x32_bf16 v[24:27], v[174:177], a[116:119], v[24:27]
ds_read_b128 v[154:157], v75 offset:14336
v_mfma_f32_16x16x32_bf16 v[44:47], v[174:177], a[120:123], v[44:47]
s_waitcnt vmcnt(35)
s_barrier
s_waitcnt lgkmcnt(5)
v_mfma_f32_16x16x32_bf16 v[8:11], v[118:121], a[124:127], v[8:11]
v_add_u32 v75, 0x5000, v75
s_cmp_ge_u32 s42, 2
s_cselect_b32 s60, 20480, 0
s_sub_u32 s60, s88, s60
s_add_u32 s60, s60, 368640
s_add_u32 m0, s89, 0
s_nop 0
buffer_load_dwordx4 v74, s[24:27], s60 offen offset:0 sc1 lds
v_mfma_f32_16x16x32_bf16 v[28:31], v[118:121], a[128:131], v[28:31]
v_mfma_f32_16x16x32_bf16 v[12:15], v[122:125], a[124:127], v[12:15]
ds_read_b128 v[158:161], v75 offset:0
buffer_load_dwordx4 v74, s[24:27], s60 offen offset:1024 sc1 lds
v_mfma_f32_16x16x32_bf16 v[32:35], v[122:125], a[128:131], v[32:35]
v_mfma_f32_16x16x32_bf16 v[16:19], v[126:129], a[124:127], v[16:19]
ds_read_b128 v[162:165], v75 offset:1024
buffer_load_dwordx4 v74, s[24:27], s60 offen offset:2048 sc1 lds
v_mfma_f32_16x16x32_bf16 v[36:39], v[126:129], a[128:131], v[36:39]
v_mfma_f32_16x16x32_bf16 v[20:23], v[130:133], a[124:127], v[20:23]
ds_read_b128 v[166:169], v75 offset:2048
buffer_load_dwordx4 v74, s[24:27], s60 offen offset:3072 sc1 lds
v_mfma_f32_16x16x32_bf16 v[40:43], v[130:133], a[128:131], v[40:43]
v_mfma_f32_16x16x32_bf16 v[24:27], v[134:137], a[124:127], v[24:27]
ds_read_b128 v[170:173], v75 offset:3072
s_add_u32 m0, s89, 4096
s_add_u32 s60, s60, 4096
buffer_load_dwordx4 v74, s[24:27], s60 offen sc1 lds
v_mfma_f32_16x16x32_bf16 v[44:47], v[134:137], a[128:131], v[44:47]
ds_read_b128 v[174:177], v75 offset:4096
s_waitcnt lgkmcnt(5)
v_mfma_f32_16x16x32_bf16 v[8:11], v[138:141], a[132:135], v[8:11]
ds_read_b128 v[118:121], v75 offset:10240
v_mfma_f32_16x16x32_bf16 v[28:31], v[138:141], a[136:139], v[28:31]
s_add_u32 s61, s90, 12288
buffer_load_dwordx4 a[168:171], v74, s[24:27], s61 offen offset:2048 sc1
v_mfma_f32_16x16x32_bf16 v[12:15], v[142:145], a[132:135], v[12:15]
ds_read_b128 v[122:125], v75 offset:11264
v_mfma_f32_16x16x32_bf16 v[32:35], v[142:145], a[136:139], v[32:35]
s_add_u32 s61, s90, 12288
buffer_load_dwordx4 a[172:175], v74, s[24:27], s61 offen offset:3072 sc1
v_mfma_f32_16x16x32_bf16 v[16:19], v[146:149], a[132:135], v[16:19]
ds_read_b128 v[126:129], v75 offset:12288
v_mfma_f32_16x16x32_bf16 v[36:39], v[146:149], a[136:139], v[36:39]
s_add_u32 s61, s90, 16384
buffer_load_dwordx4 a[176:179], v74, s[24:27], s61 offen offset:0 sc1
v_mfma_f32_16x16x32_bf16 v[20:23], v[150:153], a[132:135], v[20:23]
ds_read_b128 v[130:133], v75 offset:13312
v_mfma_f32_16x16x32_bf16 v[40:43], v[150:153], a[136:139], v[40:43]
s_add_u32 s61, s90, 16384
buffer_load_dwordx4 a[180:183], v74, s[24:27], s61 offen offset:1024 sc1
v_mfma_f32_16x16x32_bf16 v[24:27], v[154:157], a[132:135], v[24:27]
ds_read_b128 v[134:137], v75 offset:14336
v_mfma_f32_16x16x32_bf16 v[44:47], v[154:157], a[136:139], v[44:47]
s_waitcnt vmcnt(39)
s_barrier
s_waitcnt vmcnt(38) lgkmcnt(5)
v_mfma_f32_16x16x32_bf16 v[8:11], v[158:161], a[140:143], v[8:11]
v_add_u32 v75, 0xa000, v75
s_add_u32 s61, s90, 16384
buffer_load_dwordx4 a[184:187], v74, s[24:27], s61 offen offset:2048 sc1
v_mfma_f32_16x16x32_bf16 v[28:31], v[158:161], a[36:39], v[28:31]
v_mfma_f32_16x16x32_bf16 v[12:15], v[162:165], a[140:143], v[12:15]
ds_read_b128 v[138:141], v75 offset:0
v_mfma_f32_16x16x32_bf16 v[32:35], v[162:165], a[36:39], v[32:35]
v_mfma_f32_16x16x32_bf16 v[16:19], v[166:169], a[140:143], v[16:19]
ds_read_b128 v[142:145], v75 offset:1024
v_mfma_f32_16x16x32_bf16 v[36:39], v[166:169], a[36:39], v[36:39]
v_mfma_f32_16x16x32_bf16 v[20:23], v[170:173], a[140:143], v[20:23]
ds_read_b128 v[146:149], v75 offset:2048
v_mfma_f32_16x16x32_bf16 v[40:43], v[170:173], a[36:39], v[40:43]
v_mfma_f32_16x16x32_bf16 v[24:27], v[174:177], a[140:143], v[24:27]
ds_read_b128 v[150:153], v75 offset:3072
v_mfma_f32_16x16x32_bf16 v[44:47], v[174:177], a[36:39], v[44:47]
ds_read_b128 v[154:157], v75 offset:4096
s_waitcnt vmcnt(32) lgkmcnt(5)
v_mfma_f32_16x16x32_bf16 v[48:51], v[118:121], a[40:43], 0
ds_read_b128 v[158:161], v75 offset:10240
s_add_u32 s61, s90, 16384
buffer_load_dwordx4 a[188:191], v74, s[24:27], s61 offen offset:3072 sc1
v_mfma_f32_16x16x32_bf16 v[98:101], v[118:121], a[44:47], 0
v_mfma_f32_16x16x32_bf16 v[52:55], v[122:125], a[40:43], 0
ds_read_b128 v[162:165], v75 offset:11264
v_mfma_f32_16x16x32_bf16 v[102:105], v[122:125], a[44:47], 0
v_mfma_f32_16x16x32_bf16 v[56:59], v[126:129], a[40:43], 0
ds_read_b128 v[166:169], v75 offset:12288
v_mfma_f32_16x16x32_bf16 v[106:109], v[126:129], a[44:47], 0
v_mfma_f32_16x16x32_bf16 v[60:63], v[130:133], a[40:43], 0
ds_read_b128 v[170:173], v75 offset:13312
v_mfma_f32_16x16x32_bf16 v[110:113], v[130:133], a[44:47], 0
v_mfma_f32_16x16x32_bf16 v[64:67], v[134:137], a[40:43], 0
ds_read_b128 v[174:177], v75 offset:14336
v_mfma_f32_16x16x32_bf16 v[114:117], v[134:137], a[44:47], 0
s_barrier
s_waitcnt vmcnt(31) lgkmcnt(5)
v_mfma_f32_16x16x32_bf16 v[48:51], v[138:141], a[48:51], v[48:51]
v_add_u32 v75, 0x5000, v75
ds_write_b128 v76, v[28:31] offset:0
v_mfma_f32_16x16x32_bf16 v[98:101], v[138:141], a[52:55], v[98:101]
v_mfma_f32_16x16x32_bf16 v[52:55], v[142:145], a[48:51], v[52:55]
ds_read_b128 v[118:121], v75 offset:0
v_mfma_f32_16x16x32_bf16 v[102:105], v[142:145], a[52:55], v[102:105]
v_mfma_f32_16x16x32_bf16 v[56:59], v[146:149], a[48:51], v[56:59]
ds_read_b128 v[122:125], v75 offset:1024
v_mfma_f32_16x16x32_bf16 v[106:109], v[146:149], a[52:55], v[106:109]
v_mfma_f32_16x16x32_bf16 v[60:63], v[150:153], a[48:51], v[60:63]
ds_read_b128 v[126:129], v75 offset:2048
ds_write_b128 v76, v[32:35] offset:1024
v_mfma_f32_16x16x32_bf16 v[110:113], v[150:153], a[52:55], v[110:113]
v_mfma_f32_16x16x32_bf16 v[64:67], v[154:157], a[48:51], v[64:67]
ds_read_b128 v[130:133], v75 offset:3072
v_mfma_f32_16x16x32_bf16 v[114:117], v[154:157], a[52:55], v[114:117]
ds_read_b128 v[134:137], v75 offset:4096
s_waitcnt vmcnt(29) lgkmcnt(7)
v_mfma_f32_16x16x32_bf16 v[48:51], v[158:161], a[56:59], v[48:51]
ds_read_b128 v[138:141], v75 offset:10240
v_mfma_f32_16x16x32_bf16 v[98:101], v[158:161], a[60:63], v[98:101]
v_mfma_f32_16x16x32_bf16 v[52:55], v[162:165], a[56:59], v[52:55]
ds_read_b128 v[142:145], v75 offset:11264
v_mfma_f32_16x16x32_bf16 v[102:105], v[162:165], a[60:63], v[102:105]
ds_write_b128 v76, v[36:39] offset:2048
v_mfma_f32_16x16x32_bf16 v[56:59], v[166:169], a[56:59], v[56:59]
ds_read_b128 v[146:149], v75 offset:12288
v_mfma_f32_16x16x32_bf16 v[106:109], v[166:169], a[60:63], v[106:109]
v_mfma_f32_16x16x32_bf16 v[60:63], v[170:173], a[56:59], v[60:63]
ds_read_b128 v[150:153], v75 offset:13312
v_mfma_f32_16x16x32_bf16 v[110:113], v[170:173], a[60:63], v[110:113]
v_mfma_f32_16x16x32_bf16 v[64:67], v[174:177], a[56:59], v[64:67]
ds_read_b128 v[154:157], v75 offset:14336
v_mfma_f32_16x16x32_bf16 v[114:117], v[174:177], a[60:63], v[114:117]
s_waitcnt vmcnt(24)
s_barrier
s_waitcnt vmcnt(22) lgkmcnt(6)
v_mfma_f32_16x16x32_bf16 v[48:51], v[118:121], a[64:67], v[48:51]
v_add_u32 v75, 0x5000, v75
ds_write_b128 v76, v[40:43] offset:3072
v_mfma_f32_16x16x32_bf16 v[98:101], v[118:121], a[68:71], v[98:101]
v_mfma_f32_16x16x32_bf16 v[52:55], v[122:125], a[64:67], v[52:55]
ds_read_b128 v[158:161], v75 offset:0
v_mfma_f32_16x16x32_bf16 v[102:105], v[122:125], a[68:71], v[102:105]
v_mfma_f32_16x16x32_bf16 v[56:59], v[126:129], a[64:67], v[56:59]
ds_read_b128 v[162:165], v75 offset:1024
v_mfma_f32_16x16x32_bf16 v[106:109], v[126:129], a[68:71], v[106:109]
v_mfma_f32_16x16x32_bf16 v[60:63], v[130:133], a[64:67], v[60:63]
ds_read_b128 v[166:169], v75 offset:2048
v_mfma_f32_16x16x32_bf16 v[110:113], v[130:133], a[68:71], v[110:113]
v_mfma_f32_16x16x32_bf16 v[64:67], v[134:137], a[64:67], v[64:67]
ds_read_b128 v[170:173], v75 offset:3072
v_mfma_f32_16x16x32_bf16 v[114:117], v[134:137], a[68:71], v[114:117]
ds_read_b128 v[174:177], v75 offset:4096
s_waitcnt vmcnt(20) lgkmcnt(6)
v_mfma_f32_16x16x32_bf16 v[48:51], v[138:141], a[144:147], v[48:51]
ds_read_b128 v[118:121], v75 offset:10240
ds_write_b128 v76, v[44:47] offset:4096
v_mfma_f32_16x16x32_bf16 v[98:101], v[138:141], a[148:151], v[98:101]
v_mfma_f32_16x16x32_bf16 v[52:55], v[142:145], a[144:147], v[52:55]
ds_read_b128 v[122:125], v75 offset:11264
v_mfma_f32_16x16x32_bf16 v[102:105], v[142:145], a[148:151], v[102:105]
v_mfma_f32_16x16x32_bf16 v[56:59], v[146:149], a[144:147], v[56:59]
ds_read_b128 v[126:129], v75 offset:12288
v_mfma_f32_16x16x32_bf16 v[106:109], v[146:149], a[148:151], v[106:109]
v_mfma_f32_16x16x32_bf16 v[60:63], v[150:153], a[144:147], v[60:63]
ds_read_b128 v[130:133], v75 offset:13312
v_mfma_f32_16x16x32_bf16 v[110:113], v[150:153], a[148:151], v[110:113]
v_mfma_f32_16x16x32_bf16 v[64:67], v[154:157], a[144:147], v[64:67]
ds_read_b128 v[134:137], v75 offset:14336
v_mfma_f32_16x16x32_bf16 v[114:117], v[154:157], a[148:151], v[114:117]
s_waitcnt vmcnt(15) lgkmcnt(4)
s_barrier
s_waitcnt vmcnt(13)
v_mfma_f32_16x16x32_bf16 v[48:51], v[158:161], a[152:155], v[48:51]
v_add_u32 v79, 143360, v74
buffer_load_dwordx4 v[80:83], v78, s[8:11], s93 offen
v_mfma_f32_16x16x32_bf16 v[98:101], v[158:161], a[156:159], v[98:101]
buffer_load_dwordx4 v[84:87], v78, s[8:11], s93 offen offset:16
v_mfma_f32_16x16x32_bf16 v[52:55], v[162:165], a[152:155], v[52:55]
ds_read_b128 v[138:141], v79 offset:0
buffer_load_dwordx2 v[88:89], v78, s[8:11], s93 offen offset:32
v_mfma_f32_16x16x32_bf16 v[102:105], v[162:165], a[156:159], v[102:105]
v_mfma_f32_16x16x32_bf16 v[56:59], v[166:169], a[152:155], v[56:59]
ds_read_b128 v[142:145], v79 offset:1024
ds_read_b128 v[28:31], v77 offset:0
v_mfma_f32_16x16x32_bf16 v[106:109], v[166:169], a[156:159], v[106:109]
ds_read_b128 v[32:35], v77 offset:1024
v_mfma_f32_16x16x32_bf16 v[60:63], v[170:173], a[152:155], v[60:63]
ds_read_b128 v[146:149], v79 offset:2048
ds_read_b128 v[36:39], v77 offset:2048
v_mfma_f32_16x16x32_bf16 v[110:113], v[170:173], a[156:159], v[110:113]
v_mfma_f32_16x16x32_bf16 v[64:67], v[174:177], a[152:155], v[64:67]
ds_read_b128 v[150:153], v79 offset:3072
ds_read_b128 v[40:43], v77 offset:3072
v_mfma_f32_16x16x32_bf16 v[114:117], v[174:177], a[156:159], v[114:117]
ds_read_b128 v[44:47], v77 offset:4096
ds_read_b128 v[154:157], v79 offset:4096
s_waitcnt vmcnt(14) lgkmcnt(10)
v_mfma_f32_16x16x32_bf16 v[48:51], v[118:121], a[160:163], v[48:51]
ds_read_b128 v[158:161], v79 offset:5120
s_waitcnt lgkmcnt(2)
v_add_f32 v8, v8, v28
v_add_f32 v9, v9, v29
v_add_f32 v10, v10, v30
v_mfma_f32_16x16x32_bf16 v[98:101], v[118:121], a[164:167], v[98:101]
v_mfma_f32_16x16x32_bf16 v[52:55], v[122:125], a[160:163], v[52:55]
ds_read_b128 v[162:165], v79 offset:6144
v_add_f32 v11, v11, v31
v_add_f32 v12, v12, v32
v_add_f32 v13, v13, v33
v_mfma_f32_16x16x32_bf16 v[102:105], v[122:125], a[164:167], v[102:105]
v_add_f32 v14, v14, v34
v_add_f32 v15, v15, v35
v_add_f32 v16, v16, v36
v_mfma_f32_16x16x32_bf16 v[56:59], v[126:129], a[160:163], v[56:59]
ds_read_b128 v[166:169], v79 offset:7168
v_add_f32 v17, v17, v37
v_add_f32 v18, v18, v38
v_add_f32 v19, v19, v39
v_mfma_f32_16x16x32_bf16 v[106:109], v[126:129], a[164:167], v[106:109]
v_mfma_f32_16x16x32_bf16 v[60:63], v[130:133], a[160:163], v[60:63]
ds_read_b128 v[170:173], v79 offset:8192
v_add_f32 v20, v20, v40
v_add_f32 v21, v21, v41
v_add_f32 v22, v22, v42
v_mfma_f32_16x16x32_bf16 v[110:113], v[130:133], a[164:167], v[110:113]
v_add_f32 v23, v23, v43
v_add_f32 v24, v24, v44
v_add_f32 v25, v25, v45
v_mfma_f32_16x16x32_bf16 v[64:67], v[134:137], a[160:163], v[64:67]
ds_read_b128 v[174:177], v79 offset:9216
v_add_f32 v26, v26, v46
v_add_f32 v27, v27, v47
v_mfma_f32_16x16x32_bf16 v[114:117], v[134:137], a[164:167], v[114:117]
s_waitcnt vmcnt(9)
s_barrier
s_waitcnt vmcnt(8) lgkmcnt(5)
v_mfma_f32_16x16x32_bf16 v[48:51], v[138:141], a[168:171], v[48:51]
ds_read_b128 v[118:121], v79 offset:10240
ds_write_b128 v76, v[98:101] offset:0
v_mfma_f32_16x16x32_bf16 v[52:55], v[142:145], a[168:171], v[52:55]
ds_read_b128 v[122:125], v79 offset:11264
v_mfma_f32_16x16x32_bf16 v[56:59], v[146:149], a[168:171], v[56:59]
ds_read_b128 v[126:129], v79 offset:12288
v_mfma_f32_16x16x32_bf16 v[60:63], v[150:153], a[168:171], v[60:63]
ds_read_b128 v[130:133], v79 offset:13312
v_mfma_f32_16x16x32_bf16 v[64:67], v[154:157], a[168:171], v[64:67]
ds_read_b128 v[134:137], v79 offset:14336
ds_write_b128 v76, v[102:105] offset:1024
s_waitcnt vmcnt(7) lgkmcnt(7)
v_mfma_f32_16x16x32_bf16 v[48:51], v[158:161], a[172:175], v[48:51]
ds_read_b128 v[138:141], v79 offset:15360
v_mfma_f32_16x16x32_bf16 v[52:55], v[162:165], a[172:175], v[52:55]
ds_read_b128 v[142:145], v79 offset:16384
v_mfma_f32_16x16x32_bf16 v[56:59], v[166:169], a[172:175], v[56:59]
ds_read_b128 v[146:149], v79 offset:17408
v_mfma_f32_16x16x32_bf16 v[60:63], v[170:173], a[172:175], v[60:63]
ds_read_b128 v[150:153], v79 offset:18432
ds_write_b128 v76, v[106:109] offset:2048
v_mfma_f32_16x16x32_bf16 v[64:67], v[174:177], a[172:175], v[64:67]
ds_read_b128 v[154:157], v79 offset:19456
s_waitcnt vmcnt(6) lgkmcnt(7)
v_mfma_f32_16x16x32_bf16 v[48:51], v[118:121], a[176:179], v[48:51]
v_add_u32 v79, 0xfffdd000, v79
v_mfma_f32_16x16x32_bf16 v[52:55], v[122:125], a[176:179], v[52:55]
ds_read_b128 v[158:161], v79 offset:0
v_mfma_f32_16x16x32_bf16 v[56:59], v[126:129], a[176:179], v[56:59]
ds_read_b128 v[162:165], v79 offset:1024
ds_write_b128 v76, v[110:113] offset:3072
v_mfma_f32_16x16x32_bf16 v[60:63], v[130:133], a[176:179], v[60:63]
ds_read_b128 v[166:169], v79 offset:2048
v_mfma_f32_16x16x32_bf16 v[64:67], v[134:137], a[176:179], v[64:67]
ds_read_b128 v[170:173], v79 offset:3072
ds_read_b128 v[174:177], v79 offset:4096
s_waitcnt vmcnt(5) lgkmcnt(6)
v_mfma_f32_16x16x32_bf16 v[48:51], v[138:141], a[180:183], v[48:51]
ds_read_b128 v[118:121], v79 offset:5120
v_mfma_f32_16x16x32_bf16 v[52:55], v[142:145], a[180:183], v[52:55]
ds_read_b128 v[122:125], v79 offset:6144
ds_write_b128 v76, v[114:117] offset:4096
v_mfma_f32_16x16x32_bf16 v[56:59], v[146:149], a[180:183], v[56:59]
ds_read_b128 v[126:129], v79 offset:7168
v_mfma_f32_16x16x32_bf16 v[60:63], v[150:153], a[180:183], v[60:63]
ds_read_b128 v[130:133], v79 offset:8192
v_mfma_f32_16x16x32_bf16 v[64:67], v[154:157], a[180:183], v[64:67]
ds_read_b128 v[134:137], v79 offset:9216
s_waitcnt lgkmcnt(3)
s_barrier
s_waitcnt vmcnt(4)
v_mfma_f32_16x16x32_bf16 v[48:51], v[158:161], a[184:187], v[48:51]
ds_read_b128 v[98:101], v77 offset:0
v_mfma_f32_16x16x32_bf16 v[52:55], v[162:165], a[184:187], v[52:55]
v_mfma_f32_16x16x32_bf16 v[56:59], v[166:169], a[184:187], v[56:59]
ds_read_b128 v[102:105], v77 offset:1024
v_mfma_f32_16x16x32_bf16 v[60:63], v[170:173], a[184:187], v[60:63]
v_mfma_f32_16x16x32_bf16 v[64:67], v[174:177], a[184:187], v[64:67]
ds_read_b128 v[106:109], v77 offset:2048
s_waitcnt vmcnt(3) lgkmcnt(3)
v_mfma_f32_16x16x32_bf16 v[48:51], v[118:121], a[188:191], v[48:51]
v_mfma_f32_16x16x32_bf16 v[52:55], v[122:125], a[188:191], v[52:55]
ds_read_b128 v[110:113], v77 offset:3072
v_mfma_f32_16x16x32_bf16 v[56:59], v[126:129], a[188:191], v[56:59]
v_mfma_f32_16x16x32_bf16 v[60:63], v[130:133], a[188:191], v[60:63]
ds_read_b128 v[114:117], v77 offset:4096
v_mfma_f32_16x16x32_bf16 v[64:67], v[134:137], a[188:191], v[64:67]
s_waitcnt lgkmcnt(0)
s_nop 0
v_add_f32 v48, v48, v98
v_add_f32 v49, v49, v99
v_add_f32 v50, v50, v100
v_add_f32 v51, v51, v101
v_add_f32 v52, v52, v102
v_add_f32 v53, v53, v103
v_add_f32 v54, v54, v104
v_add_f32 v55, v55, v105
v_add_f32 v56, v56, v106
v_add_f32 v57, v57, v107
v_add_f32 v58, v58, v108
v_add_f32 v59, v59, v109
v_add_f32 v60, v60, v110
v_add_f32 v61, v61, v111
v_add_f32 v62, v62, v112
v_add_f32 v63, v63, v113
v_add_f32 v64, v64, v114
v_add_f32 v65, v65, v115
v_add_f32 v66, v66, v116
v_add_f32 v67, v67, v117
s_waitcnt vmcnt(0)
s_mov_b32 s44, 0xbfb8aa3b
s_mov_b32 s45, 0xbfb8aa3b
v_pk_mul_f32 v[90:91], v[8:9], s[44:45]
v_pk_mul_f32 v[92:93], v[10:11], s[44:45]
v_exp_f32 v90, v90
v_exp_f32 v91, v91
v_exp_f32 v92, v92
v_exp_f32 v93, v93
v_pk_mul_f32 v[8:9], v[8:9], v[48:49]
v_pk_mul_f32 v[10:11], v[10:11], v[50:51]
v_pk_add_f32 v[90:91], v[90:91], 1.0 op_sel_hi:[1,0]
v_pk_add_f32 v[92:93], v[92:93], 1.0 op_sel_hi:[1,0]
v_lshlrev_b32 v94, 16, v80
v_and_b32 v95, 0xffff0000, v80
v_rcp_f32 v90, v90
v_rcp_f32 v91, v91
v_rcp_f32 v92, v92
v_rcp_f32 v93, v93
v_lshlrev_b32 v96, 16, v81
v_and_b32 v97, 0xffff0000, v81
v_pk_fma_f32 v[8:9], v[8:9], v[90:91], v[94:95]
v_pk_fma_f32 v[10:11], v[10:11], v[92:93], v[96:97]
v_cvt_pk_bf16_f32 v80, v8, v9
v_cvt_pk_bf16_f32 v81, v10, v11
ds_write_b64 v68, v[80:81] offset:0
v_pk_mul_f32 v[90:91], v[12:13], s[44:45]
v_pk_mul_f32 v[92:93], v[14:15], s[44:45]
v_exp_f32 v90, v90
v_exp_f32 v91, v91
v_exp_f32 v92, v92
v_exp_f32 v93, v93
v_pk_mul_f32 v[12:13], v[12:13], v[52:53]
v_pk_mul_f32 v[14:15], v[14:15], v[54:55]
v_pk_add_f32 v[90:91], v[90:91], 1.0 op_sel_hi:[1,0]
v_pk_add_f32 v[92:93], v[92:93], 1.0 op_sel_hi:[1,0]
v_lshlrev_b32 v94, 16, v82
v_and_b32 v95, 0xffff0000, v82
v_rcp_f32 v90, v90
v_rcp_f32 v91, v91
v_rcp_f32 v92, v92
v_rcp_f32 v93, v93
v_lshlrev_b32 v96, 16, v83
v_and_b32 v97, 0xffff0000, v83
v_pk_fma_f32 v[12:13], v[12:13], v[90:91], v[94:95]
v_pk_fma_f32 v[14:15], v[14:15], v[92:93], v[96:97]
v_cvt_pk_bf16_f32 v82, v12, v13
v_cvt_pk_bf16_f32 v83, v14, v15
ds_write_b64 v68, v[82:83] offset:8
v_pk_mul_f32 v[90:91], v[16:17], s[44:45]
v_pk_mul_f32 v[92:93], v[18:19], s[44:45]
v_exp_f32 v90, v90
v_exp_f32 v91, v91
v_exp_f32 v92, v92
v_exp_f32 v93, v93
v_pk_mul_f32 v[16:17], v[16:17], v[56:57]
v_pk_mul_f32 v[18:19], v[18:19], v[58:59]
v_pk_add_f32 v[90:91], v[90:91], 1.0 op_sel_hi:[1,0]
v_pk_add_f32 v[92:93], v[92:93], 1.0 op_sel_hi:[1,0]
v_lshlrev_b32 v94, 16, v84
v_and_b32 v95, 0xffff0000, v84
v_rcp_f32 v90, v90
v_rcp_f32 v91, v91
v_rcp_f32 v92, v92
v_rcp_f32 v93, v93
v_lshlrev_b32 v96, 16, v85
v_and_b32 v97, 0xffff0000, v85
v_pk_fma_f32 v[16:17], v[16:17], v[90:91], v[94:95]
v_pk_fma_f32 v[18:19], v[18:19], v[92:93], v[96:97]
v_cvt_pk_bf16_f32 v84, v16, v17
v_cvt_pk_bf16_f32 v85, v18, v19
ds_write_b64 v68, v[84:85] offset:16
v_pk_mul_f32 v[90:91], v[20:21], s[44:45]
v_pk_mul_f32 v[92:93], v[22:23], s[44:45]
v_exp_f32 v90, v90
v_exp_f32 v91, v91
v_exp_f32 v92, v92
v_exp_f32 v93, v93
v_pk_mul_f32 v[20:21], v[20:21], v[60:61]
v_pk_mul_f32 v[22:23], v[22:23], v[62:63]
v_pk_add_f32 v[90:91], v[90:91], 1.0 op_sel_hi:[1,0]
v_pk_add_f32 v[92:93], v[92:93], 1.0 op_sel_hi:[1,0]
v_lshlrev_b32 v94, 16, v86
v_and_b32 v95, 0xffff0000, v86
v_rcp_f32 v90, v90
v_rcp_f32 v91, v91
v_rcp_f32 v92, v92
v_rcp_f32 v93, v93
v_lshlrev_b32 v96, 16, v87
v_and_b32 v97, 0xffff0000, v87
v_pk_fma_f32 v[20:21], v[20:21], v[90:91], v[94:95]
v_pk_fma_f32 v[22:23], v[22:23], v[92:93], v[96:97]
v_cvt_pk_bf16_f32 v86, v20, v21
v_cvt_pk_bf16_f32 v87, v22, v23
ds_write_b64 v68, v[86:87] offset:24
v_pk_mul_f32 v[90:91], v[24:25], s[44:45]
v_pk_mul_f32 v[92:93], v[26:27], s[44:45]
v_exp_f32 v90, v90
v_exp_f32 v91, v91
v_exp_f32 v92, v92
v_exp_f32 v93, v93
v_pk_mul_f32 v[24:25], v[24:25], v[64:65]
v_pk_mul_f32 v[26:27], v[26:27], v[66:67]
v_pk_add_f32 v[90:91], v[90:91], 1.0 op_sel_hi:[1,0]
v_pk_add_f32 v[92:93], v[92:93], 1.0 op_sel_hi:[1,0]
v_lshlrev_b32 v94, 16, v88
v_and_b32 v95, 0xffff0000, v88
v_rcp_f32 v90, v90
v_rcp_f32 v91, v91
v_rcp_f32 v92, v92
v_rcp_f32 v93, v93
v_lshlrev_b32 v96, 16, v89
v_and_b32 v97, 0xffff0000, v89
v_pk_fma_f32 v[24:25], v[24:25], v[90:91], v[94:95]
v_pk_fma_f32 v[26:27], v[26:27], v[92:93], v[96:97]
v_cvt_pk_bf16_f32 v88, v24, v25
v_cvt_pk_bf16_f32 v89, v26, v27
ds_write_b64 v68, v[88:89] offset:32
s_waitcnt lgkmcnt(0)
ds_read_b128 v[8:11], v69 offset:0
ds_read_b128 v[12:15], v69 offset:1024
ds_read_b128 v[16:19], v69 offset:2048
s_waitcnt lgkmcnt(2)
buffer_store_dwordx4 v[8:11], v70, s[36:39], s93 offen
s_waitcnt lgkmcnt(1)
buffer_store_dwordx4 v[12:15], v71, s[36:39], s93 offen
s_waitcnt lgkmcnt(0)
buffer_store_dwordx4 v[16:19], v72, s[36:39], s93 offen
L_end:
s_endpgm
.section .rodata,"a"
.p2align 6
.amdhsa_kernel recurrent_scan__sliding_block__geglu_ffn__prompt_kernel
  .amdhsa_next_free_vgpr 512
  .amdhsa_next_free_sgpr 102
  .amdhsa_accum_offset 256
  .amdhsa_group_segment_fixed_size 0
  .amdhsa_kernarg_size 80
  .amdhsa_user_sgpr_count 2
  .amdhsa_user_sgpr_kernarg_segment_ptr 1
  .amdhsa_system_sgpr_workgroup_id_x 1
.end_amdhsa_kernel
```
